```python
import torch

def _softmax(x, axis=-1):
    return torch.softmax(x, dim=axis)

def _gelu(x):
    return torch.nn.functional.gelu(x, approximate='tanh')

def _silu(x):
    return torch.nn.functional.silu(x)

def _sigmoid(x):
    return torch.sigmoid(x)

def _layernorm(x, axis=-1, eps=1e-05):
    m = x.mean(dim=axis, keepdim=True)
    v = x.var(dim=axis, keepdim=True, unbiased=False)
    return (x - m) / torch.sqrt(v + eps)

def _scatter_add(tgt, idx, src, axis=0):
    return tgt.clone().index_add_(axis, idx, src)

def _segment_sum(src, seg, n):
    out = torch.zeros((n,) + src.shape[1:], dtype=src.dtype)
    return out.index_add_(0, seg, src)

def _pad(x, pw):
    flat = tuple((v for pair in reversed(pw) for v in pair))
    return torch.nn.functional.pad(x, flat)
kernel_name = 'parallel_sum__memory_aug_recurrent_mem_tr__glu_gated_reglu__prompt'

def setup_inputs():

    _w = lambda a: (lambda t: t.to(torch.bfloat16) if t.is_floating_point() else t)(torch.as_tensor(a))

    def _A_setup():
        B, S, Dm = (1, 2048, 512)
        H, Dh = (32, 128)
        M, seg = (8, 32)
        seg = min(seg, S)
        S = S // seg * seg
        return {'x': _w((lambda *s: torch.randn(*s, dtype=torch.bfloat16) * 0.05)(B, S, Dm)), 'mem0': _w((lambda *s: torch.randn(*s, dtype=torch.bfloat16) * 0.2)(B, M, Dm)), 'Wq': _w((lambda *s: torch.randn(*s, dtype=torch.bfloat16) * 1.6)(Dm, H, Dh) * Dm ** (-0.5)), 'Wk': _w((lambda *s: torch.randn(*s, dtype=torch.bfloat16) * 1.6)(Dm, H, Dh) * Dm ** (-0.5)), 'Wv': _w((lambda *s: torch.randn(*s, dtype=torch.bfloat16) * 0.2)(Dm, H, Dh) * Dm ** (-0.5)), 'Wo': _w((lambda *s: torch.randn(*s, dtype=torch.bfloat16) * 0.2)(H, Dh, Dm) * (H * Dh) ** (-0.5)), 'seg_len': seg}
    _A_in = _A_setup()

    def _B_setup():
        B, S, D, F = (1, 2048, 512, 1792)
        return {'x': _w((lambda *s: torch.randn(*s, dtype=torch.bfloat16) * 0.05)(B, S, D)), 'W_gate': _w((lambda *s: torch.randn(*s, dtype=torch.bfloat16) * 0.2)(D, F) * (2.0 / D) ** 0.5), 'W_up': _w((lambda *s: torch.randn(*s, dtype=torch.bfloat16) * 0.2)(D, F) * (2.0 / D) ** 0.5), 'W_down': _w((lambda *s: torch.randn(*s, dtype=torch.bfloat16) * 0.2)(F, D) * (1.0 / F) ** 0.5)}
    _B_in = _B_setup()
    return {'A_x': _A_in['x'], 'A_mem0': _A_in['mem0'], 'A_Wq': _A_in['Wq'], 'A_Wk': _A_in['Wk'], 'A_Wv': _A_in['Wv'], 'A_Wo': _A_in['Wo'], 'A_seg_len': _A_in['seg_len'], 'B_x': _B_in['x'], 'B_W_gate': _B_in['W_gate'], 'B_W_up': _B_in['W_up'], 'B_W_down': _B_in['W_down']}

def reference(A_x, A_mem0, A_Wq, A_Wk, A_Wv, A_Wo, A_seg_len, B_x, B_W_gate, B_W_up, B_W_down):

    def _A_ref(x, mem0, Wq, Wk, Wv, Wo, seg_len):
        B, S, Dm = x.shape
        H, Dh = (Wq.shape[1], Wq.shape[2])
        M = mem0.shape[1]
        scale = Dh ** (-0.5)
        n_seg = S // seg_len
        L = M + seg_len
        idx = torch.arange(L)
        mask = (idx[:, None] < M) | (idx[:, None] >= idx[None, :])
        mem = mem0
        outs = []
        for s in range(n_seg):
            xs = x[:, s * seg_len:(s + 1) * seg_len, :].clone()
            h = torch.concatenate([mem, xs], axis=1)
            q = torch.einsum('btd,dhe->bhte', h, Wq)
            k = torch.einsum('btd,dhe->bhte', h, Wk)
            v = torch.einsum('btd,dhe->bhte', h, Wv)
            scores = torch.einsum('bhqe,bhke->bhqk', q, k) * scale
            scores = torch.where(mask[None, None], scores, -1000000000.0)
            p = _softmax(scores, axis=-1)
            o = torch.einsum('bhqk,bhke->bhqe', p, v)
            o = torch.einsum('bhte,hed->btd', o, Wo)
            mem = o[:, :M, :].clone()
            outs.append(o[:, M:, :])
        return torch.concatenate(outs, axis=1)

    def _B_ref(x, W_gate, W_up, W_down):
        gate = torch.einsum('bsd,df->bsf', x, W_gate)
        up = torch.einsum('bsd,df->bsf', x, W_up)
        gate = gate * (lambda x, dt: x.to(dt))(gate > 0, gate.dtype)
        h = gate * up
        return torch.einsum('bsf,fd->bsd', h, W_down)
    x = A_x
    xn = _layernorm(x, axis=-1)
    return x + _A_ref(xn, A_mem0, A_Wq, A_Wk, A_Wv, A_Wo, A_seg_len) + _B_ref(xn, B_W_gate, B_W_up, B_W_down)
```

```asm
; @launch grid=(256,1,1) block=(256,1,1) lds=163840
.amdgcn_target "amdgcn-amd-amdhsa--gfx950"
.text
.globl parallel_sum__memory_aug_recurrent_mem_tr__glu_gated_reglu__prompt_kernel
.p2align 8
.type parallel_sum__memory_aug_recurrent_mem_tr__glu_gated_reglu__prompt_kernel,@function
parallel_sum__memory_aug_recurrent_mem_tr__glu_gated_reglu__prompt_kernel:
  s_cmp_ge_u32 s2, 256
  s_cbranch_scc1 k_exit
  s_load_dwordx4 s[28:31], s[0:1], 96
  s_getreg_b32 s34, hwreg(HW_REG_XCC_ID, 0, 4)
  v_lshrrev_b32 v1, 6, v0
  s_mov_b32 s35, 0x10000
  s_mov_b32 s94, 0
  s_mov_b32 s95, 0
  s_mov_b32 s3, 0
  v_readfirstlane_b32 s33, v1
  s_and_b32 s34, s34, 7
  s_waitcnt lgkmcnt(0)
  s_mov_b32 s4, s30
  s_mov_b32 s5, s31
  s_mov_b32 s6, 0x10000000
  s_mov_b32 s7, 0x20000
  s_mov_b32 s30, 256
  s_mov_b32 s31, 0x20000
  s_cmp_lg_u32 s33, 0
  s_cbranch_scc1 k_noticket
  s_mov_b32 s36, s34
  s_mov_b32 s37, 0
  s_mov_b64 exec, 1
k_ticket:
  v_mov_b32 v2, 1
  s_lshl_b32 s38, s36, 5
  s_mul_i32 s40, s36, 24
  s_cmp_eq_u32 s36, 0
  s_cselect_b32 s40, 192, s40
  buffer_atomic_add v2, off, s[28:31], s40 sc0
  s_waitcnt vmcnt(0)
  v_readfirstlane_b32 s39, v2
  s_cmp_lt_u32 s39, 32
  s_cbranch_scc1 k_gotticket
  s_add_u32 s36, s36, 1
  s_and_b32 s36, s36, 7
  s_add_u32 s37, s37, 1
  s_cmp_lt_u32 s37, 8
  s_cbranch_scc1 k_ticket
  s_mov_b32 s38, 256
  s_mov_b32 s39, 0
k_gotticket:
  s_add_u32 s39, s39, s38
  v_mov_b32 v2, s39
  v_mov_b32 v3, 0
  ds_write_b32 v3, v2
  s_waitcnt lgkmcnt(0)
  s_mov_b64 exec, -1
k_noticket:
  s_barrier
  v_mov_b32 v3, 0
  ds_read_b32 v2, v3
  s_waitcnt lgkmcnt(0)
  v_readfirstlane_b32 s32, v2
  s_barrier
  s_cmp_lt_u32 s32, 32
  s_cbranch_scc1 k_chain
  s_branch w_start
k_exit:
  s_endpgm
k_chain:
  s_cmp_eq_u32 s33, 1
  s_cbranch_scc1 c_pro_1
  s_cmp_eq_u32 s33, 2
  s_cbranch_scc1 c_pro_2
  s_cmp_eq_u32 s33, 3
  s_cbranch_scc1 c_pro_3
c_pro_0:
  s_min_u32 s47, s3, 1
  s_cmp_lg_u32 s3, 0
  s_cselect_b32 s36, s2, s32
  s_cselect_b32 s57, 0, 63
  s_cselect_b32 s37, 0, 0
  s_load_dwordx4 s[8:11], s[0:1], 8
  s_load_dwordx4 s[12:15], s[0:1], 24
  s_load_dwordx2 s[20:21], s[0:1], 40
  s_waitcnt lgkmcnt(0)
  s_mov_b32 s24, s8
  s_mov_b32 s25, s9
  s_mov_b32 s26, 8192
  s_mov_b32 s27, 0x20000
  s_mov_b32 s8, s10
  s_mov_b32 s9, s11
  s_mov_b32 s10, 0x400000
  s_mov_b32 s11, 0x20000
  s_mov_b32 s16, s14
  s_mov_b32 s17, s15
  s_mov_b32 s18, 0x400000
  s_mov_b32 s19, 0x20000
  s_mov_b32 s14, 0x400000
  s_mov_b32 s15, 0x20000
  s_mov_b32 s22, 0x400000
  s_mov_b32 s23, 0x20000
  v_and_b32 v232, 63, v0
  v_and_b32 v233, 15, v232
  v_lshrrev_b32 v234, 4, v232
  v_and_b32 v236, 1, v234
  v_lshrrev_b32 v237, 1, v234
  v_lshl_add_u32 v236, v237, 5, v236
  v_lshlrev_b32 v236, 13, v236
  v_lshlrev_b32 v238, 1, v234
  v_xor_b32 v238, v238, v233
  v_lshl_add_u32 v152, v238, 4, v236
  v_xor_b32 v153, 128, v152
  s_lshl_b32 s45, s36, 8
  s_lshl_b32 s46, s36, 17
  s_mov_b32 m0, 0
  s_add_u32 s53, s45, 0
  buffer_load_dwordx4 v152, s[12:15], s53 offen lds
  s_mov_b32 m0, 1024
  s_add_u32 s53, s45, 32768
  buffer_load_dwordx4 v153, s[12:15], s53 offen lds
  s_mov_b32 m0, 2048
  s_add_u32 s53, s45, 65536
  buffer_load_dwordx4 v152, s[12:15], s53 offen lds
  s_mov_b32 m0, 3072
  s_add_u32 s53, s45, 98304
  buffer_load_dwordx4 v153, s[12:15], s53 offen lds
  s_mov_b32 m0, 4096
  s_add_u32 s53, s45, 524288
  buffer_load_dwordx4 v152, s[12:15], s53 offen lds
  s_mov_b32 m0, 5120
  s_add_u32 s53, s45, 557056
  buffer_load_dwordx4 v153, s[12:15], s53 offen lds
  s_mov_b32 m0, 6144
  s_add_u32 s53, s45, 589824
  buffer_load_dwordx4 v152, s[12:15], s53 offen lds
  s_mov_b32 m0, 7168
  s_add_u32 s53, s45, 622592
  buffer_load_dwordx4 v153, s[12:15], s53 offen lds
  s_mov_b32 m0, 8192
  s_add_u32 s53, s45, 1048576
  buffer_load_dwordx4 v152, s[12:15], s53 offen lds
  s_mov_b32 m0, 9216
  s_add_u32 s53, s45, 1081344
  buffer_load_dwordx4 v153, s[12:15], s53 offen lds
  s_mov_b32 m0, 10240
  s_add_u32 s53, s45, 1114112
  buffer_load_dwordx4 v152, s[12:15], s53 offen lds
  s_mov_b32 m0, 11264
  s_add_u32 s53, s45, 1146880
  buffer_load_dwordx4 v153, s[12:15], s53 offen lds
  s_mov_b32 m0, 12288
  s_add_u32 s53, s45, 1572864
  buffer_load_dwordx4 v152, s[12:15], s53 offen lds
  s_mov_b32 m0, 13312
  s_add_u32 s53, s45, 1605632
  buffer_load_dwordx4 v153, s[12:15], s53 offen lds
  s_mov_b32 m0, 14336
  s_add_u32 s53, s45, 1638400
  buffer_load_dwordx4 v152, s[12:15], s53 offen lds
  s_mov_b32 m0, 15360
  s_add_u32 s53, s45, 1671168
  buffer_load_dwordx4 v153, s[12:15], s53 offen lds
  v_and_b32 v236, 31, v232
  v_lshlrev_b32 v238, 2, v237
  v_xor_b32 v236, v236, v238
  v_lshlrev_b32 v236, 4, v236
  v_lshl_add_u32 v154, v237, 10, v236
  v_xor_b32 v155, 128, v154
  s_mov_b32 s52, 0
  v_lshrrev_b32 v236, 2, v232
  v_and_b32 v238, 7, v236
  v_xor_b32 v238, 0, v238
  v_lshlrev_b32 v236, 8, v236
  v_lshl_add_u32 v236, v238, 5, v236
  v_and_b32 v237, 3, v232
  v_lshl_add_u32 v156, v237, 3, v236
  v_xor_b32 v157, 32, v156
  v_add_u32 v158, 73728, v156
  v_add_u32 v159, 73728, v157
  v_bfe_u32 v236, v232, 2, 1
  v_lshl_add_u32 v236, v234, 1, v236
  v_and_b32 v238, 3, v236
  v_xor_b32 v238, 0, v238
  v_lshlrev_b32 v236, 9, v236
  v_lshl_add_u32 v236, v238, 6, v236
  v_lshl_add_u32 v236, v237, 4, v236
  v_bfe_u32 v237, v232, 3, 1
  v_lshl_add_u32 v160, v237, 3, v236
  v_add_u32 v161, 73728, v160
  v_bfe_u32 v235, v232, 1, 1
  v_bfe_u32 v239, v232, 2, 2
  v_lshlrev_b32 v236, 4, v232
  v_add_u32 v252, s52, v236
  v_add_u32 v253, 147456, v236
  v_lshl_add_u32 v254, v235, 10, v253
  v_lshrrev_b32 v236, 3, v232
  s_lshl1_add_u32 s53, s33, s36
  v_lshl_add_u32 v237, v236, 2, s53
  v_and_b32 v237, 31, v237
  v_lshlrev_b32 v236, 13, v236
  v_lshl_add_u32 v236, v237, 6, v236
  v_and_b32 v237, 7, v232
  v_lshl_add_u32 v255, v237, 3, v236
  v_mul_u32_u24 v240, 0xAAAA, v235
  v_add_u32 v240, 0x4444, v240
  v_mov_b32 v246, 0x3F003F00
  v_mov_b32 v247, 0x3F003F00
  v_and_b32 v236, 1, v232
  v_lshlrev_b32 v236, 4, v236
  v_cmp_eq_u32 vcc, v234, v239
  v_mov_b32 v237, 0x3e89
  v_lshlrev_b32 v237, v236, v237
  v_cndmask_b32 v242, 0, v237, vcc
  v_mov_b32 v243, v242
  v_mov_b32 v237, 0x3ef4
  v_lshlrev_b32 v237, v236, v237
  v_cndmask_b32 v244, 0, v237, vcc
  v_mov_b32 v245, v244
  v_bfe_u32 v236, v232, 2, 1
  v_lshlrev_b32 v236, 4, v236
  v_mov_b32 v237, 0x3F80
  v_lshlrev_b32 v237, v236, v237
  v_bfe_u32 v238, v232, 3, 1
  v_and_b32 v236, 1, v232
  v_lshl_add_u32 v238, v236, 1, v238
  v_cmp_eq_u32 vcc, 0, v238
  s_nop 1
  v_cndmask_b32 v248, 0, v237, vcc
  v_cmp_eq_u32 vcc, 1, v238
  s_nop 1
  v_cndmask_b32 v249, 0, v237, vcc
  v_cmp_eq_u32 vcc, 2, v238
  s_nop 1
  v_cndmask_b32 v250, 0, v237, vcc
  v_cmp_eq_u32 vcc, 3, v238
  s_nop 1
  v_cndmask_b32 v251, 0, v237, vcc
  v_lshlrev_b32 v236, 2, v236
  v_and_b32 v237, 0, v239
  v_mul_u32_u24 v237, 1050624, v237
  v_add_u32 v236, v237, v236
  v_lshrrev_b32 v237, 0, v239
  v_lshl_add_u32 v236, v237, 28, v236
  v_lshl_add_u32 v236, v235, 8, v236
  v_and_b32 v237, 16, v232
  v_add_u32 v236, v237, v236
  v_bfe_u32 v237, v232, 5, 1
  v_lshl_add_u32 v241, v237, 3, v236
  v_and_b32 v236, 1, v232
  v_lshl_add_u32 v236, v239, 1, v236
  v_lshlrev_b32 v236, 10, v236
  v_lshl_add_u32 v236, v235, 6, v236
  v_lshl_add_u32 v162, v234, 4, v236
  v_mov_b32 v168, -1
  v_mov_b32 v169, -1
  v_mov_b32 v170, -1
  v_mov_b32 v171, -1
  s_lshl_b32 s52, s47, 5
  s_add_u32 s52, s52, s36
  s_lshl_b32 s52, s52, 13
  s_lshl_b32 s53, s33, 11
  s_add_u32 s52, s52, s53
  s_add_u32 s52, s52, 1949696
  buffer_store_dwordx4 v[168:171], v253, s[4:7], s52 offen offset:0 sc1
  buffer_store_dwordx4 v[168:171], v253, s[4:7], s52 offen offset:1024 sc1
  s_cmp_lg_u32 s3, 0
  s_cselect_b32 s52, 8, 13
  s_cselect_b32 s44, 17, 23
  s_lshl_b32 s44, 1, s44
  v_lshlrev_b32 v172, s52, v234
  v_lshl_add_u32 v172, v233, 4, v172
  s_lshl_b32 s52, s36, 8
  s_lshl_b32 s53, s33, 17
  s_add_u32 s52, s52, s53
  s_add_u32 s52, s52, 167772160
  s_cmp_lg_u32 s3, 0
  s_cselect_b32 s52, s3, s52
  buffer_store_dwordx4 v[168:171], v172, s[4:7], s52 offen sc1
  s_add_u32 s53, s52, s44
  buffer_store_dwordx4 v[168:171], v172, s[4:7], s53 offen sc1
  s_add_u32 s52, s52, 32768
  buffer_store_dwordx4 v[168:171], v172, s[4:7], s52 offen sc1
  s_add_u32 s53, s52, s44
  buffer_store_dwordx4 v[168:171], v172, s[4:7], s53 offen sc1
  s_add_u32 s52, s52, 32768
  buffer_store_dwordx4 v[168:171], v172, s[4:7], s52 offen sc1
  s_add_u32 s53, s52, s44
  buffer_store_dwordx4 v[168:171], v172, s[4:7], s53 offen sc1
  s_add_u32 s52, s52, 32768
  buffer_store_dwordx4 v[168:171], v172, s[4:7], s52 offen sc1
  s_add_u32 s53, s52, s44
  buffer_store_dwordx4 v[168:171], v172, s[4:7], s53 offen sc1
  s_add_u32 s52, s52, 32768
  s_lshl_b32 s52, s33, 11
  s_and_b32 s56, s36, 0
  s_mul_i32 s56, s56, 1050624
  s_add_u32 s38, s52, s56
  s_add_u32 s38, s38, 167624704
  s_lshr_b32 s53, s36, 4
  s_lshl_b32 s53, s53, 10
  s_add_u32 s53, s53, s52
  s_and_b32 s44, s36, 6
  s_lshl_b32 s44, s44, 5
  s_add_u32 s53, s53, s44
  s_and_b32 s44, s36, 8
  s_lshl2_add_u32 s53, s44, s53
  s_and_b32 s44, s36, 1
  s_lshl_b32 s44, s44, 9
  s_add_u32 s53, s53, s44
  s_add_u32 s49, s53, 167780352
  s_add_u32 s48, s53, 176160768
  s_lshl_b32 s53, s37, 13
  s_add_u32 s49, s49, s53
  s_add_u32 s38, s38, s53
  s_add_u32 s56, s56, s53
  s_lshl2_add_u32 s39, s47, s33
  s_lshl_b32 s39, s39, 16
  s_add_u32 s39, s39, 2097152
  s_add_u32 s43, s39, 4096
  s_lshl_b32 s53, s36, 13
  s_add_u32 s41, s53, s52
  s_lshl_b32 s44, s47, 18
  s_add_u32 s40, s41, s44
  s_add_u32 s40, s40, 1949696
  s_lshl_b32 s44, s37, 18
  s_add_u32 s41, s41, s44
  s_mov_b32 s44, 0
  s_add_u32 s41, s41, 33406976
  s_add_u32 s42, s41, 33554432
  s_cmp_eq_u32 s33, 2
  s_cselect_b32 s50, 33554432, 0
  s_add_u32 s50, s50, 32636928
  s_add_u32 s50, s50, s53
  s_cmp_eq_u32 s33, 3
  s_cselect_b32 s50, 166600704, s50
  s_cmp_eq_u32 s33, 2
  s_cselect_b32 s51, 2048, 0
  s_add_u32 s51, s51, 1312768
  s_lshr_b32 s53, s36, 1
  s_lshl_b32 s53, s53, 7
  s_add_u32 s51, s51, s53
  s_mov_b32 s54, 0x5d800000
  s_mov_b32 s98, 0xCCCCCCCC
  s_mov_b32 s99, 0xCCCCCCCC
  buffer_load_dwordx4 v[112:115], v162, s[24:27], 0 offen offset:0
  buffer_load_dwordx4 v[116:119], v162, s[24:27], 0 offen offset:128
  v_and_b32 v236, 12, v241
  v_bfe_u32 v237, v241, 4, 1
  v_lshl_add_u32 v236, v237, 10, v236
  v_bfe_u32 v237, v241, 8, 1
  v_lshl_add_u32 v236, v237, 4, v236
  s_and_b32 s52, s36, 6
  s_lshl_b32 s52, s52, 10
  s_and_b32 s53, s36, 24
  s_lshl3_add_u32 s52, s53, s52
  s_and_b32 s53, s36, 1
  s_lshl_b32 s53, s53, 5
  s_add_u32 s52, s52, s53
  buffer_load_dword v167, v236, s[24:27], s52 offen offset:0
  v_lshlrev_b32 v232, 3, v253
  s_waitcnt vmcnt(25)
  s_waitcnt lgkmcnt(0)
  s_barrier
  s_mov_b32 m0, 16384
  s_add_u32 s53, s45, 2097152
  buffer_load_dwordx4 v152, s[12:15], s53 offen lds
  s_mov_b32 m0, 17408
  s_add_u32 s53, s45, 2129920
  buffer_load_dwordx4 v153, s[12:15], s53 offen lds
  s_mov_b32 m0, 18432
  s_add_u32 s53, s45, 2162688
  buffer_load_dwordx4 v152, s[12:15], s53 offen lds
  s_mov_b32 m0, 19456
  s_add_u32 s53, s45, 2195456
  buffer_load_dwordx4 v153, s[12:15], s53 offen lds
  ds_read_b64_tr_b16 v[184:185], v156 offset:0
  ds_read_b64_tr_b16 v[186:187], v156 offset:36864
  ds_read_b64_tr_b16 v[188:189], v158 offset:0
  ds_read_b64_tr_b16 v[190:191], v158 offset:36864
  ds_read_b64_tr_b16 v[192:193], v157 offset:0
  ds_read_b64_tr_b16 v[194:195], v157 offset:36864
  ds_read_b64_tr_b16 v[196:197], v159 offset:0
  ds_read_b64_tr_b16 v[198:199], v159 offset:36864
  s_waitcnt lgkmcnt(0)
  ds_write_b128 v252, v[184:187] offset:20480
  ds_write_b128 v252, v[188:191] offset:21504
  ds_write_b128 v252, v[192:195] offset:22528
  ds_write_b128 v252, v[196:199] offset:23552
  s_waitcnt vmcnt(25)
  s_waitcnt lgkmcnt(0)
  s_barrier
  s_mov_b32 m0, 0
  s_add_u32 s53, s45, 2621440
  buffer_load_dwordx4 v152, s[12:15], s53 offen lds
  s_mov_b32 m0, 1024
  s_add_u32 s53, s45, 2654208
  buffer_load_dwordx4 v153, s[12:15], s53 offen lds
  s_mov_b32 m0, 2048
  s_add_u32 s53, s45, 2686976
  buffer_load_dwordx4 v152, s[12:15], s53 offen lds
  s_mov_b32 m0, 3072
  s_add_u32 s53, s45, 2719744
  buffer_load_dwordx4 v153, s[12:15], s53 offen lds
  ds_read_b64_tr_b16 a[96:97], v156 offset:4096
  ds_read_b64_tr_b16 a[98:99], v156 offset:40960
  ds_read_b64_tr_b16 a[100:101], v158 offset:4096
  ds_read_b64_tr_b16 a[102:103], v158 offset:40960
  ds_read_b64_tr_b16 a[104:105], v157 offset:4096
  ds_read_b64_tr_b16 a[106:107], v157 offset:40960
  ds_read_b64_tr_b16 a[108:109], v159 offset:4096
  ds_read_b64_tr_b16 a[110:111], v159 offset:40960
  s_waitcnt vmcnt(25)
  s_waitcnt lgkmcnt(0)
  s_barrier
  s_mov_b32 m0, 4096
  s_add_u32 s53, s45, 3145728
  buffer_load_dwordx4 v152, s[12:15], s53 offen lds
  s_mov_b32 m0, 5120
  s_add_u32 s53, s45, 3178496
  buffer_load_dwordx4 v153, s[12:15], s53 offen lds
  s_mov_b32 m0, 6144
  s_add_u32 s53, s45, 3211264
  buffer_load_dwordx4 v152, s[12:15], s53 offen lds
  s_mov_b32 m0, 7168
  s_add_u32 s53, s45, 3244032
  buffer_load_dwordx4 v153, s[12:15], s53 offen lds
  ds_read_b64_tr_b16 a[112:113], v156 offset:8192
  ds_read_b64_tr_b16 a[114:115], v156 offset:45056
  ds_read_b64_tr_b16 a[116:117], v158 offset:8192
  ds_read_b64_tr_b16 a[118:119], v158 offset:45056
  ds_read_b64_tr_b16 a[120:121], v157 offset:8192
  ds_read_b64_tr_b16 a[122:123], v157 offset:45056
  ds_read_b64_tr_b16 a[124:125], v159 offset:8192
  ds_read_b64_tr_b16 a[126:127], v159 offset:45056
  s_waitcnt vmcnt(25)
  s_waitcnt lgkmcnt(0)
  s_barrier
  s_mov_b32 m0, 8192
  s_add_u32 s53, s45, 3670016
  buffer_load_dwordx4 v152, s[12:15], s53 offen lds
  s_mov_b32 m0, 9216
  s_add_u32 s53, s45, 3702784
  buffer_load_dwordx4 v153, s[12:15], s53 offen lds
  s_mov_b32 m0, 10240
  s_add_u32 s53, s45, 3735552
  buffer_load_dwordx4 v152, s[12:15], s53 offen lds
  s_mov_b32 m0, 11264
  s_add_u32 s53, s45, 3768320
  buffer_load_dwordx4 v153, s[12:15], s53 offen lds
  ds_read_b64_tr_b16 a[128:129], v156 offset:12288
  ds_read_b64_tr_b16 a[130:131], v156 offset:49152
  ds_read_b64_tr_b16 a[132:133], v158 offset:12288
  ds_read_b64_tr_b16 a[134:135], v158 offset:49152
  ds_read_b64_tr_b16 a[136:137], v157 offset:12288
  ds_read_b64_tr_b16 a[138:139], v157 offset:49152
  ds_read_b64_tr_b16 a[140:141], v159 offset:12288
  ds_read_b64_tr_b16 a[142:143], v159 offset:49152
  s_waitcnt vmcnt(12)
  s_waitcnt lgkmcnt(0)
  s_barrier
  s_mov_b32 m0, 12288
  s_add_u32 s53, s45, 0
  buffer_load_dwordx4 v152, s[16:19], s53 offen lds
  s_mov_b32 m0, 13312
  s_add_u32 s53, s45, 32768
  buffer_load_dwordx4 v153, s[16:19], s53 offen lds
  s_mov_b32 m0, 14336
  s_add_u32 s53, s45, 65536
  buffer_load_dwordx4 v152, s[16:19], s53 offen lds
  s_mov_b32 m0, 15360
  s_add_u32 s53, s45, 98304
  buffer_load_dwordx4 v153, s[16:19], s53 offen lds
  ds_read_b64_tr_b16 a[144:145], v156 offset:16384
  ds_read_b64_tr_b16 a[146:147], v156 offset:53248
  ds_read_b64_tr_b16 a[148:149], v158 offset:16384
  ds_read_b64_tr_b16 a[150:151], v158 offset:53248
  ds_read_b64_tr_b16 a[152:153], v157 offset:16384
  ds_read_b64_tr_b16 a[154:155], v157 offset:53248
  ds_read_b64_tr_b16 a[156:157], v159 offset:16384
  ds_read_b64_tr_b16 a[158:159], v159 offset:53248
  s_waitcnt vmcnt(12)
  s_waitcnt lgkmcnt(0)
  s_barrier
  s_mov_b32 m0, 16384
  s_add_u32 s53, s45, 524288
  buffer_load_dwordx4 v152, s[16:19], s53 offen lds
  s_mov_b32 m0, 17408
  s_add_u32 s53, s45, 557056
  buffer_load_dwordx4 v153, s[16:19], s53 offen lds
  s_mov_b32 m0, 18432
  s_add_u32 s53, s45, 589824
  buffer_load_dwordx4 v152, s[16:19], s53 offen lds
  s_mov_b32 m0, 19456
  s_add_u32 s53, s45, 622592
  buffer_load_dwordx4 v153, s[16:19], s53 offen lds
  ds_read_b64_tr_b16 v[184:185], v156 offset:0
  ds_read_b64_tr_b16 v[186:187], v156 offset:36864
  ds_read_b64_tr_b16 v[188:189], v158 offset:0
  ds_read_b64_tr_b16 v[190:191], v158 offset:36864
  ds_read_b64_tr_b16 v[192:193], v157 offset:0
  ds_read_b64_tr_b16 v[194:195], v157 offset:36864
  ds_read_b64_tr_b16 v[196:197], v159 offset:0
  ds_read_b64_tr_b16 v[198:199], v159 offset:36864
  s_waitcnt lgkmcnt(0)
  ds_write_b128 v252, v[184:187] offset:24576
  ds_write_b128 v252, v[188:191] offset:25600
  ds_write_b128 v252, v[192:195] offset:26624
  ds_write_b128 v252, v[196:199] offset:27648
  s_cmp_lg_u32 s34, 0
  s_cselect_b32 s52, 0x10001, 1
  s_cmp_lg_u32 s3, 0
  s_cselect_b32 s52, 0x1000000, s52
  v_mov_b32 v236, s52
  v_mov_b32 v237, 1
  s_mov_b64 exec, 1
  buffer_atomic_add v236, off, s[28:31], 0 offset:4
  s_cbranch_scc0 c_nopo
  buffer_atomic_add v237, off, s[28:31], 0 offset:164
c_nopo:
  s_mov_b64 exec, -1
  s_waitcnt vmcnt(13)
  s_waitcnt lgkmcnt(0)
  s_barrier
  s_mov_b32 m0, 0
  s_add_u32 s53, s45, 1048576
  buffer_load_dwordx4 v152, s[16:19], s53 offen lds
  s_mov_b32 m0, 1024
  s_add_u32 s53, s45, 1081344
  buffer_load_dwordx4 v153, s[16:19], s53 offen lds
  s_mov_b32 m0, 2048
  s_add_u32 s53, s45, 1114112
  buffer_load_dwordx4 v152, s[16:19], s53 offen lds
  s_mov_b32 m0, 3072
  s_add_u32 s53, s45, 1146880
  buffer_load_dwordx4 v153, s[16:19], s53 offen lds
  ds_read_b64_tr_b16 v[184:185], v156 offset:4096
  ds_read_b64_tr_b16 v[186:187], v156 offset:40960
  ds_read_b64_tr_b16 v[188:189], v158 offset:4096
  ds_read_b64_tr_b16 v[190:191], v158 offset:40960
  ds_read_b64_tr_b16 v[192:193], v157 offset:4096
  ds_read_b64_tr_b16 v[194:195], v157 offset:40960
  ds_read_b64_tr_b16 v[196:197], v159 offset:4096
  ds_read_b64_tr_b16 v[198:199], v159 offset:40960
  s_waitcnt lgkmcnt(0)
  ds_write_b128 v252, v[184:187] offset:28672
  ds_write_b128 v252, v[188:191] offset:29696
  ds_write_b128 v252, v[192:195] offset:30720
  ds_write_b128 v252, v[196:199] offset:31744
  s_waitcnt vmcnt(13)
  s_waitcnt lgkmcnt(0)
  s_barrier
  s_mov_b32 m0, 4096
  s_add_u32 s53, s45, 1572864
  buffer_load_dwordx4 v152, s[16:19], s53 offen lds
  s_mov_b32 m0, 5120
  s_add_u32 s53, s45, 1605632
  buffer_load_dwordx4 v153, s[16:19], s53 offen lds
  s_mov_b32 m0, 6144
  s_add_u32 s53, s45, 1638400
  buffer_load_dwordx4 v152, s[16:19], s53 offen lds
  s_mov_b32 m0, 7168
  s_add_u32 s53, s45, 1671168
  buffer_load_dwordx4 v153, s[16:19], s53 offen lds
  ds_read_b64_tr_b16 v[184:185], v156 offset:8192
  ds_read_b64_tr_b16 v[186:187], v156 offset:45056
  ds_read_b64_tr_b16 v[188:189], v158 offset:8192
  ds_read_b64_tr_b16 v[190:191], v158 offset:45056
  ds_read_b64_tr_b16 v[192:193], v157 offset:8192
  ds_read_b64_tr_b16 v[194:195], v157 offset:45056
  ds_read_b64_tr_b16 v[196:197], v159 offset:8192
  ds_read_b64_tr_b16 v[198:199], v159 offset:45056
  s_waitcnt lgkmcnt(0)
  ds_write_b128 v252, v[184:187] offset:32768
  ds_write_b128 v252, v[188:191] offset:33792
  ds_write_b128 v252, v[192:195] offset:34816
  ds_write_b128 v252, v[196:199] offset:35840
  s_waitcnt vmcnt(13)
  s_waitcnt lgkmcnt(0)
  s_barrier
  s_mov_b32 m0, 8192
  s_add_u32 s53, s45, 2097152
  buffer_load_dwordx4 v152, s[16:19], s53 offen lds
  s_mov_b32 m0, 9216
  s_add_u32 s53, s45, 2129920
  buffer_load_dwordx4 v153, s[16:19], s53 offen lds
  s_mov_b32 m0, 10240
  s_add_u32 s53, s45, 2162688
  buffer_load_dwordx4 v152, s[16:19], s53 offen lds
  s_mov_b32 m0, 11264
  s_add_u32 s53, s45, 2195456
  buffer_load_dwordx4 v153, s[16:19], s53 offen lds
  ds_read_b64_tr_b16 a[160:161], v156 offset:12288
  ds_read_b64_tr_b16 a[162:163], v156 offset:49152
  ds_read_b64_tr_b16 a[164:165], v158 offset:12288
  ds_read_b64_tr_b16 a[166:167], v158 offset:49152
  ds_read_b64_tr_b16 a[168:169], v157 offset:12288
  ds_read_b64_tr_b16 a[170:171], v157 offset:49152
  ds_read_b64_tr_b16 a[172:173], v159 offset:12288
  ds_read_b64_tr_b16 a[174:175], v159 offset:49152
  s_waitcnt vmcnt(13)
  s_waitcnt lgkmcnt(0)
  s_barrier
  s_mov_b32 m0, 12288
  s_add_u32 s53, s45, 2621440
  buffer_load_dwordx4 v152, s[16:19], s53 offen lds
  s_mov_b32 m0, 13312
  s_add_u32 s53, s45, 2654208
  buffer_load_dwordx4 v153, s[16:19], s53 offen lds
  s_mov_b32 m0, 14336
  s_add_u32 s53, s45, 2686976
  buffer_load_dwordx4 v152, s[16:19], s53 offen lds
  s_mov_b32 m0, 15360
  s_add_u32 s53, s45, 2719744
  buffer_load_dwordx4 v153, s[16:19], s53 offen lds
  ds_read_b64_tr_b16 a[176:177], v156 offset:16384
  ds_read_b64_tr_b16 a[178:179], v156 offset:53248
  ds_read_b64_tr_b16 a[180:181], v158 offset:16384
  ds_read_b64_tr_b16 a[182:183], v158 offset:53248
  ds_read_b64_tr_b16 a[184:185], v157 offset:16384
  ds_read_b64_tr_b16 a[186:187], v157 offset:53248
  ds_read_b64_tr_b16 a[188:189], v159 offset:16384
  ds_read_b64_tr_b16 a[190:191], v159 offset:53248
  s_waitcnt vmcnt(12)
  s_waitcnt lgkmcnt(0)
  s_barrier
  s_mov_b32 m0, 16384
  s_add_u32 s53, s45, 3145728
  buffer_load_dwordx4 v152, s[16:19], s53 offen lds
  s_mov_b32 m0, 17408
  s_add_u32 s53, s45, 3178496
  buffer_load_dwordx4 v153, s[16:19], s53 offen lds
  s_mov_b32 m0, 18432
  s_add_u32 s53, s45, 3211264
  buffer_load_dwordx4 v152, s[16:19], s53 offen lds
  s_mov_b32 m0, 19456
  s_add_u32 s53, s45, 3244032
  buffer_load_dwordx4 v153, s[16:19], s53 offen lds
  ds_read_b64_tr_b16 a[192:193], v156 offset:0
  ds_read_b64_tr_b16 a[194:195], v156 offset:36864
  ds_read_b64_tr_b16 a[196:197], v158 offset:0
  ds_read_b64_tr_b16 a[198:199], v158 offset:36864
  ds_read_b64_tr_b16 a[200:201], v157 offset:0
  ds_read_b64_tr_b16 a[202:203], v157 offset:36864
  ds_read_b64_tr_b16 a[204:205], v159 offset:0
  ds_read_b64_tr_b16 a[206:207], v159 offset:36864
  s_waitcnt vmcnt(12)
  s_waitcnt lgkmcnt(0)
  s_barrier
  s_mov_b32 m0, 0
  s_add_u32 s53, s45, 3670016
  buffer_load_dwordx4 v152, s[16:19], s53 offen lds
  s_mov_b32 m0, 1024
  s_add_u32 s53, s45, 3702784
  buffer_load_dwordx4 v153, s[16:19], s53 offen lds
  s_mov_b32 m0, 2048
  s_add_u32 s53, s45, 3735552
  buffer_load_dwordx4 v152, s[16:19], s53 offen lds
  s_mov_b32 m0, 3072
  s_add_u32 s53, s45, 3768320
  buffer_load_dwordx4 v153, s[16:19], s53 offen lds
  ds_read_b64_tr_b16 a[208:209], v156 offset:4096
  ds_read_b64_tr_b16 a[210:211], v156 offset:40960
  ds_read_b64_tr_b16 a[212:213], v158 offset:4096
  ds_read_b64_tr_b16 a[214:215], v158 offset:40960
  ds_read_b64_tr_b16 a[216:217], v157 offset:4096
  ds_read_b64_tr_b16 a[218:219], v157 offset:40960
  ds_read_b64_tr_b16 a[220:221], v159 offset:4096
  ds_read_b64_tr_b16 a[222:223], v159 offset:40960
  s_waitcnt vmcnt(12)
  s_waitcnt lgkmcnt(0)
  s_barrier
  s_mov_b32 m0, 4096
  s_add_u32 s53, s46, 0
  buffer_load_dwordx4 v154, s[20:23], s53 offen lds
  s_mov_b32 m0, 5120
  s_add_u32 s53, s46, 16384
  buffer_load_dwordx4 v155, s[20:23], s53 offen lds
  s_mov_b32 m0, 6144
  s_add_u32 s53, s46, 4096
  buffer_load_dwordx4 v154, s[20:23], s53 offen lds
  s_mov_b32 m0, 7168
  s_add_u32 s53, s46, 20480
  buffer_load_dwordx4 v155, s[20:23], s53 offen lds
  ds_read_b64_tr_b16 a[224:225], v156 offset:8192
  ds_read_b64_tr_b16 a[226:227], v156 offset:45056
  ds_read_b64_tr_b16 a[228:229], v158 offset:8192
  ds_read_b64_tr_b16 a[230:231], v158 offset:45056
  ds_read_b64_tr_b16 a[232:233], v157 offset:8192
  ds_read_b64_tr_b16 a[234:235], v157 offset:45056
  ds_read_b64_tr_b16 a[236:237], v159 offset:8192
  ds_read_b64_tr_b16 a[238:239], v159 offset:45056
  s_waitcnt vmcnt(12)
  s_waitcnt lgkmcnt(0)
  s_barrier
  s_mov_b32 m0, 8192
  s_add_u32 s53, s46, 32768
  buffer_load_dwordx4 v154, s[20:23], s53 offen lds
  s_mov_b32 m0, 9216
  s_add_u32 s53, s46, 49152
  buffer_load_dwordx4 v155, s[20:23], s53 offen lds
  s_mov_b32 m0, 10240
  s_add_u32 s53, s46, 36864
  buffer_load_dwordx4 v154, s[20:23], s53 offen lds
  s_mov_b32 m0, 11264
  s_add_u32 s53, s46, 53248
  buffer_load_dwordx4 v155, s[20:23], s53 offen lds
  ds_read_b64_tr_b16 a[240:241], v156 offset:12288
  ds_read_b64_tr_b16 a[242:243], v156 offset:49152
  ds_read_b64_tr_b16 a[244:245], v158 offset:12288
  ds_read_b64_tr_b16 a[246:247], v158 offset:49152
  ds_read_b64_tr_b16 a[248:249], v157 offset:12288
  ds_read_b64_tr_b16 a[250:251], v157 offset:49152
  ds_read_b64_tr_b16 a[252:253], v159 offset:12288
  ds_read_b64_tr_b16 a[254:255], v159 offset:49152
  s_waitcnt vmcnt(12)
  s_waitcnt lgkmcnt(0)
  s_barrier
  s_mov_b32 m0, 12288
  s_add_u32 s53, s46, 65536
  buffer_load_dwordx4 v154, s[20:23], s53 offen lds
  s_mov_b32 m0, 13312
  s_add_u32 s53, s46, 81920
  buffer_load_dwordx4 v155, s[20:23], s53 offen lds
  s_mov_b32 m0, 14336
  s_add_u32 s53, s46, 69632
  buffer_load_dwordx4 v154, s[20:23], s53 offen lds
  s_mov_b32 m0, 15360
  s_add_u32 s53, s46, 86016
  buffer_load_dwordx4 v155, s[20:23], s53 offen lds
  ds_read_b64_tr_b16 v[0:1], v156 offset:16384
  ds_read_b64_tr_b16 v[2:3], v156 offset:53248
  ds_read_b64_tr_b16 v[4:5], v158 offset:16384
  ds_read_b64_tr_b16 v[6:7], v158 offset:53248
  ds_read_b64_tr_b16 v[8:9], v157 offset:16384
  ds_read_b64_tr_b16 v[10:11], v157 offset:53248
  ds_read_b64_tr_b16 v[12:13], v159 offset:16384
  ds_read_b64_tr_b16 v[14:15], v159 offset:53248
  buffer_load_dword v163, off, s[28:31], 0 offset:36 sc1
  buffer_load_dword v164, off, s[28:31], 0 offset:4 sc1
  s_waitcnt vmcnt(14)
  s_waitcnt lgkmcnt(0)
  s_barrier
  s_mov_b32 m0, 16384
  s_add_u32 s53, s46, 98304
  buffer_load_dwordx4 v154, s[20:23], s53 offen lds
  s_mov_b32 m0, 17408
  s_add_u32 s53, s46, 114688
  buffer_load_dwordx4 v155, s[20:23], s53 offen lds
  s_mov_b32 m0, 18432
  s_add_u32 s53, s46, 102400
  buffer_load_dwordx4 v154, s[20:23], s53 offen lds
  s_mov_b32 m0, 19456
  s_add_u32 s53, s46, 118784
  buffer_load_dwordx4 v155, s[20:23], s53 offen lds
  ds_read_b64_tr_b16 v[16:17], v156 offset:0
  ds_read_b64_tr_b16 v[18:19], v156 offset:36864
  ds_read_b64_tr_b16 v[20:21], v158 offset:0
  ds_read_b64_tr_b16 v[22:23], v158 offset:36864
  ds_read_b64_tr_b16 v[24:25], v157 offset:0
  ds_read_b64_tr_b16 v[26:27], v157 offset:36864
  ds_read_b64_tr_b16 v[28:29], v159 offset:0
  ds_read_b64_tr_b16 v[30:31], v159 offset:36864
  s_waitcnt vmcnt(14)
  s_waitcnt lgkmcnt(0)
  s_barrier
  s_mov_b32 m0, 0
  s_add_u32 s53, s45, 0
  buffer_load_dwordx4 v152, s[8:11], s53 offen lds
  s_mov_b32 m0, 1024
  s_add_u32 s53, s45, 32768
  buffer_load_dwordx4 v153, s[8:11], s53 offen lds
  s_mov_b32 m0, 2048
  s_add_u32 s53, s45, 65536
  buffer_load_dwordx4 v152, s[8:11], s53 offen lds
  s_mov_b32 m0, 3072
  s_add_u32 s53, s45, 98304
  buffer_load_dwordx4 v153, s[8:11], s53 offen lds
  ds_read_b64_tr_b16 v[32:33], v160 offset:4096
  ds_read_b64_tr_b16 v[34:35], v160 offset:40960
  ds_read_b64_tr_b16 v[36:37], v161 offset:4096
  ds_read_b64_tr_b16 v[38:39], v161 offset:40960
  ds_read_b64_tr_b16 v[40:41], v160 offset:4352
  ds_read_b64_tr_b16 v[42:43], v160 offset:41216
  ds_read_b64_tr_b16 v[44:45], v161 offset:4352
  ds_read_b64_tr_b16 v[46:47], v161 offset:41216
  s_waitcnt vmcnt(14)
  s_waitcnt lgkmcnt(0)
  s_barrier
  s_mov_b32 m0, 4096
  s_add_u32 s53, s45, 524288
  buffer_load_dwordx4 v152, s[8:11], s53 offen lds
  s_mov_b32 m0, 5120
  s_add_u32 s53, s45, 557056
  buffer_load_dwordx4 v153, s[8:11], s53 offen lds
  s_mov_b32 m0, 6144
  s_add_u32 s53, s45, 589824
  buffer_load_dwordx4 v152, s[8:11], s53 offen lds
  s_mov_b32 m0, 7168
  s_add_u32 s53, s45, 622592
  buffer_load_dwordx4 v153, s[8:11], s53 offen lds
  ds_read_b64_tr_b16 v[64:65], v160 offset:8192
  ds_read_b64_tr_b16 v[66:67], v160 offset:45056
  ds_read_b64_tr_b16 v[68:69], v161 offset:8192
  ds_read_b64_tr_b16 v[70:71], v161 offset:45056
  ds_read_b64_tr_b16 v[72:73], v160 offset:8448
  ds_read_b64_tr_b16 v[74:75], v160 offset:45312
  ds_read_b64_tr_b16 v[76:77], v161 offset:8448
  ds_read_b64_tr_b16 v[78:79], v161 offset:45312
  s_waitcnt vmcnt(14)
  s_waitcnt lgkmcnt(0)
  s_barrier
  s_mov_b32 m0, 8192
  s_add_u32 s53, s45, 1048576
  buffer_load_dwordx4 v152, s[8:11], s53 offen lds
  s_mov_b32 m0, 9216
  s_add_u32 s53, s45, 1081344
  buffer_load_dwordx4 v153, s[8:11], s53 offen lds
  s_mov_b32 m0, 10240
  s_add_u32 s53, s45, 1114112
  buffer_load_dwordx4 v152, s[8:11], s53 offen lds
  s_mov_b32 m0, 11264
  s_add_u32 s53, s45, 1146880
  buffer_load_dwordx4 v153, s[8:11], s53 offen lds
  ds_read_b64_tr_b16 v[80:81], v160 offset:12288
  ds_read_b64_tr_b16 v[82:83], v160 offset:49152
  ds_read_b64_tr_b16 v[84:85], v161 offset:12288
  ds_read_b64_tr_b16 v[86:87], v161 offset:49152
  ds_read_b64_tr_b16 v[88:89], v160 offset:12544
  ds_read_b64_tr_b16 v[90:91], v160 offset:49408
  ds_read_b64_tr_b16 v[92:93], v161 offset:12544
  ds_read_b64_tr_b16 v[94:95], v161 offset:49408
  s_waitcnt vmcnt(12)
  s_waitcnt lgkmcnt(0)
  s_barrier
  s_mov_b32 m0, 12288
  s_add_u32 s53, s45, 1572864
  buffer_load_dwordx4 v152, s[8:11], s53 offen lds
  s_mov_b32 m0, 13312
  s_add_u32 s53, s45, 1605632
  buffer_load_dwordx4 v153, s[8:11], s53 offen lds
  s_mov_b32 m0, 14336
  s_add_u32 s53, s45, 1638400
  buffer_load_dwordx4 v152, s[8:11], s53 offen lds
  s_mov_b32 m0, 15360
  s_add_u32 s53, s45, 1671168
  buffer_load_dwordx4 v153, s[8:11], s53 offen lds
  ds_read_b64_tr_b16 v[96:97], v160 offset:16384
  ds_read_b64_tr_b16 v[98:99], v160 offset:53248
  ds_read_b64_tr_b16 v[100:101], v161 offset:16384
  ds_read_b64_tr_b16 v[102:103], v161 offset:53248
  ds_read_b64_tr_b16 v[104:105], v160 offset:16640
  ds_read_b64_tr_b16 v[106:107], v160 offset:53504
  ds_read_b64_tr_b16 v[108:109], v161 offset:16640
  ds_read_b64_tr_b16 v[110:111], v161 offset:53504
  s_waitcnt vmcnt(12)
  s_waitcnt lgkmcnt(0)
  s_barrier
  s_mov_b32 m0, 16384
  s_add_u32 s53, s45, 2097152
  buffer_load_dwordx4 v152, s[8:11], s53 offen lds
  s_mov_b32 m0, 17408
  s_add_u32 s53, s45, 2129920
  buffer_load_dwordx4 v153, s[8:11], s53 offen lds
  s_mov_b32 m0, 18432
  s_add_u32 s53, s45, 2162688
  buffer_load_dwordx4 v152, s[8:11], s53 offen lds
  s_mov_b32 m0, 19456
  s_add_u32 s53, s45, 2195456
  buffer_load_dwordx4 v153, s[8:11], s53 offen lds
  ds_read_b64_tr_b16 v[184:185], v156 offset:0
  ds_read_b64_tr_b16 v[186:187], v156 offset:36864
  ds_read_b64_tr_b16 v[188:189], v158 offset:0
  ds_read_b64_tr_b16 v[190:191], v158 offset:36864
  ds_read_b64_tr_b16 v[192:193], v157 offset:0
  ds_read_b64_tr_b16 v[194:195], v157 offset:36864
  ds_read_b64_tr_b16 v[196:197], v159 offset:0
  ds_read_b64_tr_b16 v[198:199], v159 offset:36864
  v_readfirstlane_b32 s52, v163
  v_readfirstlane_b32 s53, v164
  s_lshl_b32 s58, s47, 29
  s_lshl_b32 s52, s52, 5
  s_or_b32 s52, s52, s58
  s_or_b32 s58, s58, 32
  s_and_b32 s52, s52, s53
  s_cmp_eq_u32 s52, s58
  s_cbranch_scc1 c_fl_101
c_wd_102:
  buffer_load_dword v236, off, s[28:31], 0 offset:36 sc1
  s_waitcnt vmcnt(0)
  v_readfirstlane_b32 s53, v236
  s_cmp_ge_u32 s53, 1
  s_cbranch_scc1 c_wdd_103
  s_cmp_eq_u32 s35, 0
  s_cbranch_scc1 c_wdd_103
  s_sub_u32 s35, s35, 1
  s_sleep 2
  s_branch c_wd_102
c_wdd_103:
c_wd_104:
  buffer_load_dword v236, off, s[28:31], 0 offset:4 sc1
  s_waitcnt vmcnt(0)
  v_readfirstlane_b32 s53, v236
  s_and_b32 s52, s53, s58
  s_cmp_eq_u32 s52, s58
  s_cbranch_scc1 c_wdd_105
  s_cmp_eq_u32 s35, 0
  s_cbranch_scc1 c_wdd_105
  s_sub_u32 s35, s35, 1
  s_sleep 2
  s_branch c_wd_104
c_wdd_105:
c_fl_101:
  s_bfe_u32 s34, s53, 0x80010
  s_waitcnt vmcnt(12)
  s_waitcnt lgkmcnt(0)
  s_barrier
  s_mov_b32 m0, 0
  s_add_u32 s53, s45, 2621440
  buffer_load_dwordx4 v152, s[8:11], s53 offen lds
  s_mov_b32 m0, 1024
  s_add_u32 s53, s45, 2654208
  buffer_load_dwordx4 v153, s[8:11], s53 offen lds
  s_mov_b32 m0, 2048
  s_add_u32 s53, s45, 2686976
  buffer_load_dwordx4 v152, s[8:11], s53 offen lds
  s_mov_b32 m0, 3072
  s_add_u32 s53, s45, 2719744
  buffer_load_dwordx4 v153, s[8:11], s53 offen lds
  ds_read_b64_tr_b16 v[216:217], v156 offset:4096
  ds_read_b64_tr_b16 v[218:219], v156 offset:40960
  ds_read_b64_tr_b16 v[220:221], v158 offset:4096
  ds_read_b64_tr_b16 v[222:223], v158 offset:40960
  ds_read_b64_tr_b16 v[224:225], v157 offset:4096
  ds_read_b64_tr_b16 v[226:227], v157 offset:40960
  ds_read_b64_tr_b16 v[228:229], v159 offset:4096
  ds_read_b64_tr_b16 v[230:231], v159 offset:40960
  s_waitcnt vmcnt(12)
  s_waitcnt lgkmcnt(0)
  s_barrier
  s_mov_b32 m0, 4096
  s_add_u32 s53, s45, 3145728
  buffer_load_dwordx4 v152, s[8:11], s53 offen lds
  s_mov_b32 m0, 5120
  s_add_u32 s53, s45, 3178496
  buffer_load_dwordx4 v153, s[8:11], s53 offen lds
  s_mov_b32 m0, 6144
  s_add_u32 s53, s45, 3211264
  buffer_load_dwordx4 v152, s[8:11], s53 offen lds
  s_mov_b32 m0, 7168
  s_add_u32 s53, s45, 3244032
  buffer_load_dwordx4 v153, s[8:11], s53 offen lds
  ds_read_b64_tr_b16 a[0:1], v156 offset:8192
  ds_read_b64_tr_b16 a[2:3], v156 offset:45056
  ds_read_b64_tr_b16 a[4:5], v158 offset:8192
  ds_read_b64_tr_b16 a[6:7], v158 offset:45056
  ds_read_b64_tr_b16 a[8:9], v157 offset:8192
  ds_read_b64_tr_b16 a[10:11], v157 offset:45056
  ds_read_b64_tr_b16 a[12:13], v159 offset:8192
  ds_read_b64_tr_b16 a[14:15], v159 offset:45056
  s_waitcnt vmcnt(12)
  s_waitcnt lgkmcnt(0)
  s_barrier
  s_mov_b32 m0, 8192
  s_add_u32 s53, s45, 3670016
  buffer_load_dwordx4 v152, s[8:11], s53 offen lds
  s_mov_b32 m0, 9216
  s_add_u32 s53, s45, 3702784
  buffer_load_dwordx4 v153, s[8:11], s53 offen lds
  s_mov_b32 m0, 10240
  s_add_u32 s53, s45, 3735552
  buffer_load_dwordx4 v152, s[8:11], s53 offen lds
  s_mov_b32 m0, 11264
  s_add_u32 s53, s45, 3768320
  buffer_load_dwordx4 v153, s[8:11], s53 offen lds
  ds_read_b64_tr_b16 a[16:17], v156 offset:12288
  ds_read_b64_tr_b16 a[18:19], v156 offset:49152
  ds_read_b64_tr_b16 a[20:21], v158 offset:12288
  ds_read_b64_tr_b16 a[22:23], v158 offset:49152
  ds_read_b64_tr_b16 a[24:25], v157 offset:12288
  ds_read_b64_tr_b16 a[26:27], v157 offset:49152
  ds_read_b64_tr_b16 a[28:29], v159 offset:12288
  ds_read_b64_tr_b16 a[30:31], v159 offset:49152
  s_waitcnt vmcnt(12)
  s_waitcnt lgkmcnt(0)
  s_barrier
  s_mov_b32 m0, 12288
  s_add_u32 s53, s46, 512
  buffer_load_dwordx4 v154, s[20:23], s53 offen lds
  s_mov_b32 m0, 13312
  s_add_u32 s53, s46, 16896
  buffer_load_dwordx4 v155, s[20:23], s53 offen lds
  s_mov_b32 m0, 14336
  s_add_u32 s53, s46, 4608
  buffer_load_dwordx4 v154, s[20:23], s53 offen lds
  s_mov_b32 m0, 15360
  s_add_u32 s53, s46, 20992
  buffer_load_dwordx4 v155, s[20:23], s53 offen lds
  ds_read_b64_tr_b16 a[32:33], v156 offset:16384
  ds_read_b64_tr_b16 a[34:35], v156 offset:53248
  ds_read_b64_tr_b16 a[36:37], v158 offset:16384
  ds_read_b64_tr_b16 a[38:39], v158 offset:53248
  ds_read_b64_tr_b16 a[40:41], v157 offset:16384
  ds_read_b64_tr_b16 a[42:43], v157 offset:53248
  ds_read_b64_tr_b16 a[44:45], v159 offset:16384
  ds_read_b64_tr_b16 a[46:47], v159 offset:53248
  s_waitcnt vmcnt(12)
  s_waitcnt lgkmcnt(0)
  s_barrier
  s_mov_b32 m0, 16384
  s_add_u32 s53, s46, 33280
  buffer_load_dwordx4 v154, s[20:23], s53 offen lds
  s_mov_b32 m0, 17408
  s_add_u32 s53, s46, 49664
  buffer_load_dwordx4 v155, s[20:23], s53 offen lds
  s_mov_b32 m0, 18432
  s_add_u32 s53, s46, 37376
  buffer_load_dwordx4 v154, s[20:23], s53 offen lds
  s_mov_b32 m0, 19456
  s_add_u32 s53, s46, 53760
  buffer_load_dwordx4 v155, s[20:23], s53 offen lds
  ds_read_b64_tr_b16 a[48:49], v156 offset:0
  ds_read_b64_tr_b16 a[50:51], v156 offset:36864
  ds_read_b64_tr_b16 a[52:53], v158 offset:0
  ds_read_b64_tr_b16 a[54:55], v158 offset:36864
  ds_read_b64_tr_b16 a[56:57], v157 offset:0
  ds_read_b64_tr_b16 a[58:59], v157 offset:36864
  ds_read_b64_tr_b16 a[60:61], v159 offset:0
  ds_read_b64_tr_b16 a[62:63], v159 offset:36864
  s_waitcnt vmcnt(12)
  s_waitcnt lgkmcnt(0)
  s_barrier
  s_mov_b32 m0, 0
  s_add_u32 s53, s46, 66048
  buffer_load_dwordx4 v154, s[20:23], s53 offen lds
  s_mov_b32 m0, 1024
  s_add_u32 s53, s46, 82432
  buffer_load_dwordx4 v155, s[20:23], s53 offen lds
  s_mov_b32 m0, 2048
  s_add_u32 s53, s46, 70144
  buffer_load_dwordx4 v154, s[20:23], s53 offen lds
  s_mov_b32 m0, 3072
  s_add_u32 s53, s46, 86528
  buffer_load_dwordx4 v155, s[20:23], s53 offen lds
  ds_read_b64_tr_b16 a[64:65], v156 offset:4096
  ds_read_b64_tr_b16 a[66:67], v156 offset:40960
  ds_read_b64_tr_b16 a[68:69], v158 offset:4096
  ds_read_b64_tr_b16 a[70:71], v158 offset:40960
  ds_read_b64_tr_b16 a[72:73], v157 offset:4096
  ds_read_b64_tr_b16 a[74:75], v157 offset:40960
  ds_read_b64_tr_b16 a[76:77], v159 offset:4096
  ds_read_b64_tr_b16 a[78:79], v159 offset:40960
  s_waitcnt vmcnt(12)
  s_waitcnt lgkmcnt(0)
  s_barrier
  s_mov_b32 m0, 4096
  s_add_u32 s53, s46, 98816
  buffer_load_dwordx4 v154, s[20:23], s53 offen lds
  s_mov_b32 m0, 5120
  s_add_u32 s53, s46, 115200
  buffer_load_dwordx4 v155, s[20:23], s53 offen lds
  s_mov_b32 m0, 6144
  s_add_u32 s53, s46, 102912
  buffer_load_dwordx4 v154, s[20:23], s53 offen lds
  s_mov_b32 m0, 7168
  s_add_u32 s53, s46, 119296
  buffer_load_dwordx4 v155, s[20:23], s53 offen lds
  ds_read_b64_tr_b16 a[80:81], v156 offset:8192
  ds_read_b64_tr_b16 a[82:83], v156 offset:45056
  ds_read_b64_tr_b16 a[84:85], v158 offset:8192
  ds_read_b64_tr_b16 a[86:87], v158 offset:45056
  ds_read_b64_tr_b16 a[88:89], v157 offset:8192
  ds_read_b64_tr_b16 a[90:91], v157 offset:45056
  ds_read_b64_tr_b16 a[92:93], v159 offset:8192
  ds_read_b64_tr_b16 a[94:95], v159 offset:45056
  s_add_u32 s52, s51, 2048
  buffer_load_dword v165, off, s[4:7], s51 sc1
  buffer_load_dword v166, off, s[4:7], s52 sc1
  s_mov_b32 m0, 159744
  s_sub_u32 s52, s40, 1032192
  buffer_load_dword v232, s[4:7], s52 offen lds
  s_waitcnt vmcnt(15)
  s_waitcnt lgkmcnt(0)
  s_barrier
  ds_read_b64_tr_b16 v[48:49], v160 offset:12288
  ds_read_b64_tr_b16 v[50:51], v160 offset:49152
  ds_read_b64_tr_b16 v[52:53], v161 offset:12288
  ds_read_b64_tr_b16 v[54:55], v161 offset:49152
  ds_read_b64_tr_b16 v[56:57], v160 offset:12544
  ds_read_b64_tr_b16 v[58:59], v160 offset:49408
  ds_read_b64_tr_b16 v[60:61], v161 offset:12544
  ds_read_b64_tr_b16 v[62:63], v161 offset:49408
  ds_write_b128 v252, v[184:187] offset:8192
  ds_write_b128 v252, v[188:191] offset:9216
  ds_write_b128 v252, v[192:195] offset:10240
  ds_write_b128 v252, v[196:199] offset:11264
  s_waitcnt vmcnt(11)
  s_waitcnt lgkmcnt(0)
  s_barrier
  ds_read_b64_tr_b16 v[200:201], v160 offset:16384
  ds_read_b64_tr_b16 v[202:203], v160 offset:53248
  ds_read_b64_tr_b16 v[204:205], v161 offset:16384
  ds_read_b64_tr_b16 v[206:207], v161 offset:53248
  ds_read_b64_tr_b16 v[208:209], v160 offset:16640
  ds_read_b64_tr_b16 v[210:211], v160 offset:53504
  ds_read_b64_tr_b16 v[212:213], v161 offset:16640
  ds_read_b64_tr_b16 v[214:215], v161 offset:53504
  ds_write_b128 v252, v[216:219] offset:12288
  ds_write_b128 v252, v[220:223] offset:13312
  ds_write_b128 v252, v[224:227] offset:14336
  ds_write_b128 v252, v[228:231] offset:15360
  s_waitcnt vmcnt(7)
  s_waitcnt lgkmcnt(0)
  s_barrier
  ds_read_b64_tr_b16 v[120:121], v160 offset:0
  ds_read_b64_tr_b16 v[122:123], v160 offset:36864
  ds_read_b64_tr_b16 v[124:125], v161 offset:0
  ds_read_b64_tr_b16 v[126:127], v161 offset:36864
  ds_read_b64_tr_b16 v[128:129], v160 offset:256
  ds_read_b64_tr_b16 v[130:131], v160 offset:37120
  ds_read_b64_tr_b16 v[132:133], v161 offset:256
  ds_read_b64_tr_b16 v[134:135], v161 offset:37120
  ds_write_b128 v252, v[200:203] offset:16384
  ds_write_b128 v252, v[204:207] offset:17408
  ds_write_b128 v252, v[208:211] offset:18432
  ds_write_b128 v252, v[212:215] offset:19456
  s_waitcnt vmcnt(3)
  s_waitcnt lgkmcnt(0)
  s_barrier
  ds_read_b64_tr_b16 v[136:137], v160 offset:4096
  ds_read_b64_tr_b16 v[138:139], v160 offset:40960
  ds_read_b64_tr_b16 v[140:141], v161 offset:4096
  ds_read_b64_tr_b16 v[142:143], v161 offset:40960
  ds_read_b64_tr_b16 v[144:145], v160 offset:4352
  ds_read_b64_tr_b16 v[146:147], v160 offset:41216
  ds_read_b64_tr_b16 v[148:149], v161 offset:4352
  ds_read_b64_tr_b16 v[150:151], v161 offset:41216
  ds_write_b128 v252, v[120:123] offset:0
  ds_write_b128 v252, v[124:127] offset:1024
  ds_write_b128 v252, v[128:131] offset:2048
  ds_write_b128 v252, v[132:135] offset:3072
  s_mov_b32 m0, 160768
  s_waitcnt vmcnt(1)
  v_min_u32 v165, v165, v166
  s_cmp_lg_u32 s3, 0
  s_cselect_b32 s58, 0, 2
  v_readfirstlane_b32 s59, v165
  s_cmp_ge_u32 s59, s58
  s_cbranch_scc1 c_rdy_106
  s_xor_b32 s51, s51, 6144
c_sp_107:
  buffer_load_dword v236, off, s[4:7], s51 sc1
  s_waitcnt vmcnt(0)
  v_readfirstlane_b32 s59, v236
  s_cmp_ge_u32 s59, s58
  s_cbranch_scc1 c_spd_108
  s_cmp_eq_u32 s35, 0
  s_cbranch_scc1 c_spd_108
  s_sub_u32 s35, s35, 1
  s_sleep 2
  s_branch c_sp_107
c_spd_108:
  s_xor_b32 s51, s51, 6144
c_sp_109:
  buffer_load_dword v236, off, s[4:7], s51 sc1
  s_waitcnt vmcnt(0)
  v_readfirstlane_b32 s59, v236
  s_cmp_ge_u32 s59, s58
  s_cbranch_scc1 c_spd_110
  s_cmp_eq_u32 s35, 0
  s_cbranch_scc1 c_spd_110
  s_sub_u32 s35, s35, 1
  s_sleep 2
  s_branch c_sp_109
c_spd_110:
c_rdy_106:
  buffer_load_dwordx4 v[168:171], v253, s[4:7], s41 offen sc1
  buffer_load_dwordx4 v[172:175], v253, s[4:7], s41 offen offset:1024 sc1
  s_add_u32 s41, s41, 262144
  v_mov_b32 v233, v167
  s_and_b32 s52, s36, 31
  s_lshl_b32 s52, s52, 1
  s_lshl_b64 s[24:25], 3, s52
  s_mov_b32 s26, 0x000f000f
  s_mov_b32 s27, 0x000f000f
  s_waitcnt lgkmcnt(0)
  s_barrier
  ds_write_b128 v252, v[136:139] offset:4096
  ds_write_b128 v252, v[140:143] offset:5120
  ds_write_b128 v252, v[144:147] offset:6144
  ds_write_b128 v252, v[148:151] offset:7168
  s_waitcnt lgkmcnt(0)
  ds_read_b128 v[200:203], v252 offset:20480
  ds_read_b128 v[204:207], v252 offset:21504
  ds_read_b128 v[208:211], v252 offset:22528
  ds_read_b128 v[212:215], v252 offset:23552
  v_mov_b64 v[144:145], 0
  v_mov_b64 v[146:147], 0
  s_nop 0
  v_mov_b64 v[148:149], 0
  v_mov_b64 v[150:151], 0
  s_nop 0
  v_mov_b64 v[152:153], 0
  v_mov_b64 v[154:155], 0
  s_nop 0
  v_mov_b64 v[156:157], 0
  v_mov_b64 v[158:159], 0
  s_nop 0
  v_mov_b64 v[160:161], 0
  v_mov_b64 v[162:163], 0
  s_nop 0
  v_mov_b64 v[164:165], 0
  v_mov_b64 v[166:167], 0
  s_nop 0
  s_waitcnt lgkmcnt(0)
  s_cmp_lg_u32 s34, 0
  s_cbranch_scc1 c_entry_1_0
  s_branch c_entry_0_0
c_pro_1:
  s_min_u32 s47, s3, 1
  s_cmp_lg_u32 s3, 0
  s_cselect_b32 s36, s2, s32
  s_cselect_b32 s57, 0, 63
  s_cselect_b32 s37, 0, 0
  s_load_dwordx4 s[8:11], s[0:1], 8
  s_load_dwordx4 s[12:15], s[0:1], 24
  s_load_dwordx2 s[20:21], s[0:1], 40
  s_waitcnt lgkmcnt(0)
  s_mov_b32 s24, s8
  s_mov_b32 s25, s9
  s_mov_b32 s26, 8192
  s_mov_b32 s27, 0x20000
  s_mov_b32 s8, s10
  s_mov_b32 s9, s11
  s_mov_b32 s10, 0x400000
  s_mov_b32 s11, 0x20000
  s_mov_b32 s16, s14
  s_mov_b32 s17, s15
  s_mov_b32 s18, 0x400000
  s_mov_b32 s19, 0x20000
  s_mov_b32 s14, 0x400000
  s_mov_b32 s15, 0x20000
  s_mov_b32 s22, 0x400000
  s_mov_b32 s23, 0x20000
  v_and_b32 v232, 63, v0
  v_and_b32 v233, 15, v232
  v_lshrrev_b32 v234, 4, v232
  v_and_b32 v236, 1, v234
  v_lshrrev_b32 v237, 1, v234
  v_lshl_add_u32 v236, v237, 5, v236
  v_lshlrev_b32 v236, 13, v236
  v_lshlrev_b32 v238, 1, v234
  v_xor_b32 v238, v238, v233
  v_lshl_add_u32 v152, v238, 4, v236
  v_xor_b32 v153, 128, v152
  s_lshl_b32 s45, s36, 8
  s_lshl_b32 s46, s36, 17
  s_mov_b32 m0, 36864
  s_add_u32 s53, s45, 16384
  buffer_load_dwordx4 v152, s[12:15], s53 offen lds
  s_mov_b32 m0, 37888
  s_add_u32 s53, s45, 49152
  buffer_load_dwordx4 v153, s[12:15], s53 offen lds
  s_mov_b32 m0, 38912
  s_add_u32 s53, s45, 81920
  buffer_load_dwordx4 v152, s[12:15], s53 offen lds
  s_mov_b32 m0, 39936
  s_add_u32 s53, s45, 114688
  buffer_load_dwordx4 v153, s[12:15], s53 offen lds
  s_mov_b32 m0, 40960
  s_add_u32 s53, s45, 540672
  buffer_load_dwordx4 v152, s[12:15], s53 offen lds
  s_mov_b32 m0, 41984
  s_add_u32 s53, s45, 573440
  buffer_load_dwordx4 v153, s[12:15], s53 offen lds
  s_mov_b32 m0, 43008
  s_add_u32 s53, s45, 606208
  buffer_load_dwordx4 v152, s[12:15], s53 offen lds
  s_mov_b32 m0, 44032
  s_add_u32 s53, s45, 638976
  buffer_load_dwordx4 v153, s[12:15], s53 offen lds
  s_mov_b32 m0, 45056
  s_add_u32 s53, s45, 1064960
  buffer_load_dwordx4 v152, s[12:15], s53 offen lds
  s_mov_b32 m0, 46080
  s_add_u32 s53, s45, 1097728
  buffer_load_dwordx4 v153, s[12:15], s53 offen lds
  s_mov_b32 m0, 47104
  s_add_u32 s53, s45, 1130496
  buffer_load_dwordx4 v152, s[12:15], s53 offen lds
  s_mov_b32 m0, 48128
  s_add_u32 s53, s45, 1163264
  buffer_load_dwordx4 v153, s[12:15], s53 offen lds
  s_mov_b32 m0, 49152
  s_add_u32 s53, s45, 1589248
  buffer_load_dwordx4 v152, s[12:15], s53 offen lds
  s_mov_b32 m0, 50176
  s_add_u32 s53, s45, 1622016
  buffer_load_dwordx4 v153, s[12:15], s53 offen lds
  s_mov_b32 m0, 51200
  s_add_u32 s53, s45, 1654784
  buffer_load_dwordx4 v152, s[12:15], s53 offen lds
  s_mov_b32 m0, 52224
  s_add_u32 s53, s45, 1687552
  buffer_load_dwordx4 v153, s[12:15], s53 offen lds
  v_and_b32 v236, 31, v232
  v_lshlrev_b32 v238, 2, v237
  v_xor_b32 v236, v236, v238
  v_lshlrev_b32 v236, 4, v236
  v_lshl_add_u32 v154, v237, 10, v236
  v_xor_b32 v155, 128, v154
  s_mov_b32 s52, 36864
  v_lshrrev_b32 v236, 2, v232
  v_and_b32 v238, 7, v236
  v_xor_b32 v238, 2, v238
  v_lshlrev_b32 v236, 8, v236
  v_lshl_add_u32 v236, v238, 5, v236
  v_and_b32 v237, 3, v232
  v_lshl_add_u32 v156, v237, 3, v236
  v_xor_b32 v157, 32, v156
  v_add_u32 v158, 73728, v156
  v_add_u32 v159, 73728, v157
  v_bfe_u32 v236, v232, 2, 1
  v_lshl_add_u32 v236, v234, 1, v236
  v_and_b32 v238, 3, v236
  v_xor_b32 v238, 1, v238
  v_lshlrev_b32 v236, 9, v236
  v_lshl_add_u32 v236, v238, 6, v236
  v_lshl_add_u32 v236, v237, 4, v236
  v_bfe_u32 v237, v232, 3, 1
  v_lshl_add_u32 v160, v237, 3, v236
  v_add_u32 v161, 73728, v160
  v_bfe_u32 v235, v232, 1, 1
  v_bfe_u32 v239, v232, 2, 2
  v_lshlrev_b32 v236, 4, v232
  v_add_u32 v252, s52, v236
  v_add_u32 v253, 147456, v236
  v_lshl_add_u32 v254, v235, 10, v253
  v_lshrrev_b32 v236, 3, v232
  s_lshl1_add_u32 s53, s33, s36
  v_lshl_add_u32 v237, v236, 2, s53
  v_and_b32 v237, 31, v237
  v_lshlrev_b32 v236, 13, v236
  v_lshl_add_u32 v236, v237, 6, v236
  v_and_b32 v237, 7, v232
  v_lshl_add_u32 v255, v237, 3, v236
  v_mul_u32_u24 v240, 0xAAAA, v235
  v_add_u32 v240, 0x4444, v240
  v_mov_b32 v246, 0x3F003F00
  v_mov_b32 v247, 0x3F003F00
  v_and_b32 v236, 1, v232
  v_lshlrev_b32 v236, 4, v236
  v_cmp_eq_u32 vcc, v234, v239
  v_mov_b32 v237, 0x3e89
  v_lshlrev_b32 v237, v236, v237
  v_cndmask_b32 v242, 0, v237, vcc
  v_mov_b32 v243, v242
  v_mov_b32 v237, 0x3ef4
  v_lshlrev_b32 v237, v236, v237
  v_cndmask_b32 v244, 0, v237, vcc
  v_mov_b32 v245, v244
  v_bfe_u32 v236, v232, 2, 1
  v_lshlrev_b32 v236, 4, v236
  v_mov_b32 v237, 0x3F80
  v_lshlrev_b32 v237, v236, v237
  v_bfe_u32 v238, v232, 3, 1
  v_and_b32 v236, 1, v232
  v_lshl_add_u32 v238, v236, 1, v238
  v_cmp_eq_u32 vcc, 0, v238
  s_nop 1
  v_cndmask_b32 v248, 0, v237, vcc
  v_cmp_eq_u32 vcc, 1, v238
  s_nop 1
  v_cndmask_b32 v249, 0, v237, vcc
  v_cmp_eq_u32 vcc, 2, v238
  s_nop 1
  v_cndmask_b32 v250, 0, v237, vcc
  v_cmp_eq_u32 vcc, 3, v238
  s_nop 1
  v_cndmask_b32 v251, 0, v237, vcc
  v_lshlrev_b32 v236, 2, v236
  v_and_b32 v237, 0, v239
  v_mul_u32_u24 v237, 1050624, v237
  v_add_u32 v236, v237, v236
  v_lshrrev_b32 v237, 0, v239
  v_lshl_add_u32 v236, v237, 28, v236
  v_lshl_add_u32 v236, v235, 8, v236
  v_and_b32 v237, 16, v232
  v_add_u32 v236, v237, v236
  v_bfe_u32 v237, v232, 5, 1
  v_lshl_add_u32 v241, v237, 3, v236
  v_and_b32 v236, 1, v232
  v_lshl_add_u32 v236, v239, 1, v236
  v_lshlrev_b32 v236, 10, v236
  v_lshl_add_u32 v236, v235, 6, v236
  v_lshl_add_u32 v162, v234, 4, v236
  v_mov_b32 v168, -1
  v_mov_b32 v169, -1
  v_mov_b32 v170, -1
  v_mov_b32 v171, -1
  s_lshl_b32 s52, s47, 5
  s_add_u32 s52, s52, s36
  s_lshl_b32 s52, s52, 13
  s_lshl_b32 s53, s33, 11
  s_add_u32 s52, s52, s53
  s_add_u32 s52, s52, 1949696
  buffer_store_dwordx4 v[168:171], v253, s[4:7], s52 offen offset:0 sc1
  buffer_store_dwordx4 v[168:171], v253, s[4:7], s52 offen offset:1024 sc1
  s_cmp_lg_u32 s3, 0
  s_cselect_b32 s52, 8, 13
  s_cselect_b32 s44, 17, 23
  s_lshl_b32 s44, 1, s44
  v_lshlrev_b32 v172, s52, v234
  v_lshl_add_u32 v172, v233, 4, v172
  s_lshl_b32 s52, s36, 8
  s_lshl_b32 s53, s33, 17
  s_add_u32 s52, s52, s53
  s_add_u32 s52, s52, 167772160
  s_cmp_lg_u32 s3, 0
  s_cselect_b32 s52, s3, s52
  buffer_store_dwordx4 v[168:171], v172, s[4:7], s52 offen sc1
  s_add_u32 s53, s52, s44
  buffer_store_dwordx4 v[168:171], v172, s[4:7], s53 offen sc1
  s_add_u32 s52, s52, 32768
  buffer_store_dwordx4 v[168:171], v172, s[4:7], s52 offen sc1
  s_add_u32 s53, s52, s44
  buffer_store_dwordx4 v[168:171], v172, s[4:7], s53 offen sc1
  s_add_u32 s52, s52, 32768
  buffer_store_dwordx4 v[168:171], v172, s[4:7], s52 offen sc1
  s_add_u32 s53, s52, s44
  buffer_store_dwordx4 v[168:171], v172, s[4:7], s53 offen sc1
  s_add_u32 s52, s52, 32768
  buffer_store_dwordx4 v[168:171], v172, s[4:7], s52 offen sc1
  s_add_u32 s53, s52, s44
  buffer_store_dwordx4 v[168:171], v172, s[4:7], s53 offen sc1
  s_add_u32 s52, s52, 32768
  s_lshl_b32 s52, s33, 11
  s_and_b32 s56, s36, 0
  s_mul_i32 s56, s56, 1050624
  s_add_u32 s38, s52, s56
  s_add_u32 s38, s38, 167624704
  s_lshr_b32 s53, s36, 4
  s_lshl_b32 s53, s53, 10
  s_add_u32 s53, s53, s52
  s_and_b32 s44, s36, 6
  s_lshl_b32 s44, s44, 5
  s_add_u32 s53, s53, s44
  s_and_b32 s44, s36, 8
  s_lshl2_add_u32 s53, s44, s53
  s_and_b32 s44, s36, 1
  s_lshl_b32 s44, s44, 9
  s_add_u32 s53, s53, s44
  s_add_u32 s49, s53, 167780352
  s_add_u32 s48, s53, 176160768
  s_lshl_b32 s53, s37, 13
  s_add_u32 s49, s49, s53
  s_add_u32 s38, s38, s53
  s_add_u32 s56, s56, s53
  s_lshl2_add_u32 s39, s47, s33
  s_lshl_b32 s39, s39, 16
  s_add_u32 s39, s39, 2097152
  s_add_u32 s43, s39, 4096
  s_lshl_b32 s53, s36, 13
  s_add_u32 s41, s53, s52
  s_lshl_b32 s44, s47, 18
  s_add_u32 s40, s41, s44
  s_add_u32 s40, s40, 1949696
  s_lshl_b32 s44, s37, 18
  s_add_u32 s41, s41, s44
  s_mov_b32 s44, 0
  s_add_u32 s41, s41, 33406976
  s_add_u32 s42, s41, 33554432
  s_cmp_eq_u32 s33, 2
  s_cselect_b32 s50, 33554432, 0
  s_add_u32 s50, s50, 32636928
  s_add_u32 s50, s50, s53
  s_cmp_eq_u32 s33, 3
  s_cselect_b32 s50, 166600704, s50
  s_cmp_eq_u32 s33, 2
  s_cselect_b32 s51, 2048, 0
  s_add_u32 s51, s51, 1312768
  s_lshr_b32 s53, s36, 1
  s_lshl_b32 s53, s53, 7
  s_add_u32 s51, s51, s53
  s_mov_b32 s54, 0x5d800000
  s_mov_b32 s98, 0xCCCCCCCC
  s_mov_b32 s99, 0xCCCCCCCC
  buffer_load_dwordx4 v[112:115], v162, s[24:27], 0 offen offset:256
  buffer_load_dwordx4 v[116:119], v162, s[24:27], 0 offen offset:384
  v_and_b32 v236, 12, v241
  v_bfe_u32 v237, v241, 4, 1
  v_lshl_add_u32 v236, v237, 10, v236
  v_bfe_u32 v237, v241, 8, 1
  v_lshl_add_u32 v236, v237, 4, v236
  s_and_b32 s52, s36, 6
  s_lshl_b32 s52, s52, 10
  s_and_b32 s53, s36, 24
  s_lshl3_add_u32 s52, s53, s52
  s_and_b32 s53, s36, 1
  s_lshl_b32 s53, s53, 5
  s_add_u32 s52, s52, s53
  buffer_load_dword v167, v236, s[24:27], s52 offen offset:256
  v_lshlrev_b32 v232, 3, v253
  s_waitcnt vmcnt(25)
  s_waitcnt lgkmcnt(0)
  s_barrier
  s_mov_b32 m0, 53248
  s_add_u32 s53, s45, 2113536
  buffer_load_dwordx4 v152, s[12:15], s53 offen lds
  s_mov_b32 m0, 54272
  s_add_u32 s53, s45, 2146304
  buffer_load_dwordx4 v153, s[12:15], s53 offen lds
  s_mov_b32 m0, 55296
  s_add_u32 s53, s45, 2179072
  buffer_load_dwordx4 v152, s[12:15], s53 offen lds
  s_mov_b32 m0, 56320
  s_add_u32 s53, s45, 2211840
  buffer_load_dwordx4 v153, s[12:15], s53 offen lds
  ds_read_b64_tr_b16 v[184:185], v156 offset:0
  ds_read_b64_tr_b16 v[186:187], v156 offset:36864
  ds_read_b64_tr_b16 v[188:189], v158 offset:0
  ds_read_b64_tr_b16 v[190:191], v158 offset:36864
  ds_read_b64_tr_b16 v[192:193], v157 offset:0
  ds_read_b64_tr_b16 v[194:195], v157 offset:36864
  ds_read_b64_tr_b16 v[196:197], v159 offset:0
  ds_read_b64_tr_b16 v[198:199], v159 offset:36864
  s_waitcnt lgkmcnt(0)
  ds_write_b128 v252, v[184:187] offset:28672
  ds_write_b128 v252, v[188:191] offset:29696
  ds_write_b128 v252, v[192:195] offset:30720
  ds_write_b128 v252, v[196:199] offset:31744
  s_waitcnt vmcnt(25)
  s_waitcnt lgkmcnt(0)
  s_barrier
  s_mov_b32 m0, 36864
  s_add_u32 s53, s45, 2637824
  buffer_load_dwordx4 v152, s[12:15], s53 offen lds
  s_mov_b32 m0, 37888
  s_add_u32 s53, s45, 2670592
  buffer_load_dwordx4 v153, s[12:15], s53 offen lds
  s_mov_b32 m0, 38912
  s_add_u32 s53, s45, 2703360
  buffer_load_dwordx4 v152, s[12:15], s53 offen lds
  s_mov_b32 m0, 39936
  s_add_u32 s53, s45, 2736128
  buffer_load_dwordx4 v153, s[12:15], s53 offen lds
  ds_read_b64_tr_b16 v[184:185], v156 offset:4096
  ds_read_b64_tr_b16 v[186:187], v156 offset:40960
  ds_read_b64_tr_b16 v[188:189], v158 offset:4096
  ds_read_b64_tr_b16 v[190:191], v158 offset:40960
  ds_read_b64_tr_b16 v[192:193], v157 offset:4096
  ds_read_b64_tr_b16 v[194:195], v157 offset:40960
  ds_read_b64_tr_b16 v[196:197], v159 offset:4096
  ds_read_b64_tr_b16 v[198:199], v159 offset:40960
  s_waitcnt lgkmcnt(0)
  ds_write_b128 v252, v[184:187] offset:32768
  ds_write_b128 v252, v[188:191] offset:33792
  ds_write_b128 v252, v[192:195] offset:34816
  ds_write_b128 v252, v[196:199] offset:35840
  s_waitcnt vmcnt(25)
  s_waitcnt lgkmcnt(0)
  s_barrier
  s_mov_b32 m0, 40960
  s_add_u32 s53, s45, 3162112
  buffer_load_dwordx4 v152, s[12:15], s53 offen lds
  s_mov_b32 m0, 41984
  s_add_u32 s53, s45, 3194880
  buffer_load_dwordx4 v153, s[12:15], s53 offen lds
  s_mov_b32 m0, 43008
  s_add_u32 s53, s45, 3227648
  buffer_load_dwordx4 v152, s[12:15], s53 offen lds
  s_mov_b32 m0, 44032
  s_add_u32 s53, s45, 3260416
  buffer_load_dwordx4 v153, s[12:15], s53 offen lds
  ds_read_b64_tr_b16 v[184:185], v156 offset:8192
  ds_read_b64_tr_b16 v[186:187], v156 offset:45056
  ds_read_b64_tr_b16 v[188:189], v158 offset:8192
  ds_read_b64_tr_b16 v[190:191], v158 offset:45056
  ds_read_b64_tr_b16 v[192:193], v157 offset:8192
  ds_read_b64_tr_b16 v[194:195], v157 offset:45056
  ds_read_b64_tr_b16 v[196:197], v159 offset:8192
  ds_read_b64_tr_b16 v[198:199], v159 offset:45056
  s_waitcnt lgkmcnt(0)
  ds_write_b128 v252, v[184:187] offset:20480
  ds_write_b128 v252, v[188:191] offset:21504
  ds_write_b128 v252, v[192:195] offset:22528
  ds_write_b128 v252, v[196:199] offset:23552
  s_waitcnt vmcnt(25)
  s_waitcnt lgkmcnt(0)
  s_barrier
  s_mov_b32 m0, 45056
  s_add_u32 s53, s45, 3686400
  buffer_load_dwordx4 v152, s[12:15], s53 offen lds
  s_mov_b32 m0, 46080
  s_add_u32 s53, s45, 3719168
  buffer_load_dwordx4 v153, s[12:15], s53 offen lds
  s_mov_b32 m0, 47104
  s_add_u32 s53, s45, 3751936
  buffer_load_dwordx4 v152, s[12:15], s53 offen lds
  s_mov_b32 m0, 48128
  s_add_u32 s53, s45, 3784704
  buffer_load_dwordx4 v153, s[12:15], s53 offen lds
  ds_read_b64_tr_b16 a[96:97], v156 offset:12288
  ds_read_b64_tr_b16 a[98:99], v156 offset:49152
  ds_read_b64_tr_b16 a[100:101], v158 offset:12288
  ds_read_b64_tr_b16 a[102:103], v158 offset:49152
  ds_read_b64_tr_b16 a[104:105], v157 offset:12288
  ds_read_b64_tr_b16 a[106:107], v157 offset:49152
  ds_read_b64_tr_b16 a[108:109], v159 offset:12288
  ds_read_b64_tr_b16 a[110:111], v159 offset:49152
  s_waitcnt vmcnt(12)
  s_waitcnt lgkmcnt(0)
  s_barrier
  s_mov_b32 m0, 49152
  s_add_u32 s53, s45, 16384
  buffer_load_dwordx4 v152, s[16:19], s53 offen lds
  s_mov_b32 m0, 50176
  s_add_u32 s53, s45, 49152
  buffer_load_dwordx4 v153, s[16:19], s53 offen lds
  s_mov_b32 m0, 51200
  s_add_u32 s53, s45, 81920
  buffer_load_dwordx4 v152, s[16:19], s53 offen lds
  s_mov_b32 m0, 52224
  s_add_u32 s53, s45, 114688
  buffer_load_dwordx4 v153, s[16:19], s53 offen lds
  ds_read_b64_tr_b16 a[112:113], v156 offset:16384
  ds_read_b64_tr_b16 a[114:115], v156 offset:53248
  ds_read_b64_tr_b16 a[116:117], v158 offset:16384
  ds_read_b64_tr_b16 a[118:119], v158 offset:53248
  ds_read_b64_tr_b16 a[120:121], v157 offset:16384
  ds_read_b64_tr_b16 a[122:123], v157 offset:53248
  ds_read_b64_tr_b16 a[124:125], v159 offset:16384
  ds_read_b64_tr_b16 a[126:127], v159 offset:53248
  s_waitcnt vmcnt(12)
  s_waitcnt lgkmcnt(0)
  s_barrier
  s_mov_b32 m0, 53248
  s_add_u32 s53, s45, 540672
  buffer_load_dwordx4 v152, s[16:19], s53 offen lds
  s_mov_b32 m0, 54272
  s_add_u32 s53, s45, 573440
  buffer_load_dwordx4 v153, s[16:19], s53 offen lds
  s_mov_b32 m0, 55296
  s_add_u32 s53, s45, 606208
  buffer_load_dwordx4 v152, s[16:19], s53 offen lds
  s_mov_b32 m0, 56320
  s_add_u32 s53, s45, 638976
  buffer_load_dwordx4 v153, s[16:19], s53 offen lds
  ds_read_b64_tr_b16 a[128:129], v156 offset:0
  ds_read_b64_tr_b16 a[130:131], v156 offset:36864
  ds_read_b64_tr_b16 a[132:133], v158 offset:0
  ds_read_b64_tr_b16 a[134:135], v158 offset:36864
  ds_read_b64_tr_b16 a[136:137], v157 offset:0
  ds_read_b64_tr_b16 a[138:139], v157 offset:36864
  ds_read_b64_tr_b16 a[140:141], v159 offset:0
  ds_read_b64_tr_b16 a[142:143], v159 offset:36864
  s_waitcnt vmcnt(12)
  s_waitcnt lgkmcnt(0)
  s_barrier
  s_mov_b32 m0, 36864
  s_add_u32 s53, s45, 1064960
  buffer_load_dwordx4 v152, s[16:19], s53 offen lds
  s_mov_b32 m0, 37888
  s_add_u32 s53, s45, 1097728
  buffer_load_dwordx4 v153, s[16:19], s53 offen lds
  s_mov_b32 m0, 38912
  s_add_u32 s53, s45, 1130496
  buffer_load_dwordx4 v152, s[16:19], s53 offen lds
  s_mov_b32 m0, 39936
  s_add_u32 s53, s45, 1163264
  buffer_load_dwordx4 v153, s[16:19], s53 offen lds
  ds_read_b64_tr_b16 a[144:145], v156 offset:4096
  ds_read_b64_tr_b16 a[146:147], v156 offset:40960
  ds_read_b64_tr_b16 a[148:149], v158 offset:4096
  ds_read_b64_tr_b16 a[150:151], v158 offset:40960
  ds_read_b64_tr_b16 a[152:153], v157 offset:4096
  ds_read_b64_tr_b16 a[154:155], v157 offset:40960
  ds_read_b64_tr_b16 a[156:157], v159 offset:4096
  ds_read_b64_tr_b16 a[158:159], v159 offset:40960
  s_waitcnt vmcnt(12)
  s_waitcnt lgkmcnt(0)
  s_barrier
  s_mov_b32 m0, 40960
  s_add_u32 s53, s45, 1589248
  buffer_load_dwordx4 v152, s[16:19], s53 offen lds
  s_mov_b32 m0, 41984
  s_add_u32 s53, s45, 1622016
  buffer_load_dwordx4 v153, s[16:19], s53 offen lds
  s_mov_b32 m0, 43008
  s_add_u32 s53, s45, 1654784
  buffer_load_dwordx4 v152, s[16:19], s53 offen lds
  s_mov_b32 m0, 44032
  s_add_u32 s53, s45, 1687552
  buffer_load_dwordx4 v153, s[16:19], s53 offen lds
  ds_read_b64_tr_b16 v[184:185], v156 offset:8192
  ds_read_b64_tr_b16 v[186:187], v156 offset:45056
  ds_read_b64_tr_b16 v[188:189], v158 offset:8192
  ds_read_b64_tr_b16 v[190:191], v158 offset:45056
  ds_read_b64_tr_b16 v[192:193], v157 offset:8192
  ds_read_b64_tr_b16 v[194:195], v157 offset:45056
  ds_read_b64_tr_b16 v[196:197], v159 offset:8192
  ds_read_b64_tr_b16 v[198:199], v159 offset:45056
  s_waitcnt lgkmcnt(0)
  ds_write_b128 v252, v[184:187] offset:24576
  ds_write_b128 v252, v[188:191] offset:25600
  ds_write_b128 v252, v[192:195] offset:26624
  ds_write_b128 v252, v[196:199] offset:27648
  s_waitcnt vmcnt(12)
  s_waitcnt lgkmcnt(0)
  s_barrier
  s_mov_b32 m0, 45056
  s_add_u32 s53, s45, 2113536
  buffer_load_dwordx4 v152, s[16:19], s53 offen lds
  s_mov_b32 m0, 46080
  s_add_u32 s53, s45, 2146304
  buffer_load_dwordx4 v153, s[16:19], s53 offen lds
  s_mov_b32 m0, 47104
  s_add_u32 s53, s45, 2179072
  buffer_load_dwordx4 v152, s[16:19], s53 offen lds
  s_mov_b32 m0, 48128
  s_add_u32 s53, s45, 2211840
  buffer_load_dwordx4 v153, s[16:19], s53 offen lds
  ds_read_b64_tr_b16 v[0:1], v156 offset:12288
  ds_read_b64_tr_b16 v[2:3], v156 offset:49152
  ds_read_b64_tr_b16 v[4:5], v158 offset:12288
  ds_read_b64_tr_b16 v[6:7], v158 offset:49152
  ds_read_b64_tr_b16 v[8:9], v157 offset:12288
  ds_read_b64_tr_b16 v[10:11], v157 offset:49152
  ds_read_b64_tr_b16 v[12:13], v159 offset:12288
  ds_read_b64_tr_b16 v[14:15], v159 offset:49152
  s_waitcnt vmcnt(12)
  s_waitcnt lgkmcnt(0)
  s_barrier
  s_mov_b32 m0, 49152
  s_add_u32 s53, s45, 2637824
  buffer_load_dwordx4 v152, s[16:19], s53 offen lds
  s_mov_b32 m0, 50176
  s_add_u32 s53, s45, 2670592
  buffer_load_dwordx4 v153, s[16:19], s53 offen lds
  s_mov_b32 m0, 51200
  s_add_u32 s53, s45, 2703360
  buffer_load_dwordx4 v152, s[16:19], s53 offen lds
  s_mov_b32 m0, 52224
  s_add_u32 s53, s45, 2736128
  buffer_load_dwordx4 v153, s[16:19], s53 offen lds
  ds_read_b64_tr_b16 v[16:17], v156 offset:16384
  ds_read_b64_tr_b16 v[18:19], v156 offset:53248
  ds_read_b64_tr_b16 v[20:21], v158 offset:16384
  ds_read_b64_tr_b16 v[22:23], v158 offset:53248
  ds_read_b64_tr_b16 v[24:25], v157 offset:16384
  ds_read_b64_tr_b16 v[26:27], v157 offset:53248
  ds_read_b64_tr_b16 v[28:29], v159 offset:16384
  ds_read_b64_tr_b16 v[30:31], v159 offset:53248
  s_waitcnt vmcnt(12)
  s_waitcnt lgkmcnt(0)
  s_barrier
  s_mov_b32 m0, 53248
  s_add_u32 s53, s45, 3162112
  buffer_load_dwordx4 v152, s[16:19], s53 offen lds
  s_mov_b32 m0, 54272
  s_add_u32 s53, s45, 3194880
  buffer_load_dwordx4 v153, s[16:19], s53 offen lds
  s_mov_b32 m0, 55296
  s_add_u32 s53, s45, 3227648
  buffer_load_dwordx4 v152, s[16:19], s53 offen lds
  s_mov_b32 m0, 56320
  s_add_u32 s53, s45, 3260416
  buffer_load_dwordx4 v153, s[16:19], s53 offen lds
  ds_read_b64_tr_b16 a[160:161], v156 offset:0
  ds_read_b64_tr_b16 a[162:163], v156 offset:36864
  ds_read_b64_tr_b16 a[164:165], v158 offset:0
  ds_read_b64_tr_b16 a[166:167], v158 offset:36864
  ds_read_b64_tr_b16 a[168:169], v157 offset:0
  ds_read_b64_tr_b16 a[170:171], v157 offset:36864
  ds_read_b64_tr_b16 a[172:173], v159 offset:0
  ds_read_b64_tr_b16 a[174:175], v159 offset:36864
  s_waitcnt vmcnt(12)
  s_waitcnt lgkmcnt(0)
  s_barrier
  s_mov_b32 m0, 36864
  s_add_u32 s53, s45, 3686400
  buffer_load_dwordx4 v152, s[16:19], s53 offen lds
  s_mov_b32 m0, 37888
  s_add_u32 s53, s45, 3719168
  buffer_load_dwordx4 v153, s[16:19], s53 offen lds
  s_mov_b32 m0, 38912
  s_add_u32 s53, s45, 3751936
  buffer_load_dwordx4 v152, s[16:19], s53 offen lds
  s_mov_b32 m0, 39936
  s_add_u32 s53, s45, 3784704
  buffer_load_dwordx4 v153, s[16:19], s53 offen lds
  ds_read_b64_tr_b16 a[176:177], v156 offset:4096
  ds_read_b64_tr_b16 a[178:179], v156 offset:40960
  ds_read_b64_tr_b16 a[180:181], v158 offset:4096
  ds_read_b64_tr_b16 a[182:183], v158 offset:40960
  ds_read_b64_tr_b16 a[184:185], v157 offset:4096
  ds_read_b64_tr_b16 a[186:187], v157 offset:40960
  ds_read_b64_tr_b16 a[188:189], v159 offset:4096
  ds_read_b64_tr_b16 a[190:191], v159 offset:40960
  s_waitcnt vmcnt(12)
  s_waitcnt lgkmcnt(0)
  s_barrier
  s_mov_b32 m0, 40960
  s_add_u32 s53, s46, 2048
  buffer_load_dwordx4 v154, s[20:23], s53 offen lds
  s_mov_b32 m0, 41984
  s_add_u32 s53, s46, 18432
  buffer_load_dwordx4 v155, s[20:23], s53 offen lds
  s_mov_b32 m0, 43008
  s_add_u32 s53, s46, 6144
  buffer_load_dwordx4 v154, s[20:23], s53 offen lds
  s_mov_b32 m0, 44032
  s_add_u32 s53, s46, 22528
  buffer_load_dwordx4 v155, s[20:23], s53 offen lds
  ds_read_b64_tr_b16 a[192:193], v156 offset:8192
  ds_read_b64_tr_b16 a[194:195], v156 offset:45056
  ds_read_b64_tr_b16 a[196:197], v158 offset:8192
  ds_read_b64_tr_b16 a[198:199], v158 offset:45056
  ds_read_b64_tr_b16 a[200:201], v157 offset:8192
  ds_read_b64_tr_b16 a[202:203], v157 offset:45056
  ds_read_b64_tr_b16 a[204:205], v159 offset:8192
  ds_read_b64_tr_b16 a[206:207], v159 offset:45056
  s_waitcnt vmcnt(12)
  s_waitcnt lgkmcnt(0)
  s_barrier
  s_mov_b32 m0, 45056
  s_add_u32 s53, s46, 34816
  buffer_load_dwordx4 v154, s[20:23], s53 offen lds
  s_mov_b32 m0, 46080
  s_add_u32 s53, s46, 51200
  buffer_load_dwordx4 v155, s[20:23], s53 offen lds
  s_mov_b32 m0, 47104
  s_add_u32 s53, s46, 38912
  buffer_load_dwordx4 v154, s[20:23], s53 offen lds
  s_mov_b32 m0, 48128
  s_add_u32 s53, s46, 55296
  buffer_load_dwordx4 v155, s[20:23], s53 offen lds
  ds_read_b64_tr_b16 a[208:209], v156 offset:12288
  ds_read_b64_tr_b16 a[210:211], v156 offset:49152
  ds_read_b64_tr_b16 a[212:213], v158 offset:12288
  ds_read_b64_tr_b16 a[214:215], v158 offset:49152
  ds_read_b64_tr_b16 a[216:217], v157 offset:12288
  ds_read_b64_tr_b16 a[218:219], v157 offset:49152
  ds_read_b64_tr_b16 a[220:221], v159 offset:12288
  ds_read_b64_tr_b16 a[222:223], v159 offset:49152
  s_waitcnt vmcnt(12)
  s_waitcnt lgkmcnt(0)
  s_barrier
  s_mov_b32 m0, 49152
  s_add_u32 s53, s46, 67584
  buffer_load_dwordx4 v154, s[20:23], s53 offen lds
  s_mov_b32 m0, 50176
  s_add_u32 s53, s46, 83968
  buffer_load_dwordx4 v155, s[20:23], s53 offen lds
  s_mov_b32 m0, 51200
  s_add_u32 s53, s46, 71680
  buffer_load_dwordx4 v154, s[20:23], s53 offen lds
  s_mov_b32 m0, 52224
  s_add_u32 s53, s46, 88064
  buffer_load_dwordx4 v155, s[20:23], s53 offen lds
  ds_read_b64_tr_b16 a[224:225], v156 offset:16384
  ds_read_b64_tr_b16 a[226:227], v156 offset:53248
  ds_read_b64_tr_b16 a[228:229], v158 offset:16384
  ds_read_b64_tr_b16 a[230:231], v158 offset:53248
  ds_read_b64_tr_b16 a[232:233], v157 offset:16384
  ds_read_b64_tr_b16 a[234:235], v157 offset:53248
  ds_read_b64_tr_b16 a[236:237], v159 offset:16384
  ds_read_b64_tr_b16 a[238:239], v159 offset:53248
  buffer_load_dword v163, off, s[28:31], 0 offset:36 sc1
  buffer_load_dword v164, off, s[28:31], 0 offset:4 sc1
  s_waitcnt vmcnt(14)
  s_waitcnt lgkmcnt(0)
  s_barrier
  s_mov_b32 m0, 53248
  s_add_u32 s53, s46, 100352
  buffer_load_dwordx4 v154, s[20:23], s53 offen lds
  s_mov_b32 m0, 54272
  s_add_u32 s53, s46, 116736
  buffer_load_dwordx4 v155, s[20:23], s53 offen lds
  s_mov_b32 m0, 55296
  s_add_u32 s53, s46, 104448
  buffer_load_dwordx4 v154, s[20:23], s53 offen lds
  s_mov_b32 m0, 56320
  s_add_u32 s53, s46, 120832
  buffer_load_dwordx4 v155, s[20:23], s53 offen lds
  ds_read_b64_tr_b16 a[240:241], v156 offset:0
  ds_read_b64_tr_b16 a[242:243], v156 offset:36864
  ds_read_b64_tr_b16 a[244:245], v158 offset:0
  ds_read_b64_tr_b16 a[246:247], v158 offset:36864
  ds_read_b64_tr_b16 a[248:249], v157 offset:0
  ds_read_b64_tr_b16 a[250:251], v157 offset:36864
  ds_read_b64_tr_b16 a[252:253], v159 offset:0
  ds_read_b64_tr_b16 a[254:255], v159 offset:36864
  s_waitcnt vmcnt(14)
  s_waitcnt lgkmcnt(0)
  s_barrier
  s_mov_b32 m0, 36864
  s_add_u32 s53, s45, 16384
  buffer_load_dwordx4 v152, s[8:11], s53 offen lds
  s_mov_b32 m0, 37888
  s_add_u32 s53, s45, 49152
  buffer_load_dwordx4 v153, s[8:11], s53 offen lds
  s_mov_b32 m0, 38912
  s_add_u32 s53, s45, 81920
  buffer_load_dwordx4 v152, s[8:11], s53 offen lds
  s_mov_b32 m0, 39936
  s_add_u32 s53, s45, 114688
  buffer_load_dwordx4 v153, s[8:11], s53 offen lds
  ds_read_b64_tr_b16 v[96:97], v160 offset:4096
  ds_read_b64_tr_b16 v[98:99], v160 offset:40960
  ds_read_b64_tr_b16 v[100:101], v161 offset:4096
  ds_read_b64_tr_b16 v[102:103], v161 offset:40960
  ds_read_b64_tr_b16 v[104:105], v160 offset:4352
  ds_read_b64_tr_b16 v[106:107], v160 offset:41216
  ds_read_b64_tr_b16 v[108:109], v161 offset:4352
  ds_read_b64_tr_b16 v[110:111], v161 offset:41216
  s_waitcnt vmcnt(14)
  s_waitcnt lgkmcnt(0)
  s_barrier
  s_mov_b32 m0, 40960
  s_add_u32 s53, s45, 540672
  buffer_load_dwordx4 v152, s[8:11], s53 offen lds
  s_mov_b32 m0, 41984
  s_add_u32 s53, s45, 573440
  buffer_load_dwordx4 v153, s[8:11], s53 offen lds
  s_mov_b32 m0, 43008
  s_add_u32 s53, s45, 606208
  buffer_load_dwordx4 v152, s[8:11], s53 offen lds
  s_mov_b32 m0, 44032
  s_add_u32 s53, s45, 638976
  buffer_load_dwordx4 v153, s[8:11], s53 offen lds
  ds_read_b64_tr_b16 v[32:33], v160 offset:8192
  ds_read_b64_tr_b16 v[34:35], v160 offset:45056
  ds_read_b64_tr_b16 v[36:37], v161 offset:8192
  ds_read_b64_tr_b16 v[38:39], v161 offset:45056
  ds_read_b64_tr_b16 v[40:41], v160 offset:8448
  ds_read_b64_tr_b16 v[42:43], v160 offset:45312
  ds_read_b64_tr_b16 v[44:45], v161 offset:8448
  ds_read_b64_tr_b16 v[46:47], v161 offset:45312
  s_waitcnt vmcnt(14)
  s_waitcnt lgkmcnt(0)
  s_barrier
  s_mov_b32 m0, 45056
  s_add_u32 s53, s45, 1064960
  buffer_load_dwordx4 v152, s[8:11], s53 offen lds
  s_mov_b32 m0, 46080
  s_add_u32 s53, s45, 1097728
  buffer_load_dwordx4 v153, s[8:11], s53 offen lds
  s_mov_b32 m0, 47104
  s_add_u32 s53, s45, 1130496
  buffer_load_dwordx4 v152, s[8:11], s53 offen lds
  s_mov_b32 m0, 48128
  s_add_u32 s53, s45, 1163264
  buffer_load_dwordx4 v153, s[8:11], s53 offen lds
  ds_read_b64_tr_b16 v[64:65], v160 offset:12288
  ds_read_b64_tr_b16 v[66:67], v160 offset:49152
  ds_read_b64_tr_b16 v[68:69], v161 offset:12288
  ds_read_b64_tr_b16 v[70:71], v161 offset:49152
  ds_read_b64_tr_b16 v[72:73], v160 offset:12544
  ds_read_b64_tr_b16 v[74:75], v160 offset:49408
  ds_read_b64_tr_b16 v[76:77], v161 offset:12544
  ds_read_b64_tr_b16 v[78:79], v161 offset:49408
  s_waitcnt vmcnt(12)
  s_waitcnt lgkmcnt(0)
  s_barrier
  s_mov_b32 m0, 49152
  s_add_u32 s53, s45, 1589248
  buffer_load_dwordx4 v152, s[8:11], s53 offen lds
  s_mov_b32 m0, 50176
  s_add_u32 s53, s45, 1622016
  buffer_load_dwordx4 v153, s[8:11], s53 offen lds
  s_mov_b32 m0, 51200
  s_add_u32 s53, s45, 1654784
  buffer_load_dwordx4 v152, s[8:11], s53 offen lds
  s_mov_b32 m0, 52224
  s_add_u32 s53, s45, 1687552
  buffer_load_dwordx4 v153, s[8:11], s53 offen lds
  ds_read_b64_tr_b16 v[80:81], v160 offset:16384
  ds_read_b64_tr_b16 v[82:83], v160 offset:53248
  ds_read_b64_tr_b16 v[84:85], v161 offset:16384
  ds_read_b64_tr_b16 v[86:87], v161 offset:53248
  ds_read_b64_tr_b16 v[88:89], v160 offset:16640
  ds_read_b64_tr_b16 v[90:91], v160 offset:53504
  ds_read_b64_tr_b16 v[92:93], v161 offset:16640
  ds_read_b64_tr_b16 v[94:95], v161 offset:53504
  s_waitcnt vmcnt(12)
  s_waitcnt lgkmcnt(0)
  s_barrier
  s_mov_b32 m0, 53248
  s_add_u32 s53, s45, 2113536
  buffer_load_dwordx4 v152, s[8:11], s53 offen lds
  s_mov_b32 m0, 54272
  s_add_u32 s53, s45, 2146304
  buffer_load_dwordx4 v153, s[8:11], s53 offen lds
  s_mov_b32 m0, 55296
  s_add_u32 s53, s45, 2179072
  buffer_load_dwordx4 v152, s[8:11], s53 offen lds
  s_mov_b32 m0, 56320
  s_add_u32 s53, s45, 2211840
  buffer_load_dwordx4 v153, s[8:11], s53 offen lds
  ds_read_b64_tr_b16 a[64:65], v156 offset:0
  ds_read_b64_tr_b16 a[66:67], v156 offset:36864
  ds_read_b64_tr_b16 a[68:69], v158 offset:0
  ds_read_b64_tr_b16 a[70:71], v158 offset:36864
  ds_read_b64_tr_b16 a[72:73], v157 offset:0
  ds_read_b64_tr_b16 a[74:75], v157 offset:36864
  ds_read_b64_tr_b16 a[76:77], v159 offset:0
  ds_read_b64_tr_b16 a[78:79], v159 offset:36864
  v_readfirstlane_b32 s52, v163
  v_readfirstlane_b32 s53, v164
  s_lshl_b32 s58, s47, 29
  s_lshl_b32 s52, s52, 5
  s_or_b32 s52, s52, s58
  s_or_b32 s58, s58, 32
  s_and_b32 s52, s52, s53
  s_cmp_eq_u32 s52, s58
  s_cbranch_scc1 c_fl_301
c_wd_302:
  buffer_load_dword v236, off, s[28:31], 0 offset:36 sc1
  s_waitcnt vmcnt(0)
  v_readfirstlane_b32 s53, v236
  s_cmp_ge_u32 s53, 1
  s_cbranch_scc1 c_wdd_303
  s_cmp_eq_u32 s35, 0
  s_cbranch_scc1 c_wdd_303
  s_sub_u32 s35, s35, 1
  s_sleep 2
  s_branch c_wd_302
c_wdd_303:
c_wd_304:
  buffer_load_dword v236, off, s[28:31], 0 offset:4 sc1
  s_waitcnt vmcnt(0)
  v_readfirstlane_b32 s53, v236
  s_and_b32 s52, s53, s58
  s_cmp_eq_u32 s52, s58
  s_cbranch_scc1 c_wdd_305
  s_cmp_eq_u32 s35, 0
  s_cbranch_scc1 c_wdd_305
  s_sub_u32 s35, s35, 1
  s_sleep 2
  s_branch c_wd_304
c_wdd_305:
c_fl_301:
  s_bfe_u32 s34, s53, 0x80010
  s_waitcnt vmcnt(12)
  s_waitcnt lgkmcnt(0)
  s_barrier
  s_mov_b32 m0, 36864
  s_add_u32 s53, s45, 2637824
  buffer_load_dwordx4 v152, s[8:11], s53 offen lds
  s_mov_b32 m0, 37888
  s_add_u32 s53, s45, 2670592
  buffer_load_dwordx4 v153, s[8:11], s53 offen lds
  s_mov_b32 m0, 38912
  s_add_u32 s53, s45, 2703360
  buffer_load_dwordx4 v152, s[8:11], s53 offen lds
  s_mov_b32 m0, 39936
  s_add_u32 s53, s45, 2736128
  buffer_load_dwordx4 v153, s[8:11], s53 offen lds
  ds_read_b64_tr_b16 a[80:81], v156 offset:4096
  ds_read_b64_tr_b16 a[82:83], v156 offset:40960
  ds_read_b64_tr_b16 a[84:85], v158 offset:4096
  ds_read_b64_tr_b16 a[86:87], v158 offset:40960
  ds_read_b64_tr_b16 a[88:89], v157 offset:4096
  ds_read_b64_tr_b16 a[90:91], v157 offset:40960
  ds_read_b64_tr_b16 a[92:93], v159 offset:4096
  ds_read_b64_tr_b16 a[94:95], v159 offset:40960
  s_waitcnt vmcnt(12)
  s_waitcnt lgkmcnt(0)
  s_barrier
  s_mov_b32 m0, 40960
  s_add_u32 s53, s45, 3162112
  buffer_load_dwordx4 v152, s[8:11], s53 offen lds
  s_mov_b32 m0, 41984
  s_add_u32 s53, s45, 3194880
  buffer_load_dwordx4 v153, s[8:11], s53 offen lds
  s_mov_b32 m0, 43008
  s_add_u32 s53, s45, 3227648
  buffer_load_dwordx4 v152, s[8:11], s53 offen lds
  s_mov_b32 m0, 44032
  s_add_u32 s53, s45, 3260416
  buffer_load_dwordx4 v153, s[8:11], s53 offen lds
  ds_read_b64_tr_b16 v[184:185], v156 offset:8192
  ds_read_b64_tr_b16 v[186:187], v156 offset:45056
  ds_read_b64_tr_b16 v[188:189], v158 offset:8192
  ds_read_b64_tr_b16 v[190:191], v158 offset:45056
  ds_read_b64_tr_b16 v[192:193], v157 offset:8192
  ds_read_b64_tr_b16 v[194:195], v157 offset:45056
  ds_read_b64_tr_b16 v[196:197], v159 offset:8192
  ds_read_b64_tr_b16 v[198:199], v159 offset:45056
  s_waitcnt vmcnt(12)
  s_waitcnt lgkmcnt(0)
  s_barrier
  s_mov_b32 m0, 45056
  s_add_u32 s53, s45, 3686400
  buffer_load_dwordx4 v152, s[8:11], s53 offen lds
  s_mov_b32 m0, 46080
  s_add_u32 s53, s45, 3719168
  buffer_load_dwordx4 v153, s[8:11], s53 offen lds
  s_mov_b32 m0, 47104
  s_add_u32 s53, s45, 3751936
  buffer_load_dwordx4 v152, s[8:11], s53 offen lds
  s_mov_b32 m0, 48128
  s_add_u32 s53, s45, 3784704
  buffer_load_dwordx4 v153, s[8:11], s53 offen lds
  ds_read_b64_tr_b16 v[216:217], v156 offset:12288
  ds_read_b64_tr_b16 v[218:219], v156 offset:49152
  ds_read_b64_tr_b16 v[220:221], v158 offset:12288
  ds_read_b64_tr_b16 v[222:223], v158 offset:49152
  ds_read_b64_tr_b16 v[224:225], v157 offset:12288
  ds_read_b64_tr_b16 v[226:227], v157 offset:49152
  ds_read_b64_tr_b16 v[228:229], v159 offset:12288
  ds_read_b64_tr_b16 v[230:231], v159 offset:49152
  s_waitcnt vmcnt(12)
  s_waitcnt lgkmcnt(0)
  s_barrier
  s_mov_b32 m0, 49152
  s_add_u32 s53, s46, 2560
  buffer_load_dwordx4 v154, s[20:23], s53 offen lds
  s_mov_b32 m0, 50176
  s_add_u32 s53, s46, 18944
  buffer_load_dwordx4 v155, s[20:23], s53 offen lds
  s_mov_b32 m0, 51200
  s_add_u32 s53, s46, 6656
  buffer_load_dwordx4 v154, s[20:23], s53 offen lds
  s_mov_b32 m0, 52224
  s_add_u32 s53, s46, 23040
  buffer_load_dwordx4 v155, s[20:23], s53 offen lds
  ds_read_b64_tr_b16 a[0:1], v156 offset:16384
  ds_read_b64_tr_b16 a[2:3], v156 offset:53248
  ds_read_b64_tr_b16 a[4:5], v158 offset:16384
  ds_read_b64_tr_b16 a[6:7], v158 offset:53248
  ds_read_b64_tr_b16 a[8:9], v157 offset:16384
  ds_read_b64_tr_b16 a[10:11], v157 offset:53248
  ds_read_b64_tr_b16 a[12:13], v159 offset:16384
  ds_read_b64_tr_b16 a[14:15], v159 offset:53248
  s_waitcnt vmcnt(12)
  s_waitcnt lgkmcnt(0)
  s_barrier
  s_mov_b32 m0, 53248
  s_add_u32 s53, s46, 35328
  buffer_load_dwordx4 v154, s[20:23], s53 offen lds
  s_mov_b32 m0, 54272
  s_add_u32 s53, s46, 51712
  buffer_load_dwordx4 v155, s[20:23], s53 offen lds
  s_mov_b32 m0, 55296
  s_add_u32 s53, s46, 39424
  buffer_load_dwordx4 v154, s[20:23], s53 offen lds
  s_mov_b32 m0, 56320
  s_add_u32 s53, s46, 55808
  buffer_load_dwordx4 v155, s[20:23], s53 offen lds
  ds_read_b64_tr_b16 a[16:17], v156 offset:0
  ds_read_b64_tr_b16 a[18:19], v156 offset:36864
  ds_read_b64_tr_b16 a[20:21], v158 offset:0
  ds_read_b64_tr_b16 a[22:23], v158 offset:36864
  ds_read_b64_tr_b16 a[24:25], v157 offset:0
  ds_read_b64_tr_b16 a[26:27], v157 offset:36864
  ds_read_b64_tr_b16 a[28:29], v159 offset:0
  ds_read_b64_tr_b16 a[30:31], v159 offset:36864
  s_waitcnt vmcnt(12)
  s_waitcnt lgkmcnt(0)
  s_barrier
  s_mov_b32 m0, 36864
  s_add_u32 s53, s46, 68096
  buffer_load_dwordx4 v154, s[20:23], s53 offen lds
  s_mov_b32 m0, 37888
  s_add_u32 s53, s46, 84480
  buffer_load_dwordx4 v155, s[20:23], s53 offen lds
  s_mov_b32 m0, 38912
  s_add_u32 s53, s46, 72192
  buffer_load_dwordx4 v154, s[20:23], s53 offen lds
  s_mov_b32 m0, 39936
  s_add_u32 s53, s46, 88576
  buffer_load_dwordx4 v155, s[20:23], s53 offen lds
  ds_read_b64_tr_b16 a[32:33], v156 offset:4096
  ds_read_b64_tr_b16 a[34:35], v156 offset:40960
  ds_read_b64_tr_b16 a[36:37], v158 offset:4096
  ds_read_b64_tr_b16 a[38:39], v158 offset:40960
  ds_read_b64_tr_b16 a[40:41], v157 offset:4096
  ds_read_b64_tr_b16 a[42:43], v157 offset:40960
  ds_read_b64_tr_b16 a[44:45], v159 offset:4096
  ds_read_b64_tr_b16 a[46:47], v159 offset:40960
  s_waitcnt vmcnt(12)
  s_waitcnt lgkmcnt(0)
  s_barrier
  s_mov_b32 m0, 40960
  s_add_u32 s53, s46, 100864
  buffer_load_dwordx4 v154, s[20:23], s53 offen lds
  s_mov_b32 m0, 41984
  s_add_u32 s53, s46, 117248
  buffer_load_dwordx4 v155, s[20:23], s53 offen lds
  s_mov_b32 m0, 43008
  s_add_u32 s53, s46, 104960
  buffer_load_dwordx4 v154, s[20:23], s53 offen lds
  s_mov_b32 m0, 44032
  s_add_u32 s53, s46, 121344
  buffer_load_dwordx4 v155, s[20:23], s53 offen lds
  ds_read_b64_tr_b16 a[48:49], v156 offset:8192
  ds_read_b64_tr_b16 a[50:51], v156 offset:45056
  ds_read_b64_tr_b16 a[52:53], v158 offset:8192
  ds_read_b64_tr_b16 a[54:55], v158 offset:45056
  ds_read_b64_tr_b16 a[56:57], v157 offset:8192
  ds_read_b64_tr_b16 a[58:59], v157 offset:45056
  ds_read_b64_tr_b16 a[60:61], v159 offset:8192
  ds_read_b64_tr_b16 a[62:63], v159 offset:45056
  s_add_u32 s52, s51, 2048
  buffer_load_dword v165, off, s[4:7], s51 sc1
  buffer_load_dword v166, off, s[4:7], s52 sc1
  s_waitcnt vmcnt(14)
  s_waitcnt lgkmcnt(0)
  s_barrier
  ds_read_b64_tr_b16 v[136:137], v160 offset:12288
  ds_read_b64_tr_b16 v[138:139], v160 offset:49152
  ds_read_b64_tr_b16 v[140:141], v161 offset:12288
  ds_read_b64_tr_b16 v[142:143], v161 offset:49152
  ds_read_b64_tr_b16 v[144:145], v160 offset:12544
  ds_read_b64_tr_b16 v[146:147], v160 offset:49408
  ds_read_b64_tr_b16 v[148:149], v161 offset:12544
  ds_read_b64_tr_b16 v[150:151], v161 offset:49408
  ds_write_b128 v252, v[184:187] offset:8192
  ds_write_b128 v252, v[188:191] offset:9216
  ds_write_b128 v252, v[192:195] offset:10240
  ds_write_b128 v252, v[196:199] offset:11264
  s_waitcnt vmcnt(10)
  s_waitcnt lgkmcnt(0)
  s_barrier
  ds_read_b64_tr_b16 v[48:49], v160 offset:16384
  ds_read_b64_tr_b16 v[50:51], v160 offset:53248
  ds_read_b64_tr_b16 v[52:53], v161 offset:16384
  ds_read_b64_tr_b16 v[54:55], v161 offset:53248
  ds_read_b64_tr_b16 v[56:57], v160 offset:16640
  ds_read_b64_tr_b16 v[58:59], v160 offset:53504
  ds_read_b64_tr_b16 v[60:61], v161 offset:16640
  ds_read_b64_tr_b16 v[62:63], v161 offset:53504
  ds_write_b128 v252, v[216:219] offset:12288
  ds_write_b128 v252, v[220:223] offset:13312
  ds_write_b128 v252, v[224:227] offset:14336
  ds_write_b128 v252, v[228:231] offset:15360
  s_waitcnt vmcnt(6)
  s_waitcnt lgkmcnt(0)
  s_barrier
  ds_read_b64_tr_b16 v[200:201], v160 offset:0
  ds_read_b64_tr_b16 v[202:203], v160 offset:36864
  ds_read_b64_tr_b16 v[204:205], v161 offset:0
  ds_read_b64_tr_b16 v[206:207], v161 offset:36864
  ds_read_b64_tr_b16 v[208:209], v160 offset:256
  ds_read_b64_tr_b16 v[210:211], v160 offset:37120
  ds_read_b64_tr_b16 v[212:213], v161 offset:256
  ds_read_b64_tr_b16 v[214:215], v161 offset:37120
  ds_write_b128 v252, v[136:139] offset:16384
  ds_write_b128 v252, v[140:143] offset:17408
  ds_write_b128 v252, v[144:147] offset:18432
  ds_write_b128 v252, v[148:151] offset:19456
  s_waitcnt vmcnt(2)
  s_waitcnt lgkmcnt(0)
  s_barrier
  ds_read_b64_tr_b16 v[120:121], v160 offset:4096
  ds_read_b64_tr_b16 v[122:123], v160 offset:40960
  ds_read_b64_tr_b16 v[124:125], v161 offset:4096
  ds_read_b64_tr_b16 v[126:127], v161 offset:40960
  ds_read_b64_tr_b16 v[128:129], v160 offset:4352
  ds_read_b64_tr_b16 v[130:131], v160 offset:41216
  ds_read_b64_tr_b16 v[132:133], v161 offset:4352
  ds_read_b64_tr_b16 v[134:135], v161 offset:41216
  ds_write_b128 v252, v[200:203] offset:0
  ds_write_b128 v252, v[204:207] offset:1024
  ds_write_b128 v252, v[208:211] offset:2048
  ds_write_b128 v252, v[212:215] offset:3072
  s_mov_b32 m0, 159744
  s_waitcnt vmcnt(0)
  v_min_u32 v165, v165, v166
  s_cmp_lg_u32 s3, 0
  s_cselect_b32 s58, 0, 2
  v_readfirstlane_b32 s59, v165
  s_cmp_ge_u32 s59, s58
  s_cbranch_scc1 c_rdy_306
  s_xor_b32 s51, s51, 6144
c_sp_307:
  buffer_load_dword v236, off, s[4:7], s51 sc1
  s_waitcnt vmcnt(0)
  v_readfirstlane_b32 s59, v236
  s_cmp_ge_u32 s59, s58
  s_cbranch_scc1 c_spd_308
  s_cmp_eq_u32 s35, 0
  s_cbranch_scc1 c_spd_308
  s_sub_u32 s35, s35, 1
  s_sleep 2
  s_branch c_sp_307
c_spd_308:
  s_xor_b32 s51, s51, 6144
c_sp_309:
  buffer_load_dword v236, off, s[4:7], s51 sc1
  s_waitcnt vmcnt(0)
  v_readfirstlane_b32 s59, v236
  s_cmp_ge_u32 s59, s58
  s_cbranch_scc1 c_spd_310
  s_cmp_eq_u32 s35, 0
  s_cbranch_scc1 c_spd_310
  s_sub_u32 s35, s35, 1
  s_sleep 2
  s_branch c_sp_309
c_spd_310:
c_rdy_306:
  buffer_load_dwordx4 v[168:171], v253, s[4:7], s41 offen sc1
  buffer_load_dwordx4 v[172:175], v253, s[4:7], s41 offen offset:1024 sc1
  s_add_u32 s41, s41, 262144
  v_mov_b32 v233, v167
  s_and_b32 s52, s36, 31
  s_lshl_b32 s52, s52, 1
  s_lshl_b64 s[24:25], 3, s52
  s_mov_b32 s26, 0x000f000f
  s_mov_b32 s27, 0x000f000f
  s_waitcnt lgkmcnt(0)
  s_barrier
  ds_write_b128 v252, v[120:123] offset:4096
  ds_write_b128 v252, v[124:127] offset:5120
  ds_write_b128 v252, v[128:131] offset:6144
  ds_write_b128 v252, v[132:135] offset:7168
  s_waitcnt lgkmcnt(0)
  ds_read_b128 v[200:203], v252 offset:20480
  ds_read_b128 v[204:207], v252 offset:21504
  ds_read_b128 v[208:211], v252 offset:22528
  ds_read_b128 v[212:215], v252 offset:23552
  v_mov_b64 v[144:145], 0
  v_mov_b64 v[146:147], 0
  s_nop 0
  v_mov_b64 v[148:149], 0
  v_mov_b64 v[150:151], 0
  s_nop 0
  v_mov_b64 v[152:153], 0
  v_mov_b64 v[154:155], 0
  s_nop 0
  v_mov_b64 v[156:157], 0
  v_mov_b64 v[158:159], 0
  s_nop 0
  v_mov_b64 v[160:161], 0
  v_mov_b64 v[162:163], 0
  s_nop 0
  v_mov_b64 v[164:165], 0
  v_mov_b64 v[166:167], 0
  s_nop 0
  s_waitcnt lgkmcnt(0)
  s_cmp_lg_u32 s34, 0
  s_cbranch_scc1 c_entry_1_1
  s_branch c_entry_0_1
c_pro_2:
  s_min_u32 s47, s3, 1
  s_cmp_lg_u32 s3, 0
  s_cselect_b32 s36, s2, s32
  s_cselect_b32 s57, 0, 63
  s_cselect_b32 s37, 0, 0
  s_load_dwordx4 s[8:11], s[0:1], 8
  s_load_dwordx4 s[12:15], s[0:1], 24
  s_load_dwordx2 s[20:21], s[0:1], 40
  s_waitcnt lgkmcnt(0)
  s_mov_b32 s24, s8
  s_mov_b32 s25, s9
  s_mov_b32 s26, 8192
  s_mov_b32 s27, 0x20000
  s_mov_b32 s8, s10
  s_mov_b32 s9, s11
  s_mov_b32 s10, 0x400000
  s_mov_b32 s11, 0x20000
  s_mov_b32 s16, s14
  s_mov_b32 s17, s15
  s_mov_b32 s18, 0x400000
  s_mov_b32 s19, 0x20000
  s_mov_b32 s14, 0x400000
  s_mov_b32 s15, 0x20000
  s_mov_b32 s22, 0x400000
  s_mov_b32 s23, 0x20000
  v_and_b32 v232, 63, v0
  v_and_b32 v233, 15, v232
  v_lshrrev_b32 v234, 4, v232
  v_and_b32 v236, 1, v234
  v_lshrrev_b32 v237, 1, v234
  v_lshl_add_u32 v236, v237, 5, v236
  v_lshlrev_b32 v236, 13, v236
  v_lshlrev_b32 v238, 1, v234
  v_xor_b32 v238, v238, v233
  v_lshl_add_u32 v152, v238, 4, v236
  v_xor_b32 v153, 128, v152
  s_lshl_b32 s45, s36, 8
  s_lshl_b32 s46, s36, 17
  s_mov_b32 m0, 73728
  s_add_u32 s53, s45, 131072
  buffer_load_dwordx4 v152, s[12:15], s53 offen lds
  s_mov_b32 m0, 74752
  s_add_u32 s53, s45, 163840
  buffer_load_dwordx4 v153, s[12:15], s53 offen lds
  s_mov_b32 m0, 75776
  s_add_u32 s53, s45, 196608
  buffer_load_dwordx4 v152, s[12:15], s53 offen lds
  s_mov_b32 m0, 76800
  s_add_u32 s53, s45, 229376
  buffer_load_dwordx4 v153, s[12:15], s53 offen lds
  s_mov_b32 m0, 77824
  s_add_u32 s53, s45, 655360
  buffer_load_dwordx4 v152, s[12:15], s53 offen lds
  s_mov_b32 m0, 78848
  s_add_u32 s53, s45, 688128
  buffer_load_dwordx4 v153, s[12:15], s53 offen lds
  s_mov_b32 m0, 79872
  s_add_u32 s53, s45, 720896
  buffer_load_dwordx4 v152, s[12:15], s53 offen lds
  s_mov_b32 m0, 80896
  s_add_u32 s53, s45, 753664
  buffer_load_dwordx4 v153, s[12:15], s53 offen lds
  s_mov_b32 m0, 81920
  s_add_u32 s53, s45, 1179648
  buffer_load_dwordx4 v152, s[12:15], s53 offen lds
  s_mov_b32 m0, 82944
  s_add_u32 s53, s45, 1212416
  buffer_load_dwordx4 v153, s[12:15], s53 offen lds
  s_mov_b32 m0, 83968
  s_add_u32 s53, s45, 1245184
  buffer_load_dwordx4 v152, s[12:15], s53 offen lds
  s_mov_b32 m0, 84992
  s_add_u32 s53, s45, 1277952
  buffer_load_dwordx4 v153, s[12:15], s53 offen lds
  s_mov_b32 m0, 86016
  s_add_u32 s53, s45, 1703936
  buffer_load_dwordx4 v152, s[12:15], s53 offen lds
  s_mov_b32 m0, 87040
  s_add_u32 s53, s45, 1736704
  buffer_load_dwordx4 v153, s[12:15], s53 offen lds
  s_mov_b32 m0, 88064
  s_add_u32 s53, s45, 1769472
  buffer_load_dwordx4 v152, s[12:15], s53 offen lds
  s_mov_b32 m0, 89088
  s_add_u32 s53, s45, 1802240
  buffer_load_dwordx4 v153, s[12:15], s53 offen lds
  v_and_b32 v236, 31, v232
  v_lshlrev_b32 v238, 2, v237
  v_xor_b32 v236, v236, v238
  v_lshlrev_b32 v236, 4, v236
  v_lshl_add_u32 v154, v237, 10, v236
  v_xor_b32 v155, 128, v154
  s_mov_b32 s52, 73728
  v_lshrrev_b32 v236, 2, v232
  v_and_b32 v238, 7, v236
  v_xor_b32 v238, 4, v238
  v_lshlrev_b32 v236, 8, v236
  v_lshl_add_u32 v236, v238, 5, v236
  v_and_b32 v237, 3, v232
  v_lshl_add_u32 v156, v237, 3, v236
  v_xor_b32 v157, 32, v156
  v_add_u32 v158, 73728, v156
  v_add_u32 v159, 73728, v157
  v_bfe_u32 v236, v232, 2, 1
  v_lshl_add_u32 v236, v234, 1, v236
  v_and_b32 v238, 3, v236
  v_xor_b32 v238, 2, v238
  v_lshlrev_b32 v236, 9, v236
  v_lshl_add_u32 v236, v238, 6, v236
  v_lshl_add_u32 v236, v237, 4, v236
  v_bfe_u32 v237, v232, 3, 1
  v_lshl_add_u32 v160, v237, 3, v236
  v_add_u32 v161, 73728, v160
  v_bfe_u32 v235, v232, 1, 1
  v_bfe_u32 v239, v232, 2, 2
  v_lshlrev_b32 v236, 4, v232
  v_add_u32 v252, s52, v236
  v_add_u32 v253, 147456, v236
  v_lshl_add_u32 v254, v235, 10, v253
  v_lshrrev_b32 v236, 3, v232
  s_lshl1_add_u32 s53, s33, s36
  v_lshl_add_u32 v237, v236, 2, s53
  v_and_b32 v237, 31, v237
  v_lshlrev_b32 v236, 13, v236
  v_lshl_add_u32 v236, v237, 6, v236
  v_and_b32 v237, 7, v232
  v_lshl_add_u32 v255, v237, 3, v236
  v_mul_u32_u24 v240, 0xAAAA, v235
  v_add_u32 v240, 0x4444, v240
  v_mov_b32 v246, 0x3F003F00
  v_mov_b32 v247, 0x3F003F00
  v_and_b32 v236, 1, v232
  v_lshlrev_b32 v236, 4, v236
  v_cmp_eq_u32 vcc, v234, v239
  v_mov_b32 v237, 0x3e89
  v_lshlrev_b32 v237, v236, v237
  v_cndmask_b32 v242, 0, v237, vcc
  v_mov_b32 v243, v242
  v_mov_b32 v237, 0x3ef4
  v_lshlrev_b32 v237, v236, v237
  v_cndmask_b32 v244, 0, v237, vcc
  v_mov_b32 v245, v244
  v_bfe_u32 v236, v232, 2, 1
  v_lshlrev_b32 v236, 4, v236
  v_mov_b32 v237, 0x3F80
  v_lshlrev_b32 v237, v236, v237
  v_bfe_u32 v238, v232, 3, 1
  v_and_b32 v236, 1, v232
  v_lshl_add_u32 v238, v236, 1, v238
  v_cmp_eq_u32 vcc, 0, v238
  s_nop 1
  v_cndmask_b32 v248, 0, v237, vcc
  v_cmp_eq_u32 vcc, 1, v238
  s_nop 1
  v_cndmask_b32 v249, 0, v237, vcc
  v_cmp_eq_u32 vcc, 2, v238
  s_nop 1
  v_cndmask_b32 v250, 0, v237, vcc
  v_cmp_eq_u32 vcc, 3, v238
  s_nop 1
  v_cndmask_b32 v251, 0, v237, vcc
  v_lshlrev_b32 v236, 2, v236
  v_and_b32 v237, 0, v239
  v_mul_u32_u24 v237, 1050624, v237
  v_add_u32 v236, v237, v236
  v_lshrrev_b32 v237, 0, v239
  v_lshl_add_u32 v236, v237, 28, v236
  v_lshl_add_u32 v236, v235, 8, v236
  v_and_b32 v237, 16, v232
  v_add_u32 v236, v237, v236
  v_bfe_u32 v237, v232, 5, 1
  v_lshl_add_u32 v241, v237, 3, v236
  v_and_b32 v236, 1, v232
  v_lshl_add_u32 v236, v239, 1, v236
  v_lshlrev_b32 v236, 10, v236
  v_lshl_add_u32 v236, v235, 6, v236
  v_lshl_add_u32 v162, v234, 4, v236
  v_mov_b32 v168, -1
  v_mov_b32 v169, -1
  v_mov_b32 v170, -1
  v_mov_b32 v171, -1
  s_lshl_b32 s52, s47, 5
  s_add_u32 s52, s52, s36
  s_lshl_b32 s52, s52, 13
  s_lshl_b32 s53, s33, 11
  s_add_u32 s52, s52, s53
  s_add_u32 s52, s52, 1949696
  buffer_store_dwordx4 v[168:171], v253, s[4:7], s52 offen offset:0 sc1
  buffer_store_dwordx4 v[168:171], v253, s[4:7], s52 offen offset:1024 sc1
  s_cmp_lg_u32 s3, 0
  s_cselect_b32 s52, 8, 13
  s_cselect_b32 s44, 17, 23
  s_lshl_b32 s44, 1, s44
  v_lshlrev_b32 v172, s52, v234
  v_lshl_add_u32 v172, v233, 4, v172
  s_lshl_b32 s52, s36, 8
  s_lshl_b32 s53, s33, 17
  s_add_u32 s52, s52, s53
  s_add_u32 s52, s52, 167772160
  s_cmp_lg_u32 s3, 0
  s_cselect_b32 s52, s3, s52
  buffer_store_dwordx4 v[168:171], v172, s[4:7], s52 offen sc1
  s_add_u32 s53, s52, s44
  buffer_store_dwordx4 v[168:171], v172, s[4:7], s53 offen sc1
  s_add_u32 s52, s52, 32768
  buffer_store_dwordx4 v[168:171], v172, s[4:7], s52 offen sc1
  s_add_u32 s53, s52, s44
  buffer_store_dwordx4 v[168:171], v172, s[4:7], s53 offen sc1
  s_add_u32 s52, s52, 32768
  buffer_store_dwordx4 v[168:171], v172, s[4:7], s52 offen sc1
  s_add_u32 s53, s52, s44
  buffer_store_dwordx4 v[168:171], v172, s[4:7], s53 offen sc1
  s_add_u32 s52, s52, 32768
  buffer_store_dwordx4 v[168:171], v172, s[4:7], s52 offen sc1
  s_add_u32 s53, s52, s44
  buffer_store_dwordx4 v[168:171], v172, s[4:7], s53 offen sc1
  s_add_u32 s52, s52, 32768
  s_lshl_b32 s52, s33, 11
  s_and_b32 s56, s36, 0
  s_mul_i32 s56, s56, 1050624
  s_add_u32 s38, s52, s56
  s_add_u32 s38, s38, 167624704
  s_lshr_b32 s53, s36, 4
  s_lshl_b32 s53, s53, 10
  s_add_u32 s53, s53, s52
  s_and_b32 s44, s36, 6
  s_lshl_b32 s44, s44, 5
  s_add_u32 s53, s53, s44
  s_and_b32 s44, s36, 8
  s_lshl2_add_u32 s53, s44, s53
  s_and_b32 s44, s36, 1
  s_lshl_b32 s44, s44, 9
  s_add_u32 s53, s53, s44
  s_add_u32 s49, s53, 167780352
  s_add_u32 s48, s53, 176160768
  s_lshl_b32 s53, s37, 13
  s_add_u32 s49, s49, s53
  s_add_u32 s38, s38, s53
  s_add_u32 s56, s56, s53
  s_lshl2_add_u32 s39, s47, s33
  s_lshl_b32 s39, s39, 16
  s_add_u32 s39, s39, 2097152
  s_add_u32 s43, s39, 4096
  s_lshl_b32 s53, s36, 13
  s_add_u32 s41, s53, s52
  s_lshl_b32 s44, s47, 18
  s_add_u32 s40, s41, s44
  s_add_u32 s40, s40, 1949696
  s_lshl_b32 s44, s37, 18
  s_add_u32 s41, s41, s44
  s_mov_b32 s44, 0
  s_add_u32 s41, s41, 33406976
  s_add_u32 s42, s41, 33554432
  s_cmp_eq_u32 s33, 2
  s_cselect_b32 s50, 33554432, 0
  s_add_u32 s50, s50, 32636928
  s_add_u32 s50, s50, s53
  s_cmp_eq_u32 s33, 3
  s_cselect_b32 s50, 166600704, s50
  s_cmp_eq_u32 s33, 2
  s_cselect_b32 s51, 2048, 0
  s_add_u32 s51, s51, 1312768
  s_lshr_b32 s53, s36, 1
  s_lshl_b32 s53, s53, 7
  s_add_u32 s51, s51, s53
  s_mov_b32 s54, 0x5d800000
  s_mov_b32 s98, 0xCCCCCCCC
  s_mov_b32 s99, 0xCCCCCCCC
  buffer_load_dwordx4 v[112:115], v162, s[24:27], 0 offen offset:512
  buffer_load_dwordx4 v[116:119], v162, s[24:27], 0 offen offset:640
  v_and_b32 v236, 12, v241
  v_bfe_u32 v237, v241, 4, 1
  v_lshl_add_u32 v236, v237, 10, v236
  v_bfe_u32 v237, v241, 8, 1
  v_lshl_add_u32 v236, v237, 4, v236
  s_and_b32 s52, s36, 6
  s_lshl_b32 s52, s52, 10
  s_and_b32 s53, s36, 24
  s_lshl3_add_u32 s52, s53, s52
  s_and_b32 s53, s36, 1
  s_lshl_b32 s53, s53, 5
  s_add_u32 s52, s52, s53
  buffer_load_dword v167, v236, s[24:27], s52 offen offset:512
  v_lshlrev_b32 v232, 3, v253
  s_waitcnt vmcnt(25)
  s_waitcnt lgkmcnt(0)
  s_barrier
  s_mov_b32 m0, 90112
  s_add_u32 s53, s45, 2228224
  buffer_load_dwordx4 v152, s[12:15], s53 offen lds
  s_mov_b32 m0, 91136
  s_add_u32 s53, s45, 2260992
  buffer_load_dwordx4 v153, s[12:15], s53 offen lds
  s_mov_b32 m0, 92160
  s_add_u32 s53, s45, 2293760
  buffer_load_dwordx4 v152, s[12:15], s53 offen lds
  s_mov_b32 m0, 93184
  s_add_u32 s53, s45, 2326528
  buffer_load_dwordx4 v153, s[12:15], s53 offen lds
  ds_read_b64_tr_b16 a[144:145], v156 offset:0
  ds_read_b64_tr_b16 a[146:147], v156 offset:36864
  ds_read_b64_tr_b16 a[148:149], v158 offset:0
  ds_read_b64_tr_b16 a[150:151], v158 offset:36864
  ds_read_b64_tr_b16 a[152:153], v157 offset:0
  ds_read_b64_tr_b16 a[154:155], v157 offset:36864
  ds_read_b64_tr_b16 a[156:157], v159 offset:0
  ds_read_b64_tr_b16 a[158:159], v159 offset:36864
  s_waitcnt vmcnt(25)
  s_waitcnt lgkmcnt(0)
  s_barrier
  s_mov_b32 m0, 73728
  s_add_u32 s53, s45, 2752512
  buffer_load_dwordx4 v152, s[12:15], s53 offen lds
  s_mov_b32 m0, 74752
  s_add_u32 s53, s45, 2785280
  buffer_load_dwordx4 v153, s[12:15], s53 offen lds
  s_mov_b32 m0, 75776
  s_add_u32 s53, s45, 2818048
  buffer_load_dwordx4 v152, s[12:15], s53 offen lds
  s_mov_b32 m0, 76800
  s_add_u32 s53, s45, 2850816
  buffer_load_dwordx4 v153, s[12:15], s53 offen lds
  ds_read_b64_tr_b16 v[184:185], v156 offset:4096
  ds_read_b64_tr_b16 v[186:187], v156 offset:40960
  ds_read_b64_tr_b16 v[188:189], v158 offset:4096
  ds_read_b64_tr_b16 v[190:191], v158 offset:40960
  ds_read_b64_tr_b16 v[192:193], v157 offset:4096
  ds_read_b64_tr_b16 v[194:195], v157 offset:40960
  ds_read_b64_tr_b16 v[196:197], v159 offset:4096
  ds_read_b64_tr_b16 v[198:199], v159 offset:40960
  s_waitcnt lgkmcnt(0)
  ds_write_b128 v252, v[184:187] offset:24576
  ds_write_b128 v252, v[188:191] offset:25600
  ds_write_b128 v252, v[192:195] offset:26624
  ds_write_b128 v252, v[196:199] offset:27648
  s_waitcnt vmcnt(25)
  s_waitcnt lgkmcnt(0)
  s_barrier
  s_mov_b32 m0, 77824
  s_add_u32 s53, s45, 3276800
  buffer_load_dwordx4 v152, s[12:15], s53 offen lds
  s_mov_b32 m0, 78848
  s_add_u32 s53, s45, 3309568
  buffer_load_dwordx4 v153, s[12:15], s53 offen lds
  s_mov_b32 m0, 79872
  s_add_u32 s53, s45, 3342336
  buffer_load_dwordx4 v152, s[12:15], s53 offen lds
  s_mov_b32 m0, 80896
  s_add_u32 s53, s45, 3375104
  buffer_load_dwordx4 v153, s[12:15], s53 offen lds
  ds_read_b64_tr_b16 v[184:185], v156 offset:8192
  ds_read_b64_tr_b16 v[186:187], v156 offset:45056
  ds_read_b64_tr_b16 v[188:189], v158 offset:8192
  ds_read_b64_tr_b16 v[190:191], v158 offset:45056
  ds_read_b64_tr_b16 v[192:193], v157 offset:8192
  ds_read_b64_tr_b16 v[194:195], v157 offset:45056
  ds_read_b64_tr_b16 v[196:197], v159 offset:8192
  ds_read_b64_tr_b16 v[198:199], v159 offset:45056
  s_waitcnt lgkmcnt(0)
  ds_write_b128 v252, v[184:187] offset:28672
  ds_write_b128 v252, v[188:191] offset:29696
  ds_write_b128 v252, v[192:195] offset:30720
  ds_write_b128 v252, v[196:199] offset:31744
  s_waitcnt vmcnt(25)
  s_waitcnt lgkmcnt(0)
  s_barrier
  s_mov_b32 m0, 81920
  s_add_u32 s53, s45, 3801088
  buffer_load_dwordx4 v152, s[12:15], s53 offen lds
  s_mov_b32 m0, 82944
  s_add_u32 s53, s45, 3833856
  buffer_load_dwordx4 v153, s[12:15], s53 offen lds
  s_mov_b32 m0, 83968
  s_add_u32 s53, s45, 3866624
  buffer_load_dwordx4 v152, s[12:15], s53 offen lds
  s_mov_b32 m0, 84992
  s_add_u32 s53, s45, 3899392
  buffer_load_dwordx4 v153, s[12:15], s53 offen lds
  ds_read_b64_tr_b16 v[184:185], v156 offset:12288
  ds_read_b64_tr_b16 v[186:187], v156 offset:49152
  ds_read_b64_tr_b16 v[188:189], v158 offset:12288
  ds_read_b64_tr_b16 v[190:191], v158 offset:49152
  ds_read_b64_tr_b16 v[192:193], v157 offset:12288
  ds_read_b64_tr_b16 v[194:195], v157 offset:49152
  ds_read_b64_tr_b16 v[196:197], v159 offset:12288
  ds_read_b64_tr_b16 v[198:199], v159 offset:49152
  s_waitcnt lgkmcnt(0)
  ds_write_b128 v252, v[184:187] offset:32768
  ds_write_b128 v252, v[188:191] offset:33792
  ds_write_b128 v252, v[192:195] offset:34816
  ds_write_b128 v252, v[196:199] offset:35840
  s_waitcnt vmcnt(12)
  s_waitcnt lgkmcnt(0)
  s_barrier
  s_mov_b32 m0, 86016
  s_add_u32 s53, s45, 131072
  buffer_load_dwordx4 v152, s[16:19], s53 offen lds
  s_mov_b32 m0, 87040
  s_add_u32 s53, s45, 163840
  buffer_load_dwordx4 v153, s[16:19], s53 offen lds
  s_mov_b32 m0, 88064
  s_add_u32 s53, s45, 196608
  buffer_load_dwordx4 v152, s[16:19], s53 offen lds
  s_mov_b32 m0, 89088
  s_add_u32 s53, s45, 229376
  buffer_load_dwordx4 v153, s[16:19], s53 offen lds
  ds_read_b64_tr_b16 v[184:185], v156 offset:16384
  ds_read_b64_tr_b16 v[186:187], v156 offset:53248
  ds_read_b64_tr_b16 v[188:189], v158 offset:16384
  ds_read_b64_tr_b16 v[190:191], v158 offset:53248
  ds_read_b64_tr_b16 v[192:193], v157 offset:16384
  ds_read_b64_tr_b16 v[194:195], v157 offset:53248
  ds_read_b64_tr_b16 v[196:197], v159 offset:16384
  ds_read_b64_tr_b16 v[198:199], v159 offset:53248
  s_waitcnt lgkmcnt(0)
  ds_write_b128 v252, v[184:187] offset:20480
  ds_write_b128 v252, v[188:191] offset:21504
  ds_write_b128 v252, v[192:195] offset:22528
  ds_write_b128 v252, v[196:199] offset:23552
  s_waitcnt vmcnt(12)
  s_waitcnt lgkmcnt(0)
  s_barrier
  s_mov_b32 m0, 90112
  s_add_u32 s53, s45, 655360
  buffer_load_dwordx4 v152, s[16:19], s53 offen lds
  s_mov_b32 m0, 91136
  s_add_u32 s53, s45, 688128
  buffer_load_dwordx4 v153, s[16:19], s53 offen lds
  s_mov_b32 m0, 92160
  s_add_u32 s53, s45, 720896
  buffer_load_dwordx4 v152, s[16:19], s53 offen lds
  s_mov_b32 m0, 93184
  s_add_u32 s53, s45, 753664
  buffer_load_dwordx4 v153, s[16:19], s53 offen lds
  ds_read_b64_tr_b16 a[96:97], v156 offset:0
  ds_read_b64_tr_b16 a[98:99], v156 offset:36864
  ds_read_b64_tr_b16 a[100:101], v158 offset:0
  ds_read_b64_tr_b16 a[102:103], v158 offset:36864
  ds_read_b64_tr_b16 a[104:105], v157 offset:0
  ds_read_b64_tr_b16 a[106:107], v157 offset:36864
  ds_read_b64_tr_b16 a[108:109], v159 offset:0
  ds_read_b64_tr_b16 a[110:111], v159 offset:36864
  s_waitcnt vmcnt(12)
  s_waitcnt lgkmcnt(0)
  s_barrier
  s_mov_b32 m0, 73728
  s_add_u32 s53, s45, 1179648
  buffer_load_dwordx4 v152, s[16:19], s53 offen lds
  s_mov_b32 m0, 74752
  s_add_u32 s53, s45, 1212416
  buffer_load_dwordx4 v153, s[16:19], s53 offen lds
  s_mov_b32 m0, 75776
  s_add_u32 s53, s45, 1245184
  buffer_load_dwordx4 v152, s[16:19], s53 offen lds
  s_mov_b32 m0, 76800
  s_add_u32 s53, s45, 1277952
  buffer_load_dwordx4 v153, s[16:19], s53 offen lds
  ds_read_b64_tr_b16 a[112:113], v156 offset:4096
  ds_read_b64_tr_b16 a[114:115], v156 offset:40960
  ds_read_b64_tr_b16 a[116:117], v158 offset:4096
  ds_read_b64_tr_b16 a[118:119], v158 offset:40960
  ds_read_b64_tr_b16 a[120:121], v157 offset:4096
  ds_read_b64_tr_b16 a[122:123], v157 offset:40960
  ds_read_b64_tr_b16 a[124:125], v159 offset:4096
  ds_read_b64_tr_b16 a[126:127], v159 offset:40960
  s_waitcnt vmcnt(12)
  s_waitcnt lgkmcnt(0)
  s_barrier
  s_mov_b32 m0, 77824
  s_add_u32 s53, s45, 1703936
  buffer_load_dwordx4 v152, s[16:19], s53 offen lds
  s_mov_b32 m0, 78848
  s_add_u32 s53, s45, 1736704
  buffer_load_dwordx4 v153, s[16:19], s53 offen lds
  s_mov_b32 m0, 79872
  s_add_u32 s53, s45, 1769472
  buffer_load_dwordx4 v152, s[16:19], s53 offen lds
  s_mov_b32 m0, 80896
  s_add_u32 s53, s45, 1802240
  buffer_load_dwordx4 v153, s[16:19], s53 offen lds
  ds_read_b64_tr_b16 a[128:129], v156 offset:8192
  ds_read_b64_tr_b16 a[130:131], v156 offset:45056
  ds_read_b64_tr_b16 a[132:133], v158 offset:8192
  ds_read_b64_tr_b16 a[134:135], v158 offset:45056
  ds_read_b64_tr_b16 a[136:137], v157 offset:8192
  ds_read_b64_tr_b16 a[138:139], v157 offset:45056
  ds_read_b64_tr_b16 a[140:141], v159 offset:8192
  ds_read_b64_tr_b16 a[142:143], v159 offset:45056
  s_waitcnt vmcnt(12)
  s_waitcnt lgkmcnt(0)
  s_barrier
  s_mov_b32 m0, 81920
  s_add_u32 s53, s45, 2228224
  buffer_load_dwordx4 v152, s[16:19], s53 offen lds
  s_mov_b32 m0, 82944
  s_add_u32 s53, s45, 2260992
  buffer_load_dwordx4 v153, s[16:19], s53 offen lds
  s_mov_b32 m0, 83968
  s_add_u32 s53, s45, 2293760
  buffer_load_dwordx4 v152, s[16:19], s53 offen lds
  s_mov_b32 m0, 84992
  s_add_u32 s53, s45, 2326528
  buffer_load_dwordx4 v153, s[16:19], s53 offen lds
  ds_read_b64_tr_b16 a[224:225], v156 offset:12288
  ds_read_b64_tr_b16 a[226:227], v156 offset:49152
  ds_read_b64_tr_b16 a[228:229], v158 offset:12288
  ds_read_b64_tr_b16 a[230:231], v158 offset:49152
  ds_read_b64_tr_b16 a[232:233], v157 offset:12288
  ds_read_b64_tr_b16 a[234:235], v157 offset:49152
  ds_read_b64_tr_b16 a[236:237], v159 offset:12288
  ds_read_b64_tr_b16 a[238:239], v159 offset:49152
  s_waitcnt vmcnt(12)
  s_waitcnt lgkmcnt(0)
  s_barrier
  s_mov_b32 m0, 86016
  s_add_u32 s53, s45, 2752512
  buffer_load_dwordx4 v152, s[16:19], s53 offen lds
  s_mov_b32 m0, 87040
  s_add_u32 s53, s45, 2785280
  buffer_load_dwordx4 v153, s[16:19], s53 offen lds
  s_mov_b32 m0, 88064
  s_add_u32 s53, s45, 2818048
  buffer_load_dwordx4 v152, s[16:19], s53 offen lds
  s_mov_b32 m0, 89088
  s_add_u32 s53, s45, 2850816
  buffer_load_dwordx4 v153, s[16:19], s53 offen lds
  ds_read_b64_tr_b16 a[240:241], v156 offset:16384
  ds_read_b64_tr_b16 a[242:243], v156 offset:53248
  ds_read_b64_tr_b16 a[244:245], v158 offset:16384
  ds_read_b64_tr_b16 a[246:247], v158 offset:53248
  ds_read_b64_tr_b16 a[248:249], v157 offset:16384
  ds_read_b64_tr_b16 a[250:251], v157 offset:53248
  ds_read_b64_tr_b16 a[252:253], v159 offset:16384
  ds_read_b64_tr_b16 a[254:255], v159 offset:53248
  s_waitcnt vmcnt(12)
  s_waitcnt lgkmcnt(0)
  s_barrier
  s_mov_b32 m0, 90112
  s_add_u32 s53, s45, 3276800
  buffer_load_dwordx4 v152, s[16:19], s53 offen lds
  s_mov_b32 m0, 91136
  s_add_u32 s53, s45, 3309568
  buffer_load_dwordx4 v153, s[16:19], s53 offen lds
  s_mov_b32 m0, 92160
  s_add_u32 s53, s45, 3342336
  buffer_load_dwordx4 v152, s[16:19], s53 offen lds
  s_mov_b32 m0, 93184
  s_add_u32 s53, s45, 3375104
  buffer_load_dwordx4 v153, s[16:19], s53 offen lds
  ds_read_b64_tr_b16 v[0:1], v156 offset:0
  ds_read_b64_tr_b16 v[2:3], v156 offset:36864
  ds_read_b64_tr_b16 v[4:5], v158 offset:0
  ds_read_b64_tr_b16 v[6:7], v158 offset:36864
  ds_read_b64_tr_b16 v[8:9], v157 offset:0
  ds_read_b64_tr_b16 v[10:11], v157 offset:36864
  ds_read_b64_tr_b16 v[12:13], v159 offset:0
  ds_read_b64_tr_b16 v[14:15], v159 offset:36864
  s_waitcnt vmcnt(12)
  s_waitcnt lgkmcnt(0)
  s_barrier
  s_mov_b32 m0, 73728
  s_add_u32 s53, s45, 3801088
  buffer_load_dwordx4 v152, s[16:19], s53 offen lds
  s_mov_b32 m0, 74752
  s_add_u32 s53, s45, 3833856
  buffer_load_dwordx4 v153, s[16:19], s53 offen lds
  s_mov_b32 m0, 75776
  s_add_u32 s53, s45, 3866624
  buffer_load_dwordx4 v152, s[16:19], s53 offen lds
  s_mov_b32 m0, 76800
  s_add_u32 s53, s45, 3899392
  buffer_load_dwordx4 v153, s[16:19], s53 offen lds
  ds_read_b64_tr_b16 v[16:17], v156 offset:4096
  ds_read_b64_tr_b16 v[18:19], v156 offset:40960
  ds_read_b64_tr_b16 v[20:21], v158 offset:4096
  ds_read_b64_tr_b16 v[22:23], v158 offset:40960
  ds_read_b64_tr_b16 v[24:25], v157 offset:4096
  ds_read_b64_tr_b16 v[26:27], v157 offset:40960
  ds_read_b64_tr_b16 v[28:29], v159 offset:4096
  ds_read_b64_tr_b16 v[30:31], v159 offset:40960
  s_waitcnt vmcnt(12)
  s_waitcnt lgkmcnt(0)
  s_barrier
  s_mov_b32 m0, 77824
  s_add_u32 s53, s46, 8192
  buffer_load_dwordx4 v154, s[20:23], s53 offen lds
  s_mov_b32 m0, 78848
  s_add_u32 s53, s46, 24576
  buffer_load_dwordx4 v155, s[20:23], s53 offen lds
  s_mov_b32 m0, 79872
  s_add_u32 s53, s46, 12288
  buffer_load_dwordx4 v154, s[20:23], s53 offen lds
  s_mov_b32 m0, 80896
  s_add_u32 s53, s46, 28672
  buffer_load_dwordx4 v155, s[20:23], s53 offen lds
  ds_read_b64_tr_b16 a[160:161], v156 offset:8192
  ds_read_b64_tr_b16 a[162:163], v156 offset:45056
  ds_read_b64_tr_b16 a[164:165], v158 offset:8192
  ds_read_b64_tr_b16 a[166:167], v158 offset:45056
  ds_read_b64_tr_b16 a[168:169], v157 offset:8192
  ds_read_b64_tr_b16 a[170:171], v157 offset:45056
  ds_read_b64_tr_b16 a[172:173], v159 offset:8192
  ds_read_b64_tr_b16 a[174:175], v159 offset:45056
  s_waitcnt vmcnt(12)
  s_waitcnt lgkmcnt(0)
  s_barrier
  s_mov_b32 m0, 81920
  s_add_u32 s53, s46, 40960
  buffer_load_dwordx4 v154, s[20:23], s53 offen lds
  s_mov_b32 m0, 82944
  s_add_u32 s53, s46, 57344
  buffer_load_dwordx4 v155, s[20:23], s53 offen lds
  s_mov_b32 m0, 83968
  s_add_u32 s53, s46, 45056
  buffer_load_dwordx4 v154, s[20:23], s53 offen lds
  s_mov_b32 m0, 84992
  s_add_u32 s53, s46, 61440
  buffer_load_dwordx4 v155, s[20:23], s53 offen lds
  ds_read_b64_tr_b16 a[176:177], v156 offset:12288
  ds_read_b64_tr_b16 a[178:179], v156 offset:49152
  ds_read_b64_tr_b16 a[180:181], v158 offset:12288
  ds_read_b64_tr_b16 a[182:183], v158 offset:49152
  ds_read_b64_tr_b16 a[184:185], v157 offset:12288
  ds_read_b64_tr_b16 a[186:187], v157 offset:49152
  ds_read_b64_tr_b16 a[188:189], v159 offset:12288
  ds_read_b64_tr_b16 a[190:191], v159 offset:49152
  s_waitcnt vmcnt(12)
  s_waitcnt lgkmcnt(0)
  s_barrier
  s_mov_b32 m0, 86016
  s_add_u32 s53, s46, 73728
  buffer_load_dwordx4 v154, s[20:23], s53 offen lds
  s_mov_b32 m0, 87040
  s_add_u32 s53, s46, 90112
  buffer_load_dwordx4 v155, s[20:23], s53 offen lds
  s_mov_b32 m0, 88064
  s_add_u32 s53, s46, 77824
  buffer_load_dwordx4 v154, s[20:23], s53 offen lds
  s_mov_b32 m0, 89088
  s_add_u32 s53, s46, 94208
  buffer_load_dwordx4 v155, s[20:23], s53 offen lds
  ds_read_b64_tr_b16 a[192:193], v156 offset:16384
  ds_read_b64_tr_b16 a[194:195], v156 offset:53248
  ds_read_b64_tr_b16 a[196:197], v158 offset:16384
  ds_read_b64_tr_b16 a[198:199], v158 offset:53248
  ds_read_b64_tr_b16 a[200:201], v157 offset:16384
  ds_read_b64_tr_b16 a[202:203], v157 offset:53248
  ds_read_b64_tr_b16 a[204:205], v159 offset:16384
  ds_read_b64_tr_b16 a[206:207], v159 offset:53248
  buffer_load_dword v163, off, s[28:31], 0 offset:36 sc1
  buffer_load_dword v164, off, s[28:31], 0 offset:4 sc1
  s_waitcnt vmcnt(14)
  s_waitcnt lgkmcnt(0)
  s_barrier
  s_mov_b32 m0, 90112
  s_add_u32 s53, s46, 106496
  buffer_load_dwordx4 v154, s[20:23], s53 offen lds
  s_mov_b32 m0, 91136
  s_add_u32 s53, s46, 122880
  buffer_load_dwordx4 v155, s[20:23], s53 offen lds
  s_mov_b32 m0, 92160
  s_add_u32 s53, s46, 110592
  buffer_load_dwordx4 v154, s[20:23], s53 offen lds
  s_mov_b32 m0, 93184
  s_add_u32 s53, s46, 126976
  buffer_load_dwordx4 v155, s[20:23], s53 offen lds
  ds_read_b64_tr_b16 a[208:209], v156 offset:0
  ds_read_b64_tr_b16 a[210:211], v156 offset:36864
  ds_read_b64_tr_b16 a[212:213], v158 offset:0
  ds_read_b64_tr_b16 a[214:215], v158 offset:36864
  ds_read_b64_tr_b16 a[216:217], v157 offset:0
  ds_read_b64_tr_b16 a[218:219], v157 offset:36864
  ds_read_b64_tr_b16 a[220:221], v159 offset:0
  ds_read_b64_tr_b16 a[222:223], v159 offset:36864
  s_waitcnt vmcnt(14)
  s_waitcnt lgkmcnt(0)
  s_barrier
  s_mov_b32 m0, 73728
  s_add_u32 s53, s45, 131072
  buffer_load_dwordx4 v152, s[8:11], s53 offen lds
  s_mov_b32 m0, 74752
  s_add_u32 s53, s45, 163840
  buffer_load_dwordx4 v153, s[8:11], s53 offen lds
  s_mov_b32 m0, 75776
  s_add_u32 s53, s45, 196608
  buffer_load_dwordx4 v152, s[8:11], s53 offen lds
  s_mov_b32 m0, 76800
  s_add_u32 s53, s45, 229376
  buffer_load_dwordx4 v153, s[8:11], s53 offen lds
  ds_read_b64_tr_b16 v[80:81], v160 offset:4096
  ds_read_b64_tr_b16 v[82:83], v160 offset:40960
  ds_read_b64_tr_b16 v[84:85], v161 offset:4096
  ds_read_b64_tr_b16 v[86:87], v161 offset:40960
  ds_read_b64_tr_b16 v[88:89], v160 offset:4352
  ds_read_b64_tr_b16 v[90:91], v160 offset:41216
  ds_read_b64_tr_b16 v[92:93], v161 offset:4352
  ds_read_b64_tr_b16 v[94:95], v161 offset:41216
  s_waitcnt vmcnt(14)
  s_waitcnt lgkmcnt(0)
  s_barrier
  s_mov_b32 m0, 77824
  s_add_u32 s53, s45, 655360
  buffer_load_dwordx4 v152, s[8:11], s53 offen lds
  s_mov_b32 m0, 78848
  s_add_u32 s53, s45, 688128
  buffer_load_dwordx4 v153, s[8:11], s53 offen lds
  s_mov_b32 m0, 79872
  s_add_u32 s53, s45, 720896
  buffer_load_dwordx4 v152, s[8:11], s53 offen lds
  s_mov_b32 m0, 80896
  s_add_u32 s53, s45, 753664
  buffer_load_dwordx4 v153, s[8:11], s53 offen lds
  ds_read_b64_tr_b16 v[96:97], v160 offset:8192
  ds_read_b64_tr_b16 v[98:99], v160 offset:45056
  ds_read_b64_tr_b16 v[100:101], v161 offset:8192
  ds_read_b64_tr_b16 v[102:103], v161 offset:45056
  ds_read_b64_tr_b16 v[104:105], v160 offset:8448
  ds_read_b64_tr_b16 v[106:107], v160 offset:45312
  ds_read_b64_tr_b16 v[108:109], v161 offset:8448
  ds_read_b64_tr_b16 v[110:111], v161 offset:45312
  s_waitcnt vmcnt(14)
  s_waitcnt lgkmcnt(0)
  s_barrier
  s_mov_b32 m0, 81920
  s_add_u32 s53, s45, 1179648
  buffer_load_dwordx4 v152, s[8:11], s53 offen lds
  s_mov_b32 m0, 82944
  s_add_u32 s53, s45, 1212416
  buffer_load_dwordx4 v153, s[8:11], s53 offen lds
  s_mov_b32 m0, 83968
  s_add_u32 s53, s45, 1245184
  buffer_load_dwordx4 v152, s[8:11], s53 offen lds
  s_mov_b32 m0, 84992
  s_add_u32 s53, s45, 1277952
  buffer_load_dwordx4 v153, s[8:11], s53 offen lds
  ds_read_b64_tr_b16 v[32:33], v160 offset:12288
  ds_read_b64_tr_b16 v[34:35], v160 offset:49152
  ds_read_b64_tr_b16 v[36:37], v161 offset:12288
  ds_read_b64_tr_b16 v[38:39], v161 offset:49152
  ds_read_b64_tr_b16 v[40:41], v160 offset:12544
  ds_read_b64_tr_b16 v[42:43], v160 offset:49408
  ds_read_b64_tr_b16 v[44:45], v161 offset:12544
  ds_read_b64_tr_b16 v[46:47], v161 offset:49408
  s_waitcnt vmcnt(12)
  s_waitcnt lgkmcnt(0)
  s_barrier
  s_mov_b32 m0, 86016
  s_add_u32 s53, s45, 1703936
  buffer_load_dwordx4 v152, s[8:11], s53 offen lds
  s_mov_b32 m0, 87040
  s_add_u32 s53, s45, 1736704
  buffer_load_dwordx4 v153, s[8:11], s53 offen lds
  s_mov_b32 m0, 88064
  s_add_u32 s53, s45, 1769472
  buffer_load_dwordx4 v152, s[8:11], s53 offen lds
  s_mov_b32 m0, 89088
  s_add_u32 s53, s45, 1802240
  buffer_load_dwordx4 v153, s[8:11], s53 offen lds
  ds_read_b64_tr_b16 v[64:65], v160 offset:16384
  ds_read_b64_tr_b16 v[66:67], v160 offset:53248
  ds_read_b64_tr_b16 v[68:69], v161 offset:16384
  ds_read_b64_tr_b16 v[70:71], v161 offset:53248
  ds_read_b64_tr_b16 v[72:73], v160 offset:16640
  ds_read_b64_tr_b16 v[74:75], v160 offset:53504
  ds_read_b64_tr_b16 v[76:77], v161 offset:16640
  ds_read_b64_tr_b16 v[78:79], v161 offset:53504
  s_waitcnt vmcnt(12)
  s_waitcnt lgkmcnt(0)
  s_barrier
  s_mov_b32 m0, 90112
  s_add_u32 s53, s45, 2228224
  buffer_load_dwordx4 v152, s[8:11], s53 offen lds
  s_mov_b32 m0, 91136
  s_add_u32 s53, s45, 2260992
  buffer_load_dwordx4 v153, s[8:11], s53 offen lds
  s_mov_b32 m0, 92160
  s_add_u32 s53, s45, 2293760
  buffer_load_dwordx4 v152, s[8:11], s53 offen lds
  s_mov_b32 m0, 93184
  s_add_u32 s53, s45, 2326528
  buffer_load_dwordx4 v153, s[8:11], s53 offen lds
  ds_read_b64_tr_b16 a[32:33], v156 offset:0
  ds_read_b64_tr_b16 a[34:35], v156 offset:36864
  ds_read_b64_tr_b16 a[36:37], v158 offset:0
  ds_read_b64_tr_b16 a[38:39], v158 offset:36864
  ds_read_b64_tr_b16 a[40:41], v157 offset:0
  ds_read_b64_tr_b16 a[42:43], v157 offset:36864
  ds_read_b64_tr_b16 a[44:45], v159 offset:0
  ds_read_b64_tr_b16 a[46:47], v159 offset:36864
  v_readfirstlane_b32 s52, v163
  v_readfirstlane_b32 s53, v164
  s_lshl_b32 s58, s47, 29
  s_lshl_b32 s52, s52, 5
  s_or_b32 s52, s52, s58
  s_or_b32 s58, s58, 32
  s_and_b32 s52, s52, s53
  s_cmp_eq_u32 s52, s58
  s_cbranch_scc1 c_fl_501
c_wd_502:
  buffer_load_dword v236, off, s[28:31], 0 offset:36 sc1
  s_waitcnt vmcnt(0)
  v_readfirstlane_b32 s53, v236
  s_cmp_ge_u32 s53, 1
  s_cbranch_scc1 c_wdd_503
  s_cmp_eq_u32 s35, 0
  s_cbranch_scc1 c_wdd_503
  s_sub_u32 s35, s35, 1
  s_sleep 2
  s_branch c_wd_502
c_wdd_503:
c_wd_504:
  buffer_load_dword v236, off, s[28:31], 0 offset:4 sc1
  s_waitcnt vmcnt(0)
  v_readfirstlane_b32 s53, v236
  s_and_b32 s52, s53, s58
  s_cmp_eq_u32 s52, s58
  s_cbranch_scc1 c_wdd_505
  s_cmp_eq_u32 s35, 0
  s_cbranch_scc1 c_wdd_505
  s_sub_u32 s35, s35, 1
  s_sleep 2
  s_branch c_wd_504
c_wdd_505:
c_fl_501:
  s_bfe_u32 s34, s53, 0x80010
  s_waitcnt vmcnt(12)
  s_waitcnt lgkmcnt(0)
  s_barrier
  s_mov_b32 m0, 73728
  s_add_u32 s53, s45, 2752512
  buffer_load_dwordx4 v152, s[8:11], s53 offen lds
  s_mov_b32 m0, 74752
  s_add_u32 s53, s45, 2785280
  buffer_load_dwordx4 v153, s[8:11], s53 offen lds
  s_mov_b32 m0, 75776
  s_add_u32 s53, s45, 2818048
  buffer_load_dwordx4 v152, s[8:11], s53 offen lds
  s_mov_b32 m0, 76800
  s_add_u32 s53, s45, 2850816
  buffer_load_dwordx4 v153, s[8:11], s53 offen lds
  ds_read_b64_tr_b16 a[48:49], v156 offset:4096
  ds_read_b64_tr_b16 a[50:51], v156 offset:40960
  ds_read_b64_tr_b16 a[52:53], v158 offset:4096
  ds_read_b64_tr_b16 a[54:55], v158 offset:40960
  ds_read_b64_tr_b16 a[56:57], v157 offset:4096
  ds_read_b64_tr_b16 a[58:59], v157 offset:40960
  ds_read_b64_tr_b16 a[60:61], v159 offset:4096
  ds_read_b64_tr_b16 a[62:63], v159 offset:40960
  s_waitcnt vmcnt(12)
  s_waitcnt lgkmcnt(0)
  s_barrier
  s_mov_b32 m0, 77824
  s_add_u32 s53, s45, 3276800
  buffer_load_dwordx4 v152, s[8:11], s53 offen lds
  s_mov_b32 m0, 78848
  s_add_u32 s53, s45, 3309568
  buffer_load_dwordx4 v153, s[8:11], s53 offen lds
  s_mov_b32 m0, 79872
  s_add_u32 s53, s45, 3342336
  buffer_load_dwordx4 v152, s[8:11], s53 offen lds
  s_mov_b32 m0, 80896
  s_add_u32 s53, s45, 3375104
  buffer_load_dwordx4 v153, s[8:11], s53 offen lds
  ds_read_b64_tr_b16 a[64:65], v156 offset:8192
  ds_read_b64_tr_b16 a[66:67], v156 offset:45056
  ds_read_b64_tr_b16 a[68:69], v158 offset:8192
  ds_read_b64_tr_b16 a[70:71], v158 offset:45056
  ds_read_b64_tr_b16 a[72:73], v157 offset:8192
  ds_read_b64_tr_b16 a[74:75], v157 offset:45056
  ds_read_b64_tr_b16 a[76:77], v159 offset:8192
  ds_read_b64_tr_b16 a[78:79], v159 offset:45056
  s_waitcnt vmcnt(12)
  s_waitcnt lgkmcnt(0)
  s_barrier
  s_mov_b32 m0, 81920
  s_add_u32 s53, s45, 3801088
  buffer_load_dwordx4 v152, s[8:11], s53 offen lds
  s_mov_b32 m0, 82944
  s_add_u32 s53, s45, 3833856
  buffer_load_dwordx4 v153, s[8:11], s53 offen lds
  s_mov_b32 m0, 83968
  s_add_u32 s53, s45, 3866624
  buffer_load_dwordx4 v152, s[8:11], s53 offen lds
  s_mov_b32 m0, 84992
  s_add_u32 s53, s45, 3899392
  buffer_load_dwordx4 v153, s[8:11], s53 offen lds
  ds_read_b64_tr_b16 a[80:81], v156 offset:12288
  ds_read_b64_tr_b16 a[82:83], v156 offset:49152
  ds_read_b64_tr_b16 a[84:85], v158 offset:12288
  ds_read_b64_tr_b16 a[86:87], v158 offset:49152
  ds_read_b64_tr_b16 a[88:89], v157 offset:12288
  ds_read_b64_tr_b16 a[90:91], v157 offset:49152
  ds_read_b64_tr_b16 a[92:93], v159 offset:12288
  ds_read_b64_tr_b16 a[94:95], v159 offset:49152
  s_waitcnt vmcnt(12)
  s_waitcnt lgkmcnt(0)
  s_barrier
  s_mov_b32 m0, 86016
  s_add_u32 s53, s46, 8704
  buffer_load_dwordx4 v154, s[20:23], s53 offen lds
  s_mov_b32 m0, 87040
  s_add_u32 s53, s46, 25088
  buffer_load_dwordx4 v155, s[20:23], s53 offen lds
  s_mov_b32 m0, 88064
  s_add_u32 s53, s46, 12800
  buffer_load_dwordx4 v154, s[20:23], s53 offen lds
  s_mov_b32 m0, 89088
  s_add_u32 s53, s46, 29184
  buffer_load_dwordx4 v155, s[20:23], s53 offen lds
  ds_read_b64_tr_b16 v[184:185], v156 offset:16384
  ds_read_b64_tr_b16 v[186:187], v156 offset:53248
  ds_read_b64_tr_b16 v[188:189], v158 offset:16384
  ds_read_b64_tr_b16 v[190:191], v158 offset:53248
  ds_read_b64_tr_b16 v[192:193], v157 offset:16384
  ds_read_b64_tr_b16 v[194:195], v157 offset:53248
  ds_read_b64_tr_b16 v[196:197], v159 offset:16384
  ds_read_b64_tr_b16 v[198:199], v159 offset:53248
  s_waitcnt vmcnt(12)
  s_waitcnt lgkmcnt(0)
  s_barrier
  s_mov_b32 m0, 90112
  s_add_u32 s53, s46, 41472
  buffer_load_dwordx4 v154, s[20:23], s53 offen lds
  s_mov_b32 m0, 91136
  s_add_u32 s53, s46, 57856
  buffer_load_dwordx4 v155, s[20:23], s53 offen lds
  s_mov_b32 m0, 92160
  s_add_u32 s53, s46, 45568
  buffer_load_dwordx4 v154, s[20:23], s53 offen lds
  s_mov_b32 m0, 93184
  s_add_u32 s53, s46, 61952
  buffer_load_dwordx4 v155, s[20:23], s53 offen lds
  ds_read_b64_tr_b16 v[216:217], v156 offset:0
  ds_read_b64_tr_b16 v[218:219], v156 offset:36864
  ds_read_b64_tr_b16 v[220:221], v158 offset:0
  ds_read_b64_tr_b16 v[222:223], v158 offset:36864
  ds_read_b64_tr_b16 v[224:225], v157 offset:0
  ds_read_b64_tr_b16 v[226:227], v157 offset:36864
  ds_read_b64_tr_b16 v[228:229], v159 offset:0
  ds_read_b64_tr_b16 v[230:231], v159 offset:36864
  s_waitcnt vmcnt(12)
  s_waitcnt lgkmcnt(0)
  s_barrier
  s_mov_b32 m0, 73728
  s_add_u32 s53, s46, 74240
  buffer_load_dwordx4 v154, s[20:23], s53 offen lds
  s_mov_b32 m0, 74752
  s_add_u32 s53, s46, 90624
  buffer_load_dwordx4 v155, s[20:23], s53 offen lds
  s_mov_b32 m0, 75776
  s_add_u32 s53, s46, 78336
  buffer_load_dwordx4 v154, s[20:23], s53 offen lds
  s_mov_b32 m0, 76800
  s_add_u32 s53, s46, 94720
  buffer_load_dwordx4 v155, s[20:23], s53 offen lds
  ds_read_b64_tr_b16 a[0:1], v156 offset:4096
  ds_read_b64_tr_b16 a[2:3], v156 offset:40960
  ds_read_b64_tr_b16 a[4:5], v158 offset:4096
  ds_read_b64_tr_b16 a[6:7], v158 offset:40960
  ds_read_b64_tr_b16 a[8:9], v157 offset:4096
  ds_read_b64_tr_b16 a[10:11], v157 offset:40960
  ds_read_b64_tr_b16 a[12:13], v159 offset:4096
  ds_read_b64_tr_b16 a[14:15], v159 offset:40960
  s_waitcnt vmcnt(12)
  s_waitcnt lgkmcnt(0)
  s_barrier
  s_mov_b32 m0, 77824
  s_add_u32 s53, s46, 107008
  buffer_load_dwordx4 v154, s[20:23], s53 offen lds
  s_mov_b32 m0, 78848
  s_add_u32 s53, s46, 123392
  buffer_load_dwordx4 v155, s[20:23], s53 offen lds
  s_mov_b32 m0, 79872
  s_add_u32 s53, s46, 111104
  buffer_load_dwordx4 v154, s[20:23], s53 offen lds
  s_mov_b32 m0, 80896
  s_add_u32 s53, s46, 127488
  buffer_load_dwordx4 v155, s[20:23], s53 offen lds
  ds_read_b64_tr_b16 a[16:17], v156 offset:8192
  ds_read_b64_tr_b16 a[18:19], v156 offset:45056
  ds_read_b64_tr_b16 a[20:21], v158 offset:8192
  ds_read_b64_tr_b16 a[22:23], v158 offset:45056
  ds_read_b64_tr_b16 a[24:25], v157 offset:8192
  ds_read_b64_tr_b16 a[26:27], v157 offset:45056
  ds_read_b64_tr_b16 a[28:29], v159 offset:8192
  ds_read_b64_tr_b16 a[30:31], v159 offset:45056
  s_add_u32 s52, s51, -2048
  buffer_load_dword v165, off, s[4:7], s51 sc1
  buffer_load_dword v166, off, s[4:7], s52 sc1
  s_waitcnt vmcnt(14)
  s_waitcnt lgkmcnt(0)
  s_barrier
  ds_read_b64_tr_b16 v[120:121], v160 offset:12288
  ds_read_b64_tr_b16 v[122:123], v160 offset:49152
  ds_read_b64_tr_b16 v[124:125], v161 offset:12288
  ds_read_b64_tr_b16 v[126:127], v161 offset:49152
  ds_read_b64_tr_b16 v[128:129], v160 offset:12544
  ds_read_b64_tr_b16 v[130:131], v160 offset:49408
  ds_read_b64_tr_b16 v[132:133], v161 offset:12544
  ds_read_b64_tr_b16 v[134:135], v161 offset:49408
  ds_write_b128 v252, v[184:187] offset:8192
  ds_write_b128 v252, v[188:191] offset:9216
  ds_write_b128 v252, v[192:195] offset:10240
  ds_write_b128 v252, v[196:199] offset:11264
  s_waitcnt vmcnt(10)
  s_waitcnt lgkmcnt(0)
  s_barrier
  ds_read_b64_tr_b16 v[136:137], v160 offset:16384
  ds_read_b64_tr_b16 v[138:139], v160 offset:53248
  ds_read_b64_tr_b16 v[140:141], v161 offset:16384
  ds_read_b64_tr_b16 v[142:143], v161 offset:53248
  ds_read_b64_tr_b16 v[144:145], v160 offset:16640
  ds_read_b64_tr_b16 v[146:147], v160 offset:53504
  ds_read_b64_tr_b16 v[148:149], v161 offset:16640
  ds_read_b64_tr_b16 v[150:151], v161 offset:53504
  ds_write_b128 v252, v[216:219] offset:12288
  ds_write_b128 v252, v[220:223] offset:13312
  ds_write_b128 v252, v[224:227] offset:14336
  ds_write_b128 v252, v[228:231] offset:15360
  s_waitcnt vmcnt(6)
  s_waitcnt lgkmcnt(0)
  s_barrier
  ds_read_b64_tr_b16 v[48:49], v160 offset:0
  ds_read_b64_tr_b16 v[50:51], v160 offset:36864
  ds_read_b64_tr_b16 v[52:53], v161 offset:0
  ds_read_b64_tr_b16 v[54:55], v161 offset:36864
  ds_read_b64_tr_b16 v[56:57], v160 offset:256
  ds_read_b64_tr_b16 v[58:59], v160 offset:37120
  ds_read_b64_tr_b16 v[60:61], v161 offset:256
  ds_read_b64_tr_b16 v[62:63], v161 offset:37120
  ds_write_b128 v252, v[120:123] offset:16384
  ds_write_b128 v252, v[124:127] offset:17408
  ds_write_b128 v252, v[128:131] offset:18432
  ds_write_b128 v252, v[132:135] offset:19456
  s_waitcnt vmcnt(2)
  s_waitcnt lgkmcnt(0)
  s_barrier
  ds_read_b64_tr_b16 v[200:201], v160 offset:4096
  ds_read_b64_tr_b16 v[202:203], v160 offset:40960
  ds_read_b64_tr_b16 v[204:205], v161 offset:4096
  ds_read_b64_tr_b16 v[206:207], v161 offset:40960
  ds_read_b64_tr_b16 v[208:209], v160 offset:4352
  ds_read_b64_tr_b16 v[210:211], v160 offset:41216
  ds_read_b64_tr_b16 v[212:213], v161 offset:4352
  ds_read_b64_tr_b16 v[214:215], v161 offset:41216
  ds_write_b128 v252, v[136:139] offset:0
  ds_write_b128 v252, v[140:143] offset:1024
  ds_write_b128 v252, v[144:147] offset:2048
  ds_write_b128 v252, v[148:151] offset:3072
  s_mov_b32 m0, 159744
  s_waitcnt vmcnt(0)
  v_min_u32 v165, v165, v166
  s_cmp_lg_u32 s3, 0
  s_cselect_b32 s58, 0, 2
  v_readfirstlane_b32 s59, v165
  s_cmp_ge_u32 s59, s58
  s_cbranch_scc1 c_rdy_506
  s_xor_b32 s51, s51, 6144
c_sp_507:
  buffer_load_dword v236, off, s[4:7], s51 sc1
  s_waitcnt vmcnt(0)
  v_readfirstlane_b32 s59, v236
  s_cmp_ge_u32 s59, s58
  s_cbranch_scc1 c_spd_508
  s_cmp_eq_u32 s35, 0
  s_cbranch_scc1 c_spd_508
  s_sub_u32 s35, s35, 1
  s_sleep 2
  s_branch c_sp_507
c_spd_508:
  s_xor_b32 s51, s51, 6144
c_sp_509:
  buffer_load_dword v236, off, s[4:7], s51 sc1
  s_waitcnt vmcnt(0)
  v_readfirstlane_b32 s59, v236
  s_cmp_ge_u32 s59, s58
  s_cbranch_scc1 c_spd_510
  s_cmp_eq_u32 s35, 0
  s_cbranch_scc1 c_spd_510
  s_sub_u32 s35, s35, 1
  s_sleep 2
  s_branch c_sp_509
c_spd_510:
c_rdy_506:
  buffer_load_dwordx4 v[168:171], v253, s[4:7], s41 offen sc1
  buffer_load_dwordx4 v[172:175], v253, s[4:7], s41 offen offset:1024 sc1
  s_add_u32 s41, s41, 262144
  v_mov_b32 v233, v167
  s_and_b32 s52, s36, 31
  s_lshl_b32 s52, s52, 1
  s_lshl_b64 s[24:25], 3, s52
  s_mov_b32 s26, 0x000f000f
  s_mov_b32 s27, 0x000f000f
  s_waitcnt lgkmcnt(0)
  s_barrier
  ds_write_b128 v252, v[200:203] offset:4096
  ds_write_b128 v252, v[204:207] offset:5120
  ds_write_b128 v252, v[208:211] offset:6144
  ds_write_b128 v252, v[212:215] offset:7168
  s_waitcnt lgkmcnt(0)
  ds_read_b128 v[200:203], v252 offset:20480
  ds_read_b128 v[204:207], v252 offset:21504
  ds_read_b128 v[208:211], v252 offset:22528
  ds_read_b128 v[212:215], v252 offset:23552
  v_mov_b64 v[144:145], 0
  v_mov_b64 v[146:147], 0
  s_nop 0
  v_mov_b64 v[148:149], 0
  v_mov_b64 v[150:151], 0
  s_nop 0
  v_mov_b64 v[152:153], 0
  v_mov_b64 v[154:155], 0
  s_nop 0
  v_mov_b64 v[156:157], 0
  v_mov_b64 v[158:159], 0
  s_nop 0
  v_mov_b64 v[160:161], 0
  v_mov_b64 v[162:163], 0
  s_nop 0
  v_mov_b64 v[164:165], 0
  v_mov_b64 v[166:167], 0
  s_nop 0
  s_waitcnt lgkmcnt(0)
  s_cmp_lg_u32 s34, 0
  s_cbranch_scc1 c_entry_1_2
  s_branch c_entry_0_2
c_pro_3:
  s_min_u32 s47, s3, 1
  s_cmp_lg_u32 s3, 0
  s_cselect_b32 s36, s2, s32
  s_cselect_b32 s57, 0, 63
  s_cselect_b32 s37, 0, 0
  s_load_dwordx4 s[8:11], s[0:1], 8
  s_load_dwordx4 s[12:15], s[0:1], 24
  s_load_dwordx2 s[20:21], s[0:1], 40
  s_waitcnt lgkmcnt(0)
  s_mov_b32 s24, s8
  s_mov_b32 s25, s9
  s_mov_b32 s26, 8192
  s_mov_b32 s27, 0x20000
  s_mov_b32 s8, s10
  s_mov_b32 s9, s11
  s_mov_b32 s10, 0x400000
  s_mov_b32 s11, 0x20000
  s_mov_b32 s16, s14
  s_mov_b32 s17, s15
  s_mov_b32 s18, 0x400000
  s_mov_b32 s19, 0x20000
  s_mov_b32 s14, 0x400000
  s_mov_b32 s15, 0x20000
  s_mov_b32 s22, 0x400000
  s_mov_b32 s23, 0x20000
  v_and_b32 v232, 63, v0
  v_and_b32 v233, 15, v232
  v_lshrrev_b32 v234, 4, v232
  v_and_b32 v236, 1, v234
  v_lshrrev_b32 v237, 1, v234
  v_lshl_add_u32 v236, v237, 5, v236
  v_lshlrev_b32 v236, 13, v236
  v_lshlrev_b32 v238, 1, v234
  v_xor_b32 v238, v238, v233
  v_lshl_add_u32 v152, v238, 4, v236
  v_xor_b32 v153, 128, v152
  s_lshl_b32 s45, s36, 8
  s_lshl_b32 s46, s36, 17
  s_mov_b32 m0, 110592
  s_add_u32 s53, s45, 147456
  buffer_load_dwordx4 v152, s[12:15], s53 offen lds
  s_mov_b32 m0, 111616
  s_add_u32 s53, s45, 180224
  buffer_load_dwordx4 v153, s[12:15], s53 offen lds
  s_mov_b32 m0, 112640
  s_add_u32 s53, s45, 212992
  buffer_load_dwordx4 v152, s[12:15], s53 offen lds
  s_mov_b32 m0, 113664
  s_add_u32 s53, s45, 245760
  buffer_load_dwordx4 v153, s[12:15], s53 offen lds
  s_mov_b32 m0, 114688
  s_add_u32 s53, s45, 671744
  buffer_load_dwordx4 v152, s[12:15], s53 offen lds
  s_mov_b32 m0, 115712
  s_add_u32 s53, s45, 704512
  buffer_load_dwordx4 v153, s[12:15], s53 offen lds
  s_mov_b32 m0, 116736
  s_add_u32 s53, s45, 737280
  buffer_load_dwordx4 v152, s[12:15], s53 offen lds
  s_mov_b32 m0, 117760
  s_add_u32 s53, s45, 770048
  buffer_load_dwordx4 v153, s[12:15], s53 offen lds
  s_mov_b32 m0, 118784
  s_add_u32 s53, s45, 1196032
  buffer_load_dwordx4 v152, s[12:15], s53 offen lds
  s_mov_b32 m0, 119808
  s_add_u32 s53, s45, 1228800
  buffer_load_dwordx4 v153, s[12:15], s53 offen lds
  s_mov_b32 m0, 120832
  s_add_u32 s53, s45, 1261568
  buffer_load_dwordx4 v152, s[12:15], s53 offen lds
  s_mov_b32 m0, 121856
  s_add_u32 s53, s45, 1294336
  buffer_load_dwordx4 v153, s[12:15], s53 offen lds
  s_mov_b32 m0, 122880
  s_add_u32 s53, s45, 1720320
  buffer_load_dwordx4 v152, s[12:15], s53 offen lds
  s_mov_b32 m0, 123904
  s_add_u32 s53, s45, 1753088
  buffer_load_dwordx4 v153, s[12:15], s53 offen lds
  s_mov_b32 m0, 124928
  s_add_u32 s53, s45, 1785856
  buffer_load_dwordx4 v152, s[12:15], s53 offen lds
  s_mov_b32 m0, 125952
  s_add_u32 s53, s45, 1818624
  buffer_load_dwordx4 v153, s[12:15], s53 offen lds
  v_and_b32 v236, 31, v232
  v_lshlrev_b32 v238, 2, v237
  v_xor_b32 v236, v236, v238
  v_lshlrev_b32 v236, 4, v236
  v_lshl_add_u32 v154, v237, 10, v236
  v_xor_b32 v155, 128, v154
  s_mov_b32 s52, 110592
  v_lshrrev_b32 v236, 2, v232
  v_and_b32 v238, 7, v236
  v_xor_b32 v238, 6, v238
  v_lshlrev_b32 v236, 8, v236
  v_lshl_add_u32 v236, v238, 5, v236
  v_and_b32 v237, 3, v232
  v_lshl_add_u32 v156, v237, 3, v236
  v_xor_b32 v157, 32, v156
  v_add_u32 v158, 73728, v156
  v_add_u32 v159, 73728, v157
  v_bfe_u32 v236, v232, 2, 1
  v_lshl_add_u32 v236, v234, 1, v236
  v_and_b32 v238, 3, v236
  v_xor_b32 v238, 3, v238
  v_lshlrev_b32 v236, 9, v236
  v_lshl_add_u32 v236, v238, 6, v236
  v_lshl_add_u32 v236, v237, 4, v236
  v_bfe_u32 v237, v232, 3, 1
  v_lshl_add_u32 v160, v237, 3, v236
  v_add_u32 v161, 73728, v160
  v_bfe_u32 v235, v232, 1, 1
  v_bfe_u32 v239, v232, 2, 2
  v_lshlrev_b32 v236, 4, v232
  v_add_u32 v252, s52, v236
  v_add_u32 v253, 147456, v236
  v_lshl_add_u32 v254, v235, 10, v253
  v_lshrrev_b32 v236, 3, v232
  s_lshl1_add_u32 s53, s33, s36
  v_lshl_add_u32 v237, v236, 2, s53
  v_and_b32 v237, 31, v237
  v_lshlrev_b32 v236, 13, v236
  v_lshl_add_u32 v236, v237, 6, v236
  v_and_b32 v237, 7, v232
  v_lshl_add_u32 v255, v237, 3, v236
  v_mul_u32_u24 v240, 0xAAAA, v235
  v_add_u32 v240, 0x4444, v240
  v_mov_b32 v246, 0x3F003F00
  v_mov_b32 v247, 0x3F003F00
  v_and_b32 v236, 1, v232
  v_lshlrev_b32 v236, 4, v236
  v_cmp_eq_u32 vcc, v234, v239
  v_mov_b32 v237, 0x3e89
  v_lshlrev_b32 v237, v236, v237
  v_cndmask_b32 v242, 0, v237, vcc
  v_mov_b32 v243, v242
  v_mov_b32 v237, 0x3ef4
  v_lshlrev_b32 v237, v236, v237
  v_cndmask_b32 v244, 0, v237, vcc
  v_mov_b32 v245, v244
  v_bfe_u32 v236, v232, 2, 1
  v_lshlrev_b32 v236, 4, v236
  v_mov_b32 v237, 0x3F80
  v_lshlrev_b32 v237, v236, v237
  v_bfe_u32 v238, v232, 3, 1
  v_and_b32 v236, 1, v232
  v_lshl_add_u32 v238, v236, 1, v238
  v_cmp_eq_u32 vcc, 0, v238
  s_nop 1
  v_cndmask_b32 v248, 0, v237, vcc
  v_cmp_eq_u32 vcc, 1, v238
  s_nop 1
  v_cndmask_b32 v249, 0, v237, vcc
  v_cmp_eq_u32 vcc, 2, v238
  s_nop 1
  v_cndmask_b32 v250, 0, v237, vcc
  v_cmp_eq_u32 vcc, 3, v238
  s_nop 1
  v_cndmask_b32 v251, 0, v237, vcc
  v_lshlrev_b32 v236, 2, v236
  v_and_b32 v237, 0, v239
  v_mul_u32_u24 v237, 1050624, v237
  v_add_u32 v236, v237, v236
  v_lshrrev_b32 v237, 0, v239
  v_lshl_add_u32 v236, v237, 28, v236
  v_lshl_add_u32 v236, v235, 8, v236
  v_and_b32 v237, 16, v232
  v_add_u32 v236, v237, v236
  v_bfe_u32 v237, v232, 5, 1
  v_lshl_add_u32 v241, v237, 3, v236
  v_and_b32 v236, 1, v232
  v_lshl_add_u32 v236, v239, 1, v236
  v_lshlrev_b32 v236, 10, v236
  v_lshl_add_u32 v236, v235, 6, v236
  v_lshl_add_u32 v162, v234, 4, v236
  v_mov_b32 v168, -1
  v_mov_b32 v169, -1
  v_mov_b32 v170, -1
  v_mov_b32 v171, -1
  s_lshl_b32 s52, s47, 5
  s_add_u32 s52, s52, s36
  s_lshl_b32 s52, s52, 13
  s_lshl_b32 s53, s33, 11
  s_add_u32 s52, s52, s53
  s_add_u32 s52, s52, 1949696
  buffer_store_dwordx4 v[168:171], v253, s[4:7], s52 offen offset:0 sc1
  buffer_store_dwordx4 v[168:171], v253, s[4:7], s52 offen offset:1024 sc1
  s_cmp_lg_u32 s3, 0
  s_cselect_b32 s52, 8, 13
  s_cselect_b32 s44, 17, 23
  s_lshl_b32 s44, 1, s44
  v_lshlrev_b32 v172, s52, v234
  v_lshl_add_u32 v172, v233, 4, v172
  s_lshl_b32 s52, s36, 8
  s_lshl_b32 s53, s33, 17
  s_add_u32 s52, s52, s53
  s_add_u32 s52, s52, 167772160
  s_cmp_lg_u32 s3, 0
  s_cselect_b32 s52, s3, s52
  buffer_store_dwordx4 v[168:171], v172, s[4:7], s52 offen sc1
  s_add_u32 s53, s52, s44
  buffer_store_dwordx4 v[168:171], v172, s[4:7], s53 offen sc1
  s_add_u32 s52, s52, 32768
  buffer_store_dwordx4 v[168:171], v172, s[4:7], s52 offen sc1
  s_add_u32 s53, s52, s44
  buffer_store_dwordx4 v[168:171], v172, s[4:7], s53 offen sc1
  s_add_u32 s52, s52, 32768
  buffer_store_dwordx4 v[168:171], v172, s[4:7], s52 offen sc1
  s_add_u32 s53, s52, s44
  buffer_store_dwordx4 v[168:171], v172, s[4:7], s53 offen sc1
  s_add_u32 s52, s52, 32768
  buffer_store_dwordx4 v[168:171], v172, s[4:7], s52 offen sc1
  s_add_u32 s53, s52, s44
  buffer_store_dwordx4 v[168:171], v172, s[4:7], s53 offen sc1
  s_add_u32 s52, s52, 32768
  s_lshl_b32 s52, s33, 11
  s_and_b32 s56, s36, 0
  s_mul_i32 s56, s56, 1050624
  s_add_u32 s38, s52, s56
  s_add_u32 s38, s38, 167624704
  s_lshr_b32 s53, s36, 4
  s_lshl_b32 s53, s53, 10
  s_add_u32 s53, s53, s52
  s_and_b32 s44, s36, 6
  s_lshl_b32 s44, s44, 5
  s_add_u32 s53, s53, s44
  s_and_b32 s44, s36, 8
  s_lshl2_add_u32 s53, s44, s53
  s_and_b32 s44, s36, 1
  s_lshl_b32 s44, s44, 9
  s_add_u32 s53, s53, s44
  s_add_u32 s49, s53, 167780352
  s_add_u32 s48, s53, 176160768
  s_lshl_b32 s53, s37, 13
  s_add_u32 s49, s49, s53
  s_add_u32 s38, s38, s53
  s_add_u32 s56, s56, s53
  s_lshl2_add_u32 s39, s47, s33
  s_lshl_b32 s39, s39, 16
  s_add_u32 s39, s39, 2097152
  s_add_u32 s43, s39, 4096
  s_lshl_b32 s53, s36, 13
  s_add_u32 s41, s53, s52
  s_lshl_b32 s44, s47, 18
  s_add_u32 s40, s41, s44
  s_add_u32 s40, s40, 1949696
  s_lshl_b32 s44, s37, 18
  s_add_u32 s41, s41, s44
  s_mov_b32 s44, 0
  s_add_u32 s41, s41, 33406976
  s_add_u32 s42, s41, 33554432
  s_cmp_eq_u32 s33, 2
  s_cselect_b32 s50, 33554432, 0
  s_add_u32 s50, s50, 32636928
  s_add_u32 s50, s50, s53
  s_cmp_eq_u32 s33, 3
  s_cselect_b32 s50, 166600704, s50
  s_add_u32 s50, s50, s56
  s_cmp_eq_u32 s33, 2
  s_cselect_b32 s51, 2048, 0
  s_add_u32 s51, s51, 1312768
  s_lshr_b32 s53, s36, 1
  s_lshl_b32 s53, s53, 7
  s_add_u32 s51, s51, s53
  s_mov_b32 s54, 0x5d800000
  s_mov_b32 s98, 0xCCCCCCCC
  s_mov_b32 s99, 0xCCCCCCCC
  buffer_load_dwordx4 v[112:115], v162, s[24:27], 0 offen offset:768
  buffer_load_dwordx4 v[116:119], v162, s[24:27], 0 offen offset:896
  v_and_b32 v236, 12, v241
  v_bfe_u32 v237, v241, 4, 1
  v_lshl_add_u32 v236, v237, 10, v236
  v_bfe_u32 v237, v241, 8, 1
  v_lshl_add_u32 v236, v237, 4, v236
  s_and_b32 s52, s36, 6
  s_lshl_b32 s52, s52, 10
  s_and_b32 s53, s36, 24
  s_lshl3_add_u32 s52, s53, s52
  s_and_b32 s53, s36, 1
  s_lshl_b32 s53, s53, 5
  s_add_u32 s52, s52, s53
  buffer_load_dword v167, v236, s[24:27], s52 offen offset:768
  v_lshlrev_b32 v232, 3, v253
  s_waitcnt vmcnt(25)
  s_waitcnt lgkmcnt(0)
  s_barrier
  s_mov_b32 m0, 126976
  s_add_u32 s53, s45, 2244608
  buffer_load_dwordx4 v152, s[12:15], s53 offen lds
  s_mov_b32 m0, 128000
  s_add_u32 s53, s45, 2277376
  buffer_load_dwordx4 v153, s[12:15], s53 offen lds
  s_mov_b32 m0, 129024
  s_add_u32 s53, s45, 2310144
  buffer_load_dwordx4 v152, s[12:15], s53 offen lds
  s_mov_b32 m0, 130048
  s_add_u32 s53, s45, 2342912
  buffer_load_dwordx4 v153, s[12:15], s53 offen lds
  ds_read_b64_tr_b16 a[112:113], v156 offset:0
  ds_read_b64_tr_b16 a[114:115], v156 offset:36864
  ds_read_b64_tr_b16 a[116:117], v158 offset:0
  ds_read_b64_tr_b16 a[118:119], v158 offset:36864
  ds_read_b64_tr_b16 a[120:121], v157 offset:0
  ds_read_b64_tr_b16 a[122:123], v157 offset:36864
  ds_read_b64_tr_b16 a[124:125], v159 offset:0
  ds_read_b64_tr_b16 a[126:127], v159 offset:36864
  s_waitcnt vmcnt(25)
  s_waitcnt lgkmcnt(0)
  s_barrier
  s_mov_b32 m0, 110592
  s_add_u32 s53, s45, 2768896
  buffer_load_dwordx4 v152, s[12:15], s53 offen lds
  s_mov_b32 m0, 111616
  s_add_u32 s53, s45, 2801664
  buffer_load_dwordx4 v153, s[12:15], s53 offen lds
  s_mov_b32 m0, 112640
  s_add_u32 s53, s45, 2834432
  buffer_load_dwordx4 v152, s[12:15], s53 offen lds
  s_mov_b32 m0, 113664
  s_add_u32 s53, s45, 2867200
  buffer_load_dwordx4 v153, s[12:15], s53 offen lds
  ds_read_b64_tr_b16 a[128:129], v156 offset:4096
  ds_read_b64_tr_b16 a[130:131], v156 offset:40960
  ds_read_b64_tr_b16 a[132:133], v158 offset:4096
  ds_read_b64_tr_b16 a[134:135], v158 offset:40960
  ds_read_b64_tr_b16 a[136:137], v157 offset:4096
  ds_read_b64_tr_b16 a[138:139], v157 offset:40960
  ds_read_b64_tr_b16 a[140:141], v159 offset:4096
  ds_read_b64_tr_b16 a[142:143], v159 offset:40960
  s_waitcnt vmcnt(25)
  s_waitcnt lgkmcnt(0)
  s_barrier
  s_mov_b32 m0, 114688
  s_add_u32 s53, s45, 3293184
  buffer_load_dwordx4 v152, s[12:15], s53 offen lds
  s_mov_b32 m0, 115712
  s_add_u32 s53, s45, 3325952
  buffer_load_dwordx4 v153, s[12:15], s53 offen lds
  s_mov_b32 m0, 116736
  s_add_u32 s53, s45, 3358720
  buffer_load_dwordx4 v152, s[12:15], s53 offen lds
  s_mov_b32 m0, 117760
  s_add_u32 s53, s45, 3391488
  buffer_load_dwordx4 v153, s[12:15], s53 offen lds
  ds_read_b64_tr_b16 a[144:145], v156 offset:8192
  ds_read_b64_tr_b16 a[146:147], v156 offset:45056
  ds_read_b64_tr_b16 a[148:149], v158 offset:8192
  ds_read_b64_tr_b16 a[150:151], v158 offset:45056
  ds_read_b64_tr_b16 a[152:153], v157 offset:8192
  ds_read_b64_tr_b16 a[154:155], v157 offset:45056
  ds_read_b64_tr_b16 a[156:157], v159 offset:8192
  ds_read_b64_tr_b16 a[158:159], v159 offset:45056
  s_waitcnt vmcnt(25)
  s_waitcnt lgkmcnt(0)
  s_barrier
  s_mov_b32 m0, 118784
  s_add_u32 s53, s45, 3817472
  buffer_load_dwordx4 v152, s[12:15], s53 offen lds
  s_mov_b32 m0, 119808
  s_add_u32 s53, s45, 3850240
  buffer_load_dwordx4 v153, s[12:15], s53 offen lds
  s_mov_b32 m0, 120832
  s_add_u32 s53, s45, 3883008
  buffer_load_dwordx4 v152, s[12:15], s53 offen lds
  s_mov_b32 m0, 121856
  s_add_u32 s53, s45, 3915776
  buffer_load_dwordx4 v153, s[12:15], s53 offen lds
  ds_read_b64_tr_b16 v[184:185], v156 offset:12288
  ds_read_b64_tr_b16 v[186:187], v156 offset:49152
  ds_read_b64_tr_b16 v[188:189], v158 offset:12288
  ds_read_b64_tr_b16 v[190:191], v158 offset:49152
  ds_read_b64_tr_b16 v[192:193], v157 offset:12288
  ds_read_b64_tr_b16 v[194:195], v157 offset:49152
  ds_read_b64_tr_b16 v[196:197], v159 offset:12288
  ds_read_b64_tr_b16 v[198:199], v159 offset:49152
  s_waitcnt lgkmcnt(0)
  ds_write_b128 v252, v[184:187] offset:24576
  ds_write_b128 v252, v[188:191] offset:25600
  ds_write_b128 v252, v[192:195] offset:26624
  ds_write_b128 v252, v[196:199] offset:27648
  s_waitcnt vmcnt(12)
  s_waitcnt lgkmcnt(0)
  s_barrier
  s_mov_b32 m0, 122880
  s_add_u32 s53, s45, 147456
  buffer_load_dwordx4 v152, s[16:19], s53 offen lds
  s_mov_b32 m0, 123904
  s_add_u32 s53, s45, 180224
  buffer_load_dwordx4 v153, s[16:19], s53 offen lds
  s_mov_b32 m0, 124928
  s_add_u32 s53, s45, 212992
  buffer_load_dwordx4 v152, s[16:19], s53 offen lds
  s_mov_b32 m0, 125952
  s_add_u32 s53, s45, 245760
  buffer_load_dwordx4 v153, s[16:19], s53 offen lds
  ds_read_b64_tr_b16 v[184:185], v156 offset:16384
  ds_read_b64_tr_b16 v[186:187], v156 offset:53248
  ds_read_b64_tr_b16 v[188:189], v158 offset:16384
  ds_read_b64_tr_b16 v[190:191], v158 offset:53248
  ds_read_b64_tr_b16 v[192:193], v157 offset:16384
  ds_read_b64_tr_b16 v[194:195], v157 offset:53248
  ds_read_b64_tr_b16 v[196:197], v159 offset:16384
  ds_read_b64_tr_b16 v[198:199], v159 offset:53248
  s_waitcnt lgkmcnt(0)
  ds_write_b128 v252, v[184:187] offset:28672
  ds_write_b128 v252, v[188:191] offset:29696
  ds_write_b128 v252, v[192:195] offset:30720
  ds_write_b128 v252, v[196:199] offset:31744
  s_waitcnt vmcnt(12)
  s_waitcnt lgkmcnt(0)
  s_barrier
  s_mov_b32 m0, 126976
  s_add_u32 s53, s45, 671744
  buffer_load_dwordx4 v152, s[16:19], s53 offen lds
  s_mov_b32 m0, 128000
  s_add_u32 s53, s45, 704512
  buffer_load_dwordx4 v153, s[16:19], s53 offen lds
  s_mov_b32 m0, 129024
  s_add_u32 s53, s45, 737280
  buffer_load_dwordx4 v152, s[16:19], s53 offen lds
  s_mov_b32 m0, 130048
  s_add_u32 s53, s45, 770048
  buffer_load_dwordx4 v153, s[16:19], s53 offen lds
  ds_read_b64_tr_b16 v[184:185], v156 offset:0
  ds_read_b64_tr_b16 v[186:187], v156 offset:36864
  ds_read_b64_tr_b16 v[188:189], v158 offset:0
  ds_read_b64_tr_b16 v[190:191], v158 offset:36864
  ds_read_b64_tr_b16 v[192:193], v157 offset:0
  ds_read_b64_tr_b16 v[194:195], v157 offset:36864
  ds_read_b64_tr_b16 v[196:197], v159 offset:0
  ds_read_b64_tr_b16 v[198:199], v159 offset:36864
  s_waitcnt lgkmcnt(0)
  ds_write_b128 v252, v[184:187] offset:32768
  ds_write_b128 v252, v[188:191] offset:33792
  ds_write_b128 v252, v[192:195] offset:34816
  ds_write_b128 v252, v[196:199] offset:35840
  s_waitcnt vmcnt(12)
  s_waitcnt lgkmcnt(0)
  s_barrier
  s_mov_b32 m0, 110592
  s_add_u32 s53, s45, 1196032
  buffer_load_dwordx4 v152, s[16:19], s53 offen lds
  s_mov_b32 m0, 111616
  s_add_u32 s53, s45, 1228800
  buffer_load_dwordx4 v153, s[16:19], s53 offen lds
  s_mov_b32 m0, 112640
  s_add_u32 s53, s45, 1261568
  buffer_load_dwordx4 v152, s[16:19], s53 offen lds
  s_mov_b32 m0, 113664
  s_add_u32 s53, s45, 1294336
  buffer_load_dwordx4 v153, s[16:19], s53 offen lds
  ds_read_b64_tr_b16 v[184:185], v156 offset:4096
  ds_read_b64_tr_b16 v[186:187], v156 offset:40960
  ds_read_b64_tr_b16 v[188:189], v158 offset:4096
  ds_read_b64_tr_b16 v[190:191], v158 offset:40960
  ds_read_b64_tr_b16 v[192:193], v157 offset:4096
  ds_read_b64_tr_b16 v[194:195], v157 offset:40960
  ds_read_b64_tr_b16 v[196:197], v159 offset:4096
  ds_read_b64_tr_b16 v[198:199], v159 offset:40960
  s_waitcnt lgkmcnt(0)
  ds_write_b128 v252, v[184:187] offset:20480
  ds_write_b128 v252, v[188:191] offset:21504
  ds_write_b128 v252, v[192:195] offset:22528
  ds_write_b128 v252, v[196:199] offset:23552
  s_waitcnt vmcnt(12)
  s_waitcnt lgkmcnt(0)
  s_barrier
  s_mov_b32 m0, 114688
  s_add_u32 s53, s45, 1720320
  buffer_load_dwordx4 v152, s[16:19], s53 offen lds
  s_mov_b32 m0, 115712
  s_add_u32 s53, s45, 1753088
  buffer_load_dwordx4 v153, s[16:19], s53 offen lds
  s_mov_b32 m0, 116736
  s_add_u32 s53, s45, 1785856
  buffer_load_dwordx4 v152, s[16:19], s53 offen lds
  s_mov_b32 m0, 117760
  s_add_u32 s53, s45, 1818624
  buffer_load_dwordx4 v153, s[16:19], s53 offen lds
  ds_read_b64_tr_b16 a[96:97], v156 offset:8192
  ds_read_b64_tr_b16 a[98:99], v156 offset:45056
  ds_read_b64_tr_b16 a[100:101], v158 offset:8192
  ds_read_b64_tr_b16 a[102:103], v158 offset:45056
  ds_read_b64_tr_b16 a[104:105], v157 offset:8192
  ds_read_b64_tr_b16 a[106:107], v157 offset:45056
  ds_read_b64_tr_b16 a[108:109], v159 offset:8192
  ds_read_b64_tr_b16 a[110:111], v159 offset:45056
  s_waitcnt vmcnt(12)
  s_waitcnt lgkmcnt(0)
  s_barrier
  s_mov_b32 m0, 118784
  s_add_u32 s53, s45, 2244608
  buffer_load_dwordx4 v152, s[16:19], s53 offen lds
  s_mov_b32 m0, 119808
  s_add_u32 s53, s45, 2277376
  buffer_load_dwordx4 v153, s[16:19], s53 offen lds
  s_mov_b32 m0, 120832
  s_add_u32 s53, s45, 2310144
  buffer_load_dwordx4 v152, s[16:19], s53 offen lds
  s_mov_b32 m0, 121856
  s_add_u32 s53, s45, 2342912
  buffer_load_dwordx4 v153, s[16:19], s53 offen lds
  ds_read_b64_tr_b16 a[192:193], v156 offset:12288
  ds_read_b64_tr_b16 a[194:195], v156 offset:49152
  ds_read_b64_tr_b16 a[196:197], v158 offset:12288
  ds_read_b64_tr_b16 a[198:199], v158 offset:49152
  ds_read_b64_tr_b16 a[200:201], v157 offset:12288
  ds_read_b64_tr_b16 a[202:203], v157 offset:49152
  ds_read_b64_tr_b16 a[204:205], v159 offset:12288
  ds_read_b64_tr_b16 a[206:207], v159 offset:49152
  s_waitcnt vmcnt(12)
  s_waitcnt lgkmcnt(0)
  s_barrier
  s_mov_b32 m0, 122880
  s_add_u32 s53, s45, 2768896
  buffer_load_dwordx4 v152, s[16:19], s53 offen lds
  s_mov_b32 m0, 123904
  s_add_u32 s53, s45, 2801664
  buffer_load_dwordx4 v153, s[16:19], s53 offen lds
  s_mov_b32 m0, 124928
  s_add_u32 s53, s45, 2834432
  buffer_load_dwordx4 v152, s[16:19], s53 offen lds
  s_mov_b32 m0, 125952
  s_add_u32 s53, s45, 2867200
  buffer_load_dwordx4 v153, s[16:19], s53 offen lds
  ds_read_b64_tr_b16 a[208:209], v156 offset:16384
  ds_read_b64_tr_b16 a[210:211], v156 offset:53248
  ds_read_b64_tr_b16 a[212:213], v158 offset:16384
  ds_read_b64_tr_b16 a[214:215], v158 offset:53248
  ds_read_b64_tr_b16 a[216:217], v157 offset:16384
  ds_read_b64_tr_b16 a[218:219], v157 offset:53248
  ds_read_b64_tr_b16 a[220:221], v159 offset:16384
  ds_read_b64_tr_b16 a[222:223], v159 offset:53248
  s_waitcnt vmcnt(12)
  s_waitcnt lgkmcnt(0)
  s_barrier
  s_mov_b32 m0, 126976
  s_add_u32 s53, s45, 3293184
  buffer_load_dwordx4 v152, s[16:19], s53 offen lds
  s_mov_b32 m0, 128000
  s_add_u32 s53, s45, 3325952
  buffer_load_dwordx4 v153, s[16:19], s53 offen lds
  s_mov_b32 m0, 129024
  s_add_u32 s53, s45, 3358720
  buffer_load_dwordx4 v152, s[16:19], s53 offen lds
  s_mov_b32 m0, 130048
  s_add_u32 s53, s45, 3391488
  buffer_load_dwordx4 v153, s[16:19], s53 offen lds
  ds_read_b64_tr_b16 a[224:225], v156 offset:0
  ds_read_b64_tr_b16 a[226:227], v156 offset:36864
  ds_read_b64_tr_b16 a[228:229], v158 offset:0
  ds_read_b64_tr_b16 a[230:231], v158 offset:36864
  ds_read_b64_tr_b16 a[232:233], v157 offset:0
  ds_read_b64_tr_b16 a[234:235], v157 offset:36864
  ds_read_b64_tr_b16 a[236:237], v159 offset:0
  ds_read_b64_tr_b16 a[238:239], v159 offset:36864
  s_waitcnt vmcnt(12)
  s_waitcnt lgkmcnt(0)
  s_barrier
  s_mov_b32 m0, 110592
  s_add_u32 s53, s45, 3817472
  buffer_load_dwordx4 v152, s[16:19], s53 offen lds
  s_mov_b32 m0, 111616
  s_add_u32 s53, s45, 3850240
  buffer_load_dwordx4 v153, s[16:19], s53 offen lds
  s_mov_b32 m0, 112640
  s_add_u32 s53, s45, 3883008
  buffer_load_dwordx4 v152, s[16:19], s53 offen lds
  s_mov_b32 m0, 113664
  s_add_u32 s53, s45, 3915776
  buffer_load_dwordx4 v153, s[16:19], s53 offen lds
  ds_read_b64_tr_b16 a[240:241], v156 offset:4096
  ds_read_b64_tr_b16 a[242:243], v156 offset:40960
  ds_read_b64_tr_b16 a[244:245], v158 offset:4096
  ds_read_b64_tr_b16 a[246:247], v158 offset:40960
  ds_read_b64_tr_b16 a[248:249], v157 offset:4096
  ds_read_b64_tr_b16 a[250:251], v157 offset:40960
  ds_read_b64_tr_b16 a[252:253], v159 offset:4096
  ds_read_b64_tr_b16 a[254:255], v159 offset:40960
  s_waitcnt vmcnt(12)
  s_waitcnt lgkmcnt(0)
  s_barrier
  s_mov_b32 m0, 114688
  s_add_u32 s53, s46, 10240
  buffer_load_dwordx4 v154, s[20:23], s53 offen lds
  s_mov_b32 m0, 115712
  s_add_u32 s53, s46, 26624
  buffer_load_dwordx4 v155, s[20:23], s53 offen lds
  s_mov_b32 m0, 116736
  s_add_u32 s53, s46, 14336
  buffer_load_dwordx4 v154, s[20:23], s53 offen lds
  s_mov_b32 m0, 117760
  s_add_u32 s53, s46, 30720
  buffer_load_dwordx4 v155, s[20:23], s53 offen lds
  ds_read_b64_tr_b16 v[0:1], v156 offset:8192
  ds_read_b64_tr_b16 v[2:3], v156 offset:45056
  ds_read_b64_tr_b16 v[4:5], v158 offset:8192
  ds_read_b64_tr_b16 v[6:7], v158 offset:45056
  ds_read_b64_tr_b16 v[8:9], v157 offset:8192
  ds_read_b64_tr_b16 v[10:11], v157 offset:45056
  ds_read_b64_tr_b16 v[12:13], v159 offset:8192
  ds_read_b64_tr_b16 v[14:15], v159 offset:45056
  s_waitcnt vmcnt(12)
  s_waitcnt lgkmcnt(0)
  s_barrier
  s_mov_b32 m0, 118784
  s_add_u32 s53, s46, 43008
  buffer_load_dwordx4 v154, s[20:23], s53 offen lds
  s_mov_b32 m0, 119808
  s_add_u32 s53, s46, 59392
  buffer_load_dwordx4 v155, s[20:23], s53 offen lds
  s_mov_b32 m0, 120832
  s_add_u32 s53, s46, 47104
  buffer_load_dwordx4 v154, s[20:23], s53 offen lds
  s_mov_b32 m0, 121856
  s_add_u32 s53, s46, 63488
  buffer_load_dwordx4 v155, s[20:23], s53 offen lds
  ds_read_b64_tr_b16 v[16:17], v156 offset:12288
  ds_read_b64_tr_b16 v[18:19], v156 offset:49152
  ds_read_b64_tr_b16 v[20:21], v158 offset:12288
  ds_read_b64_tr_b16 v[22:23], v158 offset:49152
  ds_read_b64_tr_b16 v[24:25], v157 offset:12288
  ds_read_b64_tr_b16 v[26:27], v157 offset:49152
  ds_read_b64_tr_b16 v[28:29], v159 offset:12288
  ds_read_b64_tr_b16 v[30:31], v159 offset:49152
  s_waitcnt vmcnt(12)
  s_waitcnt lgkmcnt(0)
  s_barrier
  s_mov_b32 m0, 122880
  s_add_u32 s53, s46, 75776
  buffer_load_dwordx4 v154, s[20:23], s53 offen lds
  s_mov_b32 m0, 123904
  s_add_u32 s53, s46, 92160
  buffer_load_dwordx4 v155, s[20:23], s53 offen lds
  s_mov_b32 m0, 124928
  s_add_u32 s53, s46, 79872
  buffer_load_dwordx4 v154, s[20:23], s53 offen lds
  s_mov_b32 m0, 125952
  s_add_u32 s53, s46, 96256
  buffer_load_dwordx4 v155, s[20:23], s53 offen lds
  ds_read_b64_tr_b16 a[160:161], v156 offset:16384
  ds_read_b64_tr_b16 a[162:163], v156 offset:53248
  ds_read_b64_tr_b16 a[164:165], v158 offset:16384
  ds_read_b64_tr_b16 a[166:167], v158 offset:53248
  ds_read_b64_tr_b16 a[168:169], v157 offset:16384
  ds_read_b64_tr_b16 a[170:171], v157 offset:53248
  ds_read_b64_tr_b16 a[172:173], v159 offset:16384
  ds_read_b64_tr_b16 a[174:175], v159 offset:53248
  buffer_load_dword v163, off, s[28:31], 0 offset:36 sc1
  buffer_load_dword v164, off, s[28:31], 0 offset:4 sc1
  s_waitcnt vmcnt(14)
  s_waitcnt lgkmcnt(0)
  s_barrier
  s_mov_b32 m0, 126976
  s_add_u32 s53, s46, 108544
  buffer_load_dwordx4 v154, s[20:23], s53 offen lds
  s_mov_b32 m0, 128000
  s_add_u32 s53, s46, 124928
  buffer_load_dwordx4 v155, s[20:23], s53 offen lds
  s_mov_b32 m0, 129024
  s_add_u32 s53, s46, 112640
  buffer_load_dwordx4 v154, s[20:23], s53 offen lds
  s_mov_b32 m0, 130048
  s_add_u32 s53, s46, 129024
  buffer_load_dwordx4 v155, s[20:23], s53 offen lds
  ds_read_b64_tr_b16 a[176:177], v156 offset:0
  ds_read_b64_tr_b16 a[178:179], v156 offset:36864
  ds_read_b64_tr_b16 a[180:181], v158 offset:0
  ds_read_b64_tr_b16 a[182:183], v158 offset:36864
  ds_read_b64_tr_b16 a[184:185], v157 offset:0
  ds_read_b64_tr_b16 a[186:187], v157 offset:36864
  ds_read_b64_tr_b16 a[188:189], v159 offset:0
  ds_read_b64_tr_b16 a[190:191], v159 offset:36864
  s_waitcnt vmcnt(14)
  s_waitcnt lgkmcnt(0)
  s_barrier
  s_mov_b32 m0, 110592
  s_add_u32 s53, s45, 147456
  buffer_load_dwordx4 v152, s[8:11], s53 offen lds
  s_mov_b32 m0, 111616
  s_add_u32 s53, s45, 180224
  buffer_load_dwordx4 v153, s[8:11], s53 offen lds
  s_mov_b32 m0, 112640
  s_add_u32 s53, s45, 212992
  buffer_load_dwordx4 v152, s[8:11], s53 offen lds
  s_mov_b32 m0, 113664
  s_add_u32 s53, s45, 245760
  buffer_load_dwordx4 v153, s[8:11], s53 offen lds
  ds_read_b64_tr_b16 v[64:65], v160 offset:4096
  ds_read_b64_tr_b16 v[66:67], v160 offset:40960
  ds_read_b64_tr_b16 v[68:69], v161 offset:4096
  ds_read_b64_tr_b16 v[70:71], v161 offset:40960
  ds_read_b64_tr_b16 v[72:73], v160 offset:4352
  ds_read_b64_tr_b16 v[74:75], v160 offset:41216
  ds_read_b64_tr_b16 v[76:77], v161 offset:4352
  ds_read_b64_tr_b16 v[78:79], v161 offset:41216
  s_waitcnt vmcnt(14)
  s_waitcnt lgkmcnt(0)
  s_barrier
  s_mov_b32 m0, 114688
  s_add_u32 s53, s45, 671744
  buffer_load_dwordx4 v152, s[8:11], s53 offen lds
  s_mov_b32 m0, 115712
  s_add_u32 s53, s45, 704512
  buffer_load_dwordx4 v153, s[8:11], s53 offen lds
  s_mov_b32 m0, 116736
  s_add_u32 s53, s45, 737280
  buffer_load_dwordx4 v152, s[8:11], s53 offen lds
  s_mov_b32 m0, 117760
  s_add_u32 s53, s45, 770048
  buffer_load_dwordx4 v153, s[8:11], s53 offen lds
  ds_read_b64_tr_b16 v[80:81], v160 offset:8192
  ds_read_b64_tr_b16 v[82:83], v160 offset:45056
  ds_read_b64_tr_b16 v[84:85], v161 offset:8192
  ds_read_b64_tr_b16 v[86:87], v161 offset:45056
  ds_read_b64_tr_b16 v[88:89], v160 offset:8448
  ds_read_b64_tr_b16 v[90:91], v160 offset:45312
  ds_read_b64_tr_b16 v[92:93], v161 offset:8448
  ds_read_b64_tr_b16 v[94:95], v161 offset:45312
  s_waitcnt vmcnt(14)
  s_waitcnt lgkmcnt(0)
  s_barrier
  s_mov_b32 m0, 118784
  s_add_u32 s53, s45, 1196032
  buffer_load_dwordx4 v152, s[8:11], s53 offen lds
  s_mov_b32 m0, 119808
  s_add_u32 s53, s45, 1228800
  buffer_load_dwordx4 v153, s[8:11], s53 offen lds
  s_mov_b32 m0, 120832
  s_add_u32 s53, s45, 1261568
  buffer_load_dwordx4 v152, s[8:11], s53 offen lds
  s_mov_b32 m0, 121856
  s_add_u32 s53, s45, 1294336
  buffer_load_dwordx4 v153, s[8:11], s53 offen lds
  ds_read_b64_tr_b16 v[96:97], v160 offset:12288
  ds_read_b64_tr_b16 v[98:99], v160 offset:49152
  ds_read_b64_tr_b16 v[100:101], v161 offset:12288
  ds_read_b64_tr_b16 v[102:103], v161 offset:49152
  ds_read_b64_tr_b16 v[104:105], v160 offset:12544
  ds_read_b64_tr_b16 v[106:107], v160 offset:49408
  ds_read_b64_tr_b16 v[108:109], v161 offset:12544
  ds_read_b64_tr_b16 v[110:111], v161 offset:49408
  s_waitcnt vmcnt(12)
  s_waitcnt lgkmcnt(0)
  s_barrier
  s_mov_b32 m0, 122880
  s_add_u32 s53, s45, 1720320
  buffer_load_dwordx4 v152, s[8:11], s53 offen lds
  s_mov_b32 m0, 123904
  s_add_u32 s53, s45, 1753088
  buffer_load_dwordx4 v153, s[8:11], s53 offen lds
  s_mov_b32 m0, 124928
  s_add_u32 s53, s45, 1785856
  buffer_load_dwordx4 v152, s[8:11], s53 offen lds
  s_mov_b32 m0, 125952
  s_add_u32 s53, s45, 1818624
  buffer_load_dwordx4 v153, s[8:11], s53 offen lds
  ds_read_b64_tr_b16 v[32:33], v160 offset:16384
  ds_read_b64_tr_b16 v[34:35], v160 offset:53248
  ds_read_b64_tr_b16 v[36:37], v161 offset:16384
  ds_read_b64_tr_b16 v[38:39], v161 offset:53248
  ds_read_b64_tr_b16 v[40:41], v160 offset:16640
  ds_read_b64_tr_b16 v[42:43], v160 offset:53504
  ds_read_b64_tr_b16 v[44:45], v161 offset:16640
  ds_read_b64_tr_b16 v[46:47], v161 offset:53504
  s_waitcnt vmcnt(12)
  s_waitcnt lgkmcnt(0)
  s_barrier
  s_mov_b32 m0, 126976
  s_add_u32 s53, s45, 2244608
  buffer_load_dwordx4 v152, s[8:11], s53 offen lds
  s_mov_b32 m0, 128000
  s_add_u32 s53, s45, 2277376
  buffer_load_dwordx4 v153, s[8:11], s53 offen lds
  s_mov_b32 m0, 129024
  s_add_u32 s53, s45, 2310144
  buffer_load_dwordx4 v152, s[8:11], s53 offen lds
  s_mov_b32 m0, 130048
  s_add_u32 s53, s45, 2342912
  buffer_load_dwordx4 v153, s[8:11], s53 offen lds
  ds_read_b64_tr_b16 a[0:1], v156 offset:0
  ds_read_b64_tr_b16 a[2:3], v156 offset:36864
  ds_read_b64_tr_b16 a[4:5], v158 offset:0
  ds_read_b64_tr_b16 a[6:7], v158 offset:36864
  ds_read_b64_tr_b16 a[8:9], v157 offset:0
  ds_read_b64_tr_b16 a[10:11], v157 offset:36864
  ds_read_b64_tr_b16 a[12:13], v159 offset:0
  ds_read_b64_tr_b16 a[14:15], v159 offset:36864
  v_readfirstlane_b32 s52, v163
  v_readfirstlane_b32 s53, v164
  s_lshl_b32 s58, s47, 29
  s_lshl_b32 s52, s52, 5
  s_or_b32 s52, s52, s58
  s_or_b32 s58, s58, 32
  s_and_b32 s52, s52, s53
  s_cmp_eq_u32 s52, s58
  s_cbranch_scc1 c_fl_701
c_wd_702:
  buffer_load_dword v236, off, s[28:31], 0 offset:36 sc1
  s_waitcnt vmcnt(0)
  v_readfirstlane_b32 s53, v236
  s_cmp_ge_u32 s53, 1
  s_cbranch_scc1 c_wdd_703
  s_cmp_eq_u32 s35, 0
  s_cbranch_scc1 c_wdd_703
  s_sub_u32 s35, s35, 1
  s_sleep 2
  s_branch c_wd_702
c_wdd_703:
c_wd_704:
  buffer_load_dword v236, off, s[28:31], 0 offset:4 sc1
  s_waitcnt vmcnt(0)
  v_readfirstlane_b32 s53, v236
  s_and_b32 s52, s53, s58
  s_cmp_eq_u32 s52, s58
  s_cbranch_scc1 c_wdd_705
  s_cmp_eq_u32 s35, 0
  s_cbranch_scc1 c_wdd_705
  s_sub_u32 s35, s35, 1
  s_sleep 2
  s_branch c_wd_704
c_wdd_705:
c_fl_701:
  s_bfe_u32 s34, s53, 0x80010
  s_waitcnt vmcnt(12)
  s_waitcnt lgkmcnt(0)
  s_barrier
  s_mov_b32 m0, 110592
  s_add_u32 s53, s45, 2768896
  buffer_load_dwordx4 v152, s[8:11], s53 offen lds
  s_mov_b32 m0, 111616
  s_add_u32 s53, s45, 2801664
  buffer_load_dwordx4 v153, s[8:11], s53 offen lds
  s_mov_b32 m0, 112640
  s_add_u32 s53, s45, 2834432
  buffer_load_dwordx4 v152, s[8:11], s53 offen lds
  s_mov_b32 m0, 113664
  s_add_u32 s53, s45, 2867200
  buffer_load_dwordx4 v153, s[8:11], s53 offen lds
  ds_read_b64_tr_b16 a[16:17], v156 offset:4096
  ds_read_b64_tr_b16 a[18:19], v156 offset:40960
  ds_read_b64_tr_b16 a[20:21], v158 offset:4096
  ds_read_b64_tr_b16 a[22:23], v158 offset:40960
  ds_read_b64_tr_b16 a[24:25], v157 offset:4096
  ds_read_b64_tr_b16 a[26:27], v157 offset:40960
  ds_read_b64_tr_b16 a[28:29], v159 offset:4096
  ds_read_b64_tr_b16 a[30:31], v159 offset:40960
  s_waitcnt vmcnt(12)
  s_waitcnt lgkmcnt(0)
  s_barrier
  s_mov_b32 m0, 114688
  s_add_u32 s53, s45, 3293184
  buffer_load_dwordx4 v152, s[8:11], s53 offen lds
  s_mov_b32 m0, 115712
  s_add_u32 s53, s45, 3325952
  buffer_load_dwordx4 v153, s[8:11], s53 offen lds
  s_mov_b32 m0, 116736
  s_add_u32 s53, s45, 3358720
  buffer_load_dwordx4 v152, s[8:11], s53 offen lds
  s_mov_b32 m0, 117760
  s_add_u32 s53, s45, 3391488
  buffer_load_dwordx4 v153, s[8:11], s53 offen lds
  ds_read_b64_tr_b16 a[32:33], v156 offset:8192
  ds_read_b64_tr_b16 a[34:35], v156 offset:45056
  ds_read_b64_tr_b16 a[36:37], v158 offset:8192
  ds_read_b64_tr_b16 a[38:39], v158 offset:45056
  ds_read_b64_tr_b16 a[40:41], v157 offset:8192
  ds_read_b64_tr_b16 a[42:43], v157 offset:45056
  ds_read_b64_tr_b16 a[44:45], v159 offset:8192
  ds_read_b64_tr_b16 a[46:47], v159 offset:45056
  s_waitcnt vmcnt(12)
  s_waitcnt lgkmcnt(0)
  s_barrier
  s_mov_b32 m0, 118784
  s_add_u32 s53, s45, 3817472
  buffer_load_dwordx4 v152, s[8:11], s53 offen lds
  s_mov_b32 m0, 119808
  s_add_u32 s53, s45, 3850240
  buffer_load_dwordx4 v153, s[8:11], s53 offen lds
  s_mov_b32 m0, 120832
  s_add_u32 s53, s45, 3883008
  buffer_load_dwordx4 v152, s[8:11], s53 offen lds
  s_mov_b32 m0, 121856
  s_add_u32 s53, s45, 3915776
  buffer_load_dwordx4 v153, s[8:11], s53 offen lds
  ds_read_b64_tr_b16 a[48:49], v156 offset:12288
  ds_read_b64_tr_b16 a[50:51], v156 offset:49152
  ds_read_b64_tr_b16 a[52:53], v158 offset:12288
  ds_read_b64_tr_b16 a[54:55], v158 offset:49152
  ds_read_b64_tr_b16 a[56:57], v157 offset:12288
  ds_read_b64_tr_b16 a[58:59], v157 offset:49152
  ds_read_b64_tr_b16 a[60:61], v159 offset:12288
  ds_read_b64_tr_b16 a[62:63], v159 offset:49152
  s_waitcnt vmcnt(12)
  s_waitcnt lgkmcnt(0)
  s_barrier
  s_mov_b32 m0, 122880
  s_add_u32 s53, s46, 10752
  buffer_load_dwordx4 v154, s[20:23], s53 offen lds
  s_mov_b32 m0, 123904
  s_add_u32 s53, s46, 27136
  buffer_load_dwordx4 v155, s[20:23], s53 offen lds
  s_mov_b32 m0, 124928
  s_add_u32 s53, s46, 14848
  buffer_load_dwordx4 v154, s[20:23], s53 offen lds
  s_mov_b32 m0, 125952
  s_add_u32 s53, s46, 31232
  buffer_load_dwordx4 v155, s[20:23], s53 offen lds
  ds_read_b64_tr_b16 a[64:65], v156 offset:16384
  ds_read_b64_tr_b16 a[66:67], v156 offset:53248
  ds_read_b64_tr_b16 a[68:69], v158 offset:16384
  ds_read_b64_tr_b16 a[70:71], v158 offset:53248
  ds_read_b64_tr_b16 a[72:73], v157 offset:16384
  ds_read_b64_tr_b16 a[74:75], v157 offset:53248
  ds_read_b64_tr_b16 a[76:77], v159 offset:16384
  ds_read_b64_tr_b16 a[78:79], v159 offset:53248
  s_waitcnt vmcnt(12)
  s_waitcnt lgkmcnt(0)
  s_barrier
  s_mov_b32 m0, 126976
  s_add_u32 s53, s46, 43520
  buffer_load_dwordx4 v154, s[20:23], s53 offen lds
  s_mov_b32 m0, 128000
  s_add_u32 s53, s46, 59904
  buffer_load_dwordx4 v155, s[20:23], s53 offen lds
  s_mov_b32 m0, 129024
  s_add_u32 s53, s46, 47616
  buffer_load_dwordx4 v154, s[20:23], s53 offen lds
  s_mov_b32 m0, 130048
  s_add_u32 s53, s46, 64000
  buffer_load_dwordx4 v155, s[20:23], s53 offen lds
  ds_read_b64_tr_b16 a[80:81], v156 offset:0
  ds_read_b64_tr_b16 a[82:83], v156 offset:36864
  ds_read_b64_tr_b16 a[84:85], v158 offset:0
  ds_read_b64_tr_b16 a[86:87], v158 offset:36864
  ds_read_b64_tr_b16 a[88:89], v157 offset:0
  ds_read_b64_tr_b16 a[90:91], v157 offset:36864
  ds_read_b64_tr_b16 a[92:93], v159 offset:0
  ds_read_b64_tr_b16 a[94:95], v159 offset:36864
  s_waitcnt vmcnt(12)
  s_waitcnt lgkmcnt(0)
  s_barrier
  s_mov_b32 m0, 110592
  s_add_u32 s53, s46, 76288
  buffer_load_dwordx4 v154, s[20:23], s53 offen lds
  s_mov_b32 m0, 111616
  s_add_u32 s53, s46, 92672
  buffer_load_dwordx4 v155, s[20:23], s53 offen lds
  s_mov_b32 m0, 112640
  s_add_u32 s53, s46, 80384
  buffer_load_dwordx4 v154, s[20:23], s53 offen lds
  s_mov_b32 m0, 113664
  s_add_u32 s53, s46, 96768
  buffer_load_dwordx4 v155, s[20:23], s53 offen lds
  ds_read_b64_tr_b16 v[184:185], v156 offset:4096
  ds_read_b64_tr_b16 v[186:187], v156 offset:40960
  ds_read_b64_tr_b16 v[188:189], v158 offset:4096
  ds_read_b64_tr_b16 v[190:191], v158 offset:40960
  ds_read_b64_tr_b16 v[192:193], v157 offset:4096
  ds_read_b64_tr_b16 v[194:195], v157 offset:40960
  ds_read_b64_tr_b16 v[196:197], v159 offset:4096
  ds_read_b64_tr_b16 v[198:199], v159 offset:40960
  s_waitcnt vmcnt(12)
  s_waitcnt lgkmcnt(0)
  s_barrier
  s_mov_b32 m0, 114688
  s_add_u32 s53, s46, 109056
  buffer_load_dwordx4 v154, s[20:23], s53 offen lds
  s_mov_b32 m0, 115712
  s_add_u32 s53, s46, 125440
  buffer_load_dwordx4 v155, s[20:23], s53 offen lds
  s_mov_b32 m0, 116736
  s_add_u32 s53, s46, 113152
  buffer_load_dwordx4 v154, s[20:23], s53 offen lds
  s_mov_b32 m0, 117760
  s_add_u32 s53, s46, 129536
  buffer_load_dwordx4 v155, s[20:23], s53 offen lds
  ds_read_b64_tr_b16 v[216:217], v156 offset:8192
  ds_read_b64_tr_b16 v[218:219], v156 offset:45056
  ds_read_b64_tr_b16 v[220:221], v158 offset:8192
  ds_read_b64_tr_b16 v[222:223], v158 offset:45056
  ds_read_b64_tr_b16 v[224:225], v157 offset:8192
  ds_read_b64_tr_b16 v[226:227], v157 offset:45056
  ds_read_b64_tr_b16 v[228:229], v159 offset:8192
  ds_read_b64_tr_b16 v[230:231], v159 offset:45056
  s_add_u32 s52, s51, 2048
  buffer_load_dword v165, off, s[4:7], s51 sc1
  buffer_load_dword v166, off, s[4:7], s52 sc1
  s_mov_b32 m0, 159744
  s_sub_u32 s52, s40, 1032192
  buffer_load_dword v232, s[4:7], s50 offen lds
  s_waitcnt vmcnt(15)
  s_waitcnt lgkmcnt(0)
  s_barrier
  ds_read_b64_tr_b16 v[200:201], v160 offset:12288
  ds_read_b64_tr_b16 v[202:203], v160 offset:49152
  ds_read_b64_tr_b16 v[204:205], v161 offset:12288
  ds_read_b64_tr_b16 v[206:207], v161 offset:49152
  ds_read_b64_tr_b16 v[208:209], v160 offset:12544
  ds_read_b64_tr_b16 v[210:211], v160 offset:49408
  ds_read_b64_tr_b16 v[212:213], v161 offset:12544
  ds_read_b64_tr_b16 v[214:215], v161 offset:49408
  ds_write_b128 v252, v[184:187] offset:8192
  ds_write_b128 v252, v[188:191] offset:9216
  ds_write_b128 v252, v[192:195] offset:10240
  ds_write_b128 v252, v[196:199] offset:11264
  s_waitcnt vmcnt(11)
  s_waitcnt lgkmcnt(0)
  s_barrier
  ds_read_b64_tr_b16 v[120:121], v160 offset:16384
  ds_read_b64_tr_b16 v[122:123], v160 offset:53248
  ds_read_b64_tr_b16 v[124:125], v161 offset:16384
  ds_read_b64_tr_b16 v[126:127], v161 offset:53248
  ds_read_b64_tr_b16 v[128:129], v160 offset:16640
  ds_read_b64_tr_b16 v[130:131], v160 offset:53504
  ds_read_b64_tr_b16 v[132:133], v161 offset:16640
  ds_read_b64_tr_b16 v[134:135], v161 offset:53504
  ds_write_b128 v252, v[216:219] offset:12288
  ds_write_b128 v252, v[220:223] offset:13312
  ds_write_b128 v252, v[224:227] offset:14336
  ds_write_b128 v252, v[228:231] offset:15360
  s_waitcnt vmcnt(7)
  s_waitcnt lgkmcnt(0)
  s_barrier
  ds_read_b64_tr_b16 v[136:137], v160 offset:0
  ds_read_b64_tr_b16 v[138:139], v160 offset:36864
  ds_read_b64_tr_b16 v[140:141], v161 offset:0
  ds_read_b64_tr_b16 v[142:143], v161 offset:36864
  ds_read_b64_tr_b16 v[144:145], v160 offset:256
  ds_read_b64_tr_b16 v[146:147], v160 offset:37120
  ds_read_b64_tr_b16 v[148:149], v161 offset:256
  ds_read_b64_tr_b16 v[150:151], v161 offset:37120
  ds_write_b128 v252, v[200:203] offset:16384
  ds_write_b128 v252, v[204:207] offset:17408
  ds_write_b128 v252, v[208:211] offset:18432
  ds_write_b128 v252, v[212:215] offset:19456
  s_waitcnt vmcnt(3)
  s_waitcnt lgkmcnt(0)
  s_barrier
  ds_read_b64_tr_b16 v[48:49], v160 offset:4096
  ds_read_b64_tr_b16 v[50:51], v160 offset:40960
  ds_read_b64_tr_b16 v[52:53], v161 offset:4096
  ds_read_b64_tr_b16 v[54:55], v161 offset:40960
  ds_read_b64_tr_b16 v[56:57], v160 offset:4352
  ds_read_b64_tr_b16 v[58:59], v160 offset:41216
  ds_read_b64_tr_b16 v[60:61], v161 offset:4352
  ds_read_b64_tr_b16 v[62:63], v161 offset:41216
  ds_write_b128 v252, v[120:123] offset:0
  ds_write_b128 v252, v[124:127] offset:1024
  ds_write_b128 v252, v[128:131] offset:2048
  ds_write_b128 v252, v[132:135] offset:3072
  s_mov_b32 m0, 159744
  s_waitcnt vmcnt(1)
  v_min_u32 v165, v165, v166
  s_cmp_lg_u32 s3, 0
  s_cselect_b32 s58, 0, 2
  v_readfirstlane_b32 s59, v165
  s_cmp_ge_u32 s59, s58
  s_cbranch_scc1 c_rdy_706
  s_xor_b32 s51, s51, 6144
c_sp_707:
  buffer_load_dword v236, off, s[4:7], s51 sc1
  s_waitcnt vmcnt(0)
  v_readfirstlane_b32 s59, v236
  s_cmp_ge_u32 s59, s58
  s_cbranch_scc1 c_spd_708
  s_cmp_eq_u32 s35, 0
  s_cbranch_scc1 c_spd_708
  s_sub_u32 s35, s35, 1
  s_sleep 2
  s_branch c_sp_707
c_spd_708:
  s_xor_b32 s51, s51, 6144
c_sp_709:
  buffer_load_dword v236, off, s[4:7], s51 sc1
  s_waitcnt vmcnt(0)
  v_readfirstlane_b32 s59, v236
  s_cmp_ge_u32 s59, s58
  s_cbranch_scc1 c_spd_710
  s_cmp_eq_u32 s35, 0
  s_cbranch_scc1 c_spd_710
  s_sub_u32 s35, s35, 1
  s_sleep 2
  s_branch c_sp_709
c_spd_710:
c_rdy_706:
  buffer_load_dwordx4 v[168:171], v253, s[4:7], s41 offen sc1
  buffer_load_dwordx4 v[172:175], v253, s[4:7], s41 offen offset:1024 sc1
  s_add_u32 s50, s50, 8192
  s_add_u32 s41, s41, 262144
  v_mov_b32 v233, v167
  s_and_b32 s52, s36, 31
  s_lshl_b32 s52, s52, 1
  s_lshl_b64 s[24:25], 3, s52
  s_mov_b32 s26, 0x000f000f
  s_mov_b32 s27, 0x000f000f
  s_waitcnt lgkmcnt(0)
  s_barrier
  ds_write_b128 v252, v[136:139] offset:4096
  ds_write_b128 v252, v[140:143] offset:5120
  ds_write_b128 v252, v[144:147] offset:6144
  ds_write_b128 v252, v[148:151] offset:7168
  s_waitcnt lgkmcnt(0)
  ds_read_b128 v[200:203], v252 offset:20480
  ds_read_b128 v[204:207], v252 offset:21504
  ds_read_b128 v[208:211], v252 offset:22528
  ds_read_b128 v[212:215], v252 offset:23552
  v_mov_b64 v[144:145], 0
  v_mov_b64 v[146:147], 0
  s_nop 0
  v_mov_b64 v[148:149], 0
  v_mov_b64 v[150:151], 0
  s_nop 0
  v_mov_b64 v[152:153], 0
  v_mov_b64 v[154:155], 0
  s_nop 0
  v_mov_b64 v[156:157], 0
  v_mov_b64 v[158:159], 0
  s_nop 0
  v_mov_b64 v[160:161], 0
  v_mov_b64 v[162:163], 0
  s_nop 0
  v_mov_b64 v[164:165], 0
  v_mov_b64 v[166:167], 0
  s_nop 0
  s_waitcnt lgkmcnt(0)
  s_cmp_lg_u32 s34, 0
  s_cbranch_scc1 c_entry_1_3
  s_branch c_entry_0_3
.p2align 6
c_top_0_0:
  s_waitcnt vmcnt(3)
  v_max3_u32 v238, v112, v113, v114
  s_waitcnt vmcnt(2)
  v_max3_u32 v238, v238, v115, v116
  v_max3_u32 v238, v238, v117, v118
  v_max_u32 v238, v238, v119
  v_cmp_eq_u32 vcc, -1, v238
  ds_write_b128 v253, v[112:115] offset:0
  s_cbranch_vccnz c_bad_0_0
c_okL_0_0:
  ds_write_b128 v253, v[116:119] offset:1024
  v_smfmac_f32_16x16x64_bf16 v[144:147], v[112:115], v[184:191], v240
  v_smfmac_f32_16x16x64_bf16 v[148:151], v[112:115], v[192:199], v240
  v_smfmac_f32_16x16x64_bf16 v[152:155], v[112:115], v[200:207], v240
  v_smfmac_f32_16x16x64_bf16 v[156:159], v[112:115], v[208:215], v240
  v_smfmac_f32_16x16x64_bf16 v[144:147], v[116:119], v[216:223], v240
  v_smfmac_f32_16x16x64_bf16 v[148:151], v[116:119], v[224:231], v240
  s_waitcnt lgkmcnt(0)
  s_barrier
  ds_read_b128 v[120:123], v253 offset:2048
  ds_read_b128 v[124:127], v253 offset:3072
  v_smfmac_f32_16x16x64_bf16 v[152:155], v[116:119], a[96:103], v240
  buffer_load_dwordx4 v[176:179], v253, s[4:7], s42 offen offset:0 sc1
  ds_read_b128 v[128:131], v253 offset:4096
  ds_read_b128 v[132:135], v253 offset:5120
  v_smfmac_f32_16x16x64_bf16 v[156:159], v[116:119], a[104:111], v240
  ds_read_b128 v[136:139], v253 offset:6144
  ds_read_b128 v[140:143], v253 offset:7168
  v_smfmac_f32_16x16x64_bf16 v[160:163], v[112:115], a[160:167], v240
  v_smfmac_f32_16x16x64_bf16 v[164:167], v[112:115], a[168:175], v240
  v_lshlrev_b32 v234, 7, v252
  s_waitcnt lgkmcnt(5)
  v_smfmac_f32_16x16x64_bf16 v[144:147], v[120:123], a[0:7], v240
  buffer_load_dwordx4 v[180:183], v253, s[4:7], s42 offen offset:1024 sc1
  ds_read_b128 v[184:187], v252 offset:24576
  s_waitcnt lgkmcnt(5)
  v_smfmac_f32_16x16x64_bf16 v[144:147], v[124:127], a[16:23], v240
  ds_read_b128 v[188:191], v252 offset:25600
  s_waitcnt lgkmcnt(5)
  v_smfmac_f32_16x16x64_bf16 v[144:147], v[128:131], a[32:39], v240
  ds_read_b128 v[192:195], v252 offset:28672
  s_waitcnt lgkmcnt(5)
  v_smfmac_f32_16x16x64_bf16 v[144:147], v[132:135], a[48:55], v240
  ds_read_b128 v[196:199], v252 offset:29696
  s_waitcnt lgkmcnt(5)
  v_smfmac_f32_16x16x64_bf16 v[144:147], v[136:139], a[64:71], v240
  buffer_store_dword v233, v241, s[4:7], s48 offen sc1
  s_add_u32 s48, s49, 8388608
  ds_read_b128 v[200:203], v252 offset:32768
  s_waitcnt lgkmcnt(5)
  v_smfmac_f32_16x16x64_bf16 v[144:147], v[140:143], a[80:87], v240
  ds_read_b128 v[204:207], v252 offset:33792
  v_smfmac_f32_16x16x64_bf16 v[148:151], v[120:123], a[8:15], v240
  ds_read_b128 v[208:211], v252 offset:26624
  v_smfmac_f32_16x16x64_bf16 v[148:151], v[124:127], a[24:31], v240
  ds_read_b128 v[212:215], v252 offset:27648
  v_cvt_pk_bf16_f32 v232, v144, v145
  v_smfmac_f32_16x16x64_bf16 v[148:151], v[128:131], a[40:47], v240
  ds_read_b128 v[216:219], v252 offset:30720
  v_cvt_pk_bf16_f32 v233, v146, v147
  v_smfmac_f32_16x16x64_bf16 v[148:151], v[132:135], a[56:63], v240
  ds_read_b128 v[220:223], v252 offset:31744
  v_mfma_f32_16x16x16_bf16 v[144:147], v[232:233], v[242:243], 0
  ds_read_b128 v[224:227], v252 offset:34816
  v_smfmac_f32_16x16x64_bf16 v[148:151], v[136:139], a[72:79], v240
  ds_read_b128 v[228:231], v252 offset:35840
  v_smfmac_f32_16x16x64_bf16 v[148:151], v[140:143], a[88:95], v240
  s_mov_b64 exec, 3
  buffer_load_dword v234, s[4:7], s51 offen sc1 lds
  s_mov_b64 exec, -1
  v_cvt_pk_bf16_f32 v236, v144, v145
  v_smfmac_f32_16x16x64_bf16 v[152:155], v[120:123], a[112:119], v240
  v_cvt_pk_bf16_f32 v237, v146, v147
  v_smfmac_f32_16x16x64_bf16 v[152:155], v[124:127], a[128:135], v240
  v_cvt_pk_bf16_f32 v234, v148, v149
  v_cvt_pk_bf16_f32 v235, v150, v151
  v_smfmac_f32_16x16x64_bf16 v[152:155], v[128:131], a[144:151], v240
  v_mfma_f32_16x16x16_bf16 v[148:151], v[234:235], v[242:243], 0
  s_waitcnt lgkmcnt(0)
  v_smfmac_f32_16x16x64_bf16 v[152:155], v[132:135], v[184:191], v240
  v_smfmac_f32_16x16x64_bf16 v[152:155], v[136:139], v[192:199], v240
  v_cvt_pk_bf16_f32 v238, v148, v149
  v_cvt_pk_bf16_f32 v239, v150, v151
  v_smfmac_f32_16x16x64_bf16 v[152:155], v[140:143], v[200:207], v240
  s_waitcnt vmcnt(4)
  v_mfma_f32_16x16x32_bf16 v[144:147], v[168:171], v[236:239], 0
  v_mfma_f32_16x16x32_bf16 v[148:151], v[172:175], v[236:239], 0
  v_cvt_pk_bf16_f32 v232, v152, v153
  v_cvt_pk_bf16_f32 v233, v154, v155
  v_smfmac_f32_16x16x64_bf16 v[156:159], v[120:123], a[120:127], v240
  v_mfma_f32_16x16x16_bf16 v[152:155], v[232:233], v[244:245], 0
  v_cndmask_b32 v144, v144, v148, s[98:99]
  v_cndmask_b32 v145, v145, v149, s[98:99]
  v_cndmask_b32 v146, v146, v150, s[98:99]
  v_cndmask_b32 v147, v147, v151, s[98:99]
  v_smfmac_f32_16x16x64_bf16 v[156:159], v[124:127], a[136:143], v240
  buffer_load_dwordx4 v[168:171], v253, s[4:7], s41 offen offset:0 sc1
  ds_write_b128 v253, v[144:147] offset:8192
  v_smfmac_f32_16x16x64_bf16 v[156:159], v[128:131], a[152:159], v240
  v_cvt_pk_bf16_f32 v200, v152, v153
  v_smfmac_f32_16x16x64_bf16 v[156:159], v[132:135], v[208:215], v240
  v_cvt_pk_bf16_f32 v201, v154, v155
  v_smfmac_f32_16x16x64_bf16 v[156:159], v[136:139], v[216:223], v240
  v_smfmac_f32_16x16x64_bf16 v[156:159], v[140:143], v[224:231], v240
  buffer_load_dwordx4 v[172:175], v253, s[4:7], s41 offen offset:1024 sc1
  v_smfmac_f32_16x16x64_bf16 v[160:163], v[120:123], a[192:199], v240
  v_smfmac_f32_16x16x64_bf16 v[164:167], v[120:123], a[200:207], v240
  v_cvt_pk_bf16_f32 v234, v156, v157
  v_cvt_pk_bf16_f32 v235, v158, v159
  s_waitcnt lgkmcnt(0)
  s_barrier
  v_mfma_f32_16x16x16_bf16 v[156:159], v[234:235], v[244:245], 0
  ds_read_b128 v[184:187], v253 offset:8192
  ds_read_b128 v[188:191], v253 offset:9216
  v_smfmac_f32_16x16x64_bf16 v[160:163], v[124:127], a[208:215], v240
  ds_read_b128 v[192:195], v253 offset:10240
  ds_read_b128 v[196:199], v253 offset:11264
  v_smfmac_f32_16x16x64_bf16 v[164:167], v[124:127], a[216:223], v240
  v_cvt_pk_bf16_f32 v202, v156, v157
  v_cvt_pk_bf16_f32 v203, v158, v159
  v_smfmac_f32_16x16x64_bf16 v[160:163], v[128:131], a[224:231], v240
  v_mfma_f32_16x16x32_bf16 v[152:155], v[200:203], v[236:239], 0
  v_smfmac_f32_16x16x64_bf16 v[164:167], v[128:131], a[232:239], v240
  v_smfmac_f32_16x16x64_bf16 v[160:163], v[132:135], a[240:247], v240
  ds_write_b64 v253, v[152:153] offset:0
  s_waitcnt lgkmcnt(1)
  v_pk_add_f32 v[184:185], v[184:185], v[188:189]
  v_pk_add_f32 v[186:187], v[186:187], v[190:191]
  v_pk_add_f32 v[192:193], v[192:193], v[196:197]
  v_pk_add_f32 v[194:195], v[194:195], v[198:199]
  v_pk_add_f32 v[184:185], v[184:185], v[192:193]
  v_pk_add_f32 v[186:187], v[186:187], v[194:195]
  v_exp_f32 v188, v184
  v_exp_f32 v189, v185
  v_smfmac_f32_16x16x64_bf16 v[160:163], v[116:119], a[176:183], v240
  v_smfmac_f32_16x16x64_bf16 v[164:167], v[116:119], a[184:191], v240
  v_smfmac_f32_16x16x64_bf16 v[164:167], v[132:135], a[248:255], v240
  s_waitcnt lgkmcnt(0)
  s_barrier
  ds_read_b128 v[208:211], v254 offset:0
  v_smfmac_f32_16x16x64_bf16 v[160:163], v[136:139], v[0:7], v240
  ds_read_b128 v[216:219], v252 offset:16384
  ds_read_b128 v[220:223], v252 offset:17408
  v_exp_f32 v190, v186
  v_exp_f32 v191, v187
  v_cvt_pk_bf16_f32 v188, v188, v189
  v_cvt_pk_bf16_f32 v189, v190, v191
  v_smfmac_f32_16x16x64_bf16 v[160:163], v[140:143], v[16:23], v240
  ds_read_b128 v[224:227], v252 offset:18432
  ds_read_b128 v[228:231], v252 offset:19456
  v_mov_b32_dpp v192, v188 quad_perm:[0,1,0,1] row_mask:0xf bank_mask:0xf
  v_mfma_f32_16x16x16_bf16 v[196:199], v[246:247], v[188:189], 0
  v_mov_b32_dpp v193, v189 quad_perm:[0,1,0,1] row_mask:0xf bank_mask:0xf
  v_mov_b32_dpp v194, v188 quad_perm:[2,3,2,3] row_mask:0xf bank_mask:0xf
  v_mov_b32_dpp v195, v189 quad_perm:[2,3,2,3] row_mask:0xf bank_mask:0xf
  v_smfmac_f32_16x16x64_bf16 v[164:167], v[136:139], v[8:15], v240
  s_waitcnt lgkmcnt(4)
  v_add_f32 v208, v208, v210
  v_smfmac_f32_16x16x64_bf16 v[164:167], v[140:143], v[24:31], v240
  ds_read_b128 v[112:115], v252 offset:0
  ds_read_b128 v[116:119], v252 offset:1024
  v_add_f32 v209, v209, v211
  s_waitcnt vmcnt(4)
  v_mfma_f32_16x16x32_bf16 v[144:147], v[176:179], v[192:195], 0
  ds_read_b128 v[128:131], v252 offset:4096
  v_add_f32_dpp v208, v208, v208 quad_perm:[2,3,0,1] row_mask:0xf bank_mask:0xf
  v_add_f32_dpp v209, v209, v209 quad_perm:[2,3,0,1] row_mask:0xf bank_mask:0xf
  v_mfma_f32_16x16x32_bf16 v[148:151], v[180:183], v[192:195], 0
  ds_read_b128 v[132:135], v252 offset:5120
  v_exp_f32 v210, v208
  v_exp_f32 v211, v209
  v_add_f32_dpp v196, v196, v196 quad_perm:[2,3,0,1] row_mask:0xf bank_mask:0xf
  v_cvt_pk_bf16_f32 v232, v210, v211
  v_cvt_pk_bf16_f32 v233, v210, v211
  v_add_f32 v196, v196, v196
  v_cvt_pk_bf16_f32 v204, v160, v161
  v_cvt_pk_bf16_f32 v205, v162, v163
  v_mfma_f32_16x16x16_bf16 v[196:199], v[246:247], v[232:233], v[196:199]
  v_cvt_pk_bf16_f32 v206, v164, v165
  v_cvt_pk_bf16_f32 v207, v166, v167
  v_mov_b64 v[152:153], 0
  v_mfma_f32_16x16x16_bf16 v[144:147], v[204:205], v[232:233], v[144:147]
  v_mov_b64 v[154:155], 0
  v_mov_b64 v[156:157], 0
  v_mov_b64 v[158:159], 0
  v_mfma_f32_16x16x16_bf16 v[148:151], v[206:207], v[232:233], v[148:151]
  v_rcp_f32 v234, v196
  v_mov_b64 v[188:189], 0
  v_mov_b64 v[190:191], 0
  v_max_f32 v235, v196, v234
  v_pk_mul_f32 v[144:145], v[144:145], v[234:235] op_sel_hi:[1,0]
  v_pk_mul_f32 v[146:147], v[146:147], v[234:235] op_sel_hi:[1,0]
  v_cvt_pk_bf16_f32 v160, v144, v145
  v_cvt_pk_bf16_f32 v161, v146, v147
  v_pk_mul_f32 v[148:149], v[148:149], v[234:235] op_sel_hi:[1,0]
  v_pk_mul_f32 v[150:151], v[150:151], v[234:235] op_sel_hi:[1,0]
  v_cvt_pk_bf16_f32 v162, v148, v149
  v_cvt_pk_bf16_f32 v163, v150, v151
  ds_write_b128 v253, v[160:163] offset:8192
  s_nop 0
  v_smfmac_f32_16x16x64_bf16 v[152:155], v[160:163], v[32:39], v240
  v_cmp_ngt_f32 vcc, s54, v235
  v_smfmac_f32_16x16x64_bf16 v[156:159], v[160:163], v[40:47], v240
  v_mov_b64 v[236:237], 0
  v_mov_b64 v[238:239], 0
  s_cbranch_vccnz c_slow_0_0
c_back_0_0:
  s_waitcnt lgkmcnt(0)
  s_barrier
  ds_read_b128 v[164:167], v253 offset:9216
  ds_read_b128 v[192:195], v253 offset:10240
  ds_read_b128 v[212:215], v253 offset:11264
  v_smfmac_f32_16x16x64_bf16 v[188:191], v[160:163], v[48:55], v240
  ds_read_b128 v[120:123], v252 offset:2048
  v_smfmac_f32_16x16x64_bf16 v[236:239], v[160:163], v[56:63], v240
  s_waitcnt lgkmcnt(3)
  v_smfmac_f32_16x16x64_bf16 v[152:155], v[164:167], v[64:71], v240
  ds_read_b128 v[124:127], v252 offset:3072
  s_add_u32 s37, s37, 1
  s_waitcnt lgkmcnt(3)
  v_smfmac_f32_16x16x64_bf16 v[152:155], v[192:195], v[80:87], v240
  ds_read_b128 v[136:139], v252 offset:6144
  s_add_u32 s38, s38, 8192
  s_waitcnt lgkmcnt(3)
  v_smfmac_f32_16x16x64_bf16 v[152:155], v[212:215], v[96:103], v240
  ds_read_b128 v[140:143], v252 offset:7168
  s_add_u32 s41, s41, 262144
  v_smfmac_f32_16x16x64_bf16 v[156:159], v[164:167], v[72:79], v240
  s_add_u32 s42, s42, 262144
  s_add_u32 s50, s50, 262144
  v_smfmac_f32_16x16x64_bf16 v[156:159], v[192:195], v[88:95], v240
  v_cvt_pk_bf16_f32 v144, v152, v153
  v_cvt_pk_bf16_f32 v145, v154, v155
  v_bfi_b32 v144, 1, s44, v144
  v_smfmac_f32_16x16x64_bf16 v[156:159], v[212:215], v[104:111], v240
  buffer_store_dwordx2 v[144:145], v255, s[4:7], s39 offen offset:0
  v_smfmac_f32_16x16x64_bf16 v[188:191], v[164:167], v[216:223], v240
  s_add_u32 s58, s37, 2
  s_min_u32 s58, s58, 63
  v_smfmac_f32_16x16x64_bf16 v[188:191], v[192:195], v[112:119], v240
  v_cvt_pk_bf16_f32 v146, v156, v157
  v_cvt_pk_bf16_f32 v147, v158, v159
  v_bfi_b32 v146, 1, s44, v146
  v_smfmac_f32_16x16x64_bf16 v[188:191], v[212:215], v[128:135], v240
  buffer_store_dwordx2 v[146:147], v255, s[4:7], s39 offen offset:2048
  v_smfmac_f32_16x16x64_bf16 v[236:239], v[164:167], v[224:231], v240
  s_waitcnt lgkmcnt(0)
  v_smfmac_f32_16x16x64_bf16 v[236:239], v[192:195], v[120:127], v240
  v_cvt_pk_bf16_f32 v148, v188, v189
  v_cvt_pk_bf16_f32 v149, v190, v191
  v_bfi_b32 v148, 1, s44, v148
  v_smfmac_f32_16x16x64_bf16 v[236:239], v[212:215], v[136:143], v240
  buffer_store_dwordx2 v[148:149], v255, s[4:7], s43 offen offset:0
  s_nop 6
  v_cvt_pk_bf16_f32 v150, v236, v237
  v_cvt_pk_bf16_f32 v151, v238, v239
  v_bfi_b32 v150, 1, s44, v150
  buffer_store_dwordx2 v[150:151], v255, s[4:7], s43 offen offset:2048
  s_waitcnt vmcnt(2)
c_pfd_0_0:
  buffer_load_dwordx4 v[120:123], v253, s[4:7], s40 offen offset:0 sc1
  buffer_load_dwordx4 v[124:127], v253, s[4:7], s40 offen offset:1024 sc1
  v_mov_b64 v[152:153], 0
  v_mov_b64 v[154:155], 0
  v_mov_b64 v[156:157], 0
  v_mov_b64 v[158:159], 0
  v_mov_b64 v[160:161], 0
  v_mov_b64 v[162:163], 0
  v_mov_b64 v[164:165], 0
  v_mov_b64 v[166:167], 0
  v_mov_b64 v[144:145], 0
  v_mov_b64 v[146:147], 0
  v_mov_b64 v[148:149], 0
  v_mov_b64 v[150:151], 0
  s_cmp_lg_u32 s44, 0
  s_cbranch_scc1 c_h1c1_0_0
c_h1c0_0_0:
  s_waitcnt vmcnt(1)
  v_mfma_f32_16x16x32_bf16 v[236:239], v[248:251], v[120:123], 0
  s_waitcnt vmcnt(0)
  v_mfma_f32_16x16x32_bf16 v[236:239], v[248:251], v[124:127], v[236:239]
  v_bitop3_b32 v232, v120, v122, v124 bitop3:0xfe
  v_bitop3_b32 v232, v232, v126, 1 bitop3:0xa8
  v_cmp_ne_u32 vcc, 0, v232
  s_nop 4
  v_add_f32_dpp v236, v236, v236 row_ror:4 row_mask:0xf bank_mask:0xf
  v_add_f32_dpp v237, v237, v237 row_ror:4 row_mask:0xf bank_mask:0xf
  s_nop 0
  v_add_f32_dpp v236, v236, v236 row_ror:8 row_mask:0xf bank_mask:0xf
  v_add_f32_dpp v237, v237, v237 row_ror:8 row_mask:0xf bank_mask:0xf
  v_cvt_pk_bf16_f32 v233, v236, v237
  s_cbranch_vccnz c_h1b0_0_0
c_h1ok0_0_0:
  buffer_store_dword v233, v241, s[4:7], s49 offen
c_pub_0_0:
  s_xor_b32 s44, s44, 1
  s_add_u32 s49, s49, 8192
  s_cmp_eq_u32 s37, s57
  s_cbranch_scc1 c_fin_0_0
  ds_read_b64 v[236:237], v253 offset:13312
  s_waitcnt lgkmcnt(0)
  v_min_u32 v236, v236, v237
  s_nop 0
  v_readfirstlane_b32 s59, v236
  s_cmp_lt_u32 s59, s58
  s_cbranch_scc1 c_prg_0_0
c_prgok_0_0:
  ds_read_b128 v[184:187], v252 offset:8192
  ds_read_b128 v[188:191], v252 offset:9216
  ds_read_b128 v[192:195], v252 offset:10240
  ds_read_b128 v[196:199], v252 offset:11264
  ds_read_b128 v[200:203], v252 offset:20480
  ds_read_b128 v[204:207], v252 offset:21504
  s_waitcnt lgkmcnt(0)
  buffer_load_dwordx4 v[112:115], v253, s[4:7], s38 offen sc1
  buffer_load_dwordx4 v[116:119], v253, s[4:7], s38 offen offset:1024 sc1
  ds_read_b128 v[208:211], v252 offset:22528
  ds_read_b128 v[212:215], v252 offset:23552
  ds_read_b128 v[216:219], v252 offset:12288
  ds_read_b128 v[220:223], v252 offset:13312
  ds_read_b128 v[224:227], v252 offset:14336
  ds_read_b128 v[228:231], v252 offset:15360
  s_waitcnt lgkmcnt(0)
  buffer_load_dwordx4 v[112:115], v253, s[4:7], s38 offen sc1
  buffer_load_dwordx4 v[116:119], v253, s[4:7], s38 offen offset:1024 sc1
  s_branch c_top_0_0
c_fin_0_0:
  buffer_store_dword v233, v241, s[4:7], s48 offen sc1
  s_nop 7
  s_mov_b64 exec, 1
  s_waitcnt vmcnt(0)
  s_endpgm
  s_nop 7
c_bad_0_0:
  s_mov_b64 exec, vcc
  buffer_load_dwordx4 v[112:115], v253, s[4:7], s38 offen sc1
  buffer_load_dwordx4 v[116:119], v253, s[4:7], s38 offen offset:1024 sc1
  s_mov_b64 exec, -1
  s_cmp_eq_u32 s35, 0
  s_cbranch_scc1 c_okL_0_0
  s_sub_u32 s35, s35, 1
  s_branch c_top_0_0
c_entry_0_0:
  ds_write_b128 v253, v[112:115] offset:0
  s_branch c_okL_0_0
c_slow_0_0:
  s_nop 15
  v_max3_f32 v234, v184, v185, v186
  v_max3_f32 v234, v234, v187, v208
  v_max_f32 v234, v234, v209
  s_nop 1
  v_max_f32_dpp v234, v234, v234 quad_perm:[2,3,0,1] row_mask:0xf bank_mask:0xf
  v_mov_b32 v235, v234
  s_nop 1
  v_permlane16_swap_b32 v234, v235
  s_nop 1
  v_max_f32 v234, v234, v235
  v_mov_b32 v235, v234
  s_nop 1
  v_permlane32_swap_b32 v234, v235
  s_nop 1
  v_max_f32 v234, v234, v235
  v_sub_f32 v188, v184, v234
  v_sub_f32 v189, v185, v234
  v_sub_f32 v190, v186, v234
  v_sub_f32 v191, v187, v234
  v_sub_f32 v210, v208, v234
  v_sub_f32 v211, v209, v234
  v_exp_f32 v188, v188
  v_exp_f32 v189, v189
  v_exp_f32 v190, v190
  v_exp_f32 v191, v191
  v_cvt_pk_bf16_f32 v188, v188, v189
  v_cvt_pk_bf16_f32 v189, v190, v191
  s_nop 1
  v_mfma_f32_16x16x16_bf16 v[196:199], v[246:247], v[188:189], 0
  v_mov_b32_dpp v192, v188 quad_perm:[0,1,0,1] row_mask:0xf bank_mask:0xf
  v_mov_b32_dpp v193, v189 quad_perm:[0,1,0,1] row_mask:0xf bank_mask:0xf
  v_mov_b32_dpp v194, v188 quad_perm:[2,3,2,3] row_mask:0xf bank_mask:0xf
  v_mov_b32_dpp v195, v189 quad_perm:[2,3,2,3] row_mask:0xf bank_mask:0xf
  v_exp_f32 v210, v210
  v_exp_f32 v211, v211
  v_mfma_f32_16x16x32_bf16 v[144:147], v[176:179], v[192:195], 0
  s_nop 0
  v_add_f32_dpp v196, v196, v196 quad_perm:[2,3,0,1] row_mask:0xf bank_mask:0xf
  v_cvt_pk_bf16_f32 v232, v210, v211
  v_mfma_f32_16x16x32_bf16 v[148:151], v[180:183], v[192:195], 0
  v_cvt_pk_bf16_f32 v233, v210, v211
  v_add_f32 v196, v196, v196
  s_nop 1
  v_mfma_f32_16x16x16_bf16 v[196:199], v[246:247], v[232:233], v[196:199]
  v_mfma_f32_16x16x16_bf16 v[144:147], v[204:205], v[232:233], v[144:147]
  v_mfma_f32_16x16x16_bf16 v[148:151], v[206:207], v[232:233], v[148:151]
  s_waitcnt lgkmcnt(0)
  v_rcp_f32 v234, v196
  s_nop 1
  v_pk_mul_f32 v[144:145], v[144:145], v[234:235] op_sel_hi:[1,0]
  v_pk_mul_f32 v[146:147], v[146:147], v[234:235] op_sel_hi:[1,0]
  v_cvt_pk_bf16_f32 v160, v144, v145
  v_cvt_pk_bf16_f32 v161, v146, v147
  v_pk_mul_f32 v[148:149], v[148:149], v[234:235] op_sel_hi:[1,0]
  v_pk_mul_f32 v[150:151], v[150:151], v[234:235] op_sel_hi:[1,0]
  v_cvt_pk_bf16_f32 v162, v148, v149
  v_cvt_pk_bf16_f32 v163, v150, v151
  ds_write_b128 v253, v[160:163] offset:8192
  v_mov_b64 v[152:153], 0
  v_mov_b64 v[154:155], 0
  v_mov_b64 v[156:157], 0
  v_mov_b64 v[158:159], 0
  v_mov_b64 v[188:189], 0
  v_mov_b64 v[190:191], 0
  v_mov_b64 v[236:237], 0
  v_mov_b64 v[238:239], 0
  v_smfmac_f32_16x16x64_bf16 v[152:155], v[160:163], v[32:39], v240
  v_smfmac_f32_16x16x64_bf16 v[156:159], v[160:163], v[40:47], v240
  s_nop 7
  s_branch c_back_0_0
c_h1c1_0_0:
  s_waitcnt vmcnt(1)
  v_mfma_f32_16x16x32_bf16 v[236:239], v[248:251], v[120:123], 0
  s_waitcnt vmcnt(0)
  v_mfma_f32_16x16x32_bf16 v[236:239], v[248:251], v[124:127], v[236:239]
  v_bitop3_b32 v232, v120, v122, v124 bitop3:0x80
  v_bitop3_b32 v232, v232, v126, 1 bitop3:0x80
  v_cmp_ne_u32 vcc, 1, v232
  s_nop 4
  v_add_f32_dpp v236, v236, v236 row_ror:4 row_mask:0xf bank_mask:0xf
  v_add_f32_dpp v237, v237, v237 row_ror:4 row_mask:0xf bank_mask:0xf
  s_nop 0
  v_add_f32_dpp v236, v236, v236 row_ror:8 row_mask:0xf bank_mask:0xf
  v_add_f32_dpp v237, v237, v237 row_ror:8 row_mask:0xf bank_mask:0xf
  v_cvt_pk_bf16_f32 v233, v236, v237
  s_cbranch_vccnz c_h1b1_0_0
c_h1ok1_0_0:
  buffer_store_dword v233, v241, s[4:7], s49 offen
  s_branch c_pub_0_0
c_h1b0_0_0:
  s_mov_b64 exec, vcc
  buffer_load_dwordx4 v[120:123], v253, s[4:7], s40 offen offset:0 sc1
  buffer_load_dwordx4 v[124:127], v253, s[4:7], s40 offen offset:1024 sc1
  s_mov_b64 exec, -1
  s_cmp_eq_u32 s35, 0
  s_cbranch_scc1 c_h1ok0_0_0
  s_sub_u32 s35, s35, 1
  s_branch c_h1c0_0_0
c_h1b1_0_0:
  s_mov_b64 exec, vcc
  buffer_load_dwordx4 v[120:123], v253, s[4:7], s40 offen offset:0 sc1
  buffer_load_dwordx4 v[124:127], v253, s[4:7], s40 offen offset:1024 sc1
  s_mov_b64 exec, -1
  s_cmp_eq_u32 s35, 0
  s_cbranch_scc1 c_h1ok1_0_0
  s_sub_u32 s35, s35, 1
  s_branch c_h1c1_0_0
c_prg_0_0:
  s_xor_b32 s51, s51, 6144
c_sp_1501:
  buffer_load_dword v236, off, s[4:7], s51 sc1
  s_waitcnt vmcnt(0)
  v_readfirstlane_b32 s59, v236
  s_cmp_ge_u32 s59, s58
  s_cbranch_scc1 c_spd_1502
  s_cmp_eq_u32 s35, 0
  s_cbranch_scc1 c_spd_1502
  s_sub_u32 s35, s35, 1
  s_sleep 2
  s_branch c_sp_1501
c_spd_1502:
  s_xor_b32 s51, s51, 6144
c_sp_1503:
  buffer_load_dword v236, off, s[4:7], s51 sc1
  s_waitcnt vmcnt(0)
  v_readfirstlane_b32 s59, v236
  s_cmp_ge_u32 s59, s58
  s_cbranch_scc1 c_spd_1504
  s_cmp_eq_u32 s35, 0
  s_cbranch_scc1 c_spd_1504
  s_sub_u32 s35, s35, 1
  s_sleep 2
  s_branch c_sp_1503
c_spd_1504:
  s_branch c_prgok_0_0
.p2align 6
c_top_0_1:
  s_waitcnt vmcnt(3)
  v_max3_u32 v238, v112, v113, v114
  s_waitcnt vmcnt(2)
  v_max3_u32 v238, v238, v115, v116
  v_max3_u32 v238, v238, v117, v118
  v_max_u32 v238, v238, v119
  v_cmp_eq_u32 vcc, -1, v238
  ds_write_b128 v253, v[112:115] offset:2048
  s_cbranch_vccnz c_bad_0_1
c_okL_0_1:
  ds_write_b128 v253, v[116:119] offset:3072
  v_smfmac_f32_16x16x64_bf16 v[144:147], v[112:115], v[184:191], v240
  v_smfmac_f32_16x16x64_bf16 v[148:151], v[112:115], v[192:199], v240
  v_smfmac_f32_16x16x64_bf16 v[152:155], v[112:115], v[200:207], v240
  v_smfmac_f32_16x16x64_bf16 v[156:159], v[112:115], v[208:215], v240
  v_smfmac_f32_16x16x64_bf16 v[144:147], v[116:119], v[216:223], v240
  v_smfmac_f32_16x16x64_bf16 v[148:151], v[116:119], v[224:231], v240
  s_waitcnt lgkmcnt(0)
  s_barrier
  ds_read_b128 v[120:123], v253 offset:4096
  ds_read_b128 v[124:127], v253 offset:5120
  v_smfmac_f32_16x16x64_bf16 v[152:155], v[116:119], a[96:103], v240
  ds_read_b128 v[128:131], v253 offset:6144
  ds_read_b128 v[132:135], v253 offset:7168
  v_smfmac_f32_16x16x64_bf16 v[156:159], v[116:119], a[104:111], v240
  buffer_load_dwordx4 v[176:179], v253, s[4:7], s42 offen offset:0 sc1
  ds_read_b128 v[136:139], v253 offset:0
  ds_read_b128 v[140:143], v253 offset:1024
  v_smfmac_f32_16x16x64_bf16 v[160:163], v[112:115], a[160:167], v240
  v_smfmac_f32_16x16x64_bf16 v[164:167], v[112:115], a[168:175], v240
  v_lshlrev_b32 v234, 3, v253
  s_waitcnt lgkmcnt(5)
  v_smfmac_f32_16x16x64_bf16 v[144:147], v[120:123], a[0:7], v240
  ds_read_b128 v[184:187], v252 offset:24576
  s_waitcnt lgkmcnt(5)
  v_smfmac_f32_16x16x64_bf16 v[144:147], v[124:127], a[16:23], v240
  buffer_load_dwordx4 v[180:183], v253, s[4:7], s42 offen offset:1024 sc1
  ds_read_b128 v[188:191], v252 offset:25600
  s_waitcnt lgkmcnt(5)
  v_smfmac_f32_16x16x64_bf16 v[144:147], v[128:131], a[32:39], v240
  ds_read_b128 v[192:195], v252 offset:28672
  s_waitcnt lgkmcnt(5)
  v_smfmac_f32_16x16x64_bf16 v[144:147], v[132:135], a[48:55], v240
  ds_read_b128 v[196:199], v252 offset:29696
  s_waitcnt lgkmcnt(5)
  v_smfmac_f32_16x16x64_bf16 v[144:147], v[136:139], a[64:71], v240
  ds_read_b128 v[200:203], v252 offset:32768
  s_waitcnt lgkmcnt(5)
  v_smfmac_f32_16x16x64_bf16 v[144:147], v[140:143], a[80:87], v240
  buffer_store_dword v233, v241, s[4:7], s48 offen sc1
  s_add_u32 s48, s49, 8388608
  ds_read_b128 v[204:207], v252 offset:33792
  v_smfmac_f32_16x16x64_bf16 v[148:151], v[120:123], a[8:15], v240
  ds_read_b128 v[208:211], v252 offset:26624
  v_smfmac_f32_16x16x64_bf16 v[148:151], v[124:127], a[24:31], v240
  ds_read_b128 v[212:215], v252 offset:27648
  v_cvt_pk_bf16_f32 v232, v144, v145
  v_smfmac_f32_16x16x64_bf16 v[148:151], v[128:131], a[40:47], v240
  ds_read_b128 v[216:219], v252 offset:30720
  v_cvt_pk_bf16_f32 v233, v146, v147
  v_smfmac_f32_16x16x64_bf16 v[148:151], v[132:135], a[56:63], v240
  ds_read_b128 v[220:223], v252 offset:31744
  v_mfma_f32_16x16x16_bf16 v[144:147], v[232:233], v[242:243], 0
  ds_read_b128 v[224:227], v252 offset:34816
  v_smfmac_f32_16x16x64_bf16 v[148:151], v[136:139], a[72:79], v240
  ds_read_b128 v[228:231], v252 offset:35840
  v_smfmac_f32_16x16x64_bf16 v[148:151], v[140:143], a[88:95], v240
  v_cvt_pk_bf16_f32 v236, v144, v145
  v_smfmac_f32_16x16x64_bf16 v[152:155], v[120:123], a[112:119], v240
  v_cvt_pk_bf16_f32 v237, v146, v147
  v_smfmac_f32_16x16x64_bf16 v[152:155], v[124:127], a[128:135], v240
  v_cvt_pk_bf16_f32 v234, v148, v149
  v_cvt_pk_bf16_f32 v235, v150, v151
  v_smfmac_f32_16x16x64_bf16 v[152:155], v[128:131], a[144:151], v240
  v_mfma_f32_16x16x16_bf16 v[148:151], v[234:235], v[242:243], 0
  s_waitcnt lgkmcnt(0)
  v_smfmac_f32_16x16x64_bf16 v[152:155], v[132:135], v[184:191], v240
  v_smfmac_f32_16x16x64_bf16 v[152:155], v[136:139], v[192:199], v240
  v_cvt_pk_bf16_f32 v238, v148, v149
  v_cvt_pk_bf16_f32 v239, v150, v151
  v_smfmac_f32_16x16x64_bf16 v[152:155], v[140:143], v[200:207], v240
  s_waitcnt vmcnt(3)
  v_mfma_f32_16x16x32_bf16 v[144:147], v[168:171], v[236:239], 0
  v_mfma_f32_16x16x32_bf16 v[148:151], v[172:175], v[236:239], 0
  v_cvt_pk_bf16_f32 v232, v152, v153
  v_cvt_pk_bf16_f32 v233, v154, v155
  v_smfmac_f32_16x16x64_bf16 v[156:159], v[120:123], a[120:127], v240
  v_mfma_f32_16x16x16_bf16 v[152:155], v[232:233], v[244:245], 0
  v_cndmask_b32 v144, v144, v148, s[98:99]
  v_cndmask_b32 v145, v145, v149, s[98:99]
  v_cndmask_b32 v146, v146, v150, s[98:99]
  v_cndmask_b32 v147, v147, v151, s[98:99]
  v_smfmac_f32_16x16x64_bf16 v[156:159], v[124:127], a[136:143], v240
  ds_write_b128 v253, v[144:147] offset:9216
  v_smfmac_f32_16x16x64_bf16 v[156:159], v[128:131], a[152:159], v240
  buffer_load_dwordx4 v[168:171], v253, s[4:7], s41 offen offset:0 sc1
  v_cvt_pk_bf16_f32 v200, v152, v153
  v_smfmac_f32_16x16x64_bf16 v[156:159], v[132:135], v[208:215], v240
  v_cvt_pk_bf16_f32 v201, v154, v155
  v_smfmac_f32_16x16x64_bf16 v[156:159], v[136:139], v[216:223], v240
  v_smfmac_f32_16x16x64_bf16 v[156:159], v[140:143], v[224:231], v240
  v_smfmac_f32_16x16x64_bf16 v[160:163], v[120:123], a[192:199], v240
  buffer_load_dwordx4 v[172:175], v253, s[4:7], s41 offen offset:1024 sc1
  v_smfmac_f32_16x16x64_bf16 v[164:167], v[120:123], a[200:207], v240
  v_cvt_pk_bf16_f32 v234, v156, v157
  v_cvt_pk_bf16_f32 v235, v158, v159
  s_waitcnt lgkmcnt(0)
  s_barrier
  v_mfma_f32_16x16x16_bf16 v[156:159], v[234:235], v[244:245], 0
  ds_read_b128 v[184:187], v253 offset:8192
  ds_read_b128 v[188:191], v253 offset:9216
  v_smfmac_f32_16x16x64_bf16 v[160:163], v[124:127], a[208:215], v240
  ds_read_b128 v[192:195], v253 offset:10240
  ds_read_b128 v[196:199], v253 offset:11264
  v_smfmac_f32_16x16x64_bf16 v[164:167], v[124:127], a[216:223], v240
  v_cvt_pk_bf16_f32 v202, v156, v157
  v_cvt_pk_bf16_f32 v203, v158, v159
  v_smfmac_f32_16x16x64_bf16 v[160:163], v[128:131], a[224:231], v240
  v_mfma_f32_16x16x32_bf16 v[152:155], v[200:203], v[236:239], 0
  v_smfmac_f32_16x16x64_bf16 v[164:167], v[128:131], a[232:239], v240
  v_smfmac_f32_16x16x64_bf16 v[160:163], v[132:135], a[240:247], v240
  ds_write_b64 v253, v[152:153] offset:8
  s_waitcnt lgkmcnt(1)
  v_pk_add_f32 v[184:185], v[184:185], v[188:189]
  v_pk_add_f32 v[186:187], v[186:187], v[190:191]
  v_pk_add_f32 v[192:193], v[192:193], v[196:197]
  v_pk_add_f32 v[194:195], v[194:195], v[198:199]
  v_pk_add_f32 v[184:185], v[184:185], v[192:193]
  v_pk_add_f32 v[186:187], v[186:187], v[194:195]
  v_exp_f32 v188, v184
  v_exp_f32 v189, v185
  v_smfmac_f32_16x16x64_bf16 v[160:163], v[116:119], a[176:183], v240
  v_smfmac_f32_16x16x64_bf16 v[164:167], v[116:119], a[184:191], v240
  v_smfmac_f32_16x16x64_bf16 v[164:167], v[132:135], a[248:255], v240
  s_waitcnt lgkmcnt(0)
  s_barrier
  ds_read_b128 v[208:211], v254 offset:0
  v_smfmac_f32_16x16x64_bf16 v[160:163], v[136:139], v[0:7], v240
  ds_read_b128 v[216:219], v252 offset:0
  ds_read_b128 v[220:223], v252 offset:1024
  v_exp_f32 v190, v186
  v_exp_f32 v191, v187
  v_cvt_pk_bf16_f32 v188, v188, v189
  v_cvt_pk_bf16_f32 v189, v190, v191
  v_smfmac_f32_16x16x64_bf16 v[160:163], v[140:143], v[16:23], v240
  ds_read_b128 v[224:227], v252 offset:2048
  ds_read_b128 v[228:231], v252 offset:3072
  v_mov_b32_dpp v192, v188 quad_perm:[0,1,0,1] row_mask:0xf bank_mask:0xf
  v_mfma_f32_16x16x16_bf16 v[196:199], v[246:247], v[188:189], 0
  v_mov_b32_dpp v193, v189 quad_perm:[0,1,0,1] row_mask:0xf bank_mask:0xf
  v_mov_b32_dpp v194, v188 quad_perm:[2,3,2,3] row_mask:0xf bank_mask:0xf
  v_mov_b32_dpp v195, v189 quad_perm:[2,3,2,3] row_mask:0xf bank_mask:0xf
  v_smfmac_f32_16x16x64_bf16 v[164:167], v[136:139], v[8:15], v240
  s_waitcnt lgkmcnt(4)
  v_add_f32 v208, v208, v210
  v_smfmac_f32_16x16x64_bf16 v[164:167], v[140:143], v[24:31], v240
  ds_read_b128 v[112:115], v252 offset:4096
  ds_read_b128 v[116:119], v252 offset:5120
  v_add_f32 v209, v209, v211
  s_waitcnt vmcnt(3)
  v_mfma_f32_16x16x32_bf16 v[144:147], v[176:179], v[192:195], 0
  ds_read_b128 v[128:131], v252 offset:16384
  v_add_f32_dpp v208, v208, v208 quad_perm:[2,3,0,1] row_mask:0xf bank_mask:0xf
  v_add_f32_dpp v209, v209, v209 quad_perm:[2,3,0,1] row_mask:0xf bank_mask:0xf
  v_mfma_f32_16x16x32_bf16 v[148:151], v[180:183], v[192:195], 0
  ds_read_b128 v[132:135], v252 offset:17408
  v_exp_f32 v210, v208
  v_exp_f32 v211, v209
  v_add_f32_dpp v196, v196, v196 quad_perm:[2,3,0,1] row_mask:0xf bank_mask:0xf
  v_cvt_pk_bf16_f32 v232, v210, v211
  v_cvt_pk_bf16_f32 v233, v210, v211
  v_add_f32 v196, v196, v196
  v_cvt_pk_bf16_f32 v204, v160, v161
  v_cvt_pk_bf16_f32 v205, v162, v163
  v_mfma_f32_16x16x16_bf16 v[196:199], v[246:247], v[232:233], v[196:199]
  v_cvt_pk_bf16_f32 v206, v164, v165
  v_cvt_pk_bf16_f32 v207, v166, v167
  v_mov_b64 v[152:153], 0
  v_mfma_f32_16x16x16_bf16 v[144:147], v[204:205], v[232:233], v[144:147]
  v_mov_b64 v[154:155], 0
  v_mov_b64 v[156:157], 0
  v_mov_b64 v[158:159], 0
  v_mfma_f32_16x16x16_bf16 v[148:151], v[206:207], v[232:233], v[148:151]
  v_rcp_f32 v234, v196
  v_mov_b64 v[188:189], 0
  v_mov_b64 v[190:191], 0
  v_max_f32 v235, v196, v234
  v_pk_mul_f32 v[144:145], v[144:145], v[234:235] op_sel_hi:[1,0]
  v_pk_mul_f32 v[146:147], v[146:147], v[234:235] op_sel_hi:[1,0]
  v_cvt_pk_bf16_f32 v160, v144, v145
  v_cvt_pk_bf16_f32 v161, v146, v147
  v_pk_mul_f32 v[148:149], v[148:149], v[234:235] op_sel_hi:[1,0]
  v_pk_mul_f32 v[150:151], v[150:151], v[234:235] op_sel_hi:[1,0]
  v_cvt_pk_bf16_f32 v162, v148, v149
  v_cvt_pk_bf16_f32 v163, v150, v151
  ds_write_b128 v253, v[160:163] offset:9216
  s_nop 0
  v_smfmac_f32_16x16x64_bf16 v[152:155], v[160:163], v[32:39], v240
  v_cmp_ngt_f32 vcc, s54, v235
  v_smfmac_f32_16x16x64_bf16 v[156:159], v[160:163], v[40:47], v240
  v_mov_b64 v[236:237], 0
  v_mov_b64 v[238:239], 0
  s_cbranch_vccnz c_slow_0_1
c_back_0_1:
  s_waitcnt lgkmcnt(0)
  s_barrier
  ds_read_b128 v[164:167], v253 offset:10240
  ds_read_b128 v[192:195], v253 offset:11264
  ds_read_b128 v[212:215], v253 offset:8192
  v_smfmac_f32_16x16x64_bf16 v[188:191], v[160:163], v[48:55], v240
  ds_read_b128 v[120:123], v252 offset:6144
  v_smfmac_f32_16x16x64_bf16 v[236:239], v[160:163], v[56:63], v240
  s_waitcnt lgkmcnt(3)
  v_smfmac_f32_16x16x64_bf16 v[152:155], v[164:167], v[64:71], v240
  ds_read_b128 v[124:127], v252 offset:7168
  s_add_u32 s37, s37, 1
  s_waitcnt lgkmcnt(3)
  v_smfmac_f32_16x16x64_bf16 v[152:155], v[192:195], v[80:87], v240
  ds_read_b128 v[136:139], v252 offset:18432
  s_add_u32 s38, s38, 8192
  s_waitcnt lgkmcnt(3)
  v_smfmac_f32_16x16x64_bf16 v[152:155], v[212:215], v[96:103], v240
  ds_read_b128 v[140:143], v252 offset:19456
  s_add_u32 s41, s41, 262144
  v_smfmac_f32_16x16x64_bf16 v[156:159], v[164:167], v[72:79], v240
  s_add_u32 s42, s42, 262144
  s_add_u32 s50, s50, 262144
  v_smfmac_f32_16x16x64_bf16 v[156:159], v[192:195], v[88:95], v240
  v_cvt_pk_bf16_f32 v144, v152, v153
  v_cvt_pk_bf16_f32 v145, v154, v155
  v_bfi_b32 v144, 1, s44, v144
  v_smfmac_f32_16x16x64_bf16 v[156:159], v[212:215], v[104:111], v240
  buffer_store_dwordx2 v[144:145], v255, s[4:7], s39 offen offset:0
  v_smfmac_f32_16x16x64_bf16 v[188:191], v[164:167], v[216:223], v240
  s_add_u32 s58, s37, 2
  s_min_u32 s58, s58, 63
  v_smfmac_f32_16x16x64_bf16 v[188:191], v[192:195], v[112:119], v240
  v_cvt_pk_bf16_f32 v146, v156, v157
  v_cvt_pk_bf16_f32 v147, v158, v159
  v_bfi_b32 v146, 1, s44, v146
  v_smfmac_f32_16x16x64_bf16 v[188:191], v[212:215], v[128:135], v240
  buffer_store_dwordx2 v[146:147], v255, s[4:7], s39 offen offset:2048
  v_smfmac_f32_16x16x64_bf16 v[236:239], v[164:167], v[224:231], v240
  s_waitcnt lgkmcnt(0)
  v_smfmac_f32_16x16x64_bf16 v[236:239], v[192:195], v[120:127], v240
  v_cvt_pk_bf16_f32 v148, v188, v189
  v_cvt_pk_bf16_f32 v149, v190, v191
  v_bfi_b32 v148, 1, s44, v148
  v_smfmac_f32_16x16x64_bf16 v[236:239], v[212:215], v[136:143], v240
  buffer_store_dwordx2 v[148:149], v255, s[4:7], s43 offen offset:0
  s_nop 6
  v_cvt_pk_bf16_f32 v150, v236, v237
  v_cvt_pk_bf16_f32 v151, v238, v239
  v_bfi_b32 v150, 1, s44, v150
  buffer_store_dwordx2 v[150:151], v255, s[4:7], s43 offen offset:2048
  s_waitcnt vmcnt(1)
c_pfd_0_1:
  buffer_load_dwordx4 v[120:123], v253, s[4:7], s40 offen offset:0 sc1
  buffer_load_dwordx4 v[124:127], v253, s[4:7], s40 offen offset:1024 sc1
  v_mov_b64 v[152:153], 0
  v_mov_b64 v[154:155], 0
  v_mov_b64 v[156:157], 0
  v_mov_b64 v[158:159], 0
  v_mov_b64 v[160:161], 0
  v_mov_b64 v[162:163], 0
  v_mov_b64 v[164:165], 0
  v_mov_b64 v[166:167], 0
  v_mov_b64 v[144:145], 0
  v_mov_b64 v[146:147], 0
  v_mov_b64 v[148:149], 0
  v_mov_b64 v[150:151], 0
  s_cmp_lg_u32 s44, 0
  s_cbranch_scc1 c_h1c1_0_1
c_h1c0_0_1:
  s_waitcnt vmcnt(1)
  v_mfma_f32_16x16x32_bf16 v[236:239], v[248:251], v[120:123], 0
  s_waitcnt vmcnt(0)
  v_mfma_f32_16x16x32_bf16 v[236:239], v[248:251], v[124:127], v[236:239]
  v_bitop3_b32 v232, v120, v122, v124 bitop3:0xfe
  v_bitop3_b32 v232, v232, v126, 1 bitop3:0xa8
  v_cmp_ne_u32 vcc, 0, v232
  s_nop 4
  v_add_f32_dpp v236, v236, v236 row_ror:4 row_mask:0xf bank_mask:0xf
  v_add_f32_dpp v237, v237, v237 row_ror:4 row_mask:0xf bank_mask:0xf
  s_nop 0
  v_add_f32_dpp v236, v236, v236 row_ror:8 row_mask:0xf bank_mask:0xf
  v_add_f32_dpp v237, v237, v237 row_ror:8 row_mask:0xf bank_mask:0xf
  v_cvt_pk_bf16_f32 v233, v236, v237
  s_cbranch_vccnz c_h1b0_0_1
c_h1ok0_0_1:
  buffer_store_dword v233, v241, s[4:7], s49 offen
c_pub_0_1:
  s_xor_b32 s44, s44, 1
  s_add_u32 s49, s49, 8192
  s_cmp_eq_u32 s37, s57
  s_cbranch_scc1 c_fin_0_1
  ds_read_b128 v[184:187], v252 offset:8192
  ds_read_b128 v[188:191], v252 offset:9216
  ds_read_b128 v[192:195], v252 offset:10240
  ds_read_b128 v[196:199], v252 offset:11264
  ds_read_b128 v[200:203], v252 offset:20480
  ds_read_b128 v[204:207], v252 offset:21504
  s_waitcnt lgkmcnt(0)
  buffer_load_dwordx4 v[112:115], v253, s[4:7], s38 offen sc1
  buffer_load_dwordx4 v[116:119], v253, s[4:7], s38 offen offset:1024 sc1
  ds_read_b128 v[208:211], v252 offset:22528
  ds_read_b128 v[212:215], v252 offset:23552
  ds_read_b128 v[216:219], v252 offset:12288
  ds_read_b128 v[220:223], v252 offset:13312
  ds_read_b128 v[224:227], v252 offset:14336
  ds_read_b128 v[228:231], v252 offset:15360
  s_waitcnt lgkmcnt(0)
  buffer_load_dwordx4 v[112:115], v253, s[4:7], s38 offen sc1
  buffer_load_dwordx4 v[116:119], v253, s[4:7], s38 offen offset:1024 sc1
  s_branch c_top_0_1
c_fin_0_1:
  buffer_store_dword v233, v241, s[4:7], s48 offen sc1
  s_nop 7
  s_mov_b64 exec, 1
  s_waitcnt vmcnt(0)
  s_endpgm
  s_nop 7
c_bad_0_1:
  s_mov_b64 exec, vcc
  buffer_load_dwordx4 v[112:115], v253, s[4:7], s38 offen sc1
  buffer_load_dwordx4 v[116:119], v253, s[4:7], s38 offen offset:1024 sc1
  s_mov_b64 exec, -1
  s_cmp_eq_u32 s35, 0
  s_cbranch_scc1 c_okL_0_1
  s_sub_u32 s35, s35, 1
  s_branch c_top_0_1
c_entry_0_1:
  ds_write_b128 v253, v[112:115] offset:2048
  s_branch c_okL_0_1
c_slow_0_1:
  s_nop 15
  v_max3_f32 v234, v184, v185, v186
  v_max3_f32 v234, v234, v187, v208
  v_max_f32 v234, v234, v209
  s_nop 1
  v_max_f32_dpp v234, v234, v234 quad_perm:[2,3,0,1] row_mask:0xf bank_mask:0xf
  v_mov_b32 v235, v234
  s_nop 1
  v_permlane16_swap_b32 v234, v235
  s_nop 1
  v_max_f32 v234, v234, v235
  v_mov_b32 v235, v234
  s_nop 1
  v_permlane32_swap_b32 v234, v235
  s_nop 1
  v_max_f32 v234, v234, v235
  v_sub_f32 v188, v184, v234
  v_sub_f32 v189, v185, v234
  v_sub_f32 v190, v186, v234
  v_sub_f32 v191, v187, v234
  v_sub_f32 v210, v208, v234
  v_sub_f32 v211, v209, v234
  v_exp_f32 v188, v188
  v_exp_f32 v189, v189
  v_exp_f32 v190, v190
  v_exp_f32 v191, v191
  v_cvt_pk_bf16_f32 v188, v188, v189
  v_cvt_pk_bf16_f32 v189, v190, v191
  s_nop 1
  v_mfma_f32_16x16x16_bf16 v[196:199], v[246:247], v[188:189], 0
  v_mov_b32_dpp v192, v188 quad_perm:[0,1,0,1] row_mask:0xf bank_mask:0xf
  v_mov_b32_dpp v193, v189 quad_perm:[0,1,0,1] row_mask:0xf bank_mask:0xf
  v_mov_b32_dpp v194, v188 quad_perm:[2,3,2,3] row_mask:0xf bank_mask:0xf
  v_mov_b32_dpp v195, v189 quad_perm:[2,3,2,3] row_mask:0xf bank_mask:0xf
  v_exp_f32 v210, v210
  v_exp_f32 v211, v211
  v_mfma_f32_16x16x32_bf16 v[144:147], v[176:179], v[192:195], 0
  s_nop 0
  v_add_f32_dpp v196, v196, v196 quad_perm:[2,3,0,1] row_mask:0xf bank_mask:0xf
  v_cvt_pk_bf16_f32 v232, v210, v211
  v_mfma_f32_16x16x32_bf16 v[148:151], v[180:183], v[192:195], 0
  v_cvt_pk_bf16_f32 v233, v210, v211
  v_add_f32 v196, v196, v196
  s_nop 1
  v_mfma_f32_16x16x16_bf16 v[196:199], v[246:247], v[232:233], v[196:199]
  v_mfma_f32_16x16x16_bf16 v[144:147], v[204:205], v[232:233], v[144:147]
  v_mfma_f32_16x16x16_bf16 v[148:151], v[206:207], v[232:233], v[148:151]
  s_waitcnt lgkmcnt(0)
  v_rcp_f32 v234, v196
  s_nop 1
  v_pk_mul_f32 v[144:145], v[144:145], v[234:235] op_sel_hi:[1,0]
  v_pk_mul_f32 v[146:147], v[146:147], v[234:235] op_sel_hi:[1,0]
  v_cvt_pk_bf16_f32 v160, v144, v145
  v_cvt_pk_bf16_f32 v161, v146, v147
  v_pk_mul_f32 v[148:149], v[148:149], v[234:235] op_sel_hi:[1,0]
  v_pk_mul_f32 v[150:151], v[150:151], v[234:235] op_sel_hi:[1,0]
  v_cvt_pk_bf16_f32 v162, v148, v149
  v_cvt_pk_bf16_f32 v163, v150, v151
  ds_write_b128 v253, v[160:163] offset:9216
  v_mov_b64 v[152:153], 0
  v_mov_b64 v[154:155], 0
  v_mov_b64 v[156:157], 0
  v_mov_b64 v[158:159], 0
  v_mov_b64 v[188:189], 0
  v_mov_b64 v[190:191], 0
  v_mov_b64 v[236:237], 0
  v_mov_b64 v[238:239], 0
  v_smfmac_f32_16x16x64_bf16 v[152:155], v[160:163], v[32:39], v240
  v_smfmac_f32_16x16x64_bf16 v[156:159], v[160:163], v[40:47], v240
  s_nop 7
  s_branch c_back_0_1
c_h1c1_0_1:
  s_waitcnt vmcnt(1)
  v_mfma_f32_16x16x32_bf16 v[236:239], v[248:251], v[120:123], 0
  s_waitcnt vmcnt(0)
  v_mfma_f32_16x16x32_bf16 v[236:239], v[248:251], v[124:127], v[236:239]
  v_bitop3_b32 v232, v120, v122, v124 bitop3:0x80
  v_bitop3_b32 v232, v232, v126, 1 bitop3:0x80
  v_cmp_ne_u32 vcc, 1, v232
  s_nop 4
  v_add_f32_dpp v236, v236, v236 row_ror:4 row_mask:0xf bank_mask:0xf
  v_add_f32_dpp v237, v237, v237 row_ror:4 row_mask:0xf bank_mask:0xf
  s_nop 0
  v_add_f32_dpp v236, v236, v236 row_ror:8 row_mask:0xf bank_mask:0xf
  v_add_f32_dpp v237, v237, v237 row_ror:8 row_mask:0xf bank_mask:0xf
  v_cvt_pk_bf16_f32 v233, v236, v237
  s_cbranch_vccnz c_h1b1_0_1
c_h1ok1_0_1:
  buffer_store_dword v233, v241, s[4:7], s49 offen
  s_branch c_pub_0_1
c_h1b0_0_1:
  s_mov_b64 exec, vcc
  buffer_load_dwordx4 v[120:123], v253, s[4:7], s40 offen offset:0 sc1
  buffer_load_dwordx4 v[124:127], v253, s[4:7], s40 offen offset:1024 sc1
  s_mov_b64 exec, -1
  s_cmp_eq_u32 s35, 0
  s_cbranch_scc1 c_h1ok0_0_1
  s_sub_u32 s35, s35, 1
  s_branch c_h1c0_0_1
c_h1b1_0_1:
  s_mov_b64 exec, vcc
  buffer_load_dwordx4 v[120:123], v253, s[4:7], s40 offen offset:0 sc1
  buffer_load_dwordx4 v[124:127], v253, s[4:7], s40 offen offset:1024 sc1
  s_mov_b64 exec, -1
  s_cmp_eq_u32 s35, 0
  s_cbranch_scc1 c_h1ok1_0_1
  s_sub_u32 s35, s35, 1
  s_branch c_h1c1_0_1
.p2align 6
c_top_0_2:
  s_waitcnt vmcnt(3)
  v_max3_u32 v238, v112, v113, v114
  s_waitcnt vmcnt(2)
  v_max3_u32 v238, v238, v115, v116
  v_max3_u32 v238, v238, v117, v118
  v_max_u32 v238, v238, v119
  v_cmp_eq_u32 vcc, -1, v238
  ds_write_b128 v253, v[112:115] offset:4096
  s_cbranch_vccnz c_bad_0_2
c_okL_0_2:
  ds_write_b128 v253, v[116:119] offset:5120
  v_smfmac_f32_16x16x64_bf16 v[144:147], v[112:115], v[184:191], v240
  v_smfmac_f32_16x16x64_bf16 v[148:151], v[112:115], v[192:199], v240
  v_smfmac_f32_16x16x64_bf16 v[152:155], v[112:115], v[200:207], v240
  v_smfmac_f32_16x16x64_bf16 v[156:159], v[112:115], v[208:215], v240
  v_smfmac_f32_16x16x64_bf16 v[144:147], v[116:119], v[216:223], v240
  v_smfmac_f32_16x16x64_bf16 v[148:151], v[116:119], v[224:231], v240
  s_waitcnt lgkmcnt(0)
  s_barrier
  ds_read_b128 v[120:123], v253 offset:6144
  ds_read_b128 v[124:127], v253 offset:7168
  v_smfmac_f32_16x16x64_bf16 v[152:155], v[116:119], a[96:103], v240
  ds_read_b128 v[128:131], v253 offset:0
  ds_read_b128 v[132:135], v253 offset:1024
  v_smfmac_f32_16x16x64_bf16 v[156:159], v[116:119], a[104:111], v240
  ds_read_b128 v[136:139], v253 offset:2048
  ds_read_b128 v[140:143], v253 offset:3072
  v_smfmac_f32_16x16x64_bf16 v[160:163], v[112:115], a[160:167], v240
  buffer_load_dwordx4 v[176:179], v253, s[4:7], s42 offen offset:0 sc1
  v_smfmac_f32_16x16x64_bf16 v[164:167], v[112:115], a[168:175], v240
  v_lshlrev_b32 v234, 3, v253
  s_waitcnt lgkmcnt(5)
  v_smfmac_f32_16x16x64_bf16 v[144:147], v[120:123], a[0:7], v240
  ds_read_b128 v[184:187], v252 offset:24576
  s_waitcnt lgkmcnt(5)
  v_smfmac_f32_16x16x64_bf16 v[144:147], v[124:127], a[16:23], v240
  ds_read_b128 v[188:191], v252 offset:25600
  s_waitcnt lgkmcnt(5)
  v_smfmac_f32_16x16x64_bf16 v[144:147], v[128:131], a[32:39], v240
  buffer_load_dwordx4 v[180:183], v253, s[4:7], s42 offen offset:1024 sc1
  ds_read_b128 v[192:195], v252 offset:28672
  s_waitcnt lgkmcnt(5)
  v_smfmac_f32_16x16x64_bf16 v[144:147], v[132:135], a[48:55], v240
  ds_read_b128 v[196:199], v252 offset:29696
  s_waitcnt lgkmcnt(5)
  v_smfmac_f32_16x16x64_bf16 v[144:147], v[136:139], a[64:71], v240
  ds_read_b128 v[200:203], v252 offset:32768
  s_waitcnt lgkmcnt(5)
  v_smfmac_f32_16x16x64_bf16 v[144:147], v[140:143], a[80:87], v240
  ds_read_b128 v[204:207], v252 offset:33792
  v_smfmac_f32_16x16x64_bf16 v[148:151], v[120:123], a[8:15], v240
  buffer_store_dword v233, v241, s[4:7], s48 offen sc1
  s_add_u32 s48, s49, 8388608
  ds_read_b128 v[208:211], v252 offset:26624
  v_smfmac_f32_16x16x64_bf16 v[148:151], v[124:127], a[24:31], v240
  ds_read_b128 v[212:215], v252 offset:27648
  v_cvt_pk_bf16_f32 v232, v144, v145
  v_smfmac_f32_16x16x64_bf16 v[148:151], v[128:131], a[40:47], v240
  ds_read_b128 v[216:219], v252 offset:30720
  v_cvt_pk_bf16_f32 v233, v146, v147
  v_smfmac_f32_16x16x64_bf16 v[148:151], v[132:135], a[56:63], v240
  ds_read_b128 v[220:223], v252 offset:31744
  v_mfma_f32_16x16x16_bf16 v[144:147], v[232:233], v[242:243], 0
  ds_read_b128 v[224:227], v252 offset:34816
  v_smfmac_f32_16x16x64_bf16 v[148:151], v[136:139], a[72:79], v240
  ds_read_b128 v[228:231], v252 offset:35840
  v_smfmac_f32_16x16x64_bf16 v[148:151], v[140:143], a[88:95], v240
  v_cvt_pk_bf16_f32 v236, v144, v145
  v_smfmac_f32_16x16x64_bf16 v[152:155], v[120:123], a[112:119], v240
  v_cvt_pk_bf16_f32 v237, v146, v147
  v_smfmac_f32_16x16x64_bf16 v[152:155], v[124:127], a[128:135], v240
  v_cvt_pk_bf16_f32 v234, v148, v149
  v_cvt_pk_bf16_f32 v235, v150, v151
  v_smfmac_f32_16x16x64_bf16 v[152:155], v[128:131], a[144:151], v240
  v_mfma_f32_16x16x16_bf16 v[148:151], v[234:235], v[242:243], 0
  s_waitcnt lgkmcnt(0)
  v_smfmac_f32_16x16x64_bf16 v[152:155], v[132:135], v[184:191], v240
  v_smfmac_f32_16x16x64_bf16 v[152:155], v[136:139], v[192:199], v240
  v_cvt_pk_bf16_f32 v238, v148, v149
  v_cvt_pk_bf16_f32 v239, v150, v151
  v_smfmac_f32_16x16x64_bf16 v[152:155], v[140:143], v[200:207], v240
  s_waitcnt vmcnt(3)
  v_mfma_f32_16x16x32_bf16 v[144:147], v[168:171], v[236:239], 0
  v_mfma_f32_16x16x32_bf16 v[148:151], v[172:175], v[236:239], 0
  v_cvt_pk_bf16_f32 v232, v152, v153
  v_cvt_pk_bf16_f32 v233, v154, v155
  v_smfmac_f32_16x16x64_bf16 v[156:159], v[120:123], a[120:127], v240
  v_mfma_f32_16x16x16_bf16 v[152:155], v[232:233], v[244:245], 0
  v_cndmask_b32 v144, v144, v148, s[98:99]
  v_cndmask_b32 v145, v145, v149, s[98:99]
  v_cndmask_b32 v146, v146, v150, s[98:99]
  v_cndmask_b32 v147, v147, v151, s[98:99]
  v_smfmac_f32_16x16x64_bf16 v[156:159], v[124:127], a[136:143], v240
  ds_write_b128 v253, v[144:147] offset:10240
  v_smfmac_f32_16x16x64_bf16 v[156:159], v[128:131], a[152:159], v240
  v_cvt_pk_bf16_f32 v200, v152, v153
  v_smfmac_f32_16x16x64_bf16 v[156:159], v[132:135], v[208:215], v240
  buffer_load_dwordx4 v[168:171], v253, s[4:7], s41 offen offset:0 sc1
  v_cvt_pk_bf16_f32 v201, v154, v155
  v_smfmac_f32_16x16x64_bf16 v[156:159], v[136:139], v[216:223], v240
  v_smfmac_f32_16x16x64_bf16 v[156:159], v[140:143], v[224:231], v240
  v_smfmac_f32_16x16x64_bf16 v[160:163], v[120:123], a[192:199], v240
  v_smfmac_f32_16x16x64_bf16 v[164:167], v[120:123], a[200:207], v240
  buffer_load_dwordx4 v[172:175], v253, s[4:7], s41 offen offset:1024 sc1
  v_cvt_pk_bf16_f32 v234, v156, v157
  v_cvt_pk_bf16_f32 v235, v158, v159
  s_waitcnt lgkmcnt(0)
  s_barrier
  v_mfma_f32_16x16x16_bf16 v[156:159], v[234:235], v[244:245], 0
  ds_read_b128 v[184:187], v253 offset:8192
  ds_read_b128 v[188:191], v253 offset:9216
  v_smfmac_f32_16x16x64_bf16 v[160:163], v[124:127], a[208:215], v240
  ds_read_b128 v[192:195], v253 offset:10240
  ds_read_b128 v[196:199], v253 offset:11264
  v_smfmac_f32_16x16x64_bf16 v[164:167], v[124:127], a[216:223], v240
  v_cvt_pk_bf16_f32 v202, v156, v157
  v_cvt_pk_bf16_f32 v203, v158, v159
  v_smfmac_f32_16x16x64_bf16 v[160:163], v[128:131], a[224:231], v240
  v_mfma_f32_16x16x32_bf16 v[152:155], v[200:203], v[236:239], 0
  v_smfmac_f32_16x16x64_bf16 v[164:167], v[128:131], a[232:239], v240
  v_smfmac_f32_16x16x64_bf16 v[160:163], v[132:135], a[240:247], v240
  ds_write_b64 v253, v[152:153] offset:1024
  s_waitcnt lgkmcnt(1)
  v_pk_add_f32 v[184:185], v[184:185], v[188:189]
  v_pk_add_f32 v[186:187], v[186:187], v[190:191]
  v_pk_add_f32 v[192:193], v[192:193], v[196:197]
  v_pk_add_f32 v[194:195], v[194:195], v[198:199]
  v_pk_add_f32 v[184:185], v[184:185], v[192:193]
  v_pk_add_f32 v[186:187], v[186:187], v[194:195]
  v_exp_f32 v188, v184
  v_exp_f32 v189, v185
  v_smfmac_f32_16x16x64_bf16 v[160:163], v[116:119], a[176:183], v240
  v_smfmac_f32_16x16x64_bf16 v[164:167], v[116:119], a[184:191], v240
  v_smfmac_f32_16x16x64_bf16 v[164:167], v[132:135], a[248:255], v240
  s_waitcnt lgkmcnt(0)
  s_barrier
  ds_read_b128 v[208:211], v254 offset:0
  v_smfmac_f32_16x16x64_bf16 v[160:163], v[136:139], v[0:7], v240
  ds_read_b128 v[216:219], v252 offset:4096
  ds_read_b128 v[220:223], v252 offset:5120
  v_exp_f32 v190, v186
  v_exp_f32 v191, v187
  v_cvt_pk_bf16_f32 v188, v188, v189
  v_cvt_pk_bf16_f32 v189, v190, v191
  v_smfmac_f32_16x16x64_bf16 v[160:163], v[140:143], v[16:23], v240
  ds_read_b128 v[224:227], v252 offset:6144
  ds_read_b128 v[228:231], v252 offset:7168
  v_mov_b32_dpp v192, v188 quad_perm:[0,1,0,1] row_mask:0xf bank_mask:0xf
  v_mfma_f32_16x16x16_bf16 v[196:199], v[246:247], v[188:189], 0
  v_mov_b32_dpp v193, v189 quad_perm:[0,1,0,1] row_mask:0xf bank_mask:0xf
  v_mov_b32_dpp v194, v188 quad_perm:[2,3,2,3] row_mask:0xf bank_mask:0xf
  v_mov_b32_dpp v195, v189 quad_perm:[2,3,2,3] row_mask:0xf bank_mask:0xf
  v_smfmac_f32_16x16x64_bf16 v[164:167], v[136:139], v[8:15], v240
  s_waitcnt lgkmcnt(4)
  v_add_f32 v208, v208, v210
  v_smfmac_f32_16x16x64_bf16 v[164:167], v[140:143], v[24:31], v240
  ds_read_b128 v[112:115], v252 offset:16384
  ds_read_b128 v[116:119], v252 offset:17408
  v_add_f32 v209, v209, v211
  s_waitcnt vmcnt(3)
  v_mfma_f32_16x16x32_bf16 v[144:147], v[176:179], v[192:195], 0
  ds_read_b128 v[128:131], v252 offset:0
  v_add_f32_dpp v208, v208, v208 quad_perm:[2,3,0,1] row_mask:0xf bank_mask:0xf
  v_add_f32_dpp v209, v209, v209 quad_perm:[2,3,0,1] row_mask:0xf bank_mask:0xf
  v_mfma_f32_16x16x32_bf16 v[148:151], v[180:183], v[192:195], 0
  ds_read_b128 v[132:135], v252 offset:1024
  v_exp_f32 v210, v208
  v_exp_f32 v211, v209
  v_add_f32_dpp v196, v196, v196 quad_perm:[2,3,0,1] row_mask:0xf bank_mask:0xf
  v_cvt_pk_bf16_f32 v232, v210, v211
  v_cvt_pk_bf16_f32 v233, v210, v211
  v_add_f32 v196, v196, v196
  v_cvt_pk_bf16_f32 v204, v160, v161
  v_cvt_pk_bf16_f32 v205, v162, v163
  v_mfma_f32_16x16x16_bf16 v[196:199], v[246:247], v[232:233], v[196:199]
  v_cvt_pk_bf16_f32 v206, v164, v165
  v_cvt_pk_bf16_f32 v207, v166, v167
  v_mov_b64 v[152:153], 0
  v_mfma_f32_16x16x16_bf16 v[144:147], v[204:205], v[232:233], v[144:147]
  v_mov_b64 v[154:155], 0
  v_mov_b64 v[156:157], 0
  v_mov_b64 v[158:159], 0
  v_mfma_f32_16x16x16_bf16 v[148:151], v[206:207], v[232:233], v[148:151]
  v_rcp_f32 v234, v196
  v_mov_b64 v[188:189], 0
  v_mov_b64 v[190:191], 0
  v_max_f32 v235, v196, v234
  v_pk_mul_f32 v[144:145], v[144:145], v[234:235] op_sel_hi:[1,0]
  v_pk_mul_f32 v[146:147], v[146:147], v[234:235] op_sel_hi:[1,0]
  v_cvt_pk_bf16_f32 v160, v144, v145
  v_cvt_pk_bf16_f32 v161, v146, v147
  v_pk_mul_f32 v[148:149], v[148:149], v[234:235] op_sel_hi:[1,0]
  v_pk_mul_f32 v[150:151], v[150:151], v[234:235] op_sel_hi:[1,0]
  v_cvt_pk_bf16_f32 v162, v148, v149
  v_cvt_pk_bf16_f32 v163, v150, v151
  ds_write_b128 v253, v[160:163] offset:10240
  s_nop 0
  v_smfmac_f32_16x16x64_bf16 v[152:155], v[160:163], v[32:39], v240
  v_cmp_ngt_f32 vcc, s54, v235
  v_smfmac_f32_16x16x64_bf16 v[156:159], v[160:163], v[40:47], v240
  v_mov_b64 v[236:237], 0
  v_mov_b64 v[238:239], 0
  s_cbranch_vccnz c_slow_0_2
c_back_0_2:
  s_waitcnt lgkmcnt(0)
  s_barrier
  ds_read_b128 v[164:167], v253 offset:11264
  ds_read_b128 v[192:195], v253 offset:8192
  ds_read_b128 v[212:215], v253 offset:9216
  v_smfmac_f32_16x16x64_bf16 v[188:191], v[160:163], v[48:55], v240
  ds_read_b128 v[120:123], v252 offset:18432
  v_smfmac_f32_16x16x64_bf16 v[236:239], v[160:163], v[56:63], v240
  s_waitcnt lgkmcnt(3)
  v_smfmac_f32_16x16x64_bf16 v[152:155], v[164:167], v[64:71], v240
  ds_read_b128 v[124:127], v252 offset:19456
  s_add_u32 s37, s37, 1
  s_waitcnt lgkmcnt(3)
  v_smfmac_f32_16x16x64_bf16 v[152:155], v[192:195], v[80:87], v240
  ds_read_b128 v[136:139], v252 offset:2048
  s_add_u32 s38, s38, 8192
  s_waitcnt lgkmcnt(3)
  v_smfmac_f32_16x16x64_bf16 v[152:155], v[212:215], v[96:103], v240
  ds_read_b128 v[140:143], v252 offset:3072
  s_add_u32 s41, s41, 262144
  v_smfmac_f32_16x16x64_bf16 v[156:159], v[164:167], v[72:79], v240
  s_add_u32 s42, s42, 262144
  s_add_u32 s50, s50, 262144
  v_smfmac_f32_16x16x64_bf16 v[156:159], v[192:195], v[88:95], v240
  v_cvt_pk_bf16_f32 v144, v152, v153
  v_cvt_pk_bf16_f32 v145, v154, v155
  v_bfi_b32 v144, 1, s44, v144
  v_smfmac_f32_16x16x64_bf16 v[156:159], v[212:215], v[104:111], v240
  buffer_store_dwordx2 v[144:145], v255, s[4:7], s39 offen offset:0
  v_smfmac_f32_16x16x64_bf16 v[188:191], v[164:167], v[216:223], v240
  s_add_u32 s58, s37, 2
  s_min_u32 s58, s58, 63
  v_smfmac_f32_16x16x64_bf16 v[188:191], v[192:195], v[112:119], v240
  v_cvt_pk_bf16_f32 v146, v156, v157
  v_cvt_pk_bf16_f32 v147, v158, v159
  v_bfi_b32 v146, 1, s44, v146
  v_smfmac_f32_16x16x64_bf16 v[188:191], v[212:215], v[128:135], v240
  buffer_store_dwordx2 v[146:147], v255, s[4:7], s39 offen offset:2048
  v_smfmac_f32_16x16x64_bf16 v[236:239], v[164:167], v[224:231], v240
  s_waitcnt lgkmcnt(0)
  v_smfmac_f32_16x16x64_bf16 v[236:239], v[192:195], v[120:127], v240
  v_cvt_pk_bf16_f32 v148, v188, v189
  v_cvt_pk_bf16_f32 v149, v190, v191
  v_bfi_b32 v148, 1, s44, v148
  v_smfmac_f32_16x16x64_bf16 v[236:239], v[212:215], v[136:143], v240
  buffer_store_dwordx2 v[148:149], v255, s[4:7], s43 offen offset:0
  s_nop 6
  v_cvt_pk_bf16_f32 v150, v236, v237
  v_cvt_pk_bf16_f32 v151, v238, v239
  v_bfi_b32 v150, 1, s44, v150
  buffer_store_dwordx2 v[150:151], v255, s[4:7], s43 offen offset:2048
  s_waitcnt vmcnt(0)
c_pfd_0_2:
  buffer_load_dwordx4 v[120:123], v253, s[4:7], s40 offen offset:0 sc1
  buffer_load_dwordx4 v[124:127], v253, s[4:7], s40 offen offset:1024 sc1
  v_mov_b64 v[152:153], 0
  v_mov_b64 v[154:155], 0
  v_mov_b64 v[156:157], 0
  v_mov_b64 v[158:159], 0
  v_mov_b64 v[160:161], 0
  v_mov_b64 v[162:163], 0
  v_mov_b64 v[164:165], 0
  v_mov_b64 v[166:167], 0
  v_mov_b64 v[144:145], 0
  v_mov_b64 v[146:147], 0
  v_mov_b64 v[148:149], 0
  v_mov_b64 v[150:151], 0
  s_cmp_lg_u32 s44, 0
  s_cbranch_scc1 c_h1c1_0_2
c_h1c0_0_2:
  s_waitcnt vmcnt(1)
  v_mfma_f32_16x16x32_bf16 v[236:239], v[248:251], v[120:123], 0
  s_waitcnt vmcnt(0)
  v_mfma_f32_16x16x32_bf16 v[236:239], v[248:251], v[124:127], v[236:239]
  v_bitop3_b32 v232, v120, v122, v124 bitop3:0xfe
  v_bitop3_b32 v232, v232, v126, 1 bitop3:0xa8
  v_cmp_ne_u32 vcc, 0, v232
  s_nop 4
  v_add_f32_dpp v236, v236, v236 row_ror:4 row_mask:0xf bank_mask:0xf
  v_add_f32_dpp v237, v237, v237 row_ror:4 row_mask:0xf bank_mask:0xf
  s_nop 0
  v_add_f32_dpp v236, v236, v236 row_ror:8 row_mask:0xf bank_mask:0xf
  v_add_f32_dpp v237, v237, v237 row_ror:8 row_mask:0xf bank_mask:0xf
  v_cvt_pk_bf16_f32 v233, v236, v237
  s_cbranch_vccnz c_h1b0_0_2
c_h1ok0_0_2:
  buffer_store_dword v233, v241, s[4:7], s49 offen
c_pub_0_2:
  s_xor_b32 s44, s44, 1
  s_add_u32 s49, s49, 8192
  s_cmp_eq_u32 s37, s57
  s_cbranch_scc1 c_fin_0_2
  ds_read_b128 v[184:187], v252 offset:8192
  ds_read_b128 v[188:191], v252 offset:9216
  ds_read_b128 v[192:195], v252 offset:10240
  ds_read_b128 v[196:199], v252 offset:11264
  ds_read_b128 v[200:203], v252 offset:20480
  ds_read_b128 v[204:207], v252 offset:21504
  s_waitcnt lgkmcnt(0)
  buffer_load_dwordx4 v[112:115], v253, s[4:7], s38 offen sc1
  buffer_load_dwordx4 v[116:119], v253, s[4:7], s38 offen offset:1024 sc1
  ds_read_b128 v[208:211], v252 offset:22528
  ds_read_b128 v[212:215], v252 offset:23552
  ds_read_b128 v[216:219], v252 offset:12288
  ds_read_b128 v[220:223], v252 offset:13312
  ds_read_b128 v[224:227], v252 offset:14336
  ds_read_b128 v[228:231], v252 offset:15360
  s_waitcnt lgkmcnt(0)
  buffer_load_dwordx4 v[112:115], v253, s[4:7], s38 offen sc1
  buffer_load_dwordx4 v[116:119], v253, s[4:7], s38 offen offset:1024 sc1
  s_branch c_top_0_2
c_fin_0_2:
  buffer_store_dword v233, v241, s[4:7], s48 offen sc1
  s_nop 7
  s_mov_b64 exec, 1
  s_waitcnt vmcnt(0)
  s_endpgm
  s_nop 7
c_bad_0_2:
  s_mov_b64 exec, vcc
  buffer_load_dwordx4 v[112:115], v253, s[4:7], s38 offen sc1
  buffer_load_dwordx4 v[116:119], v253, s[4:7], s38 offen offset:1024 sc1
  s_mov_b64 exec, -1
  s_cmp_eq_u32 s35, 0
  s_cbranch_scc1 c_okL_0_2
  s_sub_u32 s35, s35, 1
  s_branch c_top_0_2
c_entry_0_2:
  ds_write_b128 v253, v[112:115] offset:4096
  s_branch c_okL_0_2
c_slow_0_2:
  s_nop 15
  v_max3_f32 v234, v184, v185, v186
  v_max3_f32 v234, v234, v187, v208
  v_max_f32 v234, v234, v209
  s_nop 1
  v_max_f32_dpp v234, v234, v234 quad_perm:[2,3,0,1] row_mask:0xf bank_mask:0xf
  v_mov_b32 v235, v234
  s_nop 1
  v_permlane16_swap_b32 v234, v235
  s_nop 1
  v_max_f32 v234, v234, v235
  v_mov_b32 v235, v234
  s_nop 1
  v_permlane32_swap_b32 v234, v235
  s_nop 1
  v_max_f32 v234, v234, v235
  v_sub_f32 v188, v184, v234
  v_sub_f32 v189, v185, v234
  v_sub_f32 v190, v186, v234
  v_sub_f32 v191, v187, v234
  v_sub_f32 v210, v208, v234
  v_sub_f32 v211, v209, v234
  v_exp_f32 v188, v188
  v_exp_f32 v189, v189
  v_exp_f32 v190, v190
  v_exp_f32 v191, v191
  v_cvt_pk_bf16_f32 v188, v188, v189
  v_cvt_pk_bf16_f32 v189, v190, v191
  s_nop 1
  v_mfma_f32_16x16x16_bf16 v[196:199], v[246:247], v[188:189], 0
  v_mov_b32_dpp v192, v188 quad_perm:[0,1,0,1] row_mask:0xf bank_mask:0xf
  v_mov_b32_dpp v193, v189 quad_perm:[0,1,0,1] row_mask:0xf bank_mask:0xf
  v_mov_b32_dpp v194, v188 quad_perm:[2,3,2,3] row_mask:0xf bank_mask:0xf
  v_mov_b32_dpp v195, v189 quad_perm:[2,3,2,3] row_mask:0xf bank_mask:0xf
  v_exp_f32 v210, v210
  v_exp_f32 v211, v211
  v_mfma_f32_16x16x32_bf16 v[144:147], v[176:179], v[192:195], 0
  s_nop 0
  v_add_f32_dpp v196, v196, v196 quad_perm:[2,3,0,1] row_mask:0xf bank_mask:0xf
  v_cvt_pk_bf16_f32 v232, v210, v211
  v_mfma_f32_16x16x32_bf16 v[148:151], v[180:183], v[192:195], 0
  v_cvt_pk_bf16_f32 v233, v210, v211
  v_add_f32 v196, v196, v196
  s_nop 1
  v_mfma_f32_16x16x16_bf16 v[196:199], v[246:247], v[232:233], v[196:199]
  v_mfma_f32_16x16x16_bf16 v[144:147], v[204:205], v[232:233], v[144:147]
  v_mfma_f32_16x16x16_bf16 v[148:151], v[206:207], v[232:233], v[148:151]
  s_waitcnt lgkmcnt(0)
  v_rcp_f32 v234, v196
  s_nop 1
  v_pk_mul_f32 v[144:145], v[144:145], v[234:235] op_sel_hi:[1,0]
  v_pk_mul_f32 v[146:147], v[146:147], v[234:235] op_sel_hi:[1,0]
  v_cvt_pk_bf16_f32 v160, v144, v145
  v_cvt_pk_bf16_f32 v161, v146, v147
  v_pk_mul_f32 v[148:149], v[148:149], v[234:235] op_sel_hi:[1,0]
  v_pk_mul_f32 v[150:151], v[150:151], v[234:235] op_sel_hi:[1,0]
  v_cvt_pk_bf16_f32 v162, v148, v149
  v_cvt_pk_bf16_f32 v163, v150, v151
  ds_write_b128 v253, v[160:163] offset:10240
  v_mov_b64 v[152:153], 0
  v_mov_b64 v[154:155], 0
  v_mov_b64 v[156:157], 0
  v_mov_b64 v[158:159], 0
  v_mov_b64 v[188:189], 0
  v_mov_b64 v[190:191], 0
  v_mov_b64 v[236:237], 0
  v_mov_b64 v[238:239], 0
  v_smfmac_f32_16x16x64_bf16 v[152:155], v[160:163], v[32:39], v240
  v_smfmac_f32_16x16x64_bf16 v[156:159], v[160:163], v[40:47], v240
  s_nop 7
  s_branch c_back_0_2
c_h1c1_0_2:
  s_waitcnt vmcnt(1)
  v_mfma_f32_16x16x32_bf16 v[236:239], v[248:251], v[120:123], 0
  s_waitcnt vmcnt(0)
  v_mfma_f32_16x16x32_bf16 v[236:239], v[248:251], v[124:127], v[236:239]
  v_bitop3_b32 v232, v120, v122, v124 bitop3:0x80
  v_bitop3_b32 v232, v232, v126, 1 bitop3:0x80
  v_cmp_ne_u32 vcc, 1, v232
  s_nop 4
  v_add_f32_dpp v236, v236, v236 row_ror:4 row_mask:0xf bank_mask:0xf
  v_add_f32_dpp v237, v237, v237 row_ror:4 row_mask:0xf bank_mask:0xf
  s_nop 0
  v_add_f32_dpp v236, v236, v236 row_ror:8 row_mask:0xf bank_mask:0xf
  v_add_f32_dpp v237, v237, v237 row_ror:8 row_mask:0xf bank_mask:0xf
  v_cvt_pk_bf16_f32 v233, v236, v237
  s_cbranch_vccnz c_h1b1_0_2
c_h1ok1_0_2:
  buffer_store_dword v233, v241, s[4:7], s49 offen
  s_branch c_pub_0_2
c_h1b0_0_2:
  s_mov_b64 exec, vcc
  buffer_load_dwordx4 v[120:123], v253, s[4:7], s40 offen offset:0 sc1
  buffer_load_dwordx4 v[124:127], v253, s[4:7], s40 offen offset:1024 sc1
  s_mov_b64 exec, -1
  s_cmp_eq_u32 s35, 0
  s_cbranch_scc1 c_h1ok0_0_2
  s_sub_u32 s35, s35, 1
  s_branch c_h1c0_0_2
c_h1b1_0_2:
  s_mov_b64 exec, vcc
  buffer_load_dwordx4 v[120:123], v253, s[4:7], s40 offen offset:0 sc1
  buffer_load_dwordx4 v[124:127], v253, s[4:7], s40 offen offset:1024 sc1
  s_mov_b64 exec, -1
  s_cmp_eq_u32 s35, 0
  s_cbranch_scc1 c_h1ok1_0_2
  s_sub_u32 s35, s35, 1
  s_branch c_h1c1_0_2
.p2align 6
c_top_0_3:
  s_waitcnt vmcnt(3)
  v_max3_u32 v238, v112, v113, v114
  s_waitcnt vmcnt(2)
  v_max3_u32 v238, v238, v115, v116
  v_max3_u32 v238, v238, v117, v118
  v_max_u32 v238, v238, v119
  v_cmp_eq_u32 vcc, -1, v238
  ds_write_b128 v253, v[112:115] offset:6144
  s_cbranch_vccnz c_bad_0_3
c_okL_0_3:
  ds_write_b128 v253, v[116:119] offset:7168
  v_smfmac_f32_16x16x64_bf16 v[144:147], v[112:115], v[184:191], v240
  v_smfmac_f32_16x16x64_bf16 v[148:151], v[112:115], v[192:199], v240
  v_smfmac_f32_16x16x64_bf16 v[152:155], v[112:115], v[200:207], v240
  v_smfmac_f32_16x16x64_bf16 v[156:159], v[112:115], v[208:215], v240
  v_smfmac_f32_16x16x64_bf16 v[144:147], v[116:119], v[216:223], v240
  v_smfmac_f32_16x16x64_bf16 v[148:151], v[116:119], v[224:231], v240
  s_waitcnt lgkmcnt(0)
  s_barrier
  ds_read_b128 v[120:123], v253 offset:0
  ds_read_b128 v[124:127], v253 offset:1024
  v_smfmac_f32_16x16x64_bf16 v[152:155], v[116:119], a[96:103], v240
  ds_read_b128 v[128:131], v253 offset:2048
  ds_read_b128 v[132:135], v253 offset:3072
  v_smfmac_f32_16x16x64_bf16 v[156:159], v[116:119], a[104:111], v240
  ds_read_b128 v[136:139], v253 offset:4096
  ds_read_b128 v[140:143], v253 offset:5120
  v_smfmac_f32_16x16x64_bf16 v[160:163], v[112:115], a[160:167], v240
  v_smfmac_f32_16x16x64_bf16 v[164:167], v[112:115], a[168:175], v240
  buffer_load_dwordx4 v[176:179], v253, s[4:7], s42 offen offset:0 sc1
  v_lshlrev_b32 v234, 3, v253
  s_waitcnt lgkmcnt(5)
  v_smfmac_f32_16x16x64_bf16 v[144:147], v[120:123], a[0:7], v240
  ds_read_b128 v[184:187], v252 offset:24576
  s_waitcnt lgkmcnt(5)
  v_smfmac_f32_16x16x64_bf16 v[144:147], v[124:127], a[16:23], v240
  ds_read_b128 v[188:191], v252 offset:25600
  s_waitcnt lgkmcnt(5)
  v_smfmac_f32_16x16x64_bf16 v[144:147], v[128:131], a[32:39], v240
  ds_read_b128 v[192:195], v252 offset:28672
  s_waitcnt lgkmcnt(5)
  v_smfmac_f32_16x16x64_bf16 v[144:147], v[132:135], a[48:55], v240
  buffer_load_dwordx4 v[180:183], v253, s[4:7], s42 offen offset:1024 sc1
  ds_read_b128 v[196:199], v252 offset:29696
  s_waitcnt lgkmcnt(5)
  v_smfmac_f32_16x16x64_bf16 v[144:147], v[136:139], a[64:71], v240
  ds_read_b128 v[200:203], v252 offset:32768
  s_waitcnt lgkmcnt(5)
  v_smfmac_f32_16x16x64_bf16 v[144:147], v[140:143], a[80:87], v240
  ds_read_b128 v[204:207], v252 offset:33792
  v_smfmac_f32_16x16x64_bf16 v[148:151], v[120:123], a[8:15], v240
  ds_read_b128 v[208:211], v252 offset:26624
  v_smfmac_f32_16x16x64_bf16 v[148:151], v[124:127], a[24:31], v240
  buffer_store_dword v233, v241, s[4:7], s48 offen sc1
  s_add_u32 s48, s49, 8388608
  ds_read_b128 v[212:215], v252 offset:27648
  v_cvt_pk_bf16_f32 v232, v144, v145
  v_smfmac_f32_16x16x64_bf16 v[148:151], v[128:131], a[40:47], v240
  ds_read_b128 v[216:219], v252 offset:30720
  v_cvt_pk_bf16_f32 v233, v146, v147
  v_smfmac_f32_16x16x64_bf16 v[148:151], v[132:135], a[56:63], v240
  ds_read_b128 v[220:223], v252 offset:31744
  v_mfma_f32_16x16x16_bf16 v[144:147], v[232:233], v[242:243], 0
  ds_read_b128 v[224:227], v252 offset:34816
  v_smfmac_f32_16x16x64_bf16 v[148:151], v[136:139], a[72:79], v240
  ds_read_b128 v[228:231], v252 offset:35840
  v_smfmac_f32_16x16x64_bf16 v[148:151], v[140:143], a[88:95], v240
  s_mov_b64 exec, s[24:25]
  buffer_load_dword v234, s[4:7], s50 offen lds
  s_mov_b64 exec, -1
  v_cvt_pk_bf16_f32 v236, v144, v145
  v_smfmac_f32_16x16x64_bf16 v[152:155], v[120:123], a[112:119], v240
  v_cvt_pk_bf16_f32 v237, v146, v147
  v_smfmac_f32_16x16x64_bf16 v[152:155], v[124:127], a[128:135], v240
  v_cvt_pk_bf16_f32 v234, v148, v149
  v_cvt_pk_bf16_f32 v235, v150, v151
  v_smfmac_f32_16x16x64_bf16 v[152:155], v[128:131], a[144:151], v240
  v_mfma_f32_16x16x16_bf16 v[148:151], v[234:235], v[242:243], 0
  s_waitcnt lgkmcnt(0)
  v_smfmac_f32_16x16x64_bf16 v[152:155], v[132:135], v[184:191], v240
  v_smfmac_f32_16x16x64_bf16 v[152:155], v[136:139], v[192:199], v240
  v_cvt_pk_bf16_f32 v238, v148, v149
  v_cvt_pk_bf16_f32 v239, v150, v151
  v_smfmac_f32_16x16x64_bf16 v[152:155], v[140:143], v[200:207], v240
  s_waitcnt vmcnt(4)
  v_mfma_f32_16x16x32_bf16 v[144:147], v[168:171], v[236:239], 0
  v_mfma_f32_16x16x32_bf16 v[148:151], v[172:175], v[236:239], 0
  v_cvt_pk_bf16_f32 v232, v152, v153
  v_cvt_pk_bf16_f32 v233, v154, v155
  v_smfmac_f32_16x16x64_bf16 v[156:159], v[120:123], a[120:127], v240
  v_mfma_f32_16x16x16_bf16 v[152:155], v[232:233], v[244:245], 0
  v_cndmask_b32 v144, v144, v148, s[98:99]
  v_cndmask_b32 v145, v145, v149, s[98:99]
  v_cndmask_b32 v146, v146, v150, s[98:99]
  v_cndmask_b32 v147, v147, v151, s[98:99]
  v_smfmac_f32_16x16x64_bf16 v[156:159], v[124:127], a[136:143], v240
  ds_write_b128 v253, v[144:147] offset:11264
  v_smfmac_f32_16x16x64_bf16 v[156:159], v[128:131], a[152:159], v240
  v_cvt_pk_bf16_f32 v200, v152, v153
  v_smfmac_f32_16x16x64_bf16 v[156:159], v[132:135], v[208:215], v240
  v_cvt_pk_bf16_f32 v201, v154, v155
  v_smfmac_f32_16x16x64_bf16 v[156:159], v[136:139], v[216:223], v240
  buffer_load_dwordx4 v[168:171], v253, s[4:7], s41 offen offset:0 sc1
  v_smfmac_f32_16x16x64_bf16 v[156:159], v[140:143], v[224:231], v240
  v_smfmac_f32_16x16x64_bf16 v[160:163], v[120:123], a[192:199], v240
  v_smfmac_f32_16x16x64_bf16 v[164:167], v[120:123], a[200:207], v240
  v_cvt_pk_bf16_f32 v234, v156, v157
  v_cvt_pk_bf16_f32 v235, v158, v159
  s_waitcnt lgkmcnt(0)
  s_barrier
  v_mfma_f32_16x16x16_bf16 v[156:159], v[234:235], v[244:245], 0
  buffer_load_dwordx4 v[172:175], v253, s[4:7], s41 offen offset:1024 sc1
  ds_read_b128 v[184:187], v253 offset:8192
  ds_read_b128 v[188:191], v253 offset:9216
  v_smfmac_f32_16x16x64_bf16 v[160:163], v[124:127], a[208:215], v240
  ds_read_b128 v[192:195], v253 offset:10240
  ds_read_b128 v[196:199], v253 offset:11264
  v_smfmac_f32_16x16x64_bf16 v[164:167], v[124:127], a[216:223], v240
  v_cvt_pk_bf16_f32 v202, v156, v157
  v_cvt_pk_bf16_f32 v203, v158, v159
  v_smfmac_f32_16x16x64_bf16 v[160:163], v[128:131], a[224:231], v240
  v_mfma_f32_16x16x32_bf16 v[152:155], v[200:203], v[236:239], 0
  v_smfmac_f32_16x16x64_bf16 v[164:167], v[128:131], a[232:239], v240
  v_smfmac_f32_16x16x64_bf16 v[160:163], v[132:135], a[240:247], v240
  ds_write_b64 v253, v[152:153] offset:1032
  s_waitcnt lgkmcnt(1)
  v_pk_add_f32 v[184:185], v[184:185], v[188:189]
  v_pk_add_f32 v[186:187], v[186:187], v[190:191]
  v_pk_add_f32 v[192:193], v[192:193], v[196:197]
  v_pk_add_f32 v[194:195], v[194:195], v[198:199]
  v_pk_add_f32 v[184:185], v[184:185], v[192:193]
  v_pk_add_f32 v[186:187], v[186:187], v[194:195]
  v_exp_f32 v188, v184
  v_exp_f32 v189, v185
  v_smfmac_f32_16x16x64_bf16 v[160:163], v[116:119], a[176:183], v240
  v_smfmac_f32_16x16x64_bf16 v[164:167], v[116:119], a[184:191], v240
  v_smfmac_f32_16x16x64_bf16 v[164:167], v[132:135], a[248:255], v240
  s_waitcnt lgkmcnt(0)
  s_barrier
  ds_read_b128 v[208:211], v254 offset:0
  v_smfmac_f32_16x16x64_bf16 v[160:163], v[136:139], v[0:7], v240
  ds_read_b128 v[216:219], v252 offset:16384
  ds_read_b128 v[220:223], v252 offset:17408
  v_exp_f32 v190, v186
  v_exp_f32 v191, v187
  v_cvt_pk_bf16_f32 v188, v188, v189
  v_cvt_pk_bf16_f32 v189, v190, v191
  v_smfmac_f32_16x16x64_bf16 v[160:163], v[140:143], v[16:23], v240
  ds_read_b128 v[224:227], v252 offset:18432
  ds_read_b128 v[228:231], v252 offset:19456
  v_mov_b32_dpp v192, v188 quad_perm:[0,1,0,1] row_mask:0xf bank_mask:0xf
  v_mfma_f32_16x16x16_bf16 v[196:199], v[246:247], v[188:189], 0
  v_mov_b32_dpp v193, v189 quad_perm:[0,1,0,1] row_mask:0xf bank_mask:0xf
  v_mov_b32_dpp v194, v188 quad_perm:[2,3,2,3] row_mask:0xf bank_mask:0xf
  v_mov_b32_dpp v195, v189 quad_perm:[2,3,2,3] row_mask:0xf bank_mask:0xf
  v_smfmac_f32_16x16x64_bf16 v[164:167], v[136:139], v[8:15], v240
  s_waitcnt lgkmcnt(4)
  v_add_f32 v208, v208, v210
  v_smfmac_f32_16x16x64_bf16 v[164:167], v[140:143], v[24:31], v240
  ds_read_b128 v[112:115], v252 offset:0
  ds_read_b128 v[116:119], v252 offset:1024
  v_add_f32 v209, v209, v211
  s_waitcnt vmcnt(4)
  v_mfma_f32_16x16x32_bf16 v[144:147], v[176:179], v[192:195], 0
  ds_read_b128 v[128:131], v252 offset:4096
  v_add_f32_dpp v208, v208, v208 quad_perm:[2,3,0,1] row_mask:0xf bank_mask:0xf
  v_add_f32_dpp v209, v209, v209 quad_perm:[2,3,0,1] row_mask:0xf bank_mask:0xf
  v_mfma_f32_16x16x32_bf16 v[148:151], v[180:183], v[192:195], 0
  ds_read_b128 v[132:135], v252 offset:5120
  v_exp_f32 v210, v208
  v_exp_f32 v211, v209
  v_add_f32_dpp v196, v196, v196 quad_perm:[2,3,0,1] row_mask:0xf bank_mask:0xf
  v_cvt_pk_bf16_f32 v232, v210, v211
  v_cvt_pk_bf16_f32 v233, v210, v211
  v_add_f32 v196, v196, v196
  v_cvt_pk_bf16_f32 v204, v160, v161
  v_cvt_pk_bf16_f32 v205, v162, v163
  v_mfma_f32_16x16x16_bf16 v[196:199], v[246:247], v[232:233], v[196:199]
  v_cvt_pk_bf16_f32 v206, v164, v165
  v_cvt_pk_bf16_f32 v207, v166, v167
  v_mov_b64 v[152:153], 0
  v_mfma_f32_16x16x16_bf16 v[144:147], v[204:205], v[232:233], v[144:147]
  v_mov_b64 v[154:155], 0
  v_mov_b64 v[156:157], 0
  v_mov_b64 v[158:159], 0
  v_mfma_f32_16x16x16_bf16 v[148:151], v[206:207], v[232:233], v[148:151]
  v_rcp_f32 v234, v196
  v_mov_b64 v[188:189], 0
  v_mov_b64 v[190:191], 0
  v_max_f32 v235, v196, v234
  v_pk_mul_f32 v[144:145], v[144:145], v[234:235] op_sel_hi:[1,0]
  v_pk_mul_f32 v[146:147], v[146:147], v[234:235] op_sel_hi:[1,0]
  v_cvt_pk_bf16_f32 v160, v144, v145
  v_cvt_pk_bf16_f32 v161, v146, v147
  v_pk_mul_f32 v[148:149], v[148:149], v[234:235] op_sel_hi:[1,0]
  v_pk_mul_f32 v[150:151], v[150:151], v[234:235] op_sel_hi:[1,0]
  v_cvt_pk_bf16_f32 v162, v148, v149
  v_cvt_pk_bf16_f32 v163, v150, v151
  ds_write_b128 v253, v[160:163] offset:11264
  s_nop 0
  v_smfmac_f32_16x16x64_bf16 v[152:155], v[160:163], v[32:39], v240
  v_cmp_ngt_f32 vcc, s54, v235
  v_smfmac_f32_16x16x64_bf16 v[156:159], v[160:163], v[40:47], v240
  v_mov_b64 v[236:237], 0
  v_mov_b64 v[238:239], 0
  s_cbranch_vccnz c_slow_0_3
c_back_0_3:
  s_waitcnt lgkmcnt(0)
  s_barrier
  ds_read_b128 v[164:167], v253 offset:8192
  ds_read_b128 v[192:195], v253 offset:9216
  ds_read_b128 v[212:215], v253 offset:10240
  v_smfmac_f32_16x16x64_bf16 v[188:191], v[160:163], v[48:55], v240
  ds_read_b128 v[120:123], v252 offset:2048
  v_smfmac_f32_16x16x64_bf16 v[236:239], v[160:163], v[56:63], v240
  s_waitcnt lgkmcnt(3)
  v_smfmac_f32_16x16x64_bf16 v[152:155], v[164:167], v[64:71], v240
  ds_read_b128 v[124:127], v252 offset:3072
  s_add_u32 s37, s37, 1
  s_waitcnt lgkmcnt(3)
  v_smfmac_f32_16x16x64_bf16 v[152:155], v[192:195], v[80:87], v240
  ds_read_b128 v[136:139], v252 offset:6144
  s_add_u32 s38, s38, 8192
  s_waitcnt lgkmcnt(3)
  v_smfmac_f32_16x16x64_bf16 v[152:155], v[212:215], v[96:103], v240
  ds_read_b128 v[140:143], v252 offset:7168
  s_add_u32 s41, s41, 262144
  v_smfmac_f32_16x16x64_bf16 v[156:159], v[164:167], v[72:79], v240
  s_add_u32 s42, s42, 262144
  s_add_u32 s50, s50, 8192
  v_smfmac_f32_16x16x64_bf16 v[156:159], v[192:195], v[88:95], v240
  v_cvt_pk_bf16_f32 v144, v152, v153
  v_cvt_pk_bf16_f32 v145, v154, v155
  v_bfi_b32 v144, 1, s44, v144
  v_smfmac_f32_16x16x64_bf16 v[156:159], v[212:215], v[104:111], v240
  buffer_store_dwordx2 v[144:145], v255, s[4:7], s39 offen offset:0
  v_smfmac_f32_16x16x64_bf16 v[188:191], v[164:167], v[216:223], v240
  s_add_u32 s58, s37, 2
  s_min_u32 s58, s58, 63
  v_smfmac_f32_16x16x64_bf16 v[188:191], v[192:195], v[112:119], v240
  v_cvt_pk_bf16_f32 v146, v156, v157
  v_cvt_pk_bf16_f32 v147, v158, v159
  v_bfi_b32 v146, 1, s44, v146
  v_smfmac_f32_16x16x64_bf16 v[188:191], v[212:215], v[128:135], v240
  buffer_store_dwordx2 v[146:147], v255, s[4:7], s39 offen offset:2048
  v_smfmac_f32_16x16x64_bf16 v[236:239], v[164:167], v[224:231], v240
  s_waitcnt lgkmcnt(0)
  v_smfmac_f32_16x16x64_bf16 v[236:239], v[192:195], v[120:127], v240
  v_cvt_pk_bf16_f32 v148, v188, v189
  v_cvt_pk_bf16_f32 v149, v190, v191
  v_bfi_b32 v148, 1, s44, v148
  v_smfmac_f32_16x16x64_bf16 v[236:239], v[212:215], v[136:143], v240
  buffer_store_dwordx2 v[148:149], v255, s[4:7], s43 offen offset:0
  s_nop 6
  v_cvt_pk_bf16_f32 v150, v236, v237
  v_cvt_pk_bf16_f32 v151, v238, v239
  v_bfi_b32 v150, 1, s44, v150
  buffer_store_dwordx2 v[150:151], v255, s[4:7], s43 offen offset:2048
  s_waitcnt vmcnt(0)
c_pfd_0_3:
  buffer_load_dwordx4 v[120:123], v253, s[4:7], s40 offen offset:0 sc1
  buffer_load_dwordx4 v[124:127], v253, s[4:7], s40 offen offset:1024 sc1
  v_mov_b64 v[152:153], 0
  v_mov_b64 v[154:155], 0
  v_mov_b64 v[156:157], 0
  v_mov_b64 v[158:159], 0
  v_mov_b64 v[160:161], 0
  v_mov_b64 v[162:163], 0
  v_mov_b64 v[164:165], 0
  v_mov_b64 v[166:167], 0
  v_mov_b64 v[144:145], 0
  v_mov_b64 v[146:147], 0
  v_mov_b64 v[148:149], 0
  v_mov_b64 v[150:151], 0
  buffer_load_dwordx4 v[128:131], v253, s[4:7], s40 offen offset:0 sc1
  buffer_load_dwordx4 v[132:135], v253, s[4:7], s40 offen offset:1024 sc1
  s_cmp_lg_u32 s44, 0
  s_cbranch_scc1 c_h1c1_0_3
c_h1c0_0_3:
  s_waitcnt vmcnt(3)
  v_mfma_f32_16x16x32_bf16 v[236:239], v[248:251], v[120:123], 0
  s_waitcnt vmcnt(2)
  v_mfma_f32_16x16x32_bf16 v[236:239], v[248:251], v[124:127], v[236:239]
  v_bitop3_b32 v232, v120, v122, v124 bitop3:0xfe
  v_bitop3_b32 v232, v232, v126, 1 bitop3:0xa8
  v_cmp_ne_u32 vcc, 0, v232
  s_nop 4
  v_add_f32_dpp v236, v236, v236 row_ror:4 row_mask:0xf bank_mask:0xf
  v_add_f32_dpp v237, v237, v237 row_ror:4 row_mask:0xf bank_mask:0xf
  s_nop 0
  v_add_f32_dpp v236, v236, v236 row_ror:8 row_mask:0xf bank_mask:0xf
  v_add_f32_dpp v237, v237, v237 row_ror:8 row_mask:0xf bank_mask:0xf
  v_cvt_pk_bf16_f32 v233, v236, v237
  s_cbranch_vccnz c_h1b0_0_3
c_h1ok0_0_3:
  buffer_store_dword v233, v241, s[4:7], s49 offen
c_pub_0_3:
  s_xor_b32 s44, s44, 1
  s_add_u32 s49, s49, 8192
  s_cmp_eq_u32 s37, s57
  s_cbranch_scc1 c_fin_0_3
  ds_read_b128 v[184:187], v252 offset:8192
  ds_read_b128 v[188:191], v252 offset:9216
  ds_read_b128 v[192:195], v252 offset:10240
  ds_read_b128 v[196:199], v252 offset:11264
  ds_read_b128 v[200:203], v252 offset:20480
  ds_read_b128 v[204:207], v252 offset:21504
  s_waitcnt lgkmcnt(0)
  buffer_load_dwordx4 v[112:115], v253, s[4:7], s38 offen sc1
  buffer_load_dwordx4 v[116:119], v253, s[4:7], s38 offen offset:1024 sc1
  ds_read_b128 v[208:211], v252 offset:22528
  ds_read_b128 v[212:215], v252 offset:23552
  ds_read_b128 v[216:219], v252 offset:12288
  ds_read_b128 v[220:223], v252 offset:13312
  ds_read_b128 v[224:227], v252 offset:14336
  ds_read_b128 v[228:231], v252 offset:15360
  s_waitcnt lgkmcnt(0)
  buffer_load_dwordx4 v[112:115], v253, s[4:7], s38 offen sc1
  buffer_load_dwordx4 v[116:119], v253, s[4:7], s38 offen offset:1024 sc1
  s_branch c_top_0_3
c_fin_0_3:
  buffer_store_dword v233, v241, s[4:7], s48 offen sc1
  s_nop 7
  s_mov_b64 exec, 1
  s_waitcnt vmcnt(0)
  s_endpgm
  s_nop 7
c_bad_0_3:
  s_mov_b64 exec, vcc
  buffer_load_dwordx4 v[112:115], v253, s[4:7], s38 offen sc1
  buffer_load_dwordx4 v[116:119], v253, s[4:7], s38 offen offset:1024 sc1
  s_mov_b64 exec, -1
  s_cmp_eq_u32 s35, 0
  s_cbranch_scc1 c_okL_0_3
  s_sub_u32 s35, s35, 1
  s_branch c_top_0_3
c_entry_0_3:
  ds_write_b128 v253, v[112:115] offset:6144
  s_branch c_okL_0_3
c_slow_0_3:
  s_nop 15
  v_max3_f32 v234, v184, v185, v186
  v_max3_f32 v234, v234, v187, v208
  v_max_f32 v234, v234, v209
  s_nop 1
  v_max_f32_dpp v234, v234, v234 quad_perm:[2,3,0,1] row_mask:0xf bank_mask:0xf
  v_mov_b32 v235, v234
  s_nop 1
  v_permlane16_swap_b32 v234, v235
  s_nop 1
  v_max_f32 v234, v234, v235
  v_mov_b32 v235, v234
  s_nop 1
  v_permlane32_swap_b32 v234, v235
  s_nop 1
  v_max_f32 v234, v234, v235
  v_sub_f32 v188, v184, v234
  v_sub_f32 v189, v185, v234
  v_sub_f32 v190, v186, v234
  v_sub_f32 v191, v187, v234
  v_sub_f32 v210, v208, v234
  v_sub_f32 v211, v209, v234
  v_exp_f32 v188, v188
  v_exp_f32 v189, v189
  v_exp_f32 v190, v190
  v_exp_f32 v191, v191
  v_cvt_pk_bf16_f32 v188, v188, v189
  v_cvt_pk_bf16_f32 v189, v190, v191
  s_nop 1
  v_mfma_f32_16x16x16_bf16 v[196:199], v[246:247], v[188:189], 0
  v_mov_b32_dpp v192, v188 quad_perm:[0,1,0,1] row_mask:0xf bank_mask:0xf
  v_mov_b32_dpp v193, v189 quad_perm:[0,1,0,1] row_mask:0xf bank_mask:0xf
  v_mov_b32_dpp v194, v188 quad_perm:[2,3,2,3] row_mask:0xf bank_mask:0xf
  v_mov_b32_dpp v195, v189 quad_perm:[2,3,2,3] row_mask:0xf bank_mask:0xf
  v_exp_f32 v210, v210
  v_exp_f32 v211, v211
  v_mfma_f32_16x16x32_bf16 v[144:147], v[176:179], v[192:195], 0
  s_nop 0
  v_add_f32_dpp v196, v196, v196 quad_perm:[2,3,0,1] row_mask:0xf bank_mask:0xf
  v_cvt_pk_bf16_f32 v232, v210, v211
  v_mfma_f32_16x16x32_bf16 v[148:151], v[180:183], v[192:195], 0
  v_cvt_pk_bf16_f32 v233, v210, v211
  v_add_f32 v196, v196, v196
  s_nop 1
  v_mfma_f32_16x16x16_bf16 v[196:199], v[246:247], v[232:233], v[196:199]
  v_mfma_f32_16x16x16_bf16 v[144:147], v[204:205], v[232:233], v[144:147]
  v_mfma_f32_16x16x16_bf16 v[148:151], v[206:207], v[232:233], v[148:151]
  s_waitcnt lgkmcnt(0)
  v_rcp_f32 v234, v196
  s_nop 1
  v_pk_mul_f32 v[144:145], v[144:145], v[234:235] op_sel_hi:[1,0]
  v_pk_mul_f32 v[146:147], v[146:147], v[234:235] op_sel_hi:[1,0]
  v_cvt_pk_bf16_f32 v160, v144, v145
  v_cvt_pk_bf16_f32 v161, v146, v147
  v_pk_mul_f32 v[148:149], v[148:149], v[234:235] op_sel_hi:[1,0]
  v_pk_mul_f32 v[150:151], v[150:151], v[234:235] op_sel_hi:[1,0]
  v_cvt_pk_bf16_f32 v162, v148, v149
  v_cvt_pk_bf16_f32 v163, v150, v151
  ds_write_b128 v253, v[160:163] offset:11264
  v_mov_b64 v[152:153], 0
  v_mov_b64 v[154:155], 0
  v_mov_b64 v[156:157], 0
  v_mov_b64 v[158:159], 0
  v_mov_b64 v[188:189], 0
  v_mov_b64 v[190:191], 0
  v_mov_b64 v[236:237], 0
  v_mov_b64 v[238:239], 0
  v_smfmac_f32_16x16x64_bf16 v[152:155], v[160:163], v[32:39], v240
  v_smfmac_f32_16x16x64_bf16 v[156:159], v[160:163], v[40:47], v240
  s_nop 7
  s_branch c_back_0_3
c_h1c1_0_3:
  s_waitcnt vmcnt(3)
  v_mfma_f32_16x16x32_bf16 v[236:239], v[248:251], v[120:123], 0
  s_waitcnt vmcnt(2)
  v_mfma_f32_16x16x32_bf16 v[236:239], v[248:251], v[124:127], v[236:239]
  v_bitop3_b32 v232, v120, v122, v124 bitop3:0x80
  v_bitop3_b32 v232, v232, v126, 1 bitop3:0x80
  v_cmp_ne_u32 vcc, 1, v232
  s_nop 4
  v_add_f32_dpp v236, v236, v236 row_ror:4 row_mask:0xf bank_mask:0xf
  v_add_f32_dpp v237, v237, v237 row_ror:4 row_mask:0xf bank_mask:0xf
  s_nop 0
  v_add_f32_dpp v236, v236, v236 row_ror:8 row_mask:0xf bank_mask:0xf
  v_add_f32_dpp v237, v237, v237 row_ror:8 row_mask:0xf bank_mask:0xf
  v_cvt_pk_bf16_f32 v233, v236, v237
  s_cbranch_vccnz c_h1b1_0_3
c_h1ok1_0_3:
  buffer_store_dword v233, v241, s[4:7], s49 offen
  s_branch c_pub_0_3
c_h1b0_0_3:
  s_mov_b64 exec, vcc
  buffer_load_dwordx4 v[120:123], v253, s[4:7], s40 offen offset:0 sc1
  buffer_load_dwordx4 v[124:127], v253, s[4:7], s40 offen offset:1024 sc1
  s_mov_b64 exec, -1
  s_waitcnt vmcnt(3)
  v_mfma_f32_16x16x32_bf16 v[236:239], v[248:251], v[128:131], 0
  s_waitcnt vmcnt(2)
  v_mfma_f32_16x16x32_bf16 v[236:239], v[248:251], v[132:135], v[236:239]
  v_bitop3_b32 v232, v128, v130, v132 bitop3:0xfe
  v_bitop3_b32 v232, v232, v134, 1 bitop3:0xa8
  v_cmp_ne_u32 vcc, 0, v232
  s_nop 4
  v_add_f32_dpp v236, v236, v236 row_ror:4 row_mask:0xf bank_mask:0xf
  v_add_f32_dpp v237, v237, v237 row_ror:4 row_mask:0xf bank_mask:0xf
  s_nop 0
  v_add_f32_dpp v236, v236, v236 row_ror:8 row_mask:0xf bank_mask:0xf
  v_add_f32_dpp v237, v237, v237 row_ror:8 row_mask:0xf bank_mask:0xf
  v_cvt_pk_bf16_f32 v233, v236, v237
  s_cbranch_vccz c_h1ok0_0_3
  s_mov_b64 exec, vcc
  buffer_load_dwordx4 v[128:131], v253, s[4:7], s40 offen offset:0 sc1
  buffer_load_dwordx4 v[132:135], v253, s[4:7], s40 offen offset:1024 sc1
  s_mov_b64 exec, -1
  s_cmp_eq_u32 s35, 0
  s_cbranch_scc1 c_h1ok0_0_3
  s_sub_u32 s35, s35, 1
  s_branch c_h1c0_0_3
c_h1b1_0_3:
  s_mov_b64 exec, vcc
  buffer_load_dwordx4 v[120:123], v253, s[4:7], s40 offen offset:0 sc1
  buffer_load_dwordx4 v[124:127], v253, s[4:7], s40 offen offset:1024 sc1
  s_mov_b64 exec, -1
  s_waitcnt vmcnt(3)
  v_mfma_f32_16x16x32_bf16 v[236:239], v[248:251], v[128:131], 0
  s_waitcnt vmcnt(2)
  v_mfma_f32_16x16x32_bf16 v[236:239], v[248:251], v[132:135], v[236:239]
  v_bitop3_b32 v232, v128, v130, v132 bitop3:0x80
  v_bitop3_b32 v232, v232, v134, 1 bitop3:0x80
  v_cmp_ne_u32 vcc, 1, v232
  s_nop 4
  v_add_f32_dpp v236, v236, v236 row_ror:4 row_mask:0xf bank_mask:0xf
  v_add_f32_dpp v237, v237, v237 row_ror:4 row_mask:0xf bank_mask:0xf
  s_nop 0
  v_add_f32_dpp v236, v236, v236 row_ror:8 row_mask:0xf bank_mask:0xf
  v_add_f32_dpp v237, v237, v237 row_ror:8 row_mask:0xf bank_mask:0xf
  v_cvt_pk_bf16_f32 v233, v236, v237
  s_cbranch_vccz c_h1ok1_0_3
  s_mov_b64 exec, vcc
  buffer_load_dwordx4 v[128:131], v253, s[4:7], s40 offen offset:0 sc1
  buffer_load_dwordx4 v[132:135], v253, s[4:7], s40 offen offset:1024 sc1
  s_mov_b64 exec, -1
  s_cmp_eq_u32 s35, 0
  s_cbranch_scc1 c_h1ok1_0_3
  s_sub_u32 s35, s35, 1
  s_branch c_h1c1_0_3
.p2align 6
c_top_1_0:
  s_waitcnt vmcnt(3)
  v_max3_u32 v238, v112, v113, v114
  s_waitcnt vmcnt(2)
  v_max3_u32 v238, v238, v115, v116
  v_max3_u32 v238, v238, v117, v118
  v_max_u32 v238, v238, v119
  v_cmp_eq_u32 vcc, -1, v238
  ds_write_b128 v253, v[112:115] offset:0
  s_cbranch_vccnz c_bad_1_0
c_okL_1_0:
  ds_write_b128 v253, v[116:119] offset:1024
  v_smfmac_f32_16x16x64_bf16 v[144:147], v[112:115], v[184:191], v240
  v_smfmac_f32_16x16x64_bf16 v[148:151], v[112:115], v[192:199], v240
  v_smfmac_f32_16x16x64_bf16 v[152:155], v[112:115], v[200:207], v240
  v_smfmac_f32_16x16x64_bf16 v[156:159], v[112:115], v[208:215], v240
  v_smfmac_f32_16x16x64_bf16 v[144:147], v[116:119], v[216:223], v240
  v_smfmac_f32_16x16x64_bf16 v[148:151], v[116:119], v[224:231], v240
  s_waitcnt lgkmcnt(0)
  s_barrier
  ds_read_b128 v[120:123], v253 offset:2048
  ds_read_b128 v[124:127], v253 offset:3072
  v_smfmac_f32_16x16x64_bf16 v[152:155], v[116:119], a[96:103], v240
  buffer_load_dwordx4 v[176:179], v253, s[4:7], s42 offen offset:0 sc1
  ds_read_b128 v[128:131], v253 offset:4096
  ds_read_b128 v[132:135], v253 offset:5120
  v_smfmac_f32_16x16x64_bf16 v[156:159], v[116:119], a[104:111], v240
  ds_read_b128 v[136:139], v253 offset:6144
  ds_read_b128 v[140:143], v253 offset:7168
  v_smfmac_f32_16x16x64_bf16 v[160:163], v[112:115], a[160:167], v240
  v_smfmac_f32_16x16x64_bf16 v[164:167], v[112:115], a[168:175], v240
  v_lshlrev_b32 v234, 7, v252
  s_waitcnt lgkmcnt(5)
  v_smfmac_f32_16x16x64_bf16 v[144:147], v[120:123], a[0:7], v240
  buffer_load_dwordx4 v[180:183], v253, s[4:7], s42 offen offset:1024 sc1
  ds_read_b128 v[184:187], v252 offset:24576
  s_waitcnt lgkmcnt(5)
  v_smfmac_f32_16x16x64_bf16 v[144:147], v[124:127], a[16:23], v240
  ds_read_b128 v[188:191], v252 offset:25600
  s_waitcnt lgkmcnt(5)
  v_smfmac_f32_16x16x64_bf16 v[144:147], v[128:131], a[32:39], v240
  ds_read_b128 v[192:195], v252 offset:28672
  s_waitcnt lgkmcnt(5)
  v_smfmac_f32_16x16x64_bf16 v[144:147], v[132:135], a[48:55], v240
  ds_read_b128 v[196:199], v252 offset:29696
  s_waitcnt lgkmcnt(5)
  v_smfmac_f32_16x16x64_bf16 v[144:147], v[136:139], a[64:71], v240
  buffer_store_dword v233, v241, s[4:7], s48 offen sc1
  s_add_u32 s48, s49, 8388608
  ds_read_b128 v[200:203], v252 offset:32768
  s_waitcnt lgkmcnt(5)
  v_smfmac_f32_16x16x64_bf16 v[144:147], v[140:143], a[80:87], v240
  ds_read_b128 v[204:207], v252 offset:33792
  v_smfmac_f32_16x16x64_bf16 v[148:151], v[120:123], a[8:15], v240
  ds_read_b128 v[208:211], v252 offset:26624
  v_smfmac_f32_16x16x64_bf16 v[148:151], v[124:127], a[24:31], v240
  ds_read_b128 v[212:215], v252 offset:27648
  v_cvt_pk_bf16_f32 v232, v144, v145
  v_smfmac_f32_16x16x64_bf16 v[148:151], v[128:131], a[40:47], v240
  ds_read_b128 v[216:219], v252 offset:30720
  v_cvt_pk_bf16_f32 v233, v146, v147
  v_smfmac_f32_16x16x64_bf16 v[148:151], v[132:135], a[56:63], v240
  ds_read_b128 v[220:223], v252 offset:31744
  v_mfma_f32_16x16x16_bf16 v[144:147], v[232:233], v[242:243], 0
  ds_read_b128 v[224:227], v252 offset:34816
  v_smfmac_f32_16x16x64_bf16 v[148:151], v[136:139], a[72:79], v240
  ds_read_b128 v[228:231], v252 offset:35840
  v_smfmac_f32_16x16x64_bf16 v[148:151], v[140:143], a[88:95], v240
  s_mov_b64 exec, 3
  buffer_load_dword v234, s[4:7], s51 offen sc1 lds
  s_mov_b64 exec, -1
  v_cvt_pk_bf16_f32 v236, v144, v145
  v_smfmac_f32_16x16x64_bf16 v[152:155], v[120:123], a[112:119], v240
  v_cvt_pk_bf16_f32 v237, v146, v147
  v_smfmac_f32_16x16x64_bf16 v[152:155], v[124:127], a[128:135], v240
  v_cvt_pk_bf16_f32 v234, v148, v149
  v_cvt_pk_bf16_f32 v235, v150, v151
  v_smfmac_f32_16x16x64_bf16 v[152:155], v[128:131], a[144:151], v240
  v_mfma_f32_16x16x16_bf16 v[148:151], v[234:235], v[242:243], 0
  s_waitcnt lgkmcnt(0)
  v_smfmac_f32_16x16x64_bf16 v[152:155], v[132:135], v[184:191], v240
  v_smfmac_f32_16x16x64_bf16 v[152:155], v[136:139], v[192:199], v240
  v_cvt_pk_bf16_f32 v238, v148, v149
  v_cvt_pk_bf16_f32 v239, v150, v151
  v_smfmac_f32_16x16x64_bf16 v[152:155], v[140:143], v[200:207], v240
  s_waitcnt vmcnt(4)
  v_mfma_f32_16x16x32_bf16 v[144:147], v[168:171], v[236:239], 0
  v_mfma_f32_16x16x32_bf16 v[148:151], v[172:175], v[236:239], 0
  v_cvt_pk_bf16_f32 v232, v152, v153
  v_cvt_pk_bf16_f32 v233, v154, v155
  v_smfmac_f32_16x16x64_bf16 v[156:159], v[120:123], a[120:127], v240
  v_mfma_f32_16x16x16_bf16 v[152:155], v[232:233], v[244:245], 0
  v_cndmask_b32 v144, v144, v148, s[98:99]
  v_cndmask_b32 v145, v145, v149, s[98:99]
  v_cndmask_b32 v146, v146, v150, s[98:99]
  v_cndmask_b32 v147, v147, v151, s[98:99]
  v_smfmac_f32_16x16x64_bf16 v[156:159], v[124:127], a[136:143], v240
  buffer_load_dwordx4 v[168:171], v253, s[4:7], s41 offen offset:0 sc1
  ds_write_b128 v253, v[144:147] offset:8192
  v_smfmac_f32_16x16x64_bf16 v[156:159], v[128:131], a[152:159], v240
  v_cvt_pk_bf16_f32 v200, v152, v153
  v_smfmac_f32_16x16x64_bf16 v[156:159], v[132:135], v[208:215], v240
  v_cvt_pk_bf16_f32 v201, v154, v155
  v_smfmac_f32_16x16x64_bf16 v[156:159], v[136:139], v[216:223], v240
  v_smfmac_f32_16x16x64_bf16 v[156:159], v[140:143], v[224:231], v240
  buffer_load_dwordx4 v[172:175], v253, s[4:7], s41 offen offset:1024 sc1
  v_smfmac_f32_16x16x64_bf16 v[160:163], v[120:123], a[192:199], v240
  v_smfmac_f32_16x16x64_bf16 v[164:167], v[120:123], a[200:207], v240
  v_cvt_pk_bf16_f32 v234, v156, v157
  v_cvt_pk_bf16_f32 v235, v158, v159
  s_waitcnt lgkmcnt(0)
  s_barrier
  v_mfma_f32_16x16x16_bf16 v[156:159], v[234:235], v[244:245], 0
  ds_read_b128 v[184:187], v253 offset:8192
  ds_read_b128 v[188:191], v253 offset:9216
  v_smfmac_f32_16x16x64_bf16 v[160:163], v[124:127], a[208:215], v240
  ds_read_b128 v[192:195], v253 offset:10240
  ds_read_b128 v[196:199], v253 offset:11264
  v_smfmac_f32_16x16x64_bf16 v[164:167], v[124:127], a[216:223], v240
  v_cvt_pk_bf16_f32 v202, v156, v157
  v_cvt_pk_bf16_f32 v203, v158, v159
  v_smfmac_f32_16x16x64_bf16 v[160:163], v[128:131], a[224:231], v240
  v_mfma_f32_16x16x32_bf16 v[152:155], v[200:203], v[236:239], 0
  v_smfmac_f32_16x16x64_bf16 v[164:167], v[128:131], a[232:239], v240
  v_smfmac_f32_16x16x64_bf16 v[160:163], v[132:135], a[240:247], v240
  ds_write_b64 v253, v[152:153] offset:0
  s_waitcnt lgkmcnt(1)
  v_pk_add_f32 v[184:185], v[184:185], v[188:189]
  v_pk_add_f32 v[186:187], v[186:187], v[190:191]
  v_pk_add_f32 v[192:193], v[192:193], v[196:197]
  v_pk_add_f32 v[194:195], v[194:195], v[198:199]
  v_pk_add_f32 v[184:185], v[184:185], v[192:193]
  v_pk_add_f32 v[186:187], v[186:187], v[194:195]
  v_exp_f32 v188, v184
  v_exp_f32 v189, v185
  v_smfmac_f32_16x16x64_bf16 v[160:163], v[116:119], a[176:183], v240
  v_smfmac_f32_16x16x64_bf16 v[164:167], v[116:119], a[184:191], v240
  v_smfmac_f32_16x16x64_bf16 v[164:167], v[132:135], a[248:255], v240
  s_waitcnt lgkmcnt(0)
  s_barrier
  ds_read_b128 v[208:211], v254 offset:0
  v_smfmac_f32_16x16x64_bf16 v[160:163], v[136:139], v[0:7], v240
  ds_read_b128 v[216:219], v252 offset:16384
  ds_read_b128 v[220:223], v252 offset:17408
  v_exp_f32 v190, v186
  v_exp_f32 v191, v187
  v_cvt_pk_bf16_f32 v188, v188, v189
  v_cvt_pk_bf16_f32 v189, v190, v191
  v_smfmac_f32_16x16x64_bf16 v[160:163], v[140:143], v[16:23], v240
  ds_read_b128 v[224:227], v252 offset:18432
  ds_read_b128 v[228:231], v252 offset:19456
  v_mov_b32_dpp v192, v188 quad_perm:[0,1,0,1] row_mask:0xf bank_mask:0xf
  v_mfma_f32_16x16x16_bf16 v[196:199], v[246:247], v[188:189], 0
  v_mov_b32_dpp v193, v189 quad_perm:[0,1,0,1] row_mask:0xf bank_mask:0xf
  v_mov_b32_dpp v194, v188 quad_perm:[2,3,2,3] row_mask:0xf bank_mask:0xf
  v_mov_b32_dpp v195, v189 quad_perm:[2,3,2,3] row_mask:0xf bank_mask:0xf
  v_smfmac_f32_16x16x64_bf16 v[164:167], v[136:139], v[8:15], v240
  s_waitcnt lgkmcnt(4)
  v_add_f32 v208, v208, v210
  v_smfmac_f32_16x16x64_bf16 v[164:167], v[140:143], v[24:31], v240
  ds_read_b128 v[112:115], v252 offset:0
  ds_read_b128 v[116:119], v252 offset:1024
  v_add_f32 v209, v209, v211
  s_waitcnt vmcnt(4)
  v_mfma_f32_16x16x32_bf16 v[144:147], v[176:179], v[192:195], 0
  ds_read_b128 v[128:131], v252 offset:4096
  v_add_f32_dpp v208, v208, v208 quad_perm:[2,3,0,1] row_mask:0xf bank_mask:0xf
  v_add_f32_dpp v209, v209, v209 quad_perm:[2,3,0,1] row_mask:0xf bank_mask:0xf
  v_mfma_f32_16x16x32_bf16 v[148:151], v[180:183], v[192:195], 0
  ds_read_b128 v[132:135], v252 offset:5120
  v_exp_f32 v210, v208
  v_exp_f32 v211, v209
  v_add_f32_dpp v196, v196, v196 quad_perm:[2,3,0,1] row_mask:0xf bank_mask:0xf
  v_cvt_pk_bf16_f32 v232, v210, v211
  v_cvt_pk_bf16_f32 v233, v210, v211
  v_add_f32 v196, v196, v196
  v_cvt_pk_bf16_f32 v204, v160, v161
  v_cvt_pk_bf16_f32 v205, v162, v163
  v_mfma_f32_16x16x16_bf16 v[196:199], v[246:247], v[232:233], v[196:199]
  v_cvt_pk_bf16_f32 v206, v164, v165
  v_cvt_pk_bf16_f32 v207, v166, v167
  v_mov_b64 v[152:153], 0
  v_mfma_f32_16x16x16_bf16 v[144:147], v[204:205], v[232:233], v[144:147]
  v_mov_b64 v[154:155], 0
  v_mov_b64 v[156:157], 0
  v_mov_b64 v[158:159], 0
  v_mfma_f32_16x16x16_bf16 v[148:151], v[206:207], v[232:233], v[148:151]
  v_rcp_f32 v234, v196
  v_mov_b64 v[188:189], 0
  v_mov_b64 v[190:191], 0
  v_max_f32 v235, v196, v234
  v_pk_mul_f32 v[144:145], v[144:145], v[234:235] op_sel_hi:[1,0]
  v_pk_mul_f32 v[146:147], v[146:147], v[234:235] op_sel_hi:[1,0]
  v_cvt_pk_bf16_f32 v160, v144, v145
  v_cvt_pk_bf16_f32 v161, v146, v147
  v_pk_mul_f32 v[148:149], v[148:149], v[234:235] op_sel_hi:[1,0]
  v_pk_mul_f32 v[150:151], v[150:151], v[234:235] op_sel_hi:[1,0]
  v_cvt_pk_bf16_f32 v162, v148, v149
  v_cvt_pk_bf16_f32 v163, v150, v151
  ds_write_b128 v253, v[160:163] offset:8192
  s_nop 0
  v_smfmac_f32_16x16x64_bf16 v[152:155], v[160:163], v[32:39], v240
  v_cmp_ngt_f32 vcc, s54, v235
  v_smfmac_f32_16x16x64_bf16 v[156:159], v[160:163], v[40:47], v240
  v_mov_b64 v[236:237], 0
  v_mov_b64 v[238:239], 0
  s_cbranch_vccnz c_slow_1_0
c_back_1_0:
  s_waitcnt lgkmcnt(0)
  s_barrier
  ds_read_b128 v[164:167], v253 offset:9216
  ds_read_b128 v[192:195], v253 offset:10240
  ds_read_b128 v[212:215], v253 offset:11264
  v_smfmac_f32_16x16x64_bf16 v[188:191], v[160:163], v[48:55], v240
  ds_read_b128 v[120:123], v252 offset:2048
  v_smfmac_f32_16x16x64_bf16 v[236:239], v[160:163], v[56:63], v240
  s_waitcnt lgkmcnt(3)
  v_smfmac_f32_16x16x64_bf16 v[152:155], v[164:167], v[64:71], v240
  ds_read_b128 v[124:127], v252 offset:3072
  s_add_u32 s37, s37, 1
  s_waitcnt lgkmcnt(3)
  v_smfmac_f32_16x16x64_bf16 v[152:155], v[192:195], v[80:87], v240
  ds_read_b128 v[136:139], v252 offset:6144
  s_add_u32 s38, s38, 8192
  s_waitcnt lgkmcnt(3)
  v_smfmac_f32_16x16x64_bf16 v[152:155], v[212:215], v[96:103], v240
  ds_read_b128 v[140:143], v252 offset:7168
  s_add_u32 s41, s41, 262144
  v_smfmac_f32_16x16x64_bf16 v[156:159], v[164:167], v[72:79], v240
  s_add_u32 s42, s42, 262144
  s_add_u32 s50, s50, 262144
  v_smfmac_f32_16x16x64_bf16 v[156:159], v[192:195], v[88:95], v240
  v_cvt_pk_bf16_f32 v144, v152, v153
  v_cvt_pk_bf16_f32 v145, v154, v155
  v_bfi_b32 v144, 1, s44, v144
  v_smfmac_f32_16x16x64_bf16 v[156:159], v[212:215], v[104:111], v240
  buffer_store_dwordx2 v[144:145], v255, s[4:7], s39 offen offset:0 sc1
  v_smfmac_f32_16x16x64_bf16 v[188:191], v[164:167], v[216:223], v240
  s_add_u32 s58, s37, 2
  s_min_u32 s58, s58, 63
  v_smfmac_f32_16x16x64_bf16 v[188:191], v[192:195], v[112:119], v240
  v_cvt_pk_bf16_f32 v146, v156, v157
  v_cvt_pk_bf16_f32 v147, v158, v159
  v_bfi_b32 v146, 1, s44, v146
  v_smfmac_f32_16x16x64_bf16 v[188:191], v[212:215], v[128:135], v240
  buffer_store_dwordx2 v[146:147], v255, s[4:7], s39 offen offset:2048 sc1
  v_smfmac_f32_16x16x64_bf16 v[236:239], v[164:167], v[224:231], v240
  s_waitcnt lgkmcnt(0)
  v_smfmac_f32_16x16x64_bf16 v[236:239], v[192:195], v[120:127], v240
  v_cvt_pk_bf16_f32 v148, v188, v189
  v_cvt_pk_bf16_f32 v149, v190, v191
  v_bfi_b32 v148, 1, s44, v148
  v_smfmac_f32_16x16x64_bf16 v[236:239], v[212:215], v[136:143], v240
  buffer_store_dwordx2 v[148:149], v255, s[4:7], s43 offen offset:0 sc1
  s_nop 6
  v_cvt_pk_bf16_f32 v150, v236, v237
  v_cvt_pk_bf16_f32 v151, v238, v239
  v_bfi_b32 v150, 1, s44, v150
  buffer_store_dwordx2 v[150:151], v255, s[4:7], s43 offen offset:2048 sc1
  s_waitcnt vmcnt(2)
c_pfd_1_0:
  buffer_load_dwordx4 v[120:123], v253, s[4:7], s40 offen offset:0 sc1
  buffer_load_dwordx4 v[124:127], v253, s[4:7], s40 offen offset:1024 sc1
  v_mov_b64 v[152:153], 0
  v_mov_b64 v[154:155], 0
  v_mov_b64 v[156:157], 0
  v_mov_b64 v[158:159], 0
  v_mov_b64 v[160:161], 0
  v_mov_b64 v[162:163], 0
  v_mov_b64 v[164:165], 0
  v_mov_b64 v[166:167], 0
  v_mov_b64 v[144:145], 0
  v_mov_b64 v[146:147], 0
  v_mov_b64 v[148:149], 0
  v_mov_b64 v[150:151], 0
  s_cmp_lg_u32 s44, 0
  s_cbranch_scc1 c_h1c1_1_0
c_h1c0_1_0:
  s_waitcnt vmcnt(1)
  v_mfma_f32_16x16x32_bf16 v[236:239], v[248:251], v[120:123], 0
  s_waitcnt vmcnt(0)
  v_mfma_f32_16x16x32_bf16 v[236:239], v[248:251], v[124:127], v[236:239]
  v_bitop3_b32 v232, v120, v122, v124 bitop3:0xfe
  v_bitop3_b32 v232, v232, v126, 1 bitop3:0xa8
  v_cmp_ne_u32 vcc, 0, v232
  s_nop 4
  v_add_f32_dpp v236, v236, v236 row_ror:4 row_mask:0xf bank_mask:0xf
  v_add_f32_dpp v237, v237, v237 row_ror:4 row_mask:0xf bank_mask:0xf
  s_nop 0
  v_add_f32_dpp v236, v236, v236 row_ror:8 row_mask:0xf bank_mask:0xf
  v_add_f32_dpp v237, v237, v237 row_ror:8 row_mask:0xf bank_mask:0xf
  v_cvt_pk_bf16_f32 v233, v236, v237
  s_cbranch_vccnz c_h1b0_1_0
c_h1ok0_1_0:
  buffer_store_dword v233, v241, s[4:7], s49 offen sc1
c_pub_1_0:
  s_xor_b32 s44, s44, 1
  s_add_u32 s49, s49, 8192
  s_cmp_eq_u32 s37, s57
  s_cbranch_scc1 c_fin_1_0
  ds_read_b64 v[236:237], v253 offset:13312
  s_waitcnt lgkmcnt(0)
  v_min_u32 v236, v236, v237
  s_nop 0
  v_readfirstlane_b32 s59, v236
  s_cmp_lt_u32 s59, s58
  s_cbranch_scc1 c_prg_1_0
c_prgok_1_0:
  ds_read_b128 v[184:187], v252 offset:8192
  ds_read_b128 v[188:191], v252 offset:9216
  ds_read_b128 v[192:195], v252 offset:10240
  ds_read_b128 v[196:199], v252 offset:11264
  ds_read_b128 v[200:203], v252 offset:20480
  ds_read_b128 v[204:207], v252 offset:21504
  s_waitcnt lgkmcnt(0)
  buffer_load_dwordx4 v[112:115], v253, s[4:7], s38 offen sc1
  buffer_load_dwordx4 v[116:119], v253, s[4:7], s38 offen offset:1024 sc1
  ds_read_b128 v[208:211], v252 offset:22528
  ds_read_b128 v[212:215], v252 offset:23552
  ds_read_b128 v[216:219], v252 offset:12288
  ds_read_b128 v[220:223], v252 offset:13312
  ds_read_b128 v[224:227], v252 offset:14336
  ds_read_b128 v[228:231], v252 offset:15360
  s_waitcnt lgkmcnt(0)
  buffer_load_dwordx4 v[112:115], v253, s[4:7], s38 offen sc1
  buffer_load_dwordx4 v[116:119], v253, s[4:7], s38 offen offset:1024 sc1
  s_branch c_top_1_0
c_fin_1_0:
  buffer_store_dword v233, v241, s[4:7], s48 offen sc1
  s_nop 7
  s_mov_b64 exec, 1
  s_waitcnt vmcnt(0)
  s_endpgm
  s_nop 7
c_bad_1_0:
  s_mov_b64 exec, vcc
  buffer_load_dwordx4 v[112:115], v253, s[4:7], s38 offen sc1
  buffer_load_dwordx4 v[116:119], v253, s[4:7], s38 offen offset:1024 sc1
  s_mov_b64 exec, -1
  s_cmp_eq_u32 s35, 0
  s_cbranch_scc1 c_okL_1_0
  s_sub_u32 s35, s35, 1
  s_branch c_top_1_0
c_entry_1_0:
  ds_write_b128 v253, v[112:115] offset:0
  s_branch c_okL_1_0
c_slow_1_0:
  s_nop 15
  v_max3_f32 v234, v184, v185, v186
  v_max3_f32 v234, v234, v187, v208
  v_max_f32 v234, v234, v209
  s_nop 1
  v_max_f32_dpp v234, v234, v234 quad_perm:[2,3,0,1] row_mask:0xf bank_mask:0xf
  v_mov_b32 v235, v234
  s_nop 1
  v_permlane16_swap_b32 v234, v235
  s_nop 1
  v_max_f32 v234, v234, v235
  v_mov_b32 v235, v234
  s_nop 1
  v_permlane32_swap_b32 v234, v235
  s_nop 1
  v_max_f32 v234, v234, v235
  v_sub_f32 v188, v184, v234
  v_sub_f32 v189, v185, v234
  v_sub_f32 v190, v186, v234
  v_sub_f32 v191, v187, v234
  v_sub_f32 v210, v208, v234
  v_sub_f32 v211, v209, v234
  v_exp_f32 v188, v188
  v_exp_f32 v189, v189
  v_exp_f32 v190, v190
  v_exp_f32 v191, v191
  v_cvt_pk_bf16_f32 v188, v188, v189
  v_cvt_pk_bf16_f32 v189, v190, v191
  s_nop 1
  v_mfma_f32_16x16x16_bf16 v[196:199], v[246:247], v[188:189], 0
  v_mov_b32_dpp v192, v188 quad_perm:[0,1,0,1] row_mask:0xf bank_mask:0xf
  v_mov_b32_dpp v193, v189 quad_perm:[0,1,0,1] row_mask:0xf bank_mask:0xf
  v_mov_b32_dpp v194, v188 quad_perm:[2,3,2,3] row_mask:0xf bank_mask:0xf
  v_mov_b32_dpp v195, v189 quad_perm:[2,3,2,3] row_mask:0xf bank_mask:0xf
  v_exp_f32 v210, v210
  v_exp_f32 v211, v211
  v_mfma_f32_16x16x32_bf16 v[144:147], v[176:179], v[192:195], 0
  s_nop 0
  v_add_f32_dpp v196, v196, v196 quad_perm:[2,3,0,1] row_mask:0xf bank_mask:0xf
  v_cvt_pk_bf16_f32 v232, v210, v211
  v_mfma_f32_16x16x32_bf16 v[148:151], v[180:183], v[192:195], 0
  v_cvt_pk_bf16_f32 v233, v210, v211
  v_add_f32 v196, v196, v196
  s_nop 1
  v_mfma_f32_16x16x16_bf16 v[196:199], v[246:247], v[232:233], v[196:199]
  v_mfma_f32_16x16x16_bf16 v[144:147], v[204:205], v[232:233], v[144:147]
  v_mfma_f32_16x16x16_bf16 v[148:151], v[206:207], v[232:233], v[148:151]
  s_waitcnt lgkmcnt(0)
  v_rcp_f32 v234, v196
  s_nop 1
  v_pk_mul_f32 v[144:145], v[144:145], v[234:235] op_sel_hi:[1,0]
  v_pk_mul_f32 v[146:147], v[146:147], v[234:235] op_sel_hi:[1,0]
  v_cvt_pk_bf16_f32 v160, v144, v145
  v_cvt_pk_bf16_f32 v161, v146, v147
  v_pk_mul_f32 v[148:149], v[148:149], v[234:235] op_sel_hi:[1,0]
  v_pk_mul_f32 v[150:151], v[150:151], v[234:235] op_sel_hi:[1,0]
  v_cvt_pk_bf16_f32 v162, v148, v149
  v_cvt_pk_bf16_f32 v163, v150, v151
  ds_write_b128 v253, v[160:163] offset:8192
  v_mov_b64 v[152:153], 0
  v_mov_b64 v[154:155], 0
  v_mov_b64 v[156:157], 0
  v_mov_b64 v[158:159], 0
  v_mov_b64 v[188:189], 0
  v_mov_b64 v[190:191], 0
  v_mov_b64 v[236:237], 0
  v_mov_b64 v[238:239], 0
  v_smfmac_f32_16x16x64_bf16 v[152:155], v[160:163], v[32:39], v240
  v_smfmac_f32_16x16x64_bf16 v[156:159], v[160:163], v[40:47], v240
  s_nop 7
  s_branch c_back_1_0
c_h1c1_1_0:
  s_waitcnt vmcnt(1)
  v_mfma_f32_16x16x32_bf16 v[236:239], v[248:251], v[120:123], 0
  s_waitcnt vmcnt(0)
  v_mfma_f32_16x16x32_bf16 v[236:239], v[248:251], v[124:127], v[236:239]
  v_bitop3_b32 v232, v120, v122, v124 bitop3:0x80
  v_bitop3_b32 v232, v232, v126, 1 bitop3:0x80
  v_cmp_ne_u32 vcc, 1, v232
  s_nop 4
  v_add_f32_dpp v236, v236, v236 row_ror:4 row_mask:0xf bank_mask:0xf
  v_add_f32_dpp v237, v237, v237 row_ror:4 row_mask:0xf bank_mask:0xf
  s_nop 0
  v_add_f32_dpp v236, v236, v236 row_ror:8 row_mask:0xf bank_mask:0xf
  v_add_f32_dpp v237, v237, v237 row_ror:8 row_mask:0xf bank_mask:0xf
  v_cvt_pk_bf16_f32 v233, v236, v237
  s_cbranch_vccnz c_h1b1_1_0
c_h1ok1_1_0:
  buffer_store_dword v233, v241, s[4:7], s49 offen sc1
  s_branch c_pub_1_0
c_h1b0_1_0:
  s_mov_b64 exec, vcc
  buffer_load_dwordx4 v[120:123], v253, s[4:7], s40 offen offset:0 sc1
  buffer_load_dwordx4 v[124:127], v253, s[4:7], s40 offen offset:1024 sc1
  s_mov_b64 exec, -1
  s_cmp_eq_u32 s35, 0
  s_cbranch_scc1 c_h1ok0_1_0
  s_sub_u32 s35, s35, 1
  s_branch c_h1c0_1_0
c_h1b1_1_0:
  s_mov_b64 exec, vcc
  buffer_load_dwordx4 v[120:123], v253, s[4:7], s40 offen offset:0 sc1
  buffer_load_dwordx4 v[124:127], v253, s[4:7], s40 offen offset:1024 sc1
  s_mov_b64 exec, -1
  s_cmp_eq_u32 s35, 0
  s_cbranch_scc1 c_h1ok1_1_0
  s_sub_u32 s35, s35, 1
  s_branch c_h1c1_1_0
c_prg_1_0:
  s_xor_b32 s51, s51, 6144
c_sp_5501:
  buffer_load_dword v236, off, s[4:7], s51 sc1
  s_waitcnt vmcnt(0)
  v_readfirstlane_b32 s59, v236
  s_cmp_ge_u32 s59, s58
  s_cbranch_scc1 c_spd_5502
  s_cmp_eq_u32 s35, 0
  s_cbranch_scc1 c_spd_5502
  s_sub_u32 s35, s35, 1
  s_sleep 2
  s_branch c_sp_5501
c_spd_5502:
  s_xor_b32 s51, s51, 6144
c_sp_5503:
  buffer_load_dword v236, off, s[4:7], s51 sc1
  s_waitcnt vmcnt(0)
  v_readfirstlane_b32 s59, v236
  s_cmp_ge_u32 s59, s58
  s_cbranch_scc1 c_spd_5504
  s_cmp_eq_u32 s35, 0
  s_cbranch_scc1 c_spd_5504
  s_sub_u32 s35, s35, 1
  s_sleep 2
  s_branch c_sp_5503
c_spd_5504:
  s_branch c_prgok_1_0
.p2align 6
c_top_1_1:
  s_waitcnt vmcnt(3)
  v_max3_u32 v238, v112, v113, v114
  s_waitcnt vmcnt(2)
  v_max3_u32 v238, v238, v115, v116
  v_max3_u32 v238, v238, v117, v118
  v_max_u32 v238, v238, v119
  v_cmp_eq_u32 vcc, -1, v238
  ds_write_b128 v253, v[112:115] offset:2048
  s_cbranch_vccnz c_bad_1_1
c_okL_1_1:
  ds_write_b128 v253, v[116:119] offset:3072
  v_smfmac_f32_16x16x64_bf16 v[144:147], v[112:115], v[184:191], v240
  v_smfmac_f32_16x16x64_bf16 v[148:151], v[112:115], v[192:199], v240
  v_smfmac_f32_16x16x64_bf16 v[152:155], v[112:115], v[200:207], v240
  v_smfmac_f32_16x16x64_bf16 v[156:159], v[112:115], v[208:215], v240
  v_smfmac_f32_16x16x64_bf16 v[144:147], v[116:119], v[216:223], v240
  v_smfmac_f32_16x16x64_bf16 v[148:151], v[116:119], v[224:231], v240
  s_waitcnt lgkmcnt(0)
  s_barrier
  ds_read_b128 v[120:123], v253 offset:4096
  ds_read_b128 v[124:127], v253 offset:5120
  v_smfmac_f32_16x16x64_bf16 v[152:155], v[116:119], a[96:103], v240
  ds_read_b128 v[128:131], v253 offset:6144
  ds_read_b128 v[132:135], v253 offset:7168
  v_smfmac_f32_16x16x64_bf16 v[156:159], v[116:119], a[104:111], v240
  buffer_load_dwordx4 v[176:179], v253, s[4:7], s42 offen offset:0 sc1
  ds_read_b128 v[136:139], v253 offset:0
  ds_read_b128 v[140:143], v253 offset:1024
  v_smfmac_f32_16x16x64_bf16 v[160:163], v[112:115], a[160:167], v240
  v_smfmac_f32_16x16x64_bf16 v[164:167], v[112:115], a[168:175], v240
  v_lshlrev_b32 v234, 3, v253
  s_waitcnt lgkmcnt(5)
  v_smfmac_f32_16x16x64_bf16 v[144:147], v[120:123], a[0:7], v240
  ds_read_b128 v[184:187], v252 offset:24576
  s_waitcnt lgkmcnt(5)
  v_smfmac_f32_16x16x64_bf16 v[144:147], v[124:127], a[16:23], v240
  buffer_load_dwordx4 v[180:183], v253, s[4:7], s42 offen offset:1024 sc1
  ds_read_b128 v[188:191], v252 offset:25600
  s_waitcnt lgkmcnt(5)
  v_smfmac_f32_16x16x64_bf16 v[144:147], v[128:131], a[32:39], v240
  ds_read_b128 v[192:195], v252 offset:28672
  s_waitcnt lgkmcnt(5)
  v_smfmac_f32_16x16x64_bf16 v[144:147], v[132:135], a[48:55], v240
  ds_read_b128 v[196:199], v252 offset:29696
  s_waitcnt lgkmcnt(5)
  v_smfmac_f32_16x16x64_bf16 v[144:147], v[136:139], a[64:71], v240
  ds_read_b128 v[200:203], v252 offset:32768
  s_waitcnt lgkmcnt(5)
  v_smfmac_f32_16x16x64_bf16 v[144:147], v[140:143], a[80:87], v240
  buffer_store_dword v233, v241, s[4:7], s48 offen sc1
  s_add_u32 s48, s49, 8388608
  ds_read_b128 v[204:207], v252 offset:33792
  v_smfmac_f32_16x16x64_bf16 v[148:151], v[120:123], a[8:15], v240
  ds_read_b128 v[208:211], v252 offset:26624
  v_smfmac_f32_16x16x64_bf16 v[148:151], v[124:127], a[24:31], v240
  ds_read_b128 v[212:215], v252 offset:27648
  v_cvt_pk_bf16_f32 v232, v144, v145
  v_smfmac_f32_16x16x64_bf16 v[148:151], v[128:131], a[40:47], v240
  ds_read_b128 v[216:219], v252 offset:30720
  v_cvt_pk_bf16_f32 v233, v146, v147
  v_smfmac_f32_16x16x64_bf16 v[148:151], v[132:135], a[56:63], v240
  ds_read_b128 v[220:223], v252 offset:31744
  v_mfma_f32_16x16x16_bf16 v[144:147], v[232:233], v[242:243], 0
  ds_read_b128 v[224:227], v252 offset:34816
  v_smfmac_f32_16x16x64_bf16 v[148:151], v[136:139], a[72:79], v240
  ds_read_b128 v[228:231], v252 offset:35840
  v_smfmac_f32_16x16x64_bf16 v[148:151], v[140:143], a[88:95], v240
  v_cvt_pk_bf16_f32 v236, v144, v145
  v_smfmac_f32_16x16x64_bf16 v[152:155], v[120:123], a[112:119], v240
  v_cvt_pk_bf16_f32 v237, v146, v147
  v_smfmac_f32_16x16x64_bf16 v[152:155], v[124:127], a[128:135], v240
  v_cvt_pk_bf16_f32 v234, v148, v149
  v_cvt_pk_bf16_f32 v235, v150, v151
  v_smfmac_f32_16x16x64_bf16 v[152:155], v[128:131], a[144:151], v240
  v_mfma_f32_16x16x16_bf16 v[148:151], v[234:235], v[242:243], 0
  s_waitcnt lgkmcnt(0)
  v_smfmac_f32_16x16x64_bf16 v[152:155], v[132:135], v[184:191], v240
  v_smfmac_f32_16x16x64_bf16 v[152:155], v[136:139], v[192:199], v240
  v_cvt_pk_bf16_f32 v238, v148, v149
  v_cvt_pk_bf16_f32 v239, v150, v151
  v_smfmac_f32_16x16x64_bf16 v[152:155], v[140:143], v[200:207], v240
  s_waitcnt vmcnt(3)
  v_mfma_f32_16x16x32_bf16 v[144:147], v[168:171], v[236:239], 0
  v_mfma_f32_16x16x32_bf16 v[148:151], v[172:175], v[236:239], 0
  v_cvt_pk_bf16_f32 v232, v152, v153
  v_cvt_pk_bf16_f32 v233, v154, v155
  v_smfmac_f32_16x16x64_bf16 v[156:159], v[120:123], a[120:127], v240
  v_mfma_f32_16x16x16_bf16 v[152:155], v[232:233], v[244:245], 0
  v_cndmask_b32 v144, v144, v148, s[98:99]
  v_cndmask_b32 v145, v145, v149, s[98:99]
  v_cndmask_b32 v146, v146, v150, s[98:99]
  v_cndmask_b32 v147, v147, v151, s[98:99]
  v_smfmac_f32_16x16x64_bf16 v[156:159], v[124:127], a[136:143], v240
  ds_write_b128 v253, v[144:147] offset:9216
  v_smfmac_f32_16x16x64_bf16 v[156:159], v[128:131], a[152:159], v240
  buffer_load_dwordx4 v[168:171], v253, s[4:7], s41 offen offset:0 sc1
  v_cvt_pk_bf16_f32 v200, v152, v153
  v_smfmac_f32_16x16x64_bf16 v[156:159], v[132:135], v[208:215], v240
  v_cvt_pk_bf16_f32 v201, v154, v155
  v_smfmac_f32_16x16x64_bf16 v[156:159], v[136:139], v[216:223], v240
  v_smfmac_f32_16x16x64_bf16 v[156:159], v[140:143], v[224:231], v240
  v_smfmac_f32_16x16x64_bf16 v[160:163], v[120:123], a[192:199], v240
  buffer_load_dwordx4 v[172:175], v253, s[4:7], s41 offen offset:1024 sc1
  v_smfmac_f32_16x16x64_bf16 v[164:167], v[120:123], a[200:207], v240
  v_cvt_pk_bf16_f32 v234, v156, v157
  v_cvt_pk_bf16_f32 v235, v158, v159
  s_waitcnt lgkmcnt(0)
  s_barrier
  v_mfma_f32_16x16x16_bf16 v[156:159], v[234:235], v[244:245], 0
  ds_read_b128 v[184:187], v253 offset:8192
  ds_read_b128 v[188:191], v253 offset:9216
  v_smfmac_f32_16x16x64_bf16 v[160:163], v[124:127], a[208:215], v240
  ds_read_b128 v[192:195], v253 offset:10240
  ds_read_b128 v[196:199], v253 offset:11264
  v_smfmac_f32_16x16x64_bf16 v[164:167], v[124:127], a[216:223], v240
  v_cvt_pk_bf16_f32 v202, v156, v157
  v_cvt_pk_bf16_f32 v203, v158, v159
  v_smfmac_f32_16x16x64_bf16 v[160:163], v[128:131], a[224:231], v240
  v_mfma_f32_16x16x32_bf16 v[152:155], v[200:203], v[236:239], 0
  v_smfmac_f32_16x16x64_bf16 v[164:167], v[128:131], a[232:239], v240
  v_smfmac_f32_16x16x64_bf16 v[160:163], v[132:135], a[240:247], v240
  ds_write_b64 v253, v[152:153] offset:8
  s_waitcnt lgkmcnt(1)
  v_pk_add_f32 v[184:185], v[184:185], v[188:189]
  v_pk_add_f32 v[186:187], v[186:187], v[190:191]
  v_pk_add_f32 v[192:193], v[192:193], v[196:197]
  v_pk_add_f32 v[194:195], v[194:195], v[198:199]
  v_pk_add_f32 v[184:185], v[184:185], v[192:193]
  v_pk_add_f32 v[186:187], v[186:187], v[194:195]
  v_exp_f32 v188, v184
  v_exp_f32 v189, v185
  v_smfmac_f32_16x16x64_bf16 v[160:163], v[116:119], a[176:183], v240
  v_smfmac_f32_16x16x64_bf16 v[164:167], v[116:119], a[184:191], v240
  v_smfmac_f32_16x16x64_bf16 v[164:167], v[132:135], a[248:255], v240
  s_waitcnt lgkmcnt(0)
  s_barrier
  ds_read_b128 v[208:211], v254 offset:0
  v_smfmac_f32_16x16x64_bf16 v[160:163], v[136:139], v[0:7], v240
  ds_read_b128 v[216:219], v252 offset:0
  ds_read_b128 v[220:223], v252 offset:1024
  v_exp_f32 v190, v186
  v_exp_f32 v191, v187
  v_cvt_pk_bf16_f32 v188, v188, v189
  v_cvt_pk_bf16_f32 v189, v190, v191
  v_smfmac_f32_16x16x64_bf16 v[160:163], v[140:143], v[16:23], v240
  ds_read_b128 v[224:227], v252 offset:2048
  ds_read_b128 v[228:231], v252 offset:3072
  v_mov_b32_dpp v192, v188 quad_perm:[0,1,0,1] row_mask:0xf bank_mask:0xf
  v_mfma_f32_16x16x16_bf16 v[196:199], v[246:247], v[188:189], 0
  v_mov_b32_dpp v193, v189 quad_perm:[0,1,0,1] row_mask:0xf bank_mask:0xf
  v_mov_b32_dpp v194, v188 quad_perm:[2,3,2,3] row_mask:0xf bank_mask:0xf
  v_mov_b32_dpp v195, v189 quad_perm:[2,3,2,3] row_mask:0xf bank_mask:0xf
  v_smfmac_f32_16x16x64_bf16 v[164:167], v[136:139], v[8:15], v240
  s_waitcnt lgkmcnt(4)
  v_add_f32 v208, v208, v210
  v_smfmac_f32_16x16x64_bf16 v[164:167], v[140:143], v[24:31], v240
  ds_read_b128 v[112:115], v252 offset:4096
  ds_read_b128 v[116:119], v252 offset:5120
  v_add_f32 v209, v209, v211
  s_waitcnt vmcnt(3)
  v_mfma_f32_16x16x32_bf16 v[144:147], v[176:179], v[192:195], 0
  ds_read_b128 v[128:131], v252 offset:16384
  v_add_f32_dpp v208, v208, v208 quad_perm:[2,3,0,1] row_mask:0xf bank_mask:0xf
  v_add_f32_dpp v209, v209, v209 quad_perm:[2,3,0,1] row_mask:0xf bank_mask:0xf
  v_mfma_f32_16x16x32_bf16 v[148:151], v[180:183], v[192:195], 0
  ds_read_b128 v[132:135], v252 offset:17408
  v_exp_f32 v210, v208
  v_exp_f32 v211, v209
  v_add_f32_dpp v196, v196, v196 quad_perm:[2,3,0,1] row_mask:0xf bank_mask:0xf
  v_cvt_pk_bf16_f32 v232, v210, v211
  v_cvt_pk_bf16_f32 v233, v210, v211
  v_add_f32 v196, v196, v196
  v_cvt_pk_bf16_f32 v204, v160, v161
  v_cvt_pk_bf16_f32 v205, v162, v163
  v_mfma_f32_16x16x16_bf16 v[196:199], v[246:247], v[232:233], v[196:199]
  v_cvt_pk_bf16_f32 v206, v164, v165
  v_cvt_pk_bf16_f32 v207, v166, v167
  v_mov_b64 v[152:153], 0
  v_mfma_f32_16x16x16_bf16 v[144:147], v[204:205], v[232:233], v[144:147]
  v_mov_b64 v[154:155], 0
  v_mov_b64 v[156:157], 0
  v_mov_b64 v[158:159], 0
  v_mfma_f32_16x16x16_bf16 v[148:151], v[206:207], v[232:233], v[148:151]
  v_rcp_f32 v234, v196
  v_mov_b64 v[188:189], 0
  v_mov_b64 v[190:191], 0
  v_max_f32 v235, v196, v234
  v_pk_mul_f32 v[144:145], v[144:145], v[234:235] op_sel_hi:[1,0]
  v_pk_mul_f32 v[146:147], v[146:147], v[234:235] op_sel_hi:[1,0]
  v_cvt_pk_bf16_f32 v160, v144, v145
  v_cvt_pk_bf16_f32 v161, v146, v147
  v_pk_mul_f32 v[148:149], v[148:149], v[234:235] op_sel_hi:[1,0]
  v_pk_mul_f32 v[150:151], v[150:151], v[234:235] op_sel_hi:[1,0]
  v_cvt_pk_bf16_f32 v162, v148, v149
  v_cvt_pk_bf16_f32 v163, v150, v151
  ds_write_b128 v253, v[160:163] offset:9216
  s_nop 0
  v_smfmac_f32_16x16x64_bf16 v[152:155], v[160:163], v[32:39], v240
  v_cmp_ngt_f32 vcc, s54, v235
  v_smfmac_f32_16x16x64_bf16 v[156:159], v[160:163], v[40:47], v240
  v_mov_b64 v[236:237], 0
  v_mov_b64 v[238:239], 0
  s_cbranch_vccnz c_slow_1_1
c_back_1_1:
  s_waitcnt lgkmcnt(0)
  s_barrier
  ds_read_b128 v[164:167], v253 offset:10240
  ds_read_b128 v[192:195], v253 offset:11264
  ds_read_b128 v[212:215], v253 offset:8192
  v_smfmac_f32_16x16x64_bf16 v[188:191], v[160:163], v[48:55], v240
  ds_read_b128 v[120:123], v252 offset:6144
  v_smfmac_f32_16x16x64_bf16 v[236:239], v[160:163], v[56:63], v240
  s_waitcnt lgkmcnt(3)
  v_smfmac_f32_16x16x64_bf16 v[152:155], v[164:167], v[64:71], v240
  ds_read_b128 v[124:127], v252 offset:7168
  s_add_u32 s37, s37, 1
  s_waitcnt lgkmcnt(3)
  v_smfmac_f32_16x16x64_bf16 v[152:155], v[192:195], v[80:87], v240
  ds_read_b128 v[136:139], v252 offset:18432
  s_add_u32 s38, s38, 8192
  s_waitcnt lgkmcnt(3)
  v_smfmac_f32_16x16x64_bf16 v[152:155], v[212:215], v[96:103], v240
  ds_read_b128 v[140:143], v252 offset:19456
  s_add_u32 s41, s41, 262144
  v_smfmac_f32_16x16x64_bf16 v[156:159], v[164:167], v[72:79], v240
  s_add_u32 s42, s42, 262144
  s_add_u32 s50, s50, 262144
  v_smfmac_f32_16x16x64_bf16 v[156:159], v[192:195], v[88:95], v240
  v_cvt_pk_bf16_f32 v144, v152, v153
  v_cvt_pk_bf16_f32 v145, v154, v155
  v_bfi_b32 v144, 1, s44, v144
  v_smfmac_f32_16x16x64_bf16 v[156:159], v[212:215], v[104:111], v240
  buffer_store_dwordx2 v[144:145], v255, s[4:7], s39 offen offset:0 sc1
  v_smfmac_f32_16x16x64_bf16 v[188:191], v[164:167], v[216:223], v240
  s_add_u32 s58, s37, 2
  s_min_u32 s58, s58, 63
  v_smfmac_f32_16x16x64_bf16 v[188:191], v[192:195], v[112:119], v240
  v_cvt_pk_bf16_f32 v146, v156, v157
  v_cvt_pk_bf16_f32 v147, v158, v159
  v_bfi_b32 v146, 1, s44, v146
  v_smfmac_f32_16x16x64_bf16 v[188:191], v[212:215], v[128:135], v240
  buffer_store_dwordx2 v[146:147], v255, s[4:7], s39 offen offset:2048 sc1
  v_smfmac_f32_16x16x64_bf16 v[236:239], v[164:167], v[224:231], v240
  s_waitcnt lgkmcnt(0)
  v_smfmac_f32_16x16x64_bf16 v[236:239], v[192:195], v[120:127], v240
  v_cvt_pk_bf16_f32 v148, v188, v189
  v_cvt_pk_bf16_f32 v149, v190, v191
  v_bfi_b32 v148, 1, s44, v148
  v_smfmac_f32_16x16x64_bf16 v[236:239], v[212:215], v[136:143], v240
  buffer_store_dwordx2 v[148:149], v255, s[4:7], s43 offen offset:0 sc1
  s_nop 6
  v_cvt_pk_bf16_f32 v150, v236, v237
  v_cvt_pk_bf16_f32 v151, v238, v239
  v_bfi_b32 v150, 1, s44, v150
  buffer_store_dwordx2 v[150:151], v255, s[4:7], s43 offen offset:2048 sc1
  s_waitcnt vmcnt(1)
c_pfd_1_1:
  buffer_load_dwordx4 v[120:123], v253, s[4:7], s40 offen offset:0 sc1
  buffer_load_dwordx4 v[124:127], v253, s[4:7], s40 offen offset:1024 sc1
  v_mov_b64 v[152:153], 0
  v_mov_b64 v[154:155], 0
  v_mov_b64 v[156:157], 0
  v_mov_b64 v[158:159], 0
  v_mov_b64 v[160:161], 0
  v_mov_b64 v[162:163], 0
  v_mov_b64 v[164:165], 0
  v_mov_b64 v[166:167], 0
  v_mov_b64 v[144:145], 0
  v_mov_b64 v[146:147], 0
  v_mov_b64 v[148:149], 0
  v_mov_b64 v[150:151], 0
  s_cmp_lg_u32 s44, 0
  s_cbranch_scc1 c_h1c1_1_1
c_h1c0_1_1:
  s_waitcnt vmcnt(1)
  v_mfma_f32_16x16x32_bf16 v[236:239], v[248:251], v[120:123], 0
  s_waitcnt vmcnt(0)
  v_mfma_f32_16x16x32_bf16 v[236:239], v[248:251], v[124:127], v[236:239]
  v_bitop3_b32 v232, v120, v122, v124 bitop3:0xfe
  v_bitop3_b32 v232, v232, v126, 1 bitop3:0xa8
  v_cmp_ne_u32 vcc, 0, v232
  s_nop 4
  v_add_f32_dpp v236, v236, v236 row_ror:4 row_mask:0xf bank_mask:0xf
  v_add_f32_dpp v237, v237, v237 row_ror:4 row_mask:0xf bank_mask:0xf
  s_nop 0
  v_add_f32_dpp v236, v236, v236 row_ror:8 row_mask:0xf bank_mask:0xf
  v_add_f32_dpp v237, v237, v237 row_ror:8 row_mask:0xf bank_mask:0xf
  v_cvt_pk_bf16_f32 v233, v236, v237
  s_cbranch_vccnz c_h1b0_1_1
c_h1ok0_1_1:
  buffer_store_dword v233, v241, s[4:7], s49 offen sc1
c_pub_1_1:
  s_xor_b32 s44, s44, 1
  s_add_u32 s49, s49, 8192
  s_cmp_eq_u32 s37, s57
  s_cbranch_scc1 c_fin_1_1
  ds_read_b128 v[184:187], v252 offset:8192
  ds_read_b128 v[188:191], v252 offset:9216
  ds_read_b128 v[192:195], v252 offset:10240
  ds_read_b128 v[196:199], v252 offset:11264
  ds_read_b128 v[200:203], v252 offset:20480
  ds_read_b128 v[204:207], v252 offset:21504
  s_waitcnt lgkmcnt(0)
  buffer_load_dwordx4 v[112:115], v253, s[4:7], s38 offen sc1
  buffer_load_dwordx4 v[116:119], v253, s[4:7], s38 offen offset:1024 sc1
  ds_read_b128 v[208:211], v252 offset:22528
  ds_read_b128 v[212:215], v252 offset:23552
  ds_read_b128 v[216:219], v252 offset:12288
  ds_read_b128 v[220:223], v252 offset:13312
  ds_read_b128 v[224:227], v252 offset:14336
  ds_read_b128 v[228:231], v252 offset:15360
  s_waitcnt lgkmcnt(0)
  buffer_load_dwordx4 v[112:115], v253, s[4:7], s38 offen sc1
  buffer_load_dwordx4 v[116:119], v253, s[4:7], s38 offen offset:1024 sc1
  s_branch c_top_1_1
c_fin_1_1:
  buffer_store_dword v233, v241, s[4:7], s48 offen sc1
  s_nop 7
  s_mov_b64 exec, 1
  s_waitcnt vmcnt(0)
  s_endpgm
  s_nop 7
c_bad_1_1:
  s_mov_b64 exec, vcc
  buffer_load_dwordx4 v[112:115], v253, s[4:7], s38 offen sc1
  buffer_load_dwordx4 v[116:119], v253, s[4:7], s38 offen offset:1024 sc1
  s_mov_b64 exec, -1
  s_cmp_eq_u32 s35, 0
  s_cbranch_scc1 c_okL_1_1
  s_sub_u32 s35, s35, 1
  s_branch c_top_1_1
c_entry_1_1:
  ds_write_b128 v253, v[112:115] offset:2048
  s_branch c_okL_1_1
c_slow_1_1:
  s_nop 15
  v_max3_f32 v234, v184, v185, v186
  v_max3_f32 v234, v234, v187, v208
  v_max_f32 v234, v234, v209
  s_nop 1
  v_max_f32_dpp v234, v234, v234 quad_perm:[2,3,0,1] row_mask:0xf bank_mask:0xf
  v_mov_b32 v235, v234
  s_nop 1
  v_permlane16_swap_b32 v234, v235
  s_nop 1
  v_max_f32 v234, v234, v235
  v_mov_b32 v235, v234
  s_nop 1
  v_permlane32_swap_b32 v234, v235
  s_nop 1
  v_max_f32 v234, v234, v235
  v_sub_f32 v188, v184, v234
  v_sub_f32 v189, v185, v234
  v_sub_f32 v190, v186, v234
  v_sub_f32 v191, v187, v234
  v_sub_f32 v210, v208, v234
  v_sub_f32 v211, v209, v234
  v_exp_f32 v188, v188
  v_exp_f32 v189, v189
  v_exp_f32 v190, v190
  v_exp_f32 v191, v191
  v_cvt_pk_bf16_f32 v188, v188, v189
  v_cvt_pk_bf16_f32 v189, v190, v191
  s_nop 1
  v_mfma_f32_16x16x16_bf16 v[196:199], v[246:247], v[188:189], 0
  v_mov_b32_dpp v192, v188 quad_perm:[0,1,0,1] row_mask:0xf bank_mask:0xf
  v_mov_b32_dpp v193, v189 quad_perm:[0,1,0,1] row_mask:0xf bank_mask:0xf
  v_mov_b32_dpp v194, v188 quad_perm:[2,3,2,3] row_mask:0xf bank_mask:0xf
  v_mov_b32_dpp v195, v189 quad_perm:[2,3,2,3] row_mask:0xf bank_mask:0xf
  v_exp_f32 v210, v210
  v_exp_f32 v211, v211
  v_mfma_f32_16x16x32_bf16 v[144:147], v[176:179], v[192:195], 0
  s_nop 0
  v_add_f32_dpp v196, v196, v196 quad_perm:[2,3,0,1] row_mask:0xf bank_mask:0xf
  v_cvt_pk_bf16_f32 v232, v210, v211
  v_mfma_f32_16x16x32_bf16 v[148:151], v[180:183], v[192:195], 0
  v_cvt_pk_bf16_f32 v233, v210, v211
  v_add_f32 v196, v196, v196
  s_nop 1
  v_mfma_f32_16x16x16_bf16 v[196:199], v[246:247], v[232:233], v[196:199]
  v_mfma_f32_16x16x16_bf16 v[144:147], v[204:205], v[232:233], v[144:147]
  v_mfma_f32_16x16x16_bf16 v[148:151], v[206:207], v[232:233], v[148:151]
  s_waitcnt lgkmcnt(0)
  v_rcp_f32 v234, v196
  s_nop 1
  v_pk_mul_f32 v[144:145], v[144:145], v[234:235] op_sel_hi:[1,0]
  v_pk_mul_f32 v[146:147], v[146:147], v[234:235] op_sel_hi:[1,0]
  v_cvt_pk_bf16_f32 v160, v144, v145
  v_cvt_pk_bf16_f32 v161, v146, v147
  v_pk_mul_f32 v[148:149], v[148:149], v[234:235] op_sel_hi:[1,0]
  v_pk_mul_f32 v[150:151], v[150:151], v[234:235] op_sel_hi:[1,0]
  v_cvt_pk_bf16_f32 v162, v148, v149
  v_cvt_pk_bf16_f32 v163, v150, v151
  ds_write_b128 v253, v[160:163] offset:9216
  v_mov_b64 v[152:153], 0
  v_mov_b64 v[154:155], 0
  v_mov_b64 v[156:157], 0
  v_mov_b64 v[158:159], 0
  v_mov_b64 v[188:189], 0
  v_mov_b64 v[190:191], 0
  v_mov_b64 v[236:237], 0
  v_mov_b64 v[238:239], 0
  v_smfmac_f32_16x16x64_bf16 v[152:155], v[160:163], v[32:39], v240
  v_smfmac_f32_16x16x64_bf16 v[156:159], v[160:163], v[40:47], v240
  s_nop 7
  s_branch c_back_1_1
c_h1c1_1_1:
  s_waitcnt vmcnt(1)
  v_mfma_f32_16x16x32_bf16 v[236:239], v[248:251], v[120:123], 0
  s_waitcnt vmcnt(0)
  v_mfma_f32_16x16x32_bf16 v[236:239], v[248:251], v[124:127], v[236:239]
  v_bitop3_b32 v232, v120, v122, v124 bitop3:0x80
  v_bitop3_b32 v232, v232, v126, 1 bitop3:0x80
  v_cmp_ne_u32 vcc, 1, v232
  s_nop 4
  v_add_f32_dpp v236, v236, v236 row_ror:4 row_mask:0xf bank_mask:0xf
  v_add_f32_dpp v237, v237, v237 row_ror:4 row_mask:0xf bank_mask:0xf
  s_nop 0
  v_add_f32_dpp v236, v236, v236 row_ror:8 row_mask:0xf bank_mask:0xf
  v_add_f32_dpp v237, v237, v237 row_ror:8 row_mask:0xf bank_mask:0xf
  v_cvt_pk_bf16_f32 v233, v236, v237
  s_cbranch_vccnz c_h1b1_1_1
c_h1ok1_1_1:
  buffer_store_dword v233, v241, s[4:7], s49 offen sc1
  s_branch c_pub_1_1
c_h1b0_1_1:
  s_mov_b64 exec, vcc
  buffer_load_dwordx4 v[120:123], v253, s[4:7], s40 offen offset:0 sc1
  buffer_load_dwordx4 v[124:127], v253, s[4:7], s40 offen offset:1024 sc1
  s_mov_b64 exec, -1
  s_cmp_eq_u32 s35, 0
  s_cbranch_scc1 c_h1ok0_1_1
  s_sub_u32 s35, s35, 1
  s_branch c_h1c0_1_1
c_h1b1_1_1:
  s_mov_b64 exec, vcc
  buffer_load_dwordx4 v[120:123], v253, s[4:7], s40 offen offset:0 sc1
  buffer_load_dwordx4 v[124:127], v253, s[4:7], s40 offen offset:1024 sc1
  s_mov_b64 exec, -1
  s_cmp_eq_u32 s35, 0
  s_cbranch_scc1 c_h1ok1_1_1
  s_sub_u32 s35, s35, 1
  s_branch c_h1c1_1_1
.p2align 6
c_top_1_2:
  s_waitcnt vmcnt(3)
  v_max3_u32 v238, v112, v113, v114
  s_waitcnt vmcnt(2)
  v_max3_u32 v238, v238, v115, v116
  v_max3_u32 v238, v238, v117, v118
  v_max_u32 v238, v238, v119
  v_cmp_eq_u32 vcc, -1, v238
  ds_write_b128 v253, v[112:115] offset:4096
  s_cbranch_vccnz c_bad_1_2
c_okL_1_2:
  ds_write_b128 v253, v[116:119] offset:5120
  v_smfmac_f32_16x16x64_bf16 v[144:147], v[112:115], v[184:191], v240
  v_smfmac_f32_16x16x64_bf16 v[148:151], v[112:115], v[192:199], v240
  v_smfmac_f32_16x16x64_bf16 v[152:155], v[112:115], v[200:207], v240
  v_smfmac_f32_16x16x64_bf16 v[156:159], v[112:115], v[208:215], v240
  v_smfmac_f32_16x16x64_bf16 v[144:147], v[116:119], v[216:223], v240
  v_smfmac_f32_16x16x64_bf16 v[148:151], v[116:119], v[224:231], v240
  s_waitcnt lgkmcnt(0)
  s_barrier
  ds_read_b128 v[120:123], v253 offset:6144
  ds_read_b128 v[124:127], v253 offset:7168
  v_smfmac_f32_16x16x64_bf16 v[152:155], v[116:119], a[96:103], v240
  ds_read_b128 v[128:131], v253 offset:0
  ds_read_b128 v[132:135], v253 offset:1024
  v_smfmac_f32_16x16x64_bf16 v[156:159], v[116:119], a[104:111], v240
  ds_read_b128 v[136:139], v253 offset:2048
  ds_read_b128 v[140:143], v253 offset:3072
  v_smfmac_f32_16x16x64_bf16 v[160:163], v[112:115], a[160:167], v240
  buffer_load_dwordx4 v[176:179], v253, s[4:7], s42 offen offset:0 sc1
  v_smfmac_f32_16x16x64_bf16 v[164:167], v[112:115], a[168:175], v240
  v_lshlrev_b32 v234, 3, v253
  s_waitcnt lgkmcnt(5)
  v_smfmac_f32_16x16x64_bf16 v[144:147], v[120:123], a[0:7], v240
  ds_read_b128 v[184:187], v252 offset:24576
  s_waitcnt lgkmcnt(5)
  v_smfmac_f32_16x16x64_bf16 v[144:147], v[124:127], a[16:23], v240
  ds_read_b128 v[188:191], v252 offset:25600
  s_waitcnt lgkmcnt(5)
  v_smfmac_f32_16x16x64_bf16 v[144:147], v[128:131], a[32:39], v240
  buffer_load_dwordx4 v[180:183], v253, s[4:7], s42 offen offset:1024 sc1
  ds_read_b128 v[192:195], v252 offset:28672
  s_waitcnt lgkmcnt(5)
  v_smfmac_f32_16x16x64_bf16 v[144:147], v[132:135], a[48:55], v240
  ds_read_b128 v[196:199], v252 offset:29696
  s_waitcnt lgkmcnt(5)
  v_smfmac_f32_16x16x64_bf16 v[144:147], v[136:139], a[64:71], v240
  ds_read_b128 v[200:203], v252 offset:32768
  s_waitcnt lgkmcnt(5)
  v_smfmac_f32_16x16x64_bf16 v[144:147], v[140:143], a[80:87], v240
  ds_read_b128 v[204:207], v252 offset:33792
  v_smfmac_f32_16x16x64_bf16 v[148:151], v[120:123], a[8:15], v240
  buffer_store_dword v233, v241, s[4:7], s48 offen sc1
  s_add_u32 s48, s49, 8388608
  ds_read_b128 v[208:211], v252 offset:26624
  v_smfmac_f32_16x16x64_bf16 v[148:151], v[124:127], a[24:31], v240
  ds_read_b128 v[212:215], v252 offset:27648
  v_cvt_pk_bf16_f32 v232, v144, v145
  v_smfmac_f32_16x16x64_bf16 v[148:151], v[128:131], a[40:47], v240
  ds_read_b128 v[216:219], v252 offset:30720
  v_cvt_pk_bf16_f32 v233, v146, v147
  v_smfmac_f32_16x16x64_bf16 v[148:151], v[132:135], a[56:63], v240
  ds_read_b128 v[220:223], v252 offset:31744
  v_mfma_f32_16x16x16_bf16 v[144:147], v[232:233], v[242:243], 0
  ds_read_b128 v[224:227], v252 offset:34816
  v_smfmac_f32_16x16x64_bf16 v[148:151], v[136:139], a[72:79], v240
  ds_read_b128 v[228:231], v252 offset:35840
  v_smfmac_f32_16x16x64_bf16 v[148:151], v[140:143], a[88:95], v240
  v_cvt_pk_bf16_f32 v236, v144, v145
  v_smfmac_f32_16x16x64_bf16 v[152:155], v[120:123], a[112:119], v240
  v_cvt_pk_bf16_f32 v237, v146, v147
  v_smfmac_f32_16x16x64_bf16 v[152:155], v[124:127], a[128:135], v240
  v_cvt_pk_bf16_f32 v234, v148, v149
  v_cvt_pk_bf16_f32 v235, v150, v151
  v_smfmac_f32_16x16x64_bf16 v[152:155], v[128:131], a[144:151], v240
  v_mfma_f32_16x16x16_bf16 v[148:151], v[234:235], v[242:243], 0
  s_waitcnt lgkmcnt(0)
  v_smfmac_f32_16x16x64_bf16 v[152:155], v[132:135], v[184:191], v240
  v_smfmac_f32_16x16x64_bf16 v[152:155], v[136:139], v[192:199], v240
  v_cvt_pk_bf16_f32 v238, v148, v149
  v_cvt_pk_bf16_f32 v239, v150, v151
  v_smfmac_f32_16x16x64_bf16 v[152:155], v[140:143], v[200:207], v240
  s_waitcnt vmcnt(3)
  v_mfma_f32_16x16x32_bf16 v[144:147], v[168:171], v[236:239], 0
  v_mfma_f32_16x16x32_bf16 v[148:151], v[172:175], v[236:239], 0
  v_cvt_pk_bf16_f32 v232, v152, v153
  v_cvt_pk_bf16_f32 v233, v154, v155
  v_smfmac_f32_16x16x64_bf16 v[156:159], v[120:123], a[120:127], v240
  v_mfma_f32_16x16x16_bf16 v[152:155], v[232:233], v[244:245], 0
  v_cndmask_b32 v144, v144, v148, s[98:99]
  v_cndmask_b32 v145, v145, v149, s[98:99]
  v_cndmask_b32 v146, v146, v150, s[98:99]
  v_cndmask_b32 v147, v147, v151, s[98:99]
  v_smfmac_f32_16x16x64_bf16 v[156:159], v[124:127], a[136:143], v240
  ds_write_b128 v253, v[144:147] offset:10240
  v_smfmac_f32_16x16x64_bf16 v[156:159], v[128:131], a[152:159], v240
  v_cvt_pk_bf16_f32 v200, v152, v153
  v_smfmac_f32_16x16x64_bf16 v[156:159], v[132:135], v[208:215], v240
  buffer_load_dwordx4 v[168:171], v253, s[4:7], s41 offen offset:0 sc1
  v_cvt_pk_bf16_f32 v201, v154, v155
  v_smfmac_f32_16x16x64_bf16 v[156:159], v[136:139], v[216:223], v240
  v_smfmac_f32_16x16x64_bf16 v[156:159], v[140:143], v[224:231], v240
  v_smfmac_f32_16x16x64_bf16 v[160:163], v[120:123], a[192:199], v240
  v_smfmac_f32_16x16x64_bf16 v[164:167], v[120:123], a[200:207], v240
  buffer_load_dwordx4 v[172:175], v253, s[4:7], s41 offen offset:1024 sc1
  v_cvt_pk_bf16_f32 v234, v156, v157
  v_cvt_pk_bf16_f32 v235, v158, v159
  s_waitcnt lgkmcnt(0)
  s_barrier
  v_mfma_f32_16x16x16_bf16 v[156:159], v[234:235], v[244:245], 0
  ds_read_b128 v[184:187], v253 offset:8192
  ds_read_b128 v[188:191], v253 offset:9216
  v_smfmac_f32_16x16x64_bf16 v[160:163], v[124:127], a[208:215], v240
  ds_read_b128 v[192:195], v253 offset:10240
  ds_read_b128 v[196:199], v253 offset:11264
  v_smfmac_f32_16x16x64_bf16 v[164:167], v[124:127], a[216:223], v240
  v_cvt_pk_bf16_f32 v202, v156, v157
  v_cvt_pk_bf16_f32 v203, v158, v159
  v_smfmac_f32_16x16x64_bf16 v[160:163], v[128:131], a[224:231], v240
  v_mfma_f32_16x16x32_bf16 v[152:155], v[200:203], v[236:239], 0
  v_smfmac_f32_16x16x64_bf16 v[164:167], v[128:131], a[232:239], v240
  v_smfmac_f32_16x16x64_bf16 v[160:163], v[132:135], a[240:247], v240
  ds_write_b64 v253, v[152:153] offset:1024
  s_waitcnt lgkmcnt(1)
  v_pk_add_f32 v[184:185], v[184:185], v[188:189]
  v_pk_add_f32 v[186:187], v[186:187], v[190:191]
  v_pk_add_f32 v[192:193], v[192:193], v[196:197]
  v_pk_add_f32 v[194:195], v[194:195], v[198:199]
  v_pk_add_f32 v[184:185], v[184:185], v[192:193]
  v_pk_add_f32 v[186:187], v[186:187], v[194:195]
  v_exp_f32 v188, v184
  v_exp_f32 v189, v185
  v_smfmac_f32_16x16x64_bf16 v[160:163], v[116:119], a[176:183], v240
  v_smfmac_f32_16x16x64_bf16 v[164:167], v[116:119], a[184:191], v240
  v_smfmac_f32_16x16x64_bf16 v[164:167], v[132:135], a[248:255], v240
  s_waitcnt lgkmcnt(0)
  s_barrier
  ds_read_b128 v[208:211], v254 offset:0
  v_smfmac_f32_16x16x64_bf16 v[160:163], v[136:139], v[0:7], v240
  ds_read_b128 v[216:219], v252 offset:4096
  ds_read_b128 v[220:223], v252 offset:5120
  v_exp_f32 v190, v186
  v_exp_f32 v191, v187
  v_cvt_pk_bf16_f32 v188, v188, v189
  v_cvt_pk_bf16_f32 v189, v190, v191
  v_smfmac_f32_16x16x64_bf16 v[160:163], v[140:143], v[16:23], v240
  ds_read_b128 v[224:227], v252 offset:6144
  ds_read_b128 v[228:231], v252 offset:7168
  v_mov_b32_dpp v192, v188 quad_perm:[0,1,0,1] row_mask:0xf bank_mask:0xf
  v_mfma_f32_16x16x16_bf16 v[196:199], v[246:247], v[188:189], 0
  v_mov_b32_dpp v193, v189 quad_perm:[0,1,0,1] row_mask:0xf bank_mask:0xf
  v_mov_b32_dpp v194, v188 quad_perm:[2,3,2,3] row_mask:0xf bank_mask:0xf
  v_mov_b32_dpp v195, v189 quad_perm:[2,3,2,3] row_mask:0xf bank_mask:0xf
  v_smfmac_f32_16x16x64_bf16 v[164:167], v[136:139], v[8:15], v240
  s_waitcnt lgkmcnt(4)
  v_add_f32 v208, v208, v210
  v_smfmac_f32_16x16x64_bf16 v[164:167], v[140:143], v[24:31], v240
  ds_read_b128 v[112:115], v252 offset:16384
  ds_read_b128 v[116:119], v252 offset:17408
  v_add_f32 v209, v209, v211
  s_waitcnt vmcnt(3)
  v_mfma_f32_16x16x32_bf16 v[144:147], v[176:179], v[192:195], 0
  ds_read_b128 v[128:131], v252 offset:0
  v_add_f32_dpp v208, v208, v208 quad_perm:[2,3,0,1] row_mask:0xf bank_mask:0xf
  v_add_f32_dpp v209, v209, v209 quad_perm:[2,3,0,1] row_mask:0xf bank_mask:0xf
  v_mfma_f32_16x16x32_bf16 v[148:151], v[180:183], v[192:195], 0
  ds_read_b128 v[132:135], v252 offset:1024
  v_exp_f32 v210, v208
  v_exp_f32 v211, v209
  v_add_f32_dpp v196, v196, v196 quad_perm:[2,3,0,1] row_mask:0xf bank_mask:0xf
  v_cvt_pk_bf16_f32 v232, v210, v211
  v_cvt_pk_bf16_f32 v233, v210, v211
  v_add_f32 v196, v196, v196
  v_cvt_pk_bf16_f32 v204, v160, v161
  v_cvt_pk_bf16_f32 v205, v162, v163
  v_mfma_f32_16x16x16_bf16 v[196:199], v[246:247], v[232:233], v[196:199]
  v_cvt_pk_bf16_f32 v206, v164, v165
  v_cvt_pk_bf16_f32 v207, v166, v167
  v_mov_b64 v[152:153], 0
  v_mfma_f32_16x16x16_bf16 v[144:147], v[204:205], v[232:233], v[144:147]
  v_mov_b64 v[154:155], 0
  v_mov_b64 v[156:157], 0
  v_mov_b64 v[158:159], 0
  v_mfma_f32_16x16x16_bf16 v[148:151], v[206:207], v[232:233], v[148:151]
  v_rcp_f32 v234, v196
  v_mov_b64 v[188:189], 0
  v_mov_b64 v[190:191], 0
  v_max_f32 v235, v196, v234
  v_pk_mul_f32 v[144:145], v[144:145], v[234:235] op_sel_hi:[1,0]
  v_pk_mul_f32 v[146:147], v[146:147], v[234:235] op_sel_hi:[1,0]
  v_cvt_pk_bf16_f32 v160, v144, v145
  v_cvt_pk_bf16_f32 v161, v146, v147
  v_pk_mul_f32 v[148:149], v[148:149], v[234:235] op_sel_hi:[1,0]
  v_pk_mul_f32 v[150:151], v[150:151], v[234:235] op_sel_hi:[1,0]
  v_cvt_pk_bf16_f32 v162, v148, v149
  v_cvt_pk_bf16_f32 v163, v150, v151
  ds_write_b128 v253, v[160:163] offset:10240
  s_nop 0
  v_smfmac_f32_16x16x64_bf16 v[152:155], v[160:163], v[32:39], v240
  v_cmp_ngt_f32 vcc, s54, v235
  v_smfmac_f32_16x16x64_bf16 v[156:159], v[160:163], v[40:47], v240
  v_mov_b64 v[236:237], 0
  v_mov_b64 v[238:239], 0
  s_cbranch_vccnz c_slow_1_2
c_back_1_2:
  s_waitcnt lgkmcnt(0)
  s_barrier
  ds_read_b128 v[164:167], v253 offset:11264
  ds_read_b128 v[192:195], v253 offset:8192
  ds_read_b128 v[212:215], v253 offset:9216
  v_smfmac_f32_16x16x64_bf16 v[188:191], v[160:163], v[48:55], v240
  ds_read_b128 v[120:123], v252 offset:18432
  v_smfmac_f32_16x16x64_bf16 v[236:239], v[160:163], v[56:63], v240
  s_waitcnt lgkmcnt(3)
  v_smfmac_f32_16x16x64_bf16 v[152:155], v[164:167], v[64:71], v240
  ds_read_b128 v[124:127], v252 offset:19456
  s_add_u32 s37, s37, 1
  s_waitcnt lgkmcnt(3)
  v_smfmac_f32_16x16x64_bf16 v[152:155], v[192:195], v[80:87], v240
  ds_read_b128 v[136:139], v252 offset:2048
  s_add_u32 s38, s38, 8192
  s_waitcnt lgkmcnt(3)
  v_smfmac_f32_16x16x64_bf16 v[152:155], v[212:215], v[96:103], v240
  ds_read_b128 v[140:143], v252 offset:3072
  s_add_u32 s41, s41, 262144
  v_smfmac_f32_16x16x64_bf16 v[156:159], v[164:167], v[72:79], v240
  s_add_u32 s42, s42, 262144
  s_add_u32 s50, s50, 262144
  v_smfmac_f32_16x16x64_bf16 v[156:159], v[192:195], v[88:95], v240
  v_cvt_pk_bf16_f32 v144, v152, v153
  v_cvt_pk_bf16_f32 v145, v154, v155
  v_bfi_b32 v144, 1, s44, v144
  v_smfmac_f32_16x16x64_bf16 v[156:159], v[212:215], v[104:111], v240
  buffer_store_dwordx2 v[144:145], v255, s[4:7], s39 offen offset:0 sc1
  v_smfmac_f32_16x16x64_bf16 v[188:191], v[164:167], v[216:223], v240
  s_add_u32 s58, s37, 2
  s_min_u32 s58, s58, 63
  v_smfmac_f32_16x16x64_bf16 v[188:191], v[192:195], v[112:119], v240
  v_cvt_pk_bf16_f32 v146, v156, v157
  v_cvt_pk_bf16_f32 v147, v158, v159
  v_bfi_b32 v146, 1, s44, v146
  v_smfmac_f32_16x16x64_bf16 v[188:191], v[212:215], v[128:135], v240
  buffer_store_dwordx2 v[146:147], v255, s[4:7], s39 offen offset:2048 sc1
  v_smfmac_f32_16x16x64_bf16 v[236:239], v[164:167], v[224:231], v240
  s_waitcnt lgkmcnt(0)
  v_smfmac_f32_16x16x64_bf16 v[236:239], v[192:195], v[120:127], v240
  v_cvt_pk_bf16_f32 v148, v188, v189
  v_cvt_pk_bf16_f32 v149, v190, v191
  v_bfi_b32 v148, 1, s44, v148
  v_smfmac_f32_16x16x64_bf16 v[236:239], v[212:215], v[136:143], v240
  buffer_store_dwordx2 v[148:149], v255, s[4:7], s43 offen offset:0 sc1
  s_nop 6
  v_cvt_pk_bf16_f32 v150, v236, v237
  v_cvt_pk_bf16_f32 v151, v238, v239
  v_bfi_b32 v150, 1, s44, v150
  buffer_store_dwordx2 v[150:151], v255, s[4:7], s43 offen offset:2048 sc1
  s_waitcnt vmcnt(0)
c_pfd_1_2:
  buffer_load_dwordx4 v[120:123], v253, s[4:7], s40 offen offset:0 sc1
  buffer_load_dwordx4 v[124:127], v253, s[4:7], s40 offen offset:1024 sc1
  v_mov_b64 v[152:153], 0
  v_mov_b64 v[154:155], 0
  v_mov_b64 v[156:157], 0
  v_mov_b64 v[158:159], 0
  v_mov_b64 v[160:161], 0
  v_mov_b64 v[162:163], 0
  v_mov_b64 v[164:165], 0
  v_mov_b64 v[166:167], 0
  v_mov_b64 v[144:145], 0
  v_mov_b64 v[146:147], 0
  v_mov_b64 v[148:149], 0
  v_mov_b64 v[150:151], 0
  s_cmp_lg_u32 s44, 0
  s_cbranch_scc1 c_h1c1_1_2
c_h1c0_1_2:
  s_waitcnt vmcnt(1)
  v_mfma_f32_16x16x32_bf16 v[236:239], v[248:251], v[120:123], 0
  s_waitcnt vmcnt(0)
  v_mfma_f32_16x16x32_bf16 v[236:239], v[248:251], v[124:127], v[236:239]
  v_bitop3_b32 v232, v120, v122, v124 bitop3:0xfe
  v_bitop3_b32 v232, v232, v126, 1 bitop3:0xa8
  v_cmp_ne_u32 vcc, 0, v232
  s_nop 4
  v_add_f32_dpp v236, v236, v236 row_ror:4 row_mask:0xf bank_mask:0xf
  v_add_f32_dpp v237, v237, v237 row_ror:4 row_mask:0xf bank_mask:0xf
  s_nop 0
  v_add_f32_dpp v236, v236, v236 row_ror:8 row_mask:0xf bank_mask:0xf
  v_add_f32_dpp v237, v237, v237 row_ror:8 row_mask:0xf bank_mask:0xf
  v_cvt_pk_bf16_f32 v233, v236, v237
  s_cbranch_vccnz c_h1b0_1_2
c_h1ok0_1_2:
  buffer_store_dword v233, v241, s[4:7], s49 offen sc1
c_pub_1_2:
  s_xor_b32 s44, s44, 1
  s_add_u32 s49, s49, 8192
  s_cmp_eq_u32 s37, s57
  s_cbranch_scc1 c_fin_1_2
  ds_read_b128 v[184:187], v252 offset:8192
  ds_read_b128 v[188:191], v252 offset:9216
  ds_read_b128 v[192:195], v252 offset:10240
  ds_read_b128 v[196:199], v252 offset:11264
  ds_read_b128 v[200:203], v252 offset:20480
  ds_read_b128 v[204:207], v252 offset:21504
  s_waitcnt lgkmcnt(0)
  buffer_load_dwordx4 v[112:115], v253, s[4:7], s38 offen sc1
  buffer_load_dwordx4 v[116:119], v253, s[4:7], s38 offen offset:1024 sc1
  ds_read_b128 v[208:211], v252 offset:22528
  ds_read_b128 v[212:215], v252 offset:23552
  ds_read_b128 v[216:219], v252 offset:12288
  ds_read_b128 v[220:223], v252 offset:13312
  ds_read_b128 v[224:227], v252 offset:14336
  ds_read_b128 v[228:231], v252 offset:15360
  s_waitcnt lgkmcnt(0)
  buffer_load_dwordx4 v[112:115], v253, s[4:7], s38 offen sc1
  buffer_load_dwordx4 v[116:119], v253, s[4:7], s38 offen offset:1024 sc1
  s_branch c_top_1_2
c_fin_1_2:
  buffer_store_dword v233, v241, s[4:7], s48 offen sc1
  s_nop 7
  s_mov_b64 exec, 1
  s_waitcnt vmcnt(0)
  s_endpgm
  s_nop 7
c_bad_1_2:
  s_mov_b64 exec, vcc
  buffer_load_dwordx4 v[112:115], v253, s[4:7], s38 offen sc1
  buffer_load_dwordx4 v[116:119], v253, s[4:7], s38 offen offset:1024 sc1
  s_mov_b64 exec, -1
  s_cmp_eq_u32 s35, 0
  s_cbranch_scc1 c_okL_1_2
  s_sub_u32 s35, s35, 1
  s_branch c_top_1_2
c_entry_1_2:
  ds_write_b128 v253, v[112:115] offset:4096
  s_branch c_okL_1_2
c_slow_1_2:
  s_nop 15
  v_max3_f32 v234, v184, v185, v186
  v_max3_f32 v234, v234, v187, v208
  v_max_f32 v234, v234, v209
  s_nop 1
  v_max_f32_dpp v234, v234, v234 quad_perm:[2,3,0,1] row_mask:0xf bank_mask:0xf
  v_mov_b32 v235, v234
  s_nop 1
  v_permlane16_swap_b32 v234, v235
  s_nop 1
  v_max_f32 v234, v234, v235
  v_mov_b32 v235, v234
  s_nop 1
  v_permlane32_swap_b32 v234, v235
  s_nop 1
  v_max_f32 v234, v234, v235
  v_sub_f32 v188, v184, v234
  v_sub_f32 v189, v185, v234
  v_sub_f32 v190, v186, v234
  v_sub_f32 v191, v187, v234
  v_sub_f32 v210, v208, v234
  v_sub_f32 v211, v209, v234
  v_exp_f32 v188, v188
  v_exp_f32 v189, v189
  v_exp_f32 v190, v190
  v_exp_f32 v191, v191
  v_cvt_pk_bf16_f32 v188, v188, v189
  v_cvt_pk_bf16_f32 v189, v190, v191
  s_nop 1
  v_mfma_f32_16x16x16_bf16 v[196:199], v[246:247], v[188:189], 0
  v_mov_b32_dpp v192, v188 quad_perm:[0,1,0,1] row_mask:0xf bank_mask:0xf
  v_mov_b32_dpp v193, v189 quad_perm:[0,1,0,1] row_mask:0xf bank_mask:0xf
  v_mov_b32_dpp v194, v188 quad_perm:[2,3,2,3] row_mask:0xf bank_mask:0xf
  v_mov_b32_dpp v195, v189 quad_perm:[2,3,2,3] row_mask:0xf bank_mask:0xf
  v_exp_f32 v210, v210
  v_exp_f32 v211, v211
  v_mfma_f32_16x16x32_bf16 v[144:147], v[176:179], v[192:195], 0
  s_nop 0
  v_add_f32_dpp v196, v196, v196 quad_perm:[2,3,0,1] row_mask:0xf bank_mask:0xf
  v_cvt_pk_bf16_f32 v232, v210, v211
  v_mfma_f32_16x16x32_bf16 v[148:151], v[180:183], v[192:195], 0
  v_cvt_pk_bf16_f32 v233, v210, v211
  v_add_f32 v196, v196, v196
  s_nop 1
  v_mfma_f32_16x16x16_bf16 v[196:199], v[246:247], v[232:233], v[196:199]
  v_mfma_f32_16x16x16_bf16 v[144:147], v[204:205], v[232:233], v[144:147]
  v_mfma_f32_16x16x16_bf16 v[148:151], v[206:207], v[232:233], v[148:151]
  s_waitcnt lgkmcnt(0)
  v_rcp_f32 v234, v196
  s_nop 1
  v_pk_mul_f32 v[144:145], v[144:145], v[234:235] op_sel_hi:[1,0]
  v_pk_mul_f32 v[146:147], v[146:147], v[234:235] op_sel_hi:[1,0]
  v_cvt_pk_bf16_f32 v160, v144, v145
  v_cvt_pk_bf16_f32 v161, v146, v147
  v_pk_mul_f32 v[148:149], v[148:149], v[234:235] op_sel_hi:[1,0]
  v_pk_mul_f32 v[150:151], v[150:151], v[234:235] op_sel_hi:[1,0]
  v_cvt_pk_bf16_f32 v162, v148, v149
  v_cvt_pk_bf16_f32 v163, v150, v151
  ds_write_b128 v253, v[160:163] offset:10240
  v_mov_b64 v[152:153], 0
  v_mov_b64 v[154:155], 0
  v_mov_b64 v[156:157], 0
  v_mov_b64 v[158:159], 0
  v_mov_b64 v[188:189], 0
  v_mov_b64 v[190:191], 0
  v_mov_b64 v[236:237], 0
  v_mov_b64 v[238:239], 0
  v_smfmac_f32_16x16x64_bf16 v[152:155], v[160:163], v[32:39], v240
  v_smfmac_f32_16x16x64_bf16 v[156:159], v[160:163], v[40:47], v240
  s_nop 7
  s_branch c_back_1_2
c_h1c1_1_2:
  s_waitcnt vmcnt(1)
  v_mfma_f32_16x16x32_bf16 v[236:239], v[248:251], v[120:123], 0
  s_waitcnt vmcnt(0)
  v_mfma_f32_16x16x32_bf16 v[236:239], v[248:251], v[124:127], v[236:239]
  v_bitop3_b32 v232, v120, v122, v124 bitop3:0x80
  v_bitop3_b32 v232, v232, v126, 1 bitop3:0x80
  v_cmp_ne_u32 vcc, 1, v232
  s_nop 4
  v_add_f32_dpp v236, v236, v236 row_ror:4 row_mask:0xf bank_mask:0xf
  v_add_f32_dpp v237, v237, v237 row_ror:4 row_mask:0xf bank_mask:0xf
  s_nop 0
  v_add_f32_dpp v236, v236, v236 row_ror:8 row_mask:0xf bank_mask:0xf
  v_add_f32_dpp v237, v237, v237 row_ror:8 row_mask:0xf bank_mask:0xf
  v_cvt_pk_bf16_f32 v233, v236, v237
  s_cbranch_vccnz c_h1b1_1_2
c_h1ok1_1_2:
  buffer_store_dword v233, v241, s[4:7], s49 offen sc1
  s_branch c_pub_1_2
c_h1b0_1_2:
  s_mov_b64 exec, vcc
  buffer_load_dwordx4 v[120:123], v253, s[4:7], s40 offen offset:0 sc1
  buffer_load_dwordx4 v[124:127], v253, s[4:7], s40 offen offset:1024 sc1
  s_mov_b64 exec, -1
  s_cmp_eq_u32 s35, 0
  s_cbranch_scc1 c_h1ok0_1_2
  s_sub_u32 s35, s35, 1
  s_branch c_h1c0_1_2
c_h1b1_1_2:
  s_mov_b64 exec, vcc
  buffer_load_dwordx4 v[120:123], v253, s[4:7], s40 offen offset:0 sc1
  buffer_load_dwordx4 v[124:127], v253, s[4:7], s40 offen offset:1024 sc1
  s_mov_b64 exec, -1
  s_cmp_eq_u32 s35, 0
  s_cbranch_scc1 c_h1ok1_1_2
  s_sub_u32 s35, s35, 1
  s_branch c_h1c1_1_2
.p2align 6
c_top_1_3:
  s_waitcnt vmcnt(3)
  v_max3_u32 v238, v112, v113, v114
  s_waitcnt vmcnt(2)
  v_max3_u32 v238, v238, v115, v116
  v_max3_u32 v238, v238, v117, v118
  v_max_u32 v238, v238, v119
  v_cmp_eq_u32 vcc, -1, v238
  ds_write_b128 v253, v[112:115] offset:6144
  s_cbranch_vccnz c_bad_1_3
c_okL_1_3:
  ds_write_b128 v253, v[116:119] offset:7168
  v_smfmac_f32_16x16x64_bf16 v[144:147], v[112:115], v[184:191], v240
  v_smfmac_f32_16x16x64_bf16 v[148:151], v[112:115], v[192:199], v240
  v_smfmac_f32_16x16x64_bf16 v[152:155], v[112:115], v[200:207], v240
  v_smfmac_f32_16x16x64_bf16 v[156:159], v[112:115], v[208:215], v240
  v_smfmac_f32_16x16x64_bf16 v[144:147], v[116:119], v[216:223], v240
  v_smfmac_f32_16x16x64_bf16 v[148:151], v[116:119], v[224:231], v240
  s_waitcnt lgkmcnt(0)
  s_barrier
  ds_read_b128 v[120:123], v253 offset:0
  ds_read_b128 v[124:127], v253 offset:1024
  v_smfmac_f32_16x16x64_bf16 v[152:155], v[116:119], a[96:103], v240
  ds_read_b128 v[128:131], v253 offset:2048
  ds_read_b128 v[132:135], v253 offset:3072
  v_smfmac_f32_16x16x64_bf16 v[156:159], v[116:119], a[104:111], v240
  ds_read_b128 v[136:139], v253 offset:4096
  ds_read_b128 v[140:143], v253 offset:5120
  v_smfmac_f32_16x16x64_bf16 v[160:163], v[112:115], a[160:167], v240
  v_smfmac_f32_16x16x64_bf16 v[164:167], v[112:115], a[168:175], v240
  buffer_load_dwordx4 v[176:179], v253, s[4:7], s42 offen offset:0 sc1
  v_lshlrev_b32 v234, 3, v253
  s_waitcnt lgkmcnt(5)
  v_smfmac_f32_16x16x64_bf16 v[144:147], v[120:123], a[0:7], v240
  ds_read_b128 v[184:187], v252 offset:24576
  s_waitcnt lgkmcnt(5)
  v_smfmac_f32_16x16x64_bf16 v[144:147], v[124:127], a[16:23], v240
  ds_read_b128 v[188:191], v252 offset:25600
  s_waitcnt lgkmcnt(5)
  v_smfmac_f32_16x16x64_bf16 v[144:147], v[128:131], a[32:39], v240
  ds_read_b128 v[192:195], v252 offset:28672
  s_waitcnt lgkmcnt(5)
  v_smfmac_f32_16x16x64_bf16 v[144:147], v[132:135], a[48:55], v240
  buffer_load_dwordx4 v[180:183], v253, s[4:7], s42 offen offset:1024 sc1
  ds_read_b128 v[196:199], v252 offset:29696
  s_waitcnt lgkmcnt(5)
  v_smfmac_f32_16x16x64_bf16 v[144:147], v[136:139], a[64:71], v240
  ds_read_b128 v[200:203], v252 offset:32768
  s_waitcnt lgkmcnt(5)
  v_smfmac_f32_16x16x64_bf16 v[144:147], v[140:143], a[80:87], v240
  ds_read_b128 v[204:207], v252 offset:33792
  v_smfmac_f32_16x16x64_bf16 v[148:151], v[120:123], a[8:15], v240
  ds_read_b128 v[208:211], v252 offset:26624
  v_smfmac_f32_16x16x64_bf16 v[148:151], v[124:127], a[24:31], v240
  buffer_store_dword v233, v241, s[4:7], s48 offen sc1
  s_add_u32 s48, s49, 8388608
  ds_read_b128 v[212:215], v252 offset:27648
  v_cvt_pk_bf16_f32 v232, v144, v145
  v_smfmac_f32_16x16x64_bf16 v[148:151], v[128:131], a[40:47], v240
  ds_read_b128 v[216:219], v252 offset:30720
  v_cvt_pk_bf16_f32 v233, v146, v147
  v_smfmac_f32_16x16x64_bf16 v[148:151], v[132:135], a[56:63], v240
  ds_read_b128 v[220:223], v252 offset:31744
  v_mfma_f32_16x16x16_bf16 v[144:147], v[232:233], v[242:243], 0
  ds_read_b128 v[224:227], v252 offset:34816
  v_smfmac_f32_16x16x64_bf16 v[148:151], v[136:139], a[72:79], v240
  ds_read_b128 v[228:231], v252 offset:35840
  v_smfmac_f32_16x16x64_bf16 v[148:151], v[140:143], a[88:95], v240
  s_mov_b64 exec, s[24:25]
  buffer_load_dword v234, s[4:7], s50 offen lds
  s_mov_b64 exec, -1
  v_cvt_pk_bf16_f32 v236, v144, v145
  v_smfmac_f32_16x16x64_bf16 v[152:155], v[120:123], a[112:119], v240
  v_cvt_pk_bf16_f32 v237, v146, v147
  v_smfmac_f32_16x16x64_bf16 v[152:155], v[124:127], a[128:135], v240
  v_cvt_pk_bf16_f32 v234, v148, v149
  v_cvt_pk_bf16_f32 v235, v150, v151
  v_smfmac_f32_16x16x64_bf16 v[152:155], v[128:131], a[144:151], v240
  v_mfma_f32_16x16x16_bf16 v[148:151], v[234:235], v[242:243], 0
  s_waitcnt lgkmcnt(0)
  v_smfmac_f32_16x16x64_bf16 v[152:155], v[132:135], v[184:191], v240
  v_smfmac_f32_16x16x64_bf16 v[152:155], v[136:139], v[192:199], v240
  v_cvt_pk_bf16_f32 v238, v148, v149
  v_cvt_pk_bf16_f32 v239, v150, v151
  v_smfmac_f32_16x16x64_bf16 v[152:155], v[140:143], v[200:207], v240
  s_waitcnt vmcnt(4)
  v_mfma_f32_16x16x32_bf16 v[144:147], v[168:171], v[236:239], 0
  v_mfma_f32_16x16x32_bf16 v[148:151], v[172:175], v[236:239], 0
  v_cvt_pk_bf16_f32 v232, v152, v153
  v_cvt_pk_bf16_f32 v233, v154, v155
  v_smfmac_f32_16x16x64_bf16 v[156:159], v[120:123], a[120:127], v240
  v_mfma_f32_16x16x16_bf16 v[152:155], v[232:233], v[244:245], 0
  v_cndmask_b32 v144, v144, v148, s[98:99]
  v_cndmask_b32 v145, v145, v149, s[98:99]
  v_cndmask_b32 v146, v146, v150, s[98:99]
  v_cndmask_b32 v147, v147, v151, s[98:99]
  v_smfmac_f32_16x16x64_bf16 v[156:159], v[124:127], a[136:143], v240
  ds_write_b128 v253, v[144:147] offset:11264
  v_smfmac_f32_16x16x64_bf16 v[156:159], v[128:131], a[152:159], v240
  v_cvt_pk_bf16_f32 v200, v152, v153
  v_smfmac_f32_16x16x64_bf16 v[156:159], v[132:135], v[208:215], v240
  v_cvt_pk_bf16_f32 v201, v154, v155
  v_smfmac_f32_16x16x64_bf16 v[156:159], v[136:139], v[216:223], v240
  buffer_load_dwordx4 v[168:171], v253, s[4:7], s41 offen offset:0 sc1
  v_smfmac_f32_16x16x64_bf16 v[156:159], v[140:143], v[224:231], v240
  v_smfmac_f32_16x16x64_bf16 v[160:163], v[120:123], a[192:199], v240
  v_smfmac_f32_16x16x64_bf16 v[164:167], v[120:123], a[200:207], v240
  v_cvt_pk_bf16_f32 v234, v156, v157
  v_cvt_pk_bf16_f32 v235, v158, v159
  s_waitcnt lgkmcnt(0)
  s_barrier
  v_mfma_f32_16x16x16_bf16 v[156:159], v[234:235], v[244:245], 0
  buffer_load_dwordx4 v[172:175], v253, s[4:7], s41 offen offset:1024 sc1
  ds_read_b128 v[184:187], v253 offset:8192
  ds_read_b128 v[188:191], v253 offset:9216
  v_smfmac_f32_16x16x64_bf16 v[160:163], v[124:127], a[208:215], v240
  ds_read_b128 v[192:195], v253 offset:10240
  ds_read_b128 v[196:199], v253 offset:11264
  v_smfmac_f32_16x16x64_bf16 v[164:167], v[124:127], a[216:223], v240
  v_cvt_pk_bf16_f32 v202, v156, v157
  v_cvt_pk_bf16_f32 v203, v158, v159
  v_smfmac_f32_16x16x64_bf16 v[160:163], v[128:131], a[224:231], v240
  v_mfma_f32_16x16x32_bf16 v[152:155], v[200:203], v[236:239], 0
  v_smfmac_f32_16x16x64_bf16 v[164:167], v[128:131], a[232:239], v240
  v_smfmac_f32_16x16x64_bf16 v[160:163], v[132:135], a[240:247], v240
  ds_write_b64 v253, v[152:153] offset:1032
  s_waitcnt lgkmcnt(1)
  v_pk_add_f32 v[184:185], v[184:185], v[188:189]
  v_pk_add_f32 v[186:187], v[186:187], v[190:191]
  v_pk_add_f32 v[192:193], v[192:193], v[196:197]
  v_pk_add_f32 v[194:195], v[194:195], v[198:199]
  v_pk_add_f32 v[184:185], v[184:185], v[192:193]
  v_pk_add_f32 v[186:187], v[186:187], v[194:195]
  v_exp_f32 v188, v184
  v_exp_f32 v189, v185
  v_smfmac_f32_16x16x64_bf16 v[160:163], v[116:119], a[176:183], v240
  v_smfmac_f32_16x16x64_bf16 v[164:167], v[116:119], a[184:191], v240
  v_smfmac_f32_16x16x64_bf16 v[164:167], v[132:135], a[248:255], v240
  s_waitcnt lgkmcnt(0)
  s_barrier
  ds_read_b128 v[208:211], v254 offset:0
  v_smfmac_f32_16x16x64_bf16 v[160:163], v[136:139], v[0:7], v240
  ds_read_b128 v[216:219], v252 offset:16384
  ds_read_b128 v[220:223], v252 offset:17408
  v_exp_f32 v190, v186
  v_exp_f32 v191, v187
  v_cvt_pk_bf16_f32 v188, v188, v189
  v_cvt_pk_bf16_f32 v189, v190, v191
  v_smfmac_f32_16x16x64_bf16 v[160:163], v[140:143], v[16:23], v240
  ds_read_b128 v[224:227], v252 offset:18432
  ds_read_b128 v[228:231], v252 offset:19456
  v_mov_b32_dpp v192, v188 quad_perm:[0,1,0,1] row_mask:0xf bank_mask:0xf
  v_mfma_f32_16x16x16_bf16 v[196:199], v[246:247], v[188:189], 0
  v_mov_b32_dpp v193, v189 quad_perm:[0,1,0,1] row_mask:0xf bank_mask:0xf
  v_mov_b32_dpp v194, v188 quad_perm:[2,3,2,3] row_mask:0xf bank_mask:0xf
  v_mov_b32_dpp v195, v189 quad_perm:[2,3,2,3] row_mask:0xf bank_mask:0xf
  v_smfmac_f32_16x16x64_bf16 v[164:167], v[136:139], v[8:15], v240
  s_waitcnt lgkmcnt(4)
  v_add_f32 v208, v208, v210
  v_smfmac_f32_16x16x64_bf16 v[164:167], v[140:143], v[24:31], v240
  ds_read_b128 v[112:115], v252 offset:0
  ds_read_b128 v[116:119], v252 offset:1024
  v_add_f32 v209, v209, v211
  s_waitcnt vmcnt(4)
  v_mfma_f32_16x16x32_bf16 v[144:147], v[176:179], v[192:195], 0
  ds_read_b128 v[128:131], v252 offset:4096
  v_add_f32_dpp v208, v208, v208 quad_perm:[2,3,0,1] row_mask:0xf bank_mask:0xf
  v_add_f32_dpp v209, v209, v209 quad_perm:[2,3,0,1] row_mask:0xf bank_mask:0xf
  v_mfma_f32_16x16x32_bf16 v[148:151], v[180:183], v[192:195], 0
  ds_read_b128 v[132:135], v252 offset:5120
  v_exp_f32 v210, v208
  v_exp_f32 v211, v209
  v_add_f32_dpp v196, v196, v196 quad_perm:[2,3,0,1] row_mask:0xf bank_mask:0xf
  v_cvt_pk_bf16_f32 v232, v210, v211
  v_cvt_pk_bf16_f32 v233, v210, v211
  v_add_f32 v196, v196, v196
  v_cvt_pk_bf16_f32 v204, v160, v161
  v_cvt_pk_bf16_f32 v205, v162, v163
  v_mfma_f32_16x16x16_bf16 v[196:199], v[246:247], v[232:233], v[196:199]
  v_cvt_pk_bf16_f32 v206, v164, v165
  v_cvt_pk_bf16_f32 v207, v166, v167
  v_mov_b64 v[152:153], 0
  v_mfma_f32_16x16x16_bf16 v[144:147], v[204:205], v[232:233], v[144:147]
  v_mov_b64 v[154:155], 0
  v_mov_b64 v[156:157], 0
  v_mov_b64 v[158:159], 0
  v_mfma_f32_16x16x16_bf16 v[148:151], v[206:207], v[232:233], v[148:151]
  v_rcp_f32 v234, v196
  v_mov_b64 v[188:189], 0
  v_mov_b64 v[190:191], 0
  v_max_f32 v235, v196, v234
  v_pk_mul_f32 v[144:145], v[144:145], v[234:235] op_sel_hi:[1,0]
  v_pk_mul_f32 v[146:147], v[146:147], v[234:235] op_sel_hi:[1,0]
  v_cvt_pk_bf16_f32 v160, v144, v145
  v_cvt_pk_bf16_f32 v161, v146, v147
  v_pk_mul_f32 v[148:149], v[148:149], v[234:235] op_sel_hi:[1,0]
  v_pk_mul_f32 v[150:151], v[150:151], v[234:235] op_sel_hi:[1,0]
  v_cvt_pk_bf16_f32 v162, v148, v149
  v_cvt_pk_bf16_f32 v163, v150, v151
  ds_write_b128 v253, v[160:163] offset:11264
  s_nop 0
  v_smfmac_f32_16x16x64_bf16 v[152:155], v[160:163], v[32:39], v240
  v_cmp_ngt_f32 vcc, s54, v235
  v_smfmac_f32_16x16x64_bf16 v[156:159], v[160:163], v[40:47], v240
  v_mov_b64 v[236:237], 0
  v_mov_b64 v[238:239], 0
  s_cbranch_vccnz c_slow_1_3
c_back_1_3:
  s_waitcnt lgkmcnt(0)
  s_barrier
  ds_read_b128 v[164:167], v253 offset:8192
  ds_read_b128 v[192:195], v253 offset:9216
  ds_read_b128 v[212:215], v253 offset:10240
  v_smfmac_f32_16x16x64_bf16 v[188:191], v[160:163], v[48:55], v240
  ds_read_b128 v[120:123], v252 offset:2048
  v_smfmac_f32_16x16x64_bf16 v[236:239], v[160:163], v[56:63], v240
  s_waitcnt lgkmcnt(3)
  v_smfmac_f32_16x16x64_bf16 v[152:155], v[164:167], v[64:71], v240
  ds_read_b128 v[124:127], v252 offset:3072
  s_add_u32 s37, s37, 1
  s_waitcnt lgkmcnt(3)
  v_smfmac_f32_16x16x64_bf16 v[152:155], v[192:195], v[80:87], v240
  ds_read_b128 v[136:139], v252 offset:6144
  s_add_u32 s38, s38, 8192
  s_waitcnt lgkmcnt(3)
  v_smfmac_f32_16x16x64_bf16 v[152:155], v[212:215], v[96:103], v240
  ds_read_b128 v[140:143], v252 offset:7168
  s_add_u32 s41, s41, 262144
  v_smfmac_f32_16x16x64_bf16 v[156:159], v[164:167], v[72:79], v240
  s_add_u32 s42, s42, 262144
  s_add_u32 s50, s50, 8192
  v_smfmac_f32_16x16x64_bf16 v[156:159], v[192:195], v[88:95], v240
  v_cvt_pk_bf16_f32 v144, v152, v153
  v_cvt_pk_bf16_f32 v145, v154, v155
  v_bfi_b32 v144, 1, s44, v144
  v_smfmac_f32_16x16x64_bf16 v[156:159], v[212:215], v[104:111], v240
  buffer_store_dwordx2 v[144:145], v255, s[4:7], s39 offen offset:0 sc1
  v_smfmac_f32_16x16x64_bf16 v[188:191], v[164:167], v[216:223], v240
  s_add_u32 s58, s37, 2
  s_min_u32 s58, s58, 63
  v_smfmac_f32_16x16x64_bf16 v[188:191], v[192:195], v[112:119], v240
  v_cvt_pk_bf16_f32 v146, v156, v157
  v_cvt_pk_bf16_f32 v147, v158, v159
  v_bfi_b32 v146, 1, s44, v146
  v_smfmac_f32_16x16x64_bf16 v[188:191], v[212:215], v[128:135], v240
  buffer_store_dwordx2 v[146:147], v255, s[4:7], s39 offen offset:2048 sc1
  v_smfmac_f32_16x16x64_bf16 v[236:239], v[164:167], v[224:231], v240
  s_waitcnt lgkmcnt(0)
  v_smfmac_f32_16x16x64_bf16 v[236:239], v[192:195], v[120:127], v240
  v_cvt_pk_bf16_f32 v148, v188, v189
  v_cvt_pk_bf16_f32 v149, v190, v191
  v_bfi_b32 v148, 1, s44, v148
  v_smfmac_f32_16x16x64_bf16 v[236:239], v[212:215], v[136:143], v240
  buffer_store_dwordx2 v[148:149], v255, s[4:7], s43 offen offset:0 sc1
  s_nop 6
  v_cvt_pk_bf16_f32 v150, v236, v237
  v_cvt_pk_bf16_f32 v151, v238, v239
  v_bfi_b32 v150, 1, s44, v150
  buffer_store_dwordx2 v[150:151], v255, s[4:7], s43 offen offset:2048 sc1
  s_waitcnt vmcnt(0)
c_pfd_1_3:
  buffer_load_dwordx4 v[120:123], v253, s[4:7], s40 offen offset:0 sc1
  buffer_load_dwordx4 v[124:127], v253, s[4:7], s40 offen offset:1024 sc1
  v_mov_b64 v[152:153], 0
  v_mov_b64 v[154:155], 0
  v_mov_b64 v[156:157], 0
  v_mov_b64 v[158:159], 0
  v_mov_b64 v[160:161], 0
  v_mov_b64 v[162:163], 0
  v_mov_b64 v[164:165], 0
  v_mov_b64 v[166:167], 0
  v_mov_b64 v[144:145], 0
  v_mov_b64 v[146:147], 0
  v_mov_b64 v[148:149], 0
  v_mov_b64 v[150:151], 0
  buffer_load_dwordx4 v[128:131], v253, s[4:7], s40 offen offset:0 sc1
  buffer_load_dwordx4 v[132:135], v253, s[4:7], s40 offen offset:1024 sc1
  s_cmp_lg_u32 s44, 0
  s_cbranch_scc1 c_h1c1_1_3
c_h1c0_1_3:
  s_waitcnt vmcnt(3)
  v_mfma_f32_16x16x32_bf16 v[236:239], v[248:251], v[120:123], 0
  s_waitcnt vmcnt(2)
  v_mfma_f32_16x16x32_bf16 v[236:239], v[248:251], v[124:127], v[236:239]
  v_bitop3_b32 v232, v120, v122, v124 bitop3:0xfe
  v_bitop3_b32 v232, v232, v126, 1 bitop3:0xa8
  v_cmp_ne_u32 vcc, 0, v232
  s_nop 4
  v_add_f32_dpp v236, v236, v236 row_ror:4 row_mask:0xf bank_mask:0xf
  v_add_f32_dpp v237, v237, v237 row_ror:4 row_mask:0xf bank_mask:0xf
  s_nop 0
  v_add_f32_dpp v236, v236, v236 row_ror:8 row_mask:0xf bank_mask:0xf
  v_add_f32_dpp v237, v237, v237 row_ror:8 row_mask:0xf bank_mask:0xf
  v_cvt_pk_bf16_f32 v233, v236, v237
  s_cbranch_vccnz c_h1b0_1_3
c_h1ok0_1_3:
  buffer_store_dword v233, v241, s[4:7], s49 offen sc1
c_pub_1_3:
  s_xor_b32 s44, s44, 1
  s_add_u32 s49, s49, 8192
  s_cmp_eq_u32 s37, s57
  s_cbranch_scc1 c_fin_1_3
  ds_read_b128 v[184:187], v252 offset:8192
  ds_read_b128 v[188:191], v252 offset:9216
  ds_read_b128 v[192:195], v252 offset:10240
  ds_read_b128 v[196:199], v252 offset:11264
  ds_read_b128 v[200:203], v252 offset:20480
  ds_read_b128 v[204:207], v252 offset:21504
  s_waitcnt lgkmcnt(0)
  buffer_load_dwordx4 v[112:115], v253, s[4:7], s38 offen sc1
  buffer_load_dwordx4 v[116:119], v253, s[4:7], s38 offen offset:1024 sc1
  ds_read_b128 v[208:211], v252 offset:22528
  ds_read_b128 v[212:215], v252 offset:23552
  ds_read_b128 v[216:219], v252 offset:12288
  ds_read_b128 v[220:223], v252 offset:13312
  ds_read_b128 v[224:227], v252 offset:14336
  ds_read_b128 v[228:231], v252 offset:15360
  s_waitcnt lgkmcnt(0)
  buffer_load_dwordx4 v[112:115], v253, s[4:7], s38 offen sc1
  buffer_load_dwordx4 v[116:119], v253, s[4:7], s38 offen offset:1024 sc1
  s_branch c_top_1_3
c_fin_1_3:
  buffer_store_dword v233, v241, s[4:7], s48 offen sc1
  s_nop 7
  s_mov_b64 exec, 1
  s_waitcnt vmcnt(0)
  s_endpgm
  s_nop 7
c_bad_1_3:
  s_mov_b64 exec, vcc
  buffer_load_dwordx4 v[112:115], v253, s[4:7], s38 offen sc1
  buffer_load_dwordx4 v[116:119], v253, s[4:7], s38 offen offset:1024 sc1
  s_mov_b64 exec, -1
  s_cmp_eq_u32 s35, 0
  s_cbranch_scc1 c_okL_1_3
  s_sub_u32 s35, s35, 1
  s_branch c_top_1_3
c_entry_1_3:
  ds_write_b128 v253, v[112:115] offset:6144
  s_branch c_okL_1_3
c_slow_1_3:
  s_nop 15
  v_max3_f32 v234, v184, v185, v186
  v_max3_f32 v234, v234, v187, v208
  v_max_f32 v234, v234, v209
  s_nop 1
  v_max_f32_dpp v234, v234, v234 quad_perm:[2,3,0,1] row_mask:0xf bank_mask:0xf
  v_mov_b32 v235, v234
  s_nop 1
  v_permlane16_swap_b32 v234, v235
  s_nop 1
  v_max_f32 v234, v234, v235
  v_mov_b32 v235, v234
  s_nop 1
  v_permlane32_swap_b32 v234, v235
  s_nop 1
  v_max_f32 v234, v234, v235
  v_sub_f32 v188, v184, v234
  v_sub_f32 v189, v185, v234
  v_sub_f32 v190, v186, v234
  v_sub_f32 v191, v187, v234
  v_sub_f32 v210, v208, v234
  v_sub_f32 v211, v209, v234
  v_exp_f32 v188, v188
  v_exp_f32 v189, v189
  v_exp_f32 v190, v190
  v_exp_f32 v191, v191
  v_cvt_pk_bf16_f32 v188, v188, v189
  v_cvt_pk_bf16_f32 v189, v190, v191
  s_nop 1
  v_mfma_f32_16x16x16_bf16 v[196:199], v[246:247], v[188:189], 0
  v_mov_b32_dpp v192, v188 quad_perm:[0,1,0,1] row_mask:0xf bank_mask:0xf
  v_mov_b32_dpp v193, v189 quad_perm:[0,1,0,1] row_mask:0xf bank_mask:0xf
  v_mov_b32_dpp v194, v188 quad_perm:[2,3,2,3] row_mask:0xf bank_mask:0xf
  v_mov_b32_dpp v195, v189 quad_perm:[2,3,2,3] row_mask:0xf bank_mask:0xf
  v_exp_f32 v210, v210
  v_exp_f32 v211, v211
  v_mfma_f32_16x16x32_bf16 v[144:147], v[176:179], v[192:195], 0
  s_nop 0
  v_add_f32_dpp v196, v196, v196 quad_perm:[2,3,0,1] row_mask:0xf bank_mask:0xf
  v_cvt_pk_bf16_f32 v232, v210, v211
  v_mfma_f32_16x16x32_bf16 v[148:151], v[180:183], v[192:195], 0
  v_cvt_pk_bf16_f32 v233, v210, v211
  v_add_f32 v196, v196, v196
  s_nop 1
  v_mfma_f32_16x16x16_bf16 v[196:199], v[246:247], v[232:233], v[196:199]
  v_mfma_f32_16x16x16_bf16 v[144:147], v[204:205], v[232:233], v[144:147]
  v_mfma_f32_16x16x16_bf16 v[148:151], v[206:207], v[232:233], v[148:151]
  s_waitcnt lgkmcnt(0)
  v_rcp_f32 v234, v196
  s_nop 1
  v_pk_mul_f32 v[144:145], v[144:145], v[234:235] op_sel_hi:[1,0]
  v_pk_mul_f32 v[146:147], v[146:147], v[234:235] op_sel_hi:[1,0]
  v_cvt_pk_bf16_f32 v160, v144, v145
  v_cvt_pk_bf16_f32 v161, v146, v147
  v_pk_mul_f32 v[148:149], v[148:149], v[234:235] op_sel_hi:[1,0]
  v_pk_mul_f32 v[150:151], v[150:151], v[234:235] op_sel_hi:[1,0]
  v_cvt_pk_bf16_f32 v162, v148, v149
  v_cvt_pk_bf16_f32 v163, v150, v151
  ds_write_b128 v253, v[160:163] offset:11264
  v_mov_b64 v[152:153], 0
  v_mov_b64 v[154:155], 0
  v_mov_b64 v[156:157], 0
  v_mov_b64 v[158:159], 0
  v_mov_b64 v[188:189], 0
  v_mov_b64 v[190:191], 0
  v_mov_b64 v[236:237], 0
  v_mov_b64 v[238:239], 0
  v_smfmac_f32_16x16x64_bf16 v[152:155], v[160:163], v[32:39], v240
  v_smfmac_f32_16x16x64_bf16 v[156:159], v[160:163], v[40:47], v240
  s_nop 7
  s_branch c_back_1_3
c_h1c1_1_3:
  s_waitcnt vmcnt(3)
  v_mfma_f32_16x16x32_bf16 v[236:239], v[248:251], v[120:123], 0
  s_waitcnt vmcnt(2)
  v_mfma_f32_16x16x32_bf16 v[236:239], v[248:251], v[124:127], v[236:239]
  v_bitop3_b32 v232, v120, v122, v124 bitop3:0x80
  v_bitop3_b32 v232, v232, v126, 1 bitop3:0x80
  v_cmp_ne_u32 vcc, 1, v232
  s_nop 4
  v_add_f32_dpp v236, v236, v236 row_ror:4 row_mask:0xf bank_mask:0xf
  v_add_f32_dpp v237, v237, v237 row_ror:4 row_mask:0xf bank_mask:0xf
  s_nop 0
  v_add_f32_dpp v236, v236, v236 row_ror:8 row_mask:0xf bank_mask:0xf
  v_add_f32_dpp v237, v237, v237 row_ror:8 row_mask:0xf bank_mask:0xf
  v_cvt_pk_bf16_f32 v233, v236, v237
  s_cbranch_vccnz c_h1b1_1_3
c_h1ok1_1_3:
  buffer_store_dword v233, v241, s[4:7], s49 offen sc1
  s_branch c_pub_1_3
c_h1b0_1_3:
  s_mov_b64 exec, vcc
  buffer_load_dwordx4 v[120:123], v253, s[4:7], s40 offen offset:0 sc1
  buffer_load_dwordx4 v[124:127], v253, s[4:7], s40 offen offset:1024 sc1
  s_mov_b64 exec, -1
  s_waitcnt vmcnt(3)
  v_mfma_f32_16x16x32_bf16 v[236:239], v[248:251], v[128:131], 0
  s_waitcnt vmcnt(2)
  v_mfma_f32_16x16x32_bf16 v[236:239], v[248:251], v[132:135], v[236:239]
  v_bitop3_b32 v232, v128, v130, v132 bitop3:0xfe
  v_bitop3_b32 v232, v232, v134, 1 bitop3:0xa8
  v_cmp_ne_u32 vcc, 0, v232
  s_nop 4
  v_add_f32_dpp v236, v236, v236 row_ror:4 row_mask:0xf bank_mask:0xf
  v_add_f32_dpp v237, v237, v237 row_ror:4 row_mask:0xf bank_mask:0xf
  s_nop 0
  v_add_f32_dpp v236, v236, v236 row_ror:8 row_mask:0xf bank_mask:0xf
  v_add_f32_dpp v237, v237, v237 row_ror:8 row_mask:0xf bank_mask:0xf
  v_cvt_pk_bf16_f32 v233, v236, v237
  s_cbranch_vccz c_h1ok0_1_3
  s_mov_b64 exec, vcc
  buffer_load_dwordx4 v[128:131], v253, s[4:7], s40 offen offset:0 sc1
  buffer_load_dwordx4 v[132:135], v253, s[4:7], s40 offen offset:1024 sc1
  s_mov_b64 exec, -1
  s_cmp_eq_u32 s35, 0
  s_cbranch_scc1 c_h1ok0_1_3
  s_sub_u32 s35, s35, 1
  s_branch c_h1c0_1_3
c_h1b1_1_3:
  s_mov_b64 exec, vcc
  buffer_load_dwordx4 v[120:123], v253, s[4:7], s40 offen offset:0 sc1
  buffer_load_dwordx4 v[124:127], v253, s[4:7], s40 offen offset:1024 sc1
  s_mov_b64 exec, -1
  s_waitcnt vmcnt(3)
  v_mfma_f32_16x16x32_bf16 v[236:239], v[248:251], v[128:131], 0
  s_waitcnt vmcnt(2)
  v_mfma_f32_16x16x32_bf16 v[236:239], v[248:251], v[132:135], v[236:239]
  v_bitop3_b32 v232, v128, v130, v132 bitop3:0x80
  v_bitop3_b32 v232, v232, v134, 1 bitop3:0x80
  v_cmp_ne_u32 vcc, 1, v232
  s_nop 4
  v_add_f32_dpp v236, v236, v236 row_ror:4 row_mask:0xf bank_mask:0xf
  v_add_f32_dpp v237, v237, v237 row_ror:4 row_mask:0xf bank_mask:0xf
  s_nop 0
  v_add_f32_dpp v236, v236, v236 row_ror:8 row_mask:0xf bank_mask:0xf
  v_add_f32_dpp v237, v237, v237 row_ror:8 row_mask:0xf bank_mask:0xf
  v_cvt_pk_bf16_f32 v233, v236, v237
  s_cbranch_vccz c_h1ok1_1_3
  s_mov_b64 exec, vcc
  buffer_load_dwordx4 v[128:131], v253, s[4:7], s40 offen offset:0 sc1
  buffer_load_dwordx4 v[132:135], v253, s[4:7], s40 offen offset:1024 sc1
  s_mov_b64 exec, -1
  s_cmp_eq_u32 s35, 0
  s_cbranch_scc1 c_h1ok1_1_3
  s_sub_u32 s35, s35, 1
  s_branch c_h1c1_1_3
w_start:
  v_and_b32 v255, 63, v0
  v_and_b32 v254, 31, v0
  v_lshrrev_b32 v253, 5, v255
  v_lshlrev_b32 v252, 4, v255
  s_branch w_map
w_exit:
  s_waitcnt vmcnt(0)
  s_endpgm
w_map:
  s_lshr_b32 s51, s32, 5
  s_sub_u32 s51, s51, 1
  s_and_b32 s52, s32, 31
  s_cmp_ge_u32 s52, 21
  s_cbranch_scc1 w_single
  s_mul_i32 s36, s51, 6
  s_add_u32 s36, s36, s52
  s_sub_u32 s36, s36, 15
  s_cmp_ge_u32 s52, 15
  s_cbranch_scc1 w_ln
  s_mul_i32 s42, s51, 15
  s_add_u32 s42, s42, s52
  s_cmp_lt_u32 s42, 96
  s_cbranch_scc1 w_kv
  s_sub_u32 s36, s42, 54
  s_cmp_lt_u32 s42, 102
  s_cbranch_scc1 w_ln
  s_mov_b32 s53, 31
  s_cmp_eq_u32 s42, 102
  s_cbranch_scc1 w_z
  s_cmp_eq_u32 s42, 103
  s_cbranch_scc1 w_init
  s_branch w_exit
w_single:
  s_sub_u32 s53, s52, 21
  s_mul_i32 s53, s53, 7
  s_add_u32 s53, s53, s51
  s_cmp_lt_u32 s53, 16
  s_cbranch_scc1 w_pqk
  s_add_u32 s53, s53, 32
  s_cmp_lt_u32 s53, 62
  s_cbranch_scc1 w_pgu
  s_sub_u32 s36, s53, 14
  s_sub_u32 s53, s53, 78
  s_cbranch_scc0 w_z
w_ln:
  s_load_dwordx2 s[16:17], s[0:1], 0
  s_mov_b32 s18, 0x200000
  s_mov_b32 s19, 0x20000
  v_lshrrev_b32 v249, 3, v255
  v_and_b32 v248, 7, v255
  v_lshlrev_b32 v247, 10, v249
  v_lshl_add_u32 v247, v248, 4, v247
  v_lshlrev_b32 v251, 4, v249
  v_lshl_add_u32 v251, v248, 9, v251
  s_lshl_b32 s42, s36, 15
  s_lshl_b32 s43, s33, 13
  s_add_u32 s43, s43, s42
  s_waitcnt lgkmcnt(0)
  buffer_load_dwordx4 v[0:3], v247, s[16:19], s43 offen offset:0
  buffer_load_dwordx4 v[4:7], v247, s[16:19], s43 offen offset:128
  buffer_load_dwordx4 v[8:11], v247, s[16:19], s43 offen offset:256
  buffer_load_dwordx4 v[12:15], v247, s[16:19], s43 offen offset:384
  buffer_load_dwordx4 v[16:19], v247, s[16:19], s43 offen offset:512
  buffer_load_dwordx4 v[20:23], v247, s[16:19], s43 offen offset:640
  buffer_load_dwordx4 v[24:27], v247, s[16:19], s43 offen offset:768
  buffer_load_dwordx4 v[28:31], v247, s[16:19], s43 offen offset:896
  s_lshl_b32 s43, s33, 7
  s_add_u32 s42, s42, s43
  s_add_u32 s42, s42, 3145728
  s_mov_b32 s44, 0xffff0000
  s_waitcnt vmcnt(7)
  v_lshlrev_b32 v32, 16, v0
  v_and_b32 v33, s44, v0
  v_mov_b64 v[96:97], v[32:33]
  v_lshlrev_b32 v34, 16, v1
  v_and_b32 v35, s44, v1
  v_pk_add_f32 v[96:97], v[96:97], v[34:35]
  v_lshlrev_b32 v36, 16, v2
  v_and_b32 v37, s44, v2
  v_pk_add_f32 v[96:97], v[96:97], v[36:37]
  v_lshlrev_b32 v38, 16, v3
  v_and_b32 v39, s44, v3
  v_pk_add_f32 v[96:97], v[96:97], v[38:39]
  s_waitcnt vmcnt(6)
  v_lshlrev_b32 v40, 16, v4
  v_and_b32 v41, s44, v4
  v_pk_add_f32 v[96:97], v[96:97], v[40:41]
  v_lshlrev_b32 v42, 16, v5
  v_and_b32 v43, s44, v5
  v_pk_add_f32 v[96:97], v[96:97], v[42:43]
  v_lshlrev_b32 v44, 16, v6
  v_and_b32 v45, s44, v6
  v_pk_add_f32 v[96:97], v[96:97], v[44:45]
  v_lshlrev_b32 v46, 16, v7
  v_and_b32 v47, s44, v7
  v_pk_add_f32 v[96:97], v[96:97], v[46:47]
  s_waitcnt vmcnt(5)
  v_lshlrev_b32 v48, 16, v8
  v_and_b32 v49, s44, v8
  v_pk_add_f32 v[96:97], v[96:97], v[48:49]
  v_lshlrev_b32 v50, 16, v9
  v_and_b32 v51, s44, v9
  v_pk_add_f32 v[96:97], v[96:97], v[50:51]
  v_lshlrev_b32 v52, 16, v10
  v_and_b32 v53, s44, v10
  v_pk_add_f32 v[96:97], v[96:97], v[52:53]
  v_lshlrev_b32 v54, 16, v11
  v_and_b32 v55, s44, v11
  v_pk_add_f32 v[96:97], v[96:97], v[54:55]
  s_waitcnt vmcnt(4)
  v_lshlrev_b32 v56, 16, v12
  v_and_b32 v57, s44, v12
  v_pk_add_f32 v[96:97], v[96:97], v[56:57]
  v_lshlrev_b32 v58, 16, v13
  v_and_b32 v59, s44, v13
  v_pk_add_f32 v[96:97], v[96:97], v[58:59]
  v_lshlrev_b32 v60, 16, v14
  v_and_b32 v61, s44, v14
  v_pk_add_f32 v[96:97], v[96:97], v[60:61]
  v_lshlrev_b32 v62, 16, v15
  v_and_b32 v63, s44, v15
  v_pk_add_f32 v[96:97], v[96:97], v[62:63]
  s_waitcnt vmcnt(3)
  v_lshlrev_b32 v64, 16, v16
  v_and_b32 v65, s44, v16
  v_pk_add_f32 v[96:97], v[96:97], v[64:65]
  v_lshlrev_b32 v66, 16, v17
  v_and_b32 v67, s44, v17
  v_pk_add_f32 v[96:97], v[96:97], v[66:67]
  v_lshlrev_b32 v68, 16, v18
  v_and_b32 v69, s44, v18
  v_pk_add_f32 v[96:97], v[96:97], v[68:69]
  v_lshlrev_b32 v70, 16, v19
  v_and_b32 v71, s44, v19
  v_pk_add_f32 v[96:97], v[96:97], v[70:71]
  s_waitcnt vmcnt(2)
  v_lshlrev_b32 v72, 16, v20
  v_and_b32 v73, s44, v20
  v_pk_add_f32 v[96:97], v[96:97], v[72:73]
  v_lshlrev_b32 v74, 16, v21
  v_and_b32 v75, s44, v21
  v_pk_add_f32 v[96:97], v[96:97], v[74:75]
  v_lshlrev_b32 v76, 16, v22
  v_and_b32 v77, s44, v22
  v_pk_add_f32 v[96:97], v[96:97], v[76:77]
  v_lshlrev_b32 v78, 16, v23
  v_and_b32 v79, s44, v23
  v_pk_add_f32 v[96:97], v[96:97], v[78:79]
  s_waitcnt vmcnt(1)
  v_lshlrev_b32 v80, 16, v24
  v_and_b32 v81, s44, v24
  v_pk_add_f32 v[96:97], v[96:97], v[80:81]
  v_lshlrev_b32 v82, 16, v25
  v_and_b32 v83, s44, v25
  v_pk_add_f32 v[96:97], v[96:97], v[82:83]
  v_lshlrev_b32 v84, 16, v26
  v_and_b32 v85, s44, v26
  v_pk_add_f32 v[96:97], v[96:97], v[84:85]
  v_lshlrev_b32 v86, 16, v27
  v_and_b32 v87, s44, v27
  v_pk_add_f32 v[96:97], v[96:97], v[86:87]
  s_waitcnt vmcnt(0)
  v_lshlrev_b32 v88, 16, v28
  v_and_b32 v89, s44, v28
  v_pk_add_f32 v[96:97], v[96:97], v[88:89]
  v_lshlrev_b32 v90, 16, v29
  v_and_b32 v91, s44, v29
  v_pk_add_f32 v[96:97], v[96:97], v[90:91]
  v_lshlrev_b32 v92, 16, v30
  v_and_b32 v93, s44, v30
  v_pk_add_f32 v[96:97], v[96:97], v[92:93]
  v_lshlrev_b32 v94, 16, v31
  v_and_b32 v95, s44, v31
  v_pk_add_f32 v[96:97], v[96:97], v[94:95]
  v_add_f32 v96, v96, v97
  s_nop 1
  v_add_f32_dpp v96, v96, v96 quad_perm:[1,0,3,2] row_mask:0xf bank_mask:0xf
  s_nop 1
  v_add_f32_dpp v96, v96, v96 quad_perm:[2,3,0,1] row_mask:0xf bank_mask:0xf
  s_nop 1
  v_add_f32_dpp v96, v96, v96 row_half_mirror row_mask:0xf bank_mask:0xf
  v_mul_f32 v96, 0xbb000000, v96
  v_mov_b32 v97, v96
  v_mov_b64 v[98:99], 0
  v_pk_add_f32 v[0:1], v[32:33], v[96:97]
  v_pk_fma_f32 v[98:99], v[0:1], v[0:1], v[98:99]
  v_pk_add_f32 v[2:3], v[34:35], v[96:97]
  v_pk_fma_f32 v[98:99], v[2:3], v[2:3], v[98:99]
  v_pk_add_f32 v[4:5], v[36:37], v[96:97]
  v_pk_fma_f32 v[98:99], v[4:5], v[4:5], v[98:99]
  v_pk_add_f32 v[6:7], v[38:39], v[96:97]
  v_pk_fma_f32 v[98:99], v[6:7], v[6:7], v[98:99]
  v_pk_add_f32 v[8:9], v[40:41], v[96:97]
  v_pk_fma_f32 v[98:99], v[8:9], v[8:9], v[98:99]
  v_pk_add_f32 v[10:11], v[42:43], v[96:97]
  v_pk_fma_f32 v[98:99], v[10:11], v[10:11], v[98:99]
  v_pk_add_f32 v[12:13], v[44:45], v[96:97]
  v_pk_fma_f32 v[98:99], v[12:13], v[12:13], v[98:99]
  v_pk_add_f32 v[14:15], v[46:47], v[96:97]
  v_pk_fma_f32 v[98:99], v[14:15], v[14:15], v[98:99]
  v_pk_add_f32 v[0:1], v[48:49], v[96:97]
  v_pk_fma_f32 v[98:99], v[0:1], v[0:1], v[98:99]
  v_pk_add_f32 v[2:3], v[50:51], v[96:97]
  v_pk_fma_f32 v[98:99], v[2:3], v[2:3], v[98:99]
  v_pk_add_f32 v[4:5], v[52:53], v[96:97]
  v_pk_fma_f32 v[98:99], v[4:5], v[4:5], v[98:99]
  v_pk_add_f32 v[6:7], v[54:55], v[96:97]
  v_pk_fma_f32 v[98:99], v[6:7], v[6:7], v[98:99]
  v_pk_add_f32 v[8:9], v[56:57], v[96:97]
  v_pk_fma_f32 v[98:99], v[8:9], v[8:9], v[98:99]
  v_pk_add_f32 v[10:11], v[58:59], v[96:97]
  v_pk_fma_f32 v[98:99], v[10:11], v[10:11], v[98:99]
  v_pk_add_f32 v[12:13], v[60:61], v[96:97]
  v_pk_fma_f32 v[98:99], v[12:13], v[12:13], v[98:99]
  v_pk_add_f32 v[14:15], v[62:63], v[96:97]
  v_pk_fma_f32 v[98:99], v[14:15], v[14:15], v[98:99]
  v_pk_add_f32 v[0:1], v[64:65], v[96:97]
  v_pk_fma_f32 v[98:99], v[0:1], v[0:1], v[98:99]
  v_pk_add_f32 v[2:3], v[66:67], v[96:97]
  v_pk_fma_f32 v[98:99], v[2:3], v[2:3], v[98:99]
  v_pk_add_f32 v[4:5], v[68:69], v[96:97]
  v_pk_fma_f32 v[98:99], v[4:5], v[4:5], v[98:99]
  v_pk_add_f32 v[6:7], v[70:71], v[96:97]
  v_pk_fma_f32 v[98:99], v[6:7], v[6:7], v[98:99]
  v_pk_add_f32 v[8:9], v[72:73], v[96:97]
  v_pk_fma_f32 v[98:99], v[8:9], v[8:9], v[98:99]
  v_pk_add_f32 v[10:11], v[74:75], v[96:97]
  v_pk_fma_f32 v[98:99], v[10:11], v[10:11], v[98:99]
  v_pk_add_f32 v[12:13], v[76:77], v[96:97]
  v_pk_fma_f32 v[98:99], v[12:13], v[12:13], v[98:99]
  v_pk_add_f32 v[14:15], v[78:79], v[96:97]
  v_pk_fma_f32 v[98:99], v[14:15], v[14:15], v[98:99]
  v_pk_add_f32 v[0:1], v[80:81], v[96:97]
  v_pk_fma_f32 v[98:99], v[0:1], v[0:1], v[98:99]
  v_pk_add_f32 v[2:3], v[82:83], v[96:97]
  v_pk_fma_f32 v[98:99], v[2:3], v[2:3], v[98:99]
  v_pk_add_f32 v[4:5], v[84:85], v[96:97]
  v_pk_fma_f32 v[98:99], v[4:5], v[4:5], v[98:99]
  v_pk_add_f32 v[6:7], v[86:87], v[96:97]
  v_pk_fma_f32 v[98:99], v[6:7], v[6:7], v[98:99]
  v_pk_add_f32 v[8:9], v[88:89], v[96:97]
  v_pk_fma_f32 v[98:99], v[8:9], v[8:9], v[98:99]
  v_pk_add_f32 v[10:11], v[90:91], v[96:97]
  v_pk_fma_f32 v[98:99], v[10:11], v[10:11], v[98:99]
  v_pk_add_f32 v[12:13], v[92:93], v[96:97]
  v_pk_fma_f32 v[98:99], v[12:13], v[12:13], v[98:99]
  v_pk_add_f32 v[14:15], v[94:95], v[96:97]
  v_pk_fma_f32 v[98:99], v[14:15], v[14:15], v[98:99]
  v_add_f32 v98, v98, v99
  s_nop 1
  v_add_f32_dpp v98, v98, v98 quad_perm:[1,0,3,2] row_mask:0xf bank_mask:0xf
  s_nop 1
  v_add_f32_dpp v98, v98, v98 quad_perm:[2,3,0,1] row_mask:0xf bank_mask:0xf
  s_nop 1
  v_add_f32_dpp v98, v98, v98 row_half_mirror row_mask:0xf bank_mask:0xf
  v_mul_f32 v98, 0x3b000000, v98
  v_cvt_pk_bf16_f32 v98, v98, v98
  v_lshlrev_b32 v98, 16, v98
  v_add_f32 v98, 0x3727c5ac, v98
  v_cvt_pk_bf16_f32 v98, v98, v98
  v_lshlrev_b32 v98, 16, v98
  v_sqrt_f32 v98, v98
  s_nop 0
  v_cvt_pk_bf16_f32 v98, v98, v98
  v_lshlrev_b32 v98, 16, v98
  v_rcp_f32 v98, v98
  v_cvt_pk_bf16_f32 v96, v96, v96
  v_lshlrev_b32 v96, 16, v96
  v_mov_b32 v97, v96
  v_mov_b32 v99, v98
  v_pk_add_f32 v[32:33], v[32:33], v[96:97]
  v_cvt_pk_bf16_f32 v33, v32, v33
  v_lshlrev_b32 v32, 16, v33
  v_and_b32 v33, s44, v33
  v_pk_mul_f32 v[32:33], v[32:33], v[98:99]
  v_cvt_pk_bf16_f32 v0, v32, v33
  v_pk_add_f32 v[34:35], v[34:35], v[96:97]
  v_cvt_pk_bf16_f32 v35, v34, v35
  v_lshlrev_b32 v34, 16, v35
  v_and_b32 v35, s44, v35
  v_pk_mul_f32 v[34:35], v[34:35], v[98:99]
  v_cvt_pk_bf16_f32 v1, v34, v35
  v_pk_add_f32 v[36:37], v[36:37], v[96:97]
  v_cvt_pk_bf16_f32 v37, v36, v37
  v_lshlrev_b32 v36, 16, v37
  v_and_b32 v37, s44, v37
  v_pk_mul_f32 v[36:37], v[36:37], v[98:99]
  v_cvt_pk_bf16_f32 v2, v36, v37
  v_pk_add_f32 v[38:39], v[38:39], v[96:97]
  v_cvt_pk_bf16_f32 v39, v38, v39
  v_lshlrev_b32 v38, 16, v39
  v_and_b32 v39, s44, v39
  v_pk_mul_f32 v[38:39], v[38:39], v[98:99]
  v_cvt_pk_bf16_f32 v3, v38, v39
  buffer_store_dwordx4 v[0:3], v251, s[4:7], s42 offen sc1
  s_add_u32 s42, s42, 4096
  v_pk_add_f32 v[40:41], v[40:41], v[96:97]
  v_cvt_pk_bf16_f32 v41, v40, v41
  v_lshlrev_b32 v40, 16, v41
  v_and_b32 v41, s44, v41
  v_pk_mul_f32 v[40:41], v[40:41], v[98:99]
  v_cvt_pk_bf16_f32 v4, v40, v41
  v_pk_add_f32 v[42:43], v[42:43], v[96:97]
  v_cvt_pk_bf16_f32 v43, v42, v43
  v_lshlrev_b32 v42, 16, v43
  v_and_b32 v43, s44, v43
  v_pk_mul_f32 v[42:43], v[42:43], v[98:99]
  v_cvt_pk_bf16_f32 v5, v42, v43
  v_pk_add_f32 v[44:45], v[44:45], v[96:97]
  v_cvt_pk_bf16_f32 v45, v44, v45
  v_lshlrev_b32 v44, 16, v45
  v_and_b32 v45, s44, v45
  v_pk_mul_f32 v[44:45], v[44:45], v[98:99]
  v_cvt_pk_bf16_f32 v6, v44, v45
  v_pk_add_f32 v[46:47], v[46:47], v[96:97]
  v_cvt_pk_bf16_f32 v47, v46, v47
  v_lshlrev_b32 v46, 16, v47
  v_and_b32 v47, s44, v47
  v_pk_mul_f32 v[46:47], v[46:47], v[98:99]
  v_cvt_pk_bf16_f32 v7, v46, v47
  buffer_store_dwordx4 v[4:7], v251, s[4:7], s42 offen sc1
  s_add_u32 s42, s42, 4096
  v_pk_add_f32 v[48:49], v[48:49], v[96:97]
  v_cvt_pk_bf16_f32 v49, v48, v49
  v_lshlrev_b32 v48, 16, v49
  v_and_b32 v49, s44, v49
  v_pk_mul_f32 v[48:49], v[48:49], v[98:99]
  v_cvt_pk_bf16_f32 v8, v48, v49
  v_pk_add_f32 v[50:51], v[50:51], v[96:97]
  v_cvt_pk_bf16_f32 v51, v50, v51
  v_lshlrev_b32 v50, 16, v51
  v_and_b32 v51, s44, v51
  v_pk_mul_f32 v[50:51], v[50:51], v[98:99]
  v_cvt_pk_bf16_f32 v9, v50, v51
  v_pk_add_f32 v[52:53], v[52:53], v[96:97]
  v_cvt_pk_bf16_f32 v53, v52, v53
  v_lshlrev_b32 v52, 16, v53
  v_and_b32 v53, s44, v53
  v_pk_mul_f32 v[52:53], v[52:53], v[98:99]
  v_cvt_pk_bf16_f32 v10, v52, v53
  v_pk_add_f32 v[54:55], v[54:55], v[96:97]
  v_cvt_pk_bf16_f32 v55, v54, v55
  v_lshlrev_b32 v54, 16, v55
  v_and_b32 v55, s44, v55
  v_pk_mul_f32 v[54:55], v[54:55], v[98:99]
  v_cvt_pk_bf16_f32 v11, v54, v55
  buffer_store_dwordx4 v[8:11], v251, s[4:7], s42 offen sc1
  s_add_u32 s42, s42, 4096
  v_pk_add_f32 v[56:57], v[56:57], v[96:97]
  v_cvt_pk_bf16_f32 v57, v56, v57
  v_lshlrev_b32 v56, 16, v57
  v_and_b32 v57, s44, v57
  v_pk_mul_f32 v[56:57], v[56:57], v[98:99]
  v_cvt_pk_bf16_f32 v12, v56, v57
  v_pk_add_f32 v[58:59], v[58:59], v[96:97]
  v_cvt_pk_bf16_f32 v59, v58, v59
  v_lshlrev_b32 v58, 16, v59
  v_and_b32 v59, s44, v59
  v_pk_mul_f32 v[58:59], v[58:59], v[98:99]
  v_cvt_pk_bf16_f32 v13, v58, v59
  v_pk_add_f32 v[60:61], v[60:61], v[96:97]
  v_cvt_pk_bf16_f32 v61, v60, v61
  v_lshlrev_b32 v60, 16, v61
  v_and_b32 v61, s44, v61
  v_pk_mul_f32 v[60:61], v[60:61], v[98:99]
  v_cvt_pk_bf16_f32 v14, v60, v61
  v_pk_add_f32 v[62:63], v[62:63], v[96:97]
  v_cvt_pk_bf16_f32 v63, v62, v63
  v_lshlrev_b32 v62, 16, v63
  v_and_b32 v63, s44, v63
  v_pk_mul_f32 v[62:63], v[62:63], v[98:99]
  v_cvt_pk_bf16_f32 v15, v62, v63
  buffer_store_dwordx4 v[12:15], v251, s[4:7], s42 offen sc1
  s_add_u32 s42, s42, 4096
  v_pk_add_f32 v[64:65], v[64:65], v[96:97]
  v_cvt_pk_bf16_f32 v65, v64, v65
  v_lshlrev_b32 v64, 16, v65
  v_and_b32 v65, s44, v65
  v_pk_mul_f32 v[64:65], v[64:65], v[98:99]
  v_cvt_pk_bf16_f32 v16, v64, v65
  v_pk_add_f32 v[66:67], v[66:67], v[96:97]
  v_cvt_pk_bf16_f32 v67, v66, v67
  v_lshlrev_b32 v66, 16, v67
  v_and_b32 v67, s44, v67
  v_pk_mul_f32 v[66:67], v[66:67], v[98:99]
  v_cvt_pk_bf16_f32 v17, v66, v67
  v_pk_add_f32 v[68:69], v[68:69], v[96:97]
  v_cvt_pk_bf16_f32 v69, v68, v69
  v_lshlrev_b32 v68, 16, v69
  v_and_b32 v69, s44, v69
  v_pk_mul_f32 v[68:69], v[68:69], v[98:99]
  v_cvt_pk_bf16_f32 v18, v68, v69
  v_pk_add_f32 v[70:71], v[70:71], v[96:97]
  v_cvt_pk_bf16_f32 v71, v70, v71
  v_lshlrev_b32 v70, 16, v71
  v_and_b32 v71, s44, v71
  v_pk_mul_f32 v[70:71], v[70:71], v[98:99]
  v_cvt_pk_bf16_f32 v19, v70, v71
  buffer_store_dwordx4 v[16:19], v251, s[4:7], s42 offen sc1
  s_add_u32 s42, s42, 4096
  v_pk_add_f32 v[72:73], v[72:73], v[96:97]
  v_cvt_pk_bf16_f32 v73, v72, v73
  v_lshlrev_b32 v72, 16, v73
  v_and_b32 v73, s44, v73
  v_pk_mul_f32 v[72:73], v[72:73], v[98:99]
  v_cvt_pk_bf16_f32 v20, v72, v73
  v_pk_add_f32 v[74:75], v[74:75], v[96:97]
  v_cvt_pk_bf16_f32 v75, v74, v75
  v_lshlrev_b32 v74, 16, v75
  v_and_b32 v75, s44, v75
  v_pk_mul_f32 v[74:75], v[74:75], v[98:99]
  v_cvt_pk_bf16_f32 v21, v74, v75
  v_pk_add_f32 v[76:77], v[76:77], v[96:97]
  v_cvt_pk_bf16_f32 v77, v76, v77
  v_lshlrev_b32 v76, 16, v77
  v_and_b32 v77, s44, v77
  v_pk_mul_f32 v[76:77], v[76:77], v[98:99]
  v_cvt_pk_bf16_f32 v22, v76, v77
  v_pk_add_f32 v[78:79], v[78:79], v[96:97]
  v_cvt_pk_bf16_f32 v79, v78, v79
  v_lshlrev_b32 v78, 16, v79
  v_and_b32 v79, s44, v79
  v_pk_mul_f32 v[78:79], v[78:79], v[98:99]
  v_cvt_pk_bf16_f32 v23, v78, v79
  buffer_store_dwordx4 v[20:23], v251, s[4:7], s42 offen sc1
  s_add_u32 s42, s42, 4096
  v_pk_add_f32 v[80:81], v[80:81], v[96:97]
  v_cvt_pk_bf16_f32 v81, v80, v81
  v_lshlrev_b32 v80, 16, v81
  v_and_b32 v81, s44, v81
  v_pk_mul_f32 v[80:81], v[80:81], v[98:99]
  v_cvt_pk_bf16_f32 v24, v80, v81
  v_pk_add_f32 v[82:83], v[82:83], v[96:97]
  v_cvt_pk_bf16_f32 v83, v82, v83
  v_lshlrev_b32 v82, 16, v83
  v_and_b32 v83, s44, v83
  v_pk_mul_f32 v[82:83], v[82:83], v[98:99]
  v_cvt_pk_bf16_f32 v25, v82, v83
  v_pk_add_f32 v[84:85], v[84:85], v[96:97]
  v_cvt_pk_bf16_f32 v85, v84, v85
  v_lshlrev_b32 v84, 16, v85
  v_and_b32 v85, s44, v85
  v_pk_mul_f32 v[84:85], v[84:85], v[98:99]
  v_cvt_pk_bf16_f32 v26, v84, v85
  v_pk_add_f32 v[86:87], v[86:87], v[96:97]
  v_cvt_pk_bf16_f32 v87, v86, v87
  v_lshlrev_b32 v86, 16, v87
  v_and_b32 v87, s44, v87
  v_pk_mul_f32 v[86:87], v[86:87], v[98:99]
  v_cvt_pk_bf16_f32 v27, v86, v87
  buffer_store_dwordx4 v[24:27], v251, s[4:7], s42 offen sc1
  s_add_u32 s42, s42, 4096
  v_pk_add_f32 v[88:89], v[88:89], v[96:97]
  v_cvt_pk_bf16_f32 v89, v88, v89
  v_lshlrev_b32 v88, 16, v89
  v_and_b32 v89, s44, v89
  v_pk_mul_f32 v[88:89], v[88:89], v[98:99]
  v_cvt_pk_bf16_f32 v28, v88, v89
  v_pk_add_f32 v[90:91], v[90:91], v[96:97]
  v_cvt_pk_bf16_f32 v91, v90, v91
  v_lshlrev_b32 v90, 16, v91
  v_and_b32 v91, s44, v91
  v_pk_mul_f32 v[90:91], v[90:91], v[98:99]
  v_cvt_pk_bf16_f32 v29, v90, v91
  v_pk_add_f32 v[92:93], v[92:93], v[96:97]
  v_cvt_pk_bf16_f32 v93, v92, v93
  v_lshlrev_b32 v92, 16, v93
  v_and_b32 v93, s44, v93
  v_pk_mul_f32 v[92:93], v[92:93], v[98:99]
  v_cvt_pk_bf16_f32 v30, v92, v93
  v_pk_add_f32 v[94:95], v[94:95], v[96:97]
  v_cvt_pk_bf16_f32 v95, v94, v95
  v_lshlrev_b32 v94, 16, v95
  v_and_b32 v95, s44, v95
  v_pk_mul_f32 v[94:95], v[94:95], v[98:99]
  v_cvt_pk_bf16_f32 v31, v94, v95
  buffer_store_dwordx4 v[28:31], v251, s[4:7], s42 offen sc1
  s_add_u32 s42, s42, 4096
  s_waitcnt vmcnt(0)
  s_barrier
  s_cmp_lg_u32 s33, 0
  s_cbranch_scc1 w_cu_50001
  v_mov_b32 v250, 1
  s_mov_b64 exec, 1
  buffer_atomic_add v250, off, s[28:31], 0 offset:132
  s_mov_b64 exec, -1
w_cu_50001:
  s_mov_b32 s53, s36
  s_cmp_lt_u32 s53, 48
  s_cbranch_scc1 w_xy
  s_sub_u32 s53, s53, 48
  s_branch w_d
w_kv:
  s_mul_i32 s53, s42, 171
  s_lshr_b32 s53, s53, 9
  s_mul_i32 s43, s53, 3
  s_sub_u32 s36, s42, s43
  s_add_u32 s53, s53, 16
  s_sub_u32 s36, s36, 1
  s_cbranch_scc0 w_ism
  s_cmp_lt_u32 s53, 32
  s_cbranch_scc1 w_pqk
  s_branch w_pv
w_ism:
  s_cmp_lt_u32 s53, 32
  s_cbranch_scc1 w_mqk
  s_branch w_mv
w_init:
  v_lshlrev_b32 v249, 7, v0
  v_mov_b32 v4, 0
  v_mov_b32 v5, 0
  v_mov_b32 v6, 0
  v_mov_b32 v7, 0
  s_mov_b32 s42, 1310720
  buffer_store_dwordx4 v[4:7], v249, s[4:7], s42 offen sc1
  s_mov_b32 s42, 1343488
  buffer_store_dwordx4 v[4:7], v249, s[4:7], s42 offen sc1
  s_waitcnt vmcnt(0)
  s_barrier
  s_cmp_lg_u32 s33, 0
  s_cbranch_scc1 w_exit
  v_mov_b32 v250, 1
  s_mov_b64 exec, 1
  buffer_store_dword v250, off, s[28:31], 0 offset:36 sc1
  s_branch w_exit
w_z:
  s_mov_b32 s2, s53
  s_load_dwordx2 s[16:17], s[0:1], 0
  s_mov_b32 s18, 0x200000
  s_mov_b32 s19, 0x20000
  s_load_dwordx2 s[20:21], s[0:1], 88
  s_mov_b32 s22, 0x200000
  s_mov_b32 s23, 0x20000
  s_lshr_b32 s36, s53, 3
  s_and_b32 s53, s53, 7
  s_lshl2_add_u32 s42, s53, s33
  s_lshl_b32 s38, s42, 10
  s_mul_i32 s43, s36, 393216
  s_add_u32 s38, s38, s43
  s_add_u32 s38, s38, 117440512
  s_lshr_b32 s43, s42, 1
  s_lshl_b32 s43, s43, 6
  s_and_b32 s42, s42, 1
  s_lshl4_add_u32 s51, s42, s43
  s_lshl_b32 s43, s36, 15
  s_add_u32 s51, s51, s43
  s_lshr_b32 s53, s53, 2
  s_and_b32 s42, s36, 1
  s_lshl1_add_u32 s42, s42, s53
  s_lshl_b32 s42, s42, 9
  s_add_u32 s49, s42, 1335296
  s_lshl_b32 s40, s53, 10
  s_add_u32 s40, s40, 1327104
  s_cmp_eq_u32 s36, 3
  s_cselect_b32 s52, 0, s36
  v_lshlrev_b32 v246, 7, v255
  v_lshlrev_b32 v251, 10, v254
  v_lshl_add_u32 v251, v253, 5, v251
  s_mov_b32 s41, 0xffff0000
  s_waitcnt lgkmcnt(0)
  v_mov_b32 v0, -1
  v_mov_b32 v1, -1
  v_mov_b32 v2, -1
  v_mov_b32 v3, -1
  s_add_u32 s42, s38, 23592960
  buffer_store_dwordx4 v[0:3], v252, s[4:7], s42 offen sc1
  s_add_u32 s42, s38, 23625728
  buffer_store_dwordx4 v[0:3], v252, s[4:7], s42 offen sc1
  s_add_u32 s42, s38, 23658496
  buffer_store_dwordx4 v[0:3], v252, s[4:7], s42 offen sc1
  s_add_u32 s42, s38, 23691264
  buffer_store_dwordx4 v[0:3], v252, s[4:7], s42 offen sc1
  s_add_u32 s42, s38, 23724032
  buffer_store_dwordx4 v[0:3], v252, s[4:7], s42 offen sc1
  s_add_u32 s42, s38, 23756800
  buffer_store_dwordx4 v[0:3], v252, s[4:7], s42 offen sc1
  s_add_u32 s42, s38, 23789568
  buffer_store_dwordx4 v[0:3], v252, s[4:7], s42 offen sc1
  s_add_u32 s42, s38, 23822336
  buffer_store_dwordx4 v[0:3], v252, s[4:7], s42 offen sc1
  s_waitcnt vmcnt(0)
  s_barrier
  s_cmp_lg_u32 s33, 0
  s_cbranch_scc1 w_cu_50002
  v_mov_b32 v250, 1
  s_mov_b64 exec, 1
  buffer_atomic_add v250, off, s[28:31], 0 offset:164
  s_mov_b64 exec, -1
w_cu_50002:
  s_cmp_lg_u32 s33, 0
  s_cbranch_scc1 w_wds_50005
  s_mov_b64 exec, 1
w_wd_50003:
  buffer_load_dword v250, off, s[28:31], 0 offset:36 sc1
  s_waitcnt vmcnt(0)
  v_readfirstlane_b32 s43, v250
  s_cmp_ge_u32 s43, 1
  s_cbranch_scc1 w_wdd_50004
  s_cmp_eq_u32 s35, 0
  s_cbranch_scc1 w_wdd_50004
  s_sub_u32 s35, s35, 1
  s_sleep 16
  s_branch w_wd_50003
w_wdd_50004:
  s_mov_b64 exec, -1
w_wds_50005:
  s_barrier
w_top_z:
  s_add_u32 s50, s36, 1
  buffer_load_dwordx4 v[48:51], v251, s[16:19], s51 offen
  s_mov_b64 exec, 0xf
w_pl_50006:
  buffer_load_dword v250, v246, s[4:7], s49 offen sc1
  s_waitcnt vmcnt(0)
  v_cmp_gt_u32 vcc, s50, v250
  s_cbranch_vccz w_pld_50007
  s_cmp_eq_u32 s35, 0
  s_cbranch_scc1 w_pld_50007
  s_sub_u32 s35, s35, 1
  s_sleep 16
  s_branch w_pl_50006
w_pld_50007:
  s_mov_b64 exec, -1
  s_add_u32 s42, s38, 262144
  buffer_load_dwordx4 v[32:35], v252, s[4:7], s42 offen sc1
  s_add_u32 s42, s38, 294912
  buffer_load_dwordx4 v[36:39], v252, s[4:7], s42 offen sc1
  s_add_u32 s42, s38, 327680
  buffer_load_dwordx4 v[40:43], v252, s[4:7], s42 offen sc1
  s_add_u32 s42, s38, 360448
  buffer_load_dwordx4 v[44:47], v252, s[4:7], s42 offen sc1
  s_waitcnt vmcnt(3)
  v_lshlrev_b32 v60, 16, v32
  v_and_b32 v61, s41, v32
  v_lshlrev_b32 v62, 16, v33
  v_and_b32 v63, s41, v33
  v_lshlrev_b32 v64, 16, v34
  v_and_b32 v65, s41, v34
  v_lshlrev_b32 v66, 16, v35
  v_and_b32 v67, s41, v35
  s_waitcnt vmcnt(2)
  v_lshlrev_b32 v68, 16, v36
  v_and_b32 v69, s41, v36
  v_lshlrev_b32 v70, 16, v37
  v_and_b32 v71, s41, v37
  v_lshlrev_b32 v72, 16, v38
  v_and_b32 v73, s41, v38
  v_lshlrev_b32 v74, 16, v39
  v_and_b32 v75, s41, v39
  v_pk_add_f32 v[60:61], v[60:61], v[68:69]
  v_pk_add_f32 v[62:63], v[62:63], v[70:71]
  v_pk_add_f32 v[64:65], v[64:65], v[72:73]
  v_pk_add_f32 v[66:67], v[66:67], v[74:75]
  s_waitcnt vmcnt(1)
  v_lshlrev_b32 v68, 16, v40
  v_and_b32 v69, s41, v40
  v_lshlrev_b32 v70, 16, v41
  v_and_b32 v71, s41, v41
  v_lshlrev_b32 v72, 16, v42
  v_and_b32 v73, s41, v42
  v_lshlrev_b32 v74, 16, v43
  v_and_b32 v75, s41, v43
  v_pk_add_f32 v[60:61], v[60:61], v[68:69]
  v_pk_add_f32 v[62:63], v[62:63], v[70:71]
  v_pk_add_f32 v[64:65], v[64:65], v[72:73]
  v_pk_add_f32 v[66:67], v[66:67], v[74:75]
  s_waitcnt vmcnt(0)
  v_lshlrev_b32 v68, 16, v44
  v_and_b32 v69, s41, v44
  v_lshlrev_b32 v70, 16, v45
  v_and_b32 v71, s41, v45
  v_lshlrev_b32 v72, 16, v46
  v_and_b32 v73, s41, v46
  v_lshlrev_b32 v74, 16, v47
  v_and_b32 v75, s41, v47
  v_pk_add_f32 v[60:61], v[60:61], v[68:69]
  v_pk_add_f32 v[62:63], v[62:63], v[70:71]
  v_pk_add_f32 v[64:65], v[64:65], v[72:73]
  v_pk_add_f32 v[66:67], v[66:67], v[74:75]
  v_cvt_pk_bf16_f32 v61, v60, v61
  v_cvt_pk_bf16_f32 v63, v62, v63
  v_cvt_pk_bf16_f32 v65, v64, v65
  v_cvt_pk_bf16_f32 v67, v66, v67
  v_lshlrev_b32 v60, 16, v61
  v_and_b32 v61, s41, v61
  v_lshlrev_b32 v62, 16, v63
  v_and_b32 v63, s41, v63
  v_lshlrev_b32 v64, 16, v65
  v_and_b32 v65, s41, v65
  v_lshlrev_b32 v66, 16, v67
  v_and_b32 v67, s41, v67
  v_lshlrev_b32 v32, 16, v48
  v_and_b32 v33, s41, v48
  v_lshlrev_b32 v34, 16, v49
  v_and_b32 v35, s41, v49
  v_lshlrev_b32 v36, 16, v50
  v_and_b32 v37, s41, v50
  v_lshlrev_b32 v38, 16, v51
  v_and_b32 v39, s41, v51
  s_lshl_b32 s44, s52, 11
  s_add_u32 s44, s44, s40
  s_cmp_ge_u32 s36, 60
  s_cbranch_scc1 w_last_z
  s_mov_b64 exec, 0xff
w_pl_50008:
  buffer_load_dword v250, v246, s[4:7], s44 offen sc1
  s_waitcnt vmcnt(0)
  v_cmp_gt_u32 vcc, s50, v250
  s_cbranch_vccz w_pld_50009
  s_cmp_eq_u32 s35, 0
  s_cbranch_scc1 w_pld_50009
  s_sub_u32 s35, s35, 1
  s_sleep 8
  s_branch w_pl_50008
w_pld_50009:
  s_mov_b64 exec, -1
w_last_z:
  s_add_u32 s42, s38, 0
  buffer_load_dwordx4 v[0:3], v252, s[4:7], s42 offen sc1
  s_add_u32 s42, s38, 32768
  buffer_load_dwordx4 v[4:7], v252, s[4:7], s42 offen sc1
  s_add_u32 s42, s38, 65536
  buffer_load_dwordx4 v[8:11], v252, s[4:7], s42 offen sc1
  s_add_u32 s42, s38, 98304
  buffer_load_dwordx4 v[12:15], v252, s[4:7], s42 offen sc1
  s_add_u32 s42, s38, 131072
  buffer_load_dwordx4 v[16:19], v252, s[4:7], s42 offen sc1
  s_add_u32 s42, s38, 163840
  buffer_load_dwordx4 v[20:23], v252, s[4:7], s42 offen sc1
  s_add_u32 s42, s38, 196608
  buffer_load_dwordx4 v[24:27], v252, s[4:7], s42 offen sc1
  s_add_u32 s42, s38, 229376
  buffer_load_dwordx4 v[28:31], v252, s[4:7], s42 offen sc1
  s_cmp_lt_u32 s36, 60
  s_cbranch_scc1 w_ok_z
  s_waitcnt vmcnt(0)
  v_max3_u32 v250, v0, v1, v2
  v_max3_u32 v250, v250, v3, v4
  v_max3_u32 v250, v250, v5, v6
  v_max3_u32 v250, v250, v7, v8
  v_max3_u32 v250, v250, v9, v10
  v_max3_u32 v250, v250, v11, v12
  v_max3_u32 v250, v250, v13, v14
  v_max3_u32 v250, v250, v15, v16
  v_max3_u32 v250, v250, v17, v18
  v_max3_u32 v250, v250, v19, v20
  v_max3_u32 v250, v250, v21, v22
  v_max3_u32 v250, v250, v23, v24
  v_max3_u32 v250, v250, v25, v26
  v_max3_u32 v250, v250, v27, v28
  v_max3_u32 v250, v250, v29, v30
  v_max_u32 v250, v250, v31
  v_cmp_eq_u32 vcc, -1, v250
  s_cbranch_vccz w_ok_z
  s_cmp_eq_u32 s35, 0
  s_cbranch_scc1 w_ok_z
  s_sub_u32 s35, s35, 1
  s_sleep 1
  s_branch w_last_z
w_ok_z:
  s_waitcnt vmcnt(7)
  v_lshlrev_b32 v52, 16, v0
  v_and_b32 v53, s41, v0
  v_lshlrev_b32 v54, 16, v1
  v_and_b32 v55, s41, v1
  v_lshlrev_b32 v56, 16, v2
  v_and_b32 v57, s41, v2
  v_lshlrev_b32 v58, 16, v3
  v_and_b32 v59, s41, v3
  s_waitcnt vmcnt(6)
  v_lshlrev_b32 v68, 16, v4
  v_and_b32 v69, s41, v4
  v_lshlrev_b32 v70, 16, v5
  v_and_b32 v71, s41, v5
  v_lshlrev_b32 v72, 16, v6
  v_and_b32 v73, s41, v6
  v_lshlrev_b32 v74, 16, v7
  v_and_b32 v75, s41, v7
  v_pk_add_f32 v[52:53], v[52:53], v[68:69]
  v_pk_add_f32 v[54:55], v[54:55], v[70:71]
  v_pk_add_f32 v[56:57], v[56:57], v[72:73]
  v_pk_add_f32 v[58:59], v[58:59], v[74:75]
  s_waitcnt vmcnt(5)
  v_lshlrev_b32 v68, 16, v8
  v_and_b32 v69, s41, v8
  v_lshlrev_b32 v70, 16, v9
  v_and_b32 v71, s41, v9
  v_lshlrev_b32 v72, 16, v10
  v_and_b32 v73, s41, v10
  v_lshlrev_b32 v74, 16, v11
  v_and_b32 v75, s41, v11
  v_pk_add_f32 v[52:53], v[52:53], v[68:69]
  v_pk_add_f32 v[54:55], v[54:55], v[70:71]
  v_pk_add_f32 v[56:57], v[56:57], v[72:73]
  v_pk_add_f32 v[58:59], v[58:59], v[74:75]
  s_waitcnt vmcnt(4)
  v_lshlrev_b32 v68, 16, v12
  v_and_b32 v69, s41, v12
  v_lshlrev_b32 v70, 16, v13
  v_and_b32 v71, s41, v13
  v_lshlrev_b32 v72, 16, v14
  v_and_b32 v73, s41, v14
  v_lshlrev_b32 v74, 16, v15
  v_and_b32 v75, s41, v15
  v_pk_add_f32 v[52:53], v[52:53], v[68:69]
  v_pk_add_f32 v[54:55], v[54:55], v[70:71]
  v_pk_add_f32 v[56:57], v[56:57], v[72:73]
  v_pk_add_f32 v[58:59], v[58:59], v[74:75]
  s_waitcnt vmcnt(3)
  v_lshlrev_b32 v68, 16, v16
  v_and_b32 v69, s41, v16
  v_lshlrev_b32 v70, 16, v17
  v_and_b32 v71, s41, v17
  v_lshlrev_b32 v72, 16, v18
  v_and_b32 v73, s41, v18
  v_lshlrev_b32 v74, 16, v19
  v_and_b32 v75, s41, v19
  v_pk_add_f32 v[52:53], v[52:53], v[68:69]
  v_pk_add_f32 v[54:55], v[54:55], v[70:71]
  v_pk_add_f32 v[56:57], v[56:57], v[72:73]
  v_pk_add_f32 v[58:59], v[58:59], v[74:75]
  s_waitcnt vmcnt(2)
  v_lshlrev_b32 v68, 16, v20
  v_and_b32 v69, s41, v20
  v_lshlrev_b32 v70, 16, v21
  v_and_b32 v71, s41, v21
  v_lshlrev_b32 v72, 16, v22
  v_and_b32 v73, s41, v22
  v_lshlrev_b32 v74, 16, v23
  v_and_b32 v75, s41, v23
  v_pk_add_f32 v[52:53], v[52:53], v[68:69]
  v_pk_add_f32 v[54:55], v[54:55], v[70:71]
  v_pk_add_f32 v[56:57], v[56:57], v[72:73]
  v_pk_add_f32 v[58:59], v[58:59], v[74:75]
  s_waitcnt vmcnt(1)
  v_lshlrev_b32 v68, 16, v24
  v_and_b32 v69, s41, v24
  v_lshlrev_b32 v70, 16, v25
  v_and_b32 v71, s41, v25
  v_lshlrev_b32 v72, 16, v26
  v_and_b32 v73, s41, v26
  v_lshlrev_b32 v74, 16, v27
  v_and_b32 v75, s41, v27
  v_pk_add_f32 v[52:53], v[52:53], v[68:69]
  v_pk_add_f32 v[54:55], v[54:55], v[70:71]
  v_pk_add_f32 v[56:57], v[56:57], v[72:73]
  v_pk_add_f32 v[58:59], v[58:59], v[74:75]
  s_waitcnt vmcnt(0)
  v_lshlrev_b32 v68, 16, v28
  v_and_b32 v69, s41, v28
  v_lshlrev_b32 v70, 16, v29
  v_and_b32 v71, s41, v29
  v_lshlrev_b32 v72, 16, v30
  v_and_b32 v73, s41, v30
  v_lshlrev_b32 v74, 16, v31
  v_and_b32 v75, s41, v31
  v_pk_add_f32 v[52:53], v[52:53], v[68:69]
  v_pk_add_f32 v[54:55], v[54:55], v[70:71]
  v_pk_add_f32 v[56:57], v[56:57], v[72:73]
  v_pk_add_f32 v[58:59], v[58:59], v[74:75]
  v_cvt_pk_bf16_f32 v53, v52, v53
  v_cvt_pk_bf16_f32 v55, v54, v55
  v_cvt_pk_bf16_f32 v57, v56, v57
  v_cvt_pk_bf16_f32 v59, v58, v59
  v_lshlrev_b32 v52, 16, v53
  v_and_b32 v53, s41, v53
  v_lshlrev_b32 v54, 16, v55
  v_and_b32 v55, s41, v55
  v_lshlrev_b32 v56, 16, v57
  v_and_b32 v57, s41, v57
  v_lshlrev_b32 v58, 16, v59
  v_and_b32 v59, s41, v59
  v_pk_add_f32 v[52:53], v[52:53], v[32:33]
  v_pk_add_f32 v[54:55], v[54:55], v[34:35]
  v_pk_add_f32 v[56:57], v[56:57], v[36:37]
  v_pk_add_f32 v[58:59], v[58:59], v[38:39]
  v_cvt_pk_bf16_f32 v53, v52, v53
  v_cvt_pk_bf16_f32 v55, v54, v55
  v_cvt_pk_bf16_f32 v57, v56, v57
  v_cvt_pk_bf16_f32 v59, v58, v59
  v_lshlrev_b32 v52, 16, v53
  v_and_b32 v53, s41, v53
  v_lshlrev_b32 v54, 16, v55
  v_and_b32 v55, s41, v55
  v_lshlrev_b32 v56, 16, v57
  v_and_b32 v57, s41, v57
  v_lshlrev_b32 v58, 16, v59
  v_and_b32 v59, s41, v59
  v_pk_add_f32 v[52:53], v[52:53], v[60:61]
  v_pk_add_f32 v[54:55], v[54:55], v[62:63]
  v_pk_add_f32 v[56:57], v[56:57], v[64:65]
  v_pk_add_f32 v[58:59], v[58:59], v[66:67]
  v_cvt_pk_bf16_f32 v68, v52, v53
  v_cvt_pk_bf16_f32 v69, v54, v55
  v_cvt_pk_bf16_f32 v70, v56, v57
  v_cvt_pk_bf16_f32 v71, v58, v59
  buffer_store_dwordx4 v[68:71], v251, s[20:23], s51 offen
  s_add_u32 s36, s36, 4
  s_add_u32 s38, s38, 1572864
  s_add_u32 s51, s51, 131072
  s_add_u32 s52, s52, 1
  s_cmp_eq_u32 s52, 3
  s_cselect_b32 s52, 0, s52
  s_cmp_lt_u32 s36, 64
  s_cbranch_scc1 w_top_z
  s_branch w_exit
w_pgu:
  s_lshl_b32 s40, s53, 7
  s_add_u32 s40, s40, 1310720
  s_mov_b32 s36, 0
  s_load_dwordx2 s[8:9], s[0:1], 64
  s_mov_b32 s10, 0x1c0000
  s_mov_b32 s11, 0x20000
  s_load_dwordx2 s[12:13], s[0:1], 72
  s_mov_b32 s14, 0x1c0000
  s_mov_b32 s15, 0x20000
  s_mov_b32 s45, 3584
  s_sub_u32 s53, s53, 48
  s_lshl2_add_u32 s42, s53, s33
  s_lshl_b32 s46, s42, 6
  s_mov_b32 s47, s46
  s_lshl_b32 s39, s42, 11
  s_add_u32 s39, s39, 100663296
  v_mov_b32 v251, v252
  s_waitcnt lgkmcnt(0)
  s_mov_b32 s38, 3145728
  s_mov_b32 s51, s39
  s_mov_b32 s39, 7340032
  s_lshl_b32 s48, s33, 15
  v_lshrrev_b32 v250, 2, v255
  v_mul_lo_u32 v250, v250, s45
  v_and_b32 v249, 3, v255
  v_lshl_add_u32 v247, v249, 4, v250
  s_lshl_b32 s44, s45, 4
  s_add_u32 m0, s48, 0
  s_nop 0
  buffer_load_dwordx4 v247, s[8:11], s46 offen lds
  s_add_u32 m0, s48, 2048
  s_nop 0
  buffer_load_dwordx4 v247, s[12:15], s46 offen lds
  s_add_u32 s46, s46, s44
  s_add_u32 m0, s48, 1024
  s_nop 0
  buffer_load_dwordx4 v247, s[8:11], s46 offen lds
  s_add_u32 m0, s48, 3072
  s_nop 0
  buffer_load_dwordx4 v247, s[12:15], s46 offen lds
  s_add_u32 s46, s46, s44
  s_add_u32 m0, s48, 4096
  s_nop 0
  buffer_load_dwordx4 v247, s[8:11], s46 offen lds
  s_add_u32 m0, s48, 6144
  s_nop 0
  buffer_load_dwordx4 v247, s[12:15], s46 offen lds
  s_add_u32 s46, s46, s44
  s_add_u32 m0, s48, 5120
  s_nop 0
  buffer_load_dwordx4 v247, s[8:11], s46 offen lds
  s_add_u32 m0, s48, 7168
  s_nop 0
  buffer_load_dwordx4 v247, s[12:15], s46 offen lds
  s_add_u32 s46, s46, s44
  s_add_u32 m0, s48, 8192
  s_nop 0
  buffer_load_dwordx4 v247, s[8:11], s46 offen lds
  s_add_u32 m0, s48, 10240
  s_nop 0
  buffer_load_dwordx4 v247, s[12:15], s46 offen lds
  s_add_u32 s46, s46, s44
  s_add_u32 m0, s48, 9216
  s_nop 0
  buffer_load_dwordx4 v247, s[8:11], s46 offen lds
  s_add_u32 m0, s48, 11264
  s_nop 0
  buffer_load_dwordx4 v247, s[12:15], s46 offen lds
  s_add_u32 s46, s46, s44
  s_add_u32 m0, s48, 12288
  s_nop 0
  buffer_load_dwordx4 v247, s[8:11], s46 offen lds
  s_add_u32 m0, s48, 14336
  s_nop 0
  buffer_load_dwordx4 v247, s[12:15], s46 offen lds
  s_add_u32 s46, s46, s44
  s_add_u32 m0, s48, 13312
  s_nop 0
  buffer_load_dwordx4 v247, s[8:11], s46 offen lds
  s_add_u32 m0, s48, 15360
  s_nop 0
  buffer_load_dwordx4 v247, s[12:15], s46 offen lds
  s_add_u32 s46, s46, s44
  s_add_u32 m0, s48, 16384
  s_nop 0
  buffer_load_dwordx4 v247, s[8:11], s46 offen lds
  s_add_u32 m0, s48, 18432
  s_nop 0
  buffer_load_dwordx4 v247, s[12:15], s46 offen lds
  s_add_u32 s46, s46, s44
  s_add_u32 m0, s48, 17408
  s_nop 0
  buffer_load_dwordx4 v247, s[8:11], s46 offen lds
  s_add_u32 m0, s48, 19456
  s_nop 0
  buffer_load_dwordx4 v247, s[12:15], s46 offen lds
  s_add_u32 s46, s46, s44
  s_add_u32 m0, s48, 20480
  s_nop 0
  buffer_load_dwordx4 v247, s[8:11], s46 offen lds
  s_add_u32 m0, s48, 22528
  s_nop 0
  buffer_load_dwordx4 v247, s[12:15], s46 offen lds
  s_add_u32 s46, s46, s44
  s_add_u32 m0, s48, 21504
  s_nop 0
  buffer_load_dwordx4 v247, s[8:11], s46 offen lds
  s_add_u32 m0, s48, 23552
  s_nop 0
  buffer_load_dwordx4 v247, s[12:15], s46 offen lds
  s_add_u32 s46, s46, s44
  s_add_u32 m0, s48, 24576
  s_nop 0
  buffer_load_dwordx4 v247, s[8:11], s46 offen lds
  s_add_u32 m0, s48, 26624
  s_nop 0
  buffer_load_dwordx4 v247, s[12:15], s46 offen lds
  s_add_u32 s46, s46, s44
  s_add_u32 m0, s48, 25600
  s_nop 0
  buffer_load_dwordx4 v247, s[8:11], s46 offen lds
  s_add_u32 m0, s48, 27648
  s_nop 0
  buffer_load_dwordx4 v247, s[12:15], s46 offen lds
  s_add_u32 s46, s46, s44
  s_add_u32 m0, s48, 28672
  s_nop 0
  buffer_load_dwordx4 v247, s[8:11], s46 offen lds
  s_add_u32 m0, s48, 30720
  s_nop 0
  buffer_load_dwordx4 v247, s[12:15], s46 offen lds
  s_add_u32 s46, s46, s44
  s_add_u32 m0, s48, 29696
  s_nop 0
  buffer_load_dwordx4 v247, s[8:11], s46 offen lds
  s_add_u32 m0, s48, 31744
  s_nop 0
  buffer_load_dwordx4 v247, s[12:15], s46 offen lds
  s_add_u32 s46, s46, s44
  v_and_b32 v249, 3, v255
  v_bfe_u32 v250, v255, 2, 2
  v_lshl_add_u32 v250, v253, 3, v250
  v_lshlrev_b32 v250, 6, v250
  v_bfe_u32 v248, v255, 4, 1
  v_lshl_add_u32 v250, v248, 5, v250
  v_lshl_add_u32 v250, v249, 3, v250
  v_add_u32 v240, s48, v250
  v_xor_b32 v241, 2048, v240
  s_waitcnt vmcnt(28)
  ds_read_b64_tr_b16 a[0:1], v240 offset:0
  ds_read_b64_tr_b16 a[2:3], v240 offset:256
  ds_read_b64_tr_b16 a[4:5], v241 offset:0
  ds_read_b64_tr_b16 a[6:7], v241 offset:256
  ds_read_b64_tr_b16 a[8:9], v240 offset:1024
  ds_read_b64_tr_b16 a[10:11], v240 offset:1280
  ds_read_b64_tr_b16 a[12:13], v241 offset:1024
  ds_read_b64_tr_b16 a[14:15], v241 offset:1280
  s_waitcnt lgkmcnt(0)
  s_add_u32 m0, s48, 0
  s_nop 0
  buffer_load_dwordx4 v247, s[8:11], s46 offen lds
  s_add_u32 m0, s48, 2048
  s_nop 0
  buffer_load_dwordx4 v247, s[12:15], s46 offen lds
  s_add_u32 s46, s46, s44
  s_add_u32 m0, s48, 1024
  s_nop 0
  buffer_load_dwordx4 v247, s[8:11], s46 offen lds
  s_add_u32 m0, s48, 3072
  s_nop 0
  buffer_load_dwordx4 v247, s[12:15], s46 offen lds
  s_add_u32 s46, s46, s44
  s_waitcnt vmcnt(28)
  ds_read_b64_tr_b16 a[16:17], v240 offset:4096
  ds_read_b64_tr_b16 a[18:19], v240 offset:4352
  ds_read_b64_tr_b16 a[20:21], v241 offset:4096
  ds_read_b64_tr_b16 a[22:23], v241 offset:4352
  ds_read_b64_tr_b16 a[24:25], v240 offset:5120
  ds_read_b64_tr_b16 a[26:27], v240 offset:5376
  ds_read_b64_tr_b16 a[28:29], v241 offset:5120
  ds_read_b64_tr_b16 a[30:31], v241 offset:5376
  s_waitcnt lgkmcnt(0)
  s_add_u32 m0, s48, 4096
  s_nop 0
  buffer_load_dwordx4 v247, s[8:11], s46 offen lds
  s_add_u32 m0, s48, 6144
  s_nop 0
  buffer_load_dwordx4 v247, s[12:15], s46 offen lds
  s_add_u32 s46, s46, s44
  s_add_u32 m0, s48, 5120
  s_nop 0
  buffer_load_dwordx4 v247, s[8:11], s46 offen lds
  s_add_u32 m0, s48, 7168
  s_nop 0
  buffer_load_dwordx4 v247, s[12:15], s46 offen lds
  s_add_u32 s46, s46, s44
  s_waitcnt vmcnt(28)
  ds_read_b64_tr_b16 a[32:33], v240 offset:8192
  ds_read_b64_tr_b16 a[34:35], v240 offset:8448
  ds_read_b64_tr_b16 a[36:37], v241 offset:8192
  ds_read_b64_tr_b16 a[38:39], v241 offset:8448
  ds_read_b64_tr_b16 a[40:41], v240 offset:9216
  ds_read_b64_tr_b16 a[42:43], v240 offset:9472
  ds_read_b64_tr_b16 a[44:45], v241 offset:9216
  ds_read_b64_tr_b16 a[46:47], v241 offset:9472
  s_waitcnt lgkmcnt(0)
  s_add_u32 m0, s48, 8192
  s_nop 0
  buffer_load_dwordx4 v247, s[8:11], s46 offen lds
  s_add_u32 m0, s48, 10240
  s_nop 0
  buffer_load_dwordx4 v247, s[12:15], s46 offen lds
  s_add_u32 s46, s46, s44
  s_add_u32 m0, s48, 9216
  s_nop 0
  buffer_load_dwordx4 v247, s[8:11], s46 offen lds
  s_add_u32 m0, s48, 11264
  s_nop 0
  buffer_load_dwordx4 v247, s[12:15], s46 offen lds
  s_add_u32 s46, s46, s44
  s_waitcnt vmcnt(28)
  ds_read_b64_tr_b16 a[48:49], v240 offset:12288
  ds_read_b64_tr_b16 a[50:51], v240 offset:12544
  ds_read_b64_tr_b16 a[52:53], v241 offset:12288
  ds_read_b64_tr_b16 a[54:55], v241 offset:12544
  ds_read_b64_tr_b16 a[56:57], v240 offset:13312
  ds_read_b64_tr_b16 a[58:59], v240 offset:13568
  ds_read_b64_tr_b16 a[60:61], v241 offset:13312
  ds_read_b64_tr_b16 a[62:63], v241 offset:13568
  s_waitcnt lgkmcnt(0)
  s_add_u32 m0, s48, 12288
  s_nop 0
  buffer_load_dwordx4 v247, s[8:11], s46 offen lds
  s_add_u32 m0, s48, 14336
  s_nop 0
  buffer_load_dwordx4 v247, s[12:15], s46 offen lds
  s_add_u32 s46, s46, s44
  s_add_u32 m0, s48, 13312
  s_nop 0
  buffer_load_dwordx4 v247, s[8:11], s46 offen lds
  s_add_u32 m0, s48, 15360
  s_nop 0
  buffer_load_dwordx4 v247, s[12:15], s46 offen lds
  s_add_u32 s46, s46, s44
  s_waitcnt vmcnt(28)
  ds_read_b64_tr_b16 a[64:65], v240 offset:16384
  ds_read_b64_tr_b16 a[66:67], v240 offset:16640
  ds_read_b64_tr_b16 a[68:69], v241 offset:16384
  ds_read_b64_tr_b16 a[70:71], v241 offset:16640
  ds_read_b64_tr_b16 a[72:73], v240 offset:17408
  ds_read_b64_tr_b16 a[74:75], v240 offset:17664
  ds_read_b64_tr_b16 a[76:77], v241 offset:17408
  ds_read_b64_tr_b16 a[78:79], v241 offset:17664
  s_waitcnt lgkmcnt(0)
  s_add_u32 m0, s48, 16384
  s_nop 0
  buffer_load_dwordx4 v247, s[8:11], s46 offen lds
  s_add_u32 m0, s48, 18432
  s_nop 0
  buffer_load_dwordx4 v247, s[12:15], s46 offen lds
  s_add_u32 s46, s46, s44
  s_add_u32 m0, s48, 17408
  s_nop 0
  buffer_load_dwordx4 v247, s[8:11], s46 offen lds
  s_add_u32 m0, s48, 19456
  s_nop 0
  buffer_load_dwordx4 v247, s[12:15], s46 offen lds
  s_add_u32 s46, s46, s44
  s_waitcnt vmcnt(28)
  ds_read_b64_tr_b16 a[80:81], v240 offset:20480
  ds_read_b64_tr_b16 a[82:83], v240 offset:20736
  ds_read_b64_tr_b16 a[84:85], v241 offset:20480
  ds_read_b64_tr_b16 a[86:87], v241 offset:20736
  ds_read_b64_tr_b16 a[88:89], v240 offset:21504
  ds_read_b64_tr_b16 a[90:91], v240 offset:21760
  ds_read_b64_tr_b16 a[92:93], v241 offset:21504
  ds_read_b64_tr_b16 a[94:95], v241 offset:21760
  s_waitcnt lgkmcnt(0)
  s_add_u32 m0, s48, 20480
  s_nop 0
  buffer_load_dwordx4 v247, s[8:11], s46 offen lds
  s_add_u32 m0, s48, 22528
  s_nop 0
  buffer_load_dwordx4 v247, s[12:15], s46 offen lds
  s_add_u32 s46, s46, s44
  s_add_u32 m0, s48, 21504
  s_nop 0
  buffer_load_dwordx4 v247, s[8:11], s46 offen lds
  s_add_u32 m0, s48, 23552
  s_nop 0
  buffer_load_dwordx4 v247, s[12:15], s46 offen lds
  s_add_u32 s46, s46, s44
  s_waitcnt vmcnt(28)
  ds_read_b64_tr_b16 a[96:97], v240 offset:24576
  ds_read_b64_tr_b16 a[98:99], v240 offset:24832
  ds_read_b64_tr_b16 a[100:101], v241 offset:24576
  ds_read_b64_tr_b16 a[102:103], v241 offset:24832
  ds_read_b64_tr_b16 a[104:105], v240 offset:25600
  ds_read_b64_tr_b16 a[106:107], v240 offset:25856
  ds_read_b64_tr_b16 a[108:109], v241 offset:25600
  ds_read_b64_tr_b16 a[110:111], v241 offset:25856
  s_waitcnt lgkmcnt(0)
  s_add_u32 m0, s48, 24576
  s_nop 0
  buffer_load_dwordx4 v247, s[8:11], s46 offen lds
  s_add_u32 m0, s48, 26624
  s_nop 0
  buffer_load_dwordx4 v247, s[12:15], s46 offen lds
  s_add_u32 s46, s46, s44
  s_add_u32 m0, s48, 25600
  s_nop 0
  buffer_load_dwordx4 v247, s[8:11], s46 offen lds
  s_add_u32 m0, s48, 27648
  s_nop 0
  buffer_load_dwordx4 v247, s[12:15], s46 offen lds
  s_add_u32 s46, s46, s44
  s_waitcnt vmcnt(28)
  ds_read_b64_tr_b16 a[112:113], v240 offset:28672
  ds_read_b64_tr_b16 a[114:115], v240 offset:28928
  ds_read_b64_tr_b16 a[116:117], v241 offset:28672
  ds_read_b64_tr_b16 a[118:119], v241 offset:28928
  ds_read_b64_tr_b16 a[120:121], v240 offset:29696
  ds_read_b64_tr_b16 a[122:123], v240 offset:29952
  ds_read_b64_tr_b16 a[124:125], v241 offset:29696
  ds_read_b64_tr_b16 a[126:127], v241 offset:29952
  s_waitcnt lgkmcnt(0)
  s_add_u32 m0, s48, 28672
  s_nop 0
  buffer_load_dwordx4 v247, s[8:11], s46 offen lds
  s_add_u32 m0, s48, 30720
  s_nop 0
  buffer_load_dwordx4 v247, s[12:15], s46 offen lds
  s_add_u32 s46, s46, s44
  s_add_u32 m0, s48, 29696
  s_nop 0
  buffer_load_dwordx4 v247, s[8:11], s46 offen lds
  s_add_u32 m0, s48, 31744
  s_nop 0
  buffer_load_dwordx4 v247, s[12:15], s46 offen lds
  s_add_u32 s46, s46, s44
  s_waitcnt vmcnt(28)
  ds_read_b64_tr_b16 a[128:129], v240 offset:0
  ds_read_b64_tr_b16 a[130:131], v240 offset:256
  ds_read_b64_tr_b16 a[132:133], v241 offset:0
  ds_read_b64_tr_b16 a[134:135], v241 offset:256
  ds_read_b64_tr_b16 a[136:137], v240 offset:1024
  ds_read_b64_tr_b16 a[138:139], v240 offset:1280
  ds_read_b64_tr_b16 a[140:141], v241 offset:1024
  ds_read_b64_tr_b16 a[142:143], v241 offset:1280
  s_waitcnt lgkmcnt(0)
  s_waitcnt vmcnt(24)
  ds_read_b64_tr_b16 a[144:145], v240 offset:4096
  ds_read_b64_tr_b16 a[146:147], v240 offset:4352
  ds_read_b64_tr_b16 a[148:149], v241 offset:4096
  ds_read_b64_tr_b16 a[150:151], v241 offset:4352
  ds_read_b64_tr_b16 a[152:153], v240 offset:5120
  ds_read_b64_tr_b16 a[154:155], v240 offset:5376
  ds_read_b64_tr_b16 a[156:157], v241 offset:5120
  ds_read_b64_tr_b16 a[158:159], v241 offset:5376
  s_waitcnt lgkmcnt(0)
  s_waitcnt vmcnt(20)
  ds_read_b64_tr_b16 a[160:161], v240 offset:8192
  ds_read_b64_tr_b16 a[162:163], v240 offset:8448
  ds_read_b64_tr_b16 a[164:165], v241 offset:8192
  ds_read_b64_tr_b16 a[166:167], v241 offset:8448
  ds_read_b64_tr_b16 a[168:169], v240 offset:9216
  ds_read_b64_tr_b16 a[170:171], v240 offset:9472
  ds_read_b64_tr_b16 a[172:173], v241 offset:9216
  ds_read_b64_tr_b16 a[174:175], v241 offset:9472
  s_waitcnt lgkmcnt(0)
  s_waitcnt vmcnt(16)
  ds_read_b64_tr_b16 a[176:177], v240 offset:12288
  ds_read_b64_tr_b16 a[178:179], v240 offset:12544
  ds_read_b64_tr_b16 a[180:181], v241 offset:12288
  ds_read_b64_tr_b16 a[182:183], v241 offset:12544
  ds_read_b64_tr_b16 a[184:185], v240 offset:13312
  ds_read_b64_tr_b16 a[186:187], v240 offset:13568
  ds_read_b64_tr_b16 a[188:189], v241 offset:13312
  ds_read_b64_tr_b16 a[190:191], v241 offset:13568
  s_waitcnt lgkmcnt(0)
  s_mov_b64 exec, 1
  buffer_load_dword v128, off, s[28:31], 0 offset:132 sc1
  buffer_load_dword v129, off, s[28:31], 0 offset:36 sc1
  s_mov_b64 exec, -1
  s_waitcnt vmcnt(12)
  ds_read_b64_tr_b16 a[192:193], v240 offset:16384
  ds_read_b64_tr_b16 a[194:195], v240 offset:16640
  ds_read_b64_tr_b16 a[196:197], v241 offset:16384
  ds_read_b64_tr_b16 a[198:199], v241 offset:16640
  ds_read_b64_tr_b16 a[200:201], v240 offset:17408
  ds_read_b64_tr_b16 a[202:203], v240 offset:17664
  ds_read_b64_tr_b16 a[204:205], v241 offset:17408
  ds_read_b64_tr_b16 a[206:207], v241 offset:17664
  s_waitcnt lgkmcnt(0)
  s_waitcnt vmcnt(8)
  ds_read_b64_tr_b16 a[208:209], v240 offset:20480
  ds_read_b64_tr_b16 a[210:211], v240 offset:20736
  ds_read_b64_tr_b16 a[212:213], v241 offset:20480
  ds_read_b64_tr_b16 a[214:215], v241 offset:20736
  ds_read_b64_tr_b16 a[216:217], v240 offset:21504
  ds_read_b64_tr_b16 a[218:219], v240 offset:21760
  ds_read_b64_tr_b16 a[220:221], v241 offset:21504
  ds_read_b64_tr_b16 a[222:223], v241 offset:21760
  s_waitcnt lgkmcnt(0)
  s_waitcnt vmcnt(4)
  ds_read_b64_tr_b16 a[224:225], v240 offset:24576
  ds_read_b64_tr_b16 a[226:227], v240 offset:24832
  ds_read_b64_tr_b16 a[228:229], v241 offset:24576
  ds_read_b64_tr_b16 a[230:231], v241 offset:24832
  ds_read_b64_tr_b16 a[232:233], v240 offset:25600
  ds_read_b64_tr_b16 a[234:235], v240 offset:25856
  ds_read_b64_tr_b16 a[236:237], v241 offset:25600
  ds_read_b64_tr_b16 a[238:239], v241 offset:25856
  s_waitcnt lgkmcnt(0)
  s_waitcnt vmcnt(0)
  ds_read_b64_tr_b16 a[240:241], v240 offset:28672
  ds_read_b64_tr_b16 a[242:243], v240 offset:28928
  ds_read_b64_tr_b16 a[244:245], v241 offset:28672
  ds_read_b64_tr_b16 a[246:247], v241 offset:28928
  ds_read_b64_tr_b16 a[248:249], v240 offset:29696
  ds_read_b64_tr_b16 a[250:251], v240 offset:29952
  ds_read_b64_tr_b16 a[252:253], v241 offset:29696
  ds_read_b64_tr_b16 a[254:255], v241 offset:29952
  s_waitcnt lgkmcnt(0)
  s_mul_i32 s42, s33, 8192
  v_add_u32 v241, s42, v252
  v_add_u32 v242, 4096, v241
  v_readfirstlane_b32 s42, v128
  v_readfirstlane_b32 s43, v129
  s_lshl_b32 s43, s43, 6
  s_and_b32 s42, s42, s43
  s_cbranch_scc1 w_go_pgu
  s_mov_b64 exec, 1
w_wd_50010:
  buffer_load_dword v250, off, s[28:31], 0 offset:132 sc1
  s_waitcnt vmcnt(0)
  v_readfirstlane_b32 s43, v250
  s_cmp_ge_u32 s43, 64
  s_cbranch_scc1 w_wdd_50011
  s_cmp_eq_u32 s35, 0
  s_cbranch_scc1 w_wdd_50011
  s_sub_u32 s35, s35, 1
  s_sleep 4
  s_branch w_wd_50010
w_wdd_50011:
  s_mov_b64 exec, -1
w_wds_50012:
  s_mov_b64 exec, 1
w_wd_50013:
  buffer_load_dword v250, off, s[28:31], 0 offset:36 sc1
  s_waitcnt vmcnt(0)
  v_readfirstlane_b32 s43, v250
  s_cmp_ge_u32 s43, 1
  s_cbranch_scc1 w_wdd_50014
  s_cmp_eq_u32 s35, 0
  s_cbranch_scc1 w_wdd_50014
  s_sub_u32 s35, s35, 1
  s_sleep 4
  s_branch w_wd_50013
w_wdd_50014:
  s_mov_b64 exec, -1
w_wds_50015:
w_go_pgu:
  buffer_load_dwordx4 v[0:3], v241, s[4:7], s38 offen offset:0 sc1
  buffer_load_dwordx4 v[4:7], v241, s[4:7], s38 offen offset:1024 sc1
  buffer_load_dwordx4 v[8:11], v241, s[4:7], s38 offen offset:2048 sc1
  buffer_load_dwordx4 v[12:15], v241, s[4:7], s38 offen offset:3072 sc1
  buffer_load_dwordx4 v[16:19], v242, s[4:7], s38 offen offset:0 sc1
  buffer_load_dwordx4 v[20:23], v242, s[4:7], s38 offen offset:1024 sc1
  buffer_load_dwordx4 v[24:27], v242, s[4:7], s38 offen offset:2048 sc1
  buffer_load_dwordx4 v[28:31], v242, s[4:7], s38 offen offset:3072 sc1
  s_barrier
  s_waitcnt vmcnt(0)
  ds_write_b128 v241, v[0:3] offset:0
  ds_write_b128 v241, v[4:7] offset:1024
  ds_write_b128 v241, v[8:11] offset:2048
  ds_write_b128 v241, v[12:15] offset:3072
  ds_write_b128 v241, v[16:19] offset:4096
  ds_write_b128 v241, v[20:23] offset:5120
  ds_write_b128 v241, v[24:27] offset:6144
  ds_write_b128 v241, v[28:31] offset:7168
  s_waitcnt lgkmcnt(0)
  s_barrier
  s_add_u32 s38, s38, 32768
  buffer_load_dwordx4 v[0:3], v241, s[4:7], s38 offen offset:0 sc1
  buffer_load_dwordx4 v[4:7], v241, s[4:7], s38 offen offset:1024 sc1
  buffer_load_dwordx4 v[8:11], v241, s[4:7], s38 offen offset:2048 sc1
  buffer_load_dwordx4 v[12:15], v241, s[4:7], s38 offen offset:3072 sc1
  buffer_load_dwordx4 v[16:19], v242, s[4:7], s38 offen offset:0 sc1
  buffer_load_dwordx4 v[20:23], v242, s[4:7], s38 offen offset:1024 sc1
  buffer_load_dwordx4 v[24:27], v242, s[4:7], s38 offen offset:2048 sc1
  buffer_load_dwordx4 v[28:31], v242, s[4:7], s38 offen offset:3072 sc1
w_top_pgu:
  ds_read_b128 v[32:35], v252 offset:0
  ds_read_b128 v[36:39], v252 offset:1024
  ds_read_b128 v[40:43], v252 offset:2048
  s_waitcnt lgkmcnt(2)
  v_mfma_f32_32x32x16_bf16 v[48:63], a[0:3], v[32:35], 0
  ds_read_b128 v[44:47], v252 offset:3072
  v_mfma_f32_32x32x16_bf16 v[64:79], a[4:7], v[32:35], 0
  s_waitcnt lgkmcnt(2)
  v_mfma_f32_32x32x16_bf16 v[48:63], a[8:11], v[36:39], v[48:63]
  ds_read_b128 v[32:35], v252 offset:4096
  v_max_f32 v96, 0, v96
  v_max_f32 v97, 0, v97
  v_cvt_pk_bf16_f32 v97, v96, v97
  v_mfma_f32_32x32x16_bf16 v[64:79], a[12:15], v[36:39], v[64:79]
  v_lshlrev_b32 v96, 16, v97
  v_and_b32 v97, 0xffff0000, v97
  v_cvt_pk_bf16_f32 v113, v112, v113
  v_lshlrev_b32 v112, 16, v113
  s_waitcnt lgkmcnt(2)
  v_mfma_f32_32x32x16_bf16 v[48:63], a[16:19], v[40:43], v[48:63]
  ds_read_b128 v[36:39], v252 offset:5120
  v_and_b32 v113, 0xffff0000, v113
  v_mul_f32 v96, v96, v112
  v_mul_f32 v97, v97, v113
  v_mfma_f32_32x32x16_bf16 v[64:79], a[20:23], v[40:43], v[64:79]
  v_cvt_pk_bf16_f32 v80, v96, v97
  v_max_f32 v98, 0, v98
  v_max_f32 v99, 0, v99
  v_cvt_pk_bf16_f32 v99, v98, v99
  s_waitcnt lgkmcnt(2)
  v_mfma_f32_32x32x16_bf16 v[48:63], a[24:27], v[44:47], v[48:63]
  ds_read_b128 v[40:43], v252 offset:6144
  v_lshlrev_b32 v98, 16, v99
  v_and_b32 v99, 0xffff0000, v99
  v_cvt_pk_bf16_f32 v115, v114, v115
  v_mfma_f32_32x32x16_bf16 v[64:79], a[28:31], v[44:47], v[64:79]
  v_lshlrev_b32 v114, 16, v115
  v_and_b32 v115, 0xffff0000, v115
  v_mul_f32 v98, v98, v114
  v_mul_f32 v99, v99, v115
  s_waitcnt lgkmcnt(2)
  v_mfma_f32_32x32x16_bf16 v[48:63], a[32:35], v[32:35], v[48:63]
  ds_read_b128 v[44:47], v252 offset:7168
  v_cvt_pk_bf16_f32 v81, v98, v99
  v_max_f32 v104, 0, v104
  v_max_f32 v105, 0, v105
  v_mfma_f32_32x32x16_bf16 v[64:79], a[36:39], v[32:35], v[64:79]
  v_cvt_pk_bf16_f32 v105, v104, v105
  v_lshlrev_b32 v104, 16, v105
  v_and_b32 v105, 0xffff0000, v105
  v_cvt_pk_bf16_f32 v121, v120, v121
  s_waitcnt lgkmcnt(2)
  v_mfma_f32_32x32x16_bf16 v[48:63], a[40:43], v[36:39], v[48:63]
  ds_read_b128 v[32:35], v252 offset:8192
  v_lshlrev_b32 v120, 16, v121
  v_and_b32 v121, 0xffff0000, v121
  v_mul_f32 v104, v104, v120
  v_mfma_f32_32x32x16_bf16 v[64:79], a[44:47], v[36:39], v[64:79]
  v_mul_f32 v105, v105, v121
  v_cvt_pk_bf16_f32 v82, v104, v105
  v_max_f32 v106, 0, v106
  v_max_f32 v107, 0, v107
  s_waitcnt lgkmcnt(2)
  v_mfma_f32_32x32x16_bf16 v[48:63], a[48:51], v[40:43], v[48:63]
  ds_read_b128 v[36:39], v252 offset:9216
  v_cvt_pk_bf16_f32 v107, v106, v107
  v_lshlrev_b32 v106, 16, v107
  v_and_b32 v107, 0xffff0000, v107
  v_mfma_f32_32x32x16_bf16 v[64:79], a[52:55], v[40:43], v[64:79]
  v_cvt_pk_bf16_f32 v123, v122, v123
  v_lshlrev_b32 v122, 16, v123
  v_and_b32 v123, 0xffff0000, v123
  v_mul_f32 v106, v106, v122
  s_waitcnt lgkmcnt(2)
  v_mfma_f32_32x32x16_bf16 v[48:63], a[56:59], v[44:47], v[48:63]
  ds_read_b128 v[40:43], v252 offset:10240
  v_mul_f32 v107, v107, v123
  v_cvt_pk_bf16_f32 v83, v106, v107
  buffer_store_dwordx4 v[80:83], v251, s[4:7], s39 offen offset:0 sc1
  v_mfma_f32_32x32x16_bf16 v[64:79], a[60:63], v[44:47], v[64:79]
  v_max_f32 v100, 0, v100
  v_max_f32 v101, 0, v101
  v_cvt_pk_bf16_f32 v101, v100, v101
  v_lshlrev_b32 v100, 16, v101
  s_waitcnt lgkmcnt(2)
  v_mfma_f32_32x32x16_bf16 v[48:63], a[64:67], v[32:35], v[48:63]
  ds_read_b128 v[44:47], v252 offset:11264
  v_and_b32 v101, 0xffff0000, v101
  v_cvt_pk_bf16_f32 v117, v116, v117
  v_lshlrev_b32 v116, 16, v117
  v_mfma_f32_32x32x16_bf16 v[64:79], a[68:71], v[32:35], v[64:79]
  v_and_b32 v117, 0xffff0000, v117
  v_mul_f32 v100, v100, v116
  v_mul_f32 v101, v101, v117
  v_cvt_pk_bf16_f32 v84, v100, v101
  s_waitcnt lgkmcnt(2)
  v_mfma_f32_32x32x16_bf16 v[48:63], a[72:75], v[36:39], v[48:63]
  ds_read_b128 v[32:35], v252 offset:12288
  v_max_f32 v102, 0, v102
  v_max_f32 v103, 0, v103
  v_cvt_pk_bf16_f32 v103, v102, v103
  v_mfma_f32_32x32x16_bf16 v[64:79], a[76:79], v[36:39], v[64:79]
  v_lshlrev_b32 v102, 16, v103
  v_and_b32 v103, 0xffff0000, v103
  v_cvt_pk_bf16_f32 v119, v118, v119
  v_lshlrev_b32 v118, 16, v119
  s_waitcnt lgkmcnt(2)
  v_mfma_f32_32x32x16_bf16 v[48:63], a[80:83], v[40:43], v[48:63]
  ds_read_b128 v[36:39], v252 offset:13312
  v_and_b32 v119, 0xffff0000, v119
  v_mul_f32 v102, v102, v118
  v_mul_f32 v103, v103, v119
  v_mfma_f32_32x32x16_bf16 v[64:79], a[84:87], v[40:43], v[64:79]
  v_cvt_pk_bf16_f32 v85, v102, v103
  v_max_f32 v108, 0, v108
  v_max_f32 v109, 0, v109
  v_cvt_pk_bf16_f32 v109, v108, v109
  s_waitcnt lgkmcnt(2)
  v_mfma_f32_32x32x16_bf16 v[48:63], a[88:91], v[44:47], v[48:63]
  ds_read_b128 v[40:43], v252 offset:14336
  v_lshlrev_b32 v108, 16, v109
  v_and_b32 v109, 0xffff0000, v109
  v_cvt_pk_bf16_f32 v125, v124, v125
  v_mfma_f32_32x32x16_bf16 v[64:79], a[92:95], v[44:47], v[64:79]
  v_lshlrev_b32 v124, 16, v125
  v_and_b32 v125, 0xffff0000, v125
  v_mul_f32 v108, v108, v124
  v_mul_f32 v109, v109, v125
  s_waitcnt lgkmcnt(2)
  v_mfma_f32_32x32x16_bf16 v[48:63], a[96:99], v[32:35], v[48:63]
  ds_read_b128 v[44:47], v252 offset:15360
  v_cvt_pk_bf16_f32 v86, v108, v109
  v_max_f32 v110, 0, v110
  v_max_f32 v111, 0, v111
  v_mfma_f32_32x32x16_bf16 v[64:79], a[100:103], v[32:35], v[64:79]
  v_cvt_pk_bf16_f32 v111, v110, v111
  v_lshlrev_b32 v110, 16, v111
  v_and_b32 v111, 0xffff0000, v111
  v_cvt_pk_bf16_f32 v127, v126, v127
  s_waitcnt lgkmcnt(2)
  v_mfma_f32_32x32x16_bf16 v[48:63], a[104:107], v[36:39], v[48:63]
  ds_read_b128 v[32:35], v252 offset:16384
  v_lshlrev_b32 v126, 16, v127
  v_and_b32 v127, 0xffff0000, v127
  v_mul_f32 v110, v110, v126
  v_mfma_f32_32x32x16_bf16 v[64:79], a[108:111], v[36:39], v[64:79]
  v_mul_f32 v111, v111, v127
  v_cvt_pk_bf16_f32 v87, v110, v111
  buffer_store_dwordx4 v[84:87], v251, s[4:7], s39 offen offset:1024 sc1
  s_waitcnt lgkmcnt(2)
  v_mfma_f32_32x32x16_bf16 v[48:63], a[112:115], v[40:43], v[48:63]
  ds_read_b128 v[36:39], v252 offset:17408
  v_mfma_f32_32x32x16_bf16 v[64:79], a[116:119], v[40:43], v[64:79]
  s_waitcnt lgkmcnt(2)
  v_mfma_f32_32x32x16_bf16 v[48:63], a[120:123], v[44:47], v[48:63]
  ds_read_b128 v[40:43], v252 offset:18432
  s_waitcnt vmcnt(2)
  s_mov_b32 s39, s51
  s_add_u32 s51, s51, 114688
  s_add_u32 s38, s38, 32768
  v_mfma_f32_32x32x16_bf16 v[64:79], a[124:127], v[44:47], v[64:79]
  ds_write_b128 v241, v[0:3] offset:32768
  s_waitcnt lgkmcnt(3)
  v_mfma_f32_32x32x16_bf16 v[48:63], a[128:131], v[32:35], v[48:63]
  ds_read_b128 v[44:47], v252 offset:19456
  ds_write_b128 v241, v[4:7] offset:33792
  v_mfma_f32_32x32x16_bf16 v[64:79], a[132:135], v[32:35], v[64:79]
  ds_write_b128 v241, v[8:11] offset:34816
  s_waitcnt lgkmcnt(5)
  v_mfma_f32_32x32x16_bf16 v[48:63], a[136:139], v[36:39], v[48:63]
  ds_read_b128 v[32:35], v252 offset:20480
  ds_write_b128 v241, v[12:15] offset:35840
  v_mfma_f32_32x32x16_bf16 v[64:79], a[140:143], v[36:39], v[64:79]
  ds_write_b128 v241, v[16:19] offset:36864
  s_waitcnt lgkmcnt(7)
  v_mfma_f32_32x32x16_bf16 v[48:63], a[144:147], v[40:43], v[48:63]
  ds_read_b128 v[36:39], v252 offset:21504
  ds_write_b128 v241, v[20:23] offset:37888
  v_mfma_f32_32x32x16_bf16 v[64:79], a[148:151], v[40:43], v[64:79]
  ds_write_b128 v241, v[24:27] offset:38912
  s_waitcnt lgkmcnt(8)
  v_mfma_f32_32x32x16_bf16 v[48:63], a[152:155], v[44:47], v[48:63]
  ds_read_b128 v[40:43], v252 offset:22528
  ds_write_b128 v241, v[28:31] offset:39936
  v_mfma_f32_32x32x16_bf16 v[64:79], a[156:159], v[44:47], v[64:79]
  s_waitcnt lgkmcnt(7)
  v_mfma_f32_32x32x16_bf16 v[48:63], a[160:163], v[32:35], v[48:63]
  ds_read_b128 v[44:47], v252 offset:23552
  v_mfma_f32_32x32x16_bf16 v[64:79], a[164:167], v[32:35], v[64:79]
  s_waitcnt lgkmcnt(5)
  v_mfma_f32_32x32x16_bf16 v[48:63], a[168:171], v[36:39], v[48:63]
  ds_read_b128 v[32:35], v252 offset:24576
  v_mfma_f32_32x32x16_bf16 v[64:79], a[172:175], v[36:39], v[64:79]
  s_waitcnt lgkmcnt(3)
  v_mfma_f32_32x32x16_bf16 v[48:63], a[176:179], v[40:43], v[48:63]
  ds_read_b128 v[36:39], v252 offset:25600
  v_mfma_f32_32x32x16_bf16 v[64:79], a[180:183], v[40:43], v[64:79]
  s_waitcnt lgkmcnt(2)
  v_mfma_f32_32x32x16_bf16 v[48:63], a[184:187], v[44:47], v[48:63]
  ds_read_b128 v[40:43], v252 offset:26624
  buffer_load_dwordx4 v[0:3], v241, s[4:7], s38 offen offset:0 sc1
  v_mfma_f32_32x32x16_bf16 v[64:79], a[188:191], v[44:47], v[64:79]
  buffer_load_dwordx4 v[4:7], v241, s[4:7], s38 offen offset:1024 sc1
  s_waitcnt lgkmcnt(2)
  v_mfma_f32_32x32x16_bf16 v[48:63], a[192:195], v[32:35], v[48:63]
  ds_read_b128 v[44:47], v252 offset:27648
  buffer_load_dwordx4 v[8:11], v241, s[4:7], s38 offen offset:2048 sc1
  v_mfma_f32_32x32x16_bf16 v[64:79], a[196:199], v[32:35], v[64:79]
  buffer_load_dwordx4 v[12:15], v241, s[4:7], s38 offen offset:3072 sc1
  s_waitcnt lgkmcnt(2)
  v_mfma_f32_32x32x16_bf16 v[48:63], a[200:203], v[36:39], v[48:63]
  ds_read_b128 v[32:35], v252 offset:28672
  buffer_load_dwordx4 v[16:19], v242, s[4:7], s38 offen offset:0 sc1
  v_mfma_f32_32x32x16_bf16 v[64:79], a[204:207], v[36:39], v[64:79]
  buffer_load_dwordx4 v[20:23], v242, s[4:7], s38 offen offset:1024 sc1
  s_waitcnt lgkmcnt(2)
  v_mfma_f32_32x32x16_bf16 v[48:63], a[208:211], v[40:43], v[48:63]
  ds_read_b128 v[36:39], v252 offset:29696
  buffer_load_dwordx4 v[24:27], v242, s[4:7], s38 offen offset:2048 sc1
  v_mfma_f32_32x32x16_bf16 v[64:79], a[212:215], v[40:43], v[64:79]
  buffer_load_dwordx4 v[28:31], v242, s[4:7], s38 offen offset:3072 sc1
  s_waitcnt lgkmcnt(2)
  v_mfma_f32_32x32x16_bf16 v[48:63], a[216:219], v[44:47], v[48:63]
  ds_read_b128 v[40:43], v252 offset:30720
  v_mfma_f32_32x32x16_bf16 v[64:79], a[220:223], v[44:47], v[64:79]
  s_waitcnt lgkmcnt(2)
  v_mfma_f32_32x32x16_bf16 v[48:63], a[224:227], v[32:35], v[48:63]
  ds_read_b128 v[44:47], v252 offset:31744
  v_mfma_f32_32x32x16_bf16 v[64:79], a[228:231], v[32:35], v[64:79]
  s_waitcnt lgkmcnt(2)
  v_mfma_f32_32x32x16_bf16 v[48:63], a[232:235], v[36:39], v[48:63]
  v_mfma_f32_32x32x16_bf16 v[64:79], a[236:239], v[36:39], v[64:79]
  s_waitcnt lgkmcnt(1)
  v_mfma_f32_32x32x16_bf16 v[48:63], a[240:243], v[40:43], v[48:63]
  v_mfma_f32_32x32x16_bf16 v[64:79], a[244:247], v[40:43], v[64:79]
  s_waitcnt lgkmcnt(0)
  v_mfma_f32_32x32x16_bf16 v[48:63], a[248:251], v[44:47], v[48:63]
  v_mfma_f32_32x32x16_bf16 v[64:79], a[252:255], v[44:47], v[64:79]
  s_waitcnt vmcnt(8) lgkmcnt(0)
  s_barrier
  s_cmp_lg_u32 s33, 0
  s_cbranch_scc1 w_fl_50016
  v_mov_b32 v250, s36
  s_mov_b64 exec, 1
  buffer_store_dword v250, off, s[4:7], s40 sc1
  s_mov_b64 exec, -1
w_fl_50016:
  s_add_u32 s36, s36, 1
  ds_read_b128 v[32:35], v252 offset:32768
  ds_read_b128 v[36:39], v252 offset:33792
  ds_read_b128 v[40:43], v252 offset:34816
  s_waitcnt lgkmcnt(2)
  v_mfma_f32_32x32x16_bf16 v[96:111], a[0:3], v[32:35], 0
  ds_read_b128 v[44:47], v252 offset:35840
  v_mfma_f32_32x32x16_bf16 v[112:127], a[4:7], v[32:35], 0
  s_waitcnt lgkmcnt(2)
  v_mfma_f32_32x32x16_bf16 v[96:111], a[8:11], v[36:39], v[96:111]
  ds_read_b128 v[32:35], v252 offset:36864
  v_max_f32 v48, 0, v48
  v_max_f32 v49, 0, v49
  v_cvt_pk_bf16_f32 v49, v48, v49
  v_mfma_f32_32x32x16_bf16 v[112:127], a[12:15], v[36:39], v[112:127]
  v_lshlrev_b32 v48, 16, v49
  v_and_b32 v49, 0xffff0000, v49
  v_cvt_pk_bf16_f32 v65, v64, v65
  v_lshlrev_b32 v64, 16, v65
  s_waitcnt lgkmcnt(2)
  v_mfma_f32_32x32x16_bf16 v[96:111], a[16:19], v[40:43], v[96:111]
  ds_read_b128 v[36:39], v252 offset:37888
  v_and_b32 v65, 0xffff0000, v65
  v_mul_f32 v48, v48, v64
  v_mul_f32 v49, v49, v65
  v_mfma_f32_32x32x16_bf16 v[112:127], a[20:23], v[40:43], v[112:127]
  v_cvt_pk_bf16_f32 v80, v48, v49
  v_max_f32 v50, 0, v50
  v_max_f32 v51, 0, v51
  v_cvt_pk_bf16_f32 v51, v50, v51
  s_waitcnt lgkmcnt(2)
  v_mfma_f32_32x32x16_bf16 v[96:111], a[24:27], v[44:47], v[96:111]
  ds_read_b128 v[40:43], v252 offset:38912
  v_lshlrev_b32 v50, 16, v51
  v_and_b32 v51, 0xffff0000, v51
  v_cvt_pk_bf16_f32 v67, v66, v67
  v_mfma_f32_32x32x16_bf16 v[112:127], a[28:31], v[44:47], v[112:127]
  v_lshlrev_b32 v66, 16, v67
  v_and_b32 v67, 0xffff0000, v67
  v_mul_f32 v50, v50, v66
  v_mul_f32 v51, v51, v67
  s_waitcnt lgkmcnt(2)
  v_mfma_f32_32x32x16_bf16 v[96:111], a[32:35], v[32:35], v[96:111]
  ds_read_b128 v[44:47], v252 offset:39936
  v_cvt_pk_bf16_f32 v81, v50, v51
  v_max_f32 v56, 0, v56
  v_max_f32 v57, 0, v57
  v_mfma_f32_32x32x16_bf16 v[112:127], a[36:39], v[32:35], v[112:127]
  v_cvt_pk_bf16_f32 v57, v56, v57
  v_lshlrev_b32 v56, 16, v57
  v_and_b32 v57, 0xffff0000, v57
  v_cvt_pk_bf16_f32 v73, v72, v73
  s_waitcnt lgkmcnt(2)
  v_mfma_f32_32x32x16_bf16 v[96:111], a[40:43], v[36:39], v[96:111]
  ds_read_b128 v[32:35], v252 offset:40960
  v_lshlrev_b32 v72, 16, v73
  v_and_b32 v73, 0xffff0000, v73
  v_mul_f32 v56, v56, v72
  v_mfma_f32_32x32x16_bf16 v[112:127], a[44:47], v[36:39], v[112:127]
  v_mul_f32 v57, v57, v73
  v_cvt_pk_bf16_f32 v82, v56, v57
  v_max_f32 v58, 0, v58
  v_max_f32 v59, 0, v59
  s_waitcnt lgkmcnt(2)
  v_mfma_f32_32x32x16_bf16 v[96:111], a[48:51], v[40:43], v[96:111]
  ds_read_b128 v[36:39], v252 offset:41984
  v_cvt_pk_bf16_f32 v59, v58, v59
  v_lshlrev_b32 v58, 16, v59
  v_and_b32 v59, 0xffff0000, v59
  v_mfma_f32_32x32x16_bf16 v[112:127], a[52:55], v[40:43], v[112:127]
  v_cvt_pk_bf16_f32 v75, v74, v75
  v_lshlrev_b32 v74, 16, v75
  v_and_b32 v75, 0xffff0000, v75
  v_mul_f32 v58, v58, v74
  s_waitcnt lgkmcnt(2)
  v_mfma_f32_32x32x16_bf16 v[96:111], a[56:59], v[44:47], v[96:111]
  ds_read_b128 v[40:43], v252 offset:43008
  v_mul_f32 v59, v59, v75
  v_cvt_pk_bf16_f32 v83, v58, v59
  buffer_store_dwordx4 v[80:83], v251, s[4:7], s39 offen offset:0 sc1
  v_mfma_f32_32x32x16_bf16 v[112:127], a[60:63], v[44:47], v[112:127]
  v_max_f32 v52, 0, v52
  v_max_f32 v53, 0, v53
  v_cvt_pk_bf16_f32 v53, v52, v53
  v_lshlrev_b32 v52, 16, v53
  s_waitcnt lgkmcnt(2)
  v_mfma_f32_32x32x16_bf16 v[96:111], a[64:67], v[32:35], v[96:111]
  ds_read_b128 v[44:47], v252 offset:44032
  v_and_b32 v53, 0xffff0000, v53
  v_cvt_pk_bf16_f32 v69, v68, v69
  v_lshlrev_b32 v68, 16, v69
  v_mfma_f32_32x32x16_bf16 v[112:127], a[68:71], v[32:35], v[112:127]
  v_and_b32 v69, 0xffff0000, v69
  v_mul_f32 v52, v52, v68
  v_mul_f32 v53, v53, v69
  v_cvt_pk_bf16_f32 v84, v52, v53
  s_waitcnt lgkmcnt(2)
  v_mfma_f32_32x32x16_bf16 v[96:111], a[72:75], v[36:39], v[96:111]
  ds_read_b128 v[32:35], v252 offset:45056
  v_max_f32 v54, 0, v54
  v_max_f32 v55, 0, v55
  v_cvt_pk_bf16_f32 v55, v54, v55
  v_mfma_f32_32x32x16_bf16 v[112:127], a[76:79], v[36:39], v[112:127]
  v_lshlrev_b32 v54, 16, v55
  v_and_b32 v55, 0xffff0000, v55
  v_cvt_pk_bf16_f32 v71, v70, v71
  v_lshlrev_b32 v70, 16, v71
  s_waitcnt lgkmcnt(2)
  v_mfma_f32_32x32x16_bf16 v[96:111], a[80:83], v[40:43], v[96:111]
  ds_read_b128 v[36:39], v252 offset:46080
  v_and_b32 v71, 0xffff0000, v71
  v_mul_f32 v54, v54, v70
  v_mul_f32 v55, v55, v71
  v_mfma_f32_32x32x16_bf16 v[112:127], a[84:87], v[40:43], v[112:127]
  v_cvt_pk_bf16_f32 v85, v54, v55
  v_max_f32 v60, 0, v60
  v_max_f32 v61, 0, v61
  v_cvt_pk_bf16_f32 v61, v60, v61
  s_waitcnt lgkmcnt(2)
  v_mfma_f32_32x32x16_bf16 v[96:111], a[88:91], v[44:47], v[96:111]
  ds_read_b128 v[40:43], v252 offset:47104
  v_lshlrev_b32 v60, 16, v61
  v_and_b32 v61, 0xffff0000, v61
  v_cvt_pk_bf16_f32 v77, v76, v77
  v_mfma_f32_32x32x16_bf16 v[112:127], a[92:95], v[44:47], v[112:127]
  v_lshlrev_b32 v76, 16, v77
  v_and_b32 v77, 0xffff0000, v77
  v_mul_f32 v60, v60, v76
  v_mul_f32 v61, v61, v77
  s_waitcnt lgkmcnt(2)
  v_mfma_f32_32x32x16_bf16 v[96:111], a[96:99], v[32:35], v[96:111]
  ds_read_b128 v[44:47], v252 offset:48128
  v_cvt_pk_bf16_f32 v86, v60, v61
  v_max_f32 v62, 0, v62
  v_max_f32 v63, 0, v63
  v_mfma_f32_32x32x16_bf16 v[112:127], a[100:103], v[32:35], v[112:127]
  v_cvt_pk_bf16_f32 v63, v62, v63
  v_lshlrev_b32 v62, 16, v63
  v_and_b32 v63, 0xffff0000, v63
  v_cvt_pk_bf16_f32 v79, v78, v79
  s_waitcnt lgkmcnt(2)
  v_mfma_f32_32x32x16_bf16 v[96:111], a[104:107], v[36:39], v[96:111]
  ds_read_b128 v[32:35], v252 offset:49152
  v_lshlrev_b32 v78, 16, v79
  v_and_b32 v79, 0xffff0000, v79
  v_mul_f32 v62, v62, v78
  v_mfma_f32_32x32x16_bf16 v[112:127], a[108:111], v[36:39], v[112:127]
  v_mul_f32 v63, v63, v79
  v_cvt_pk_bf16_f32 v87, v62, v63
  buffer_store_dwordx4 v[84:87], v251, s[4:7], s39 offen offset:1024 sc1
  s_waitcnt lgkmcnt(2)
  v_mfma_f32_32x32x16_bf16 v[96:111], a[112:115], v[40:43], v[96:111]
  ds_read_b128 v[36:39], v252 offset:50176
  v_mfma_f32_32x32x16_bf16 v[112:127], a[116:119], v[40:43], v[112:127]
  s_waitcnt lgkmcnt(2)
  v_mfma_f32_32x32x16_bf16 v[96:111], a[120:123], v[44:47], v[96:111]
  ds_read_b128 v[40:43], v252 offset:51200
  s_waitcnt vmcnt(2)
  s_mov_b32 s39, s51
  s_add_u32 s51, s51, 114688
  s_add_u32 s38, s38, 32768
  v_mfma_f32_32x32x16_bf16 v[112:127], a[124:127], v[44:47], v[112:127]
  ds_write_b128 v241, v[0:3] offset:0
  s_waitcnt lgkmcnt(3)
  v_mfma_f32_32x32x16_bf16 v[96:111], a[128:131], v[32:35], v[96:111]
  ds_read_b128 v[44:47], v252 offset:52224
  ds_write_b128 v241, v[4:7] offset:1024
  v_mfma_f32_32x32x16_bf16 v[112:127], a[132:135], v[32:35], v[112:127]
  ds_write_b128 v241, v[8:11] offset:2048
  s_waitcnt lgkmcnt(5)
  v_mfma_f32_32x32x16_bf16 v[96:111], a[136:139], v[36:39], v[96:111]
  ds_read_b128 v[32:35], v252 offset:53248
  ds_write_b128 v241, v[12:15] offset:3072
  v_mfma_f32_32x32x16_bf16 v[112:127], a[140:143], v[36:39], v[112:127]
  ds_write_b128 v241, v[16:19] offset:4096
  s_waitcnt lgkmcnt(7)
  v_mfma_f32_32x32x16_bf16 v[96:111], a[144:147], v[40:43], v[96:111]
  ds_read_b128 v[36:39], v252 offset:54272
  ds_write_b128 v241, v[20:23] offset:5120
  v_mfma_f32_32x32x16_bf16 v[112:127], a[148:151], v[40:43], v[112:127]
  ds_write_b128 v241, v[24:27] offset:6144
  s_waitcnt lgkmcnt(8)
  v_mfma_f32_32x32x16_bf16 v[96:111], a[152:155], v[44:47], v[96:111]
  ds_read_b128 v[40:43], v252 offset:55296
  ds_write_b128 v241, v[28:31] offset:7168
  v_mfma_f32_32x32x16_bf16 v[112:127], a[156:159], v[44:47], v[112:127]
  s_waitcnt lgkmcnt(7)
  v_mfma_f32_32x32x16_bf16 v[96:111], a[160:163], v[32:35], v[96:111]
  ds_read_b128 v[44:47], v252 offset:56320
  v_mfma_f32_32x32x16_bf16 v[112:127], a[164:167], v[32:35], v[112:127]
  s_waitcnt lgkmcnt(5)
  v_mfma_f32_32x32x16_bf16 v[96:111], a[168:171], v[36:39], v[96:111]
  ds_read_b128 v[32:35], v252 offset:57344
  v_mfma_f32_32x32x16_bf16 v[112:127], a[172:175], v[36:39], v[112:127]
  s_waitcnt lgkmcnt(3)
  v_mfma_f32_32x32x16_bf16 v[96:111], a[176:179], v[40:43], v[96:111]
  ds_read_b128 v[36:39], v252 offset:58368
  v_mfma_f32_32x32x16_bf16 v[112:127], a[180:183], v[40:43], v[112:127]
  s_waitcnt lgkmcnt(2)
  v_mfma_f32_32x32x16_bf16 v[96:111], a[184:187], v[44:47], v[96:111]
  ds_read_b128 v[40:43], v252 offset:59392
  buffer_load_dwordx4 v[0:3], v241, s[4:7], s38 offen offset:0 sc1
  v_mfma_f32_32x32x16_bf16 v[112:127], a[188:191], v[44:47], v[112:127]
  buffer_load_dwordx4 v[4:7], v241, s[4:7], s38 offen offset:1024 sc1
  s_waitcnt lgkmcnt(2)
  v_mfma_f32_32x32x16_bf16 v[96:111], a[192:195], v[32:35], v[96:111]
  ds_read_b128 v[44:47], v252 offset:60416
  buffer_load_dwordx4 v[8:11], v241, s[4:7], s38 offen offset:2048 sc1
  v_mfma_f32_32x32x16_bf16 v[112:127], a[196:199], v[32:35], v[112:127]
  buffer_load_dwordx4 v[12:15], v241, s[4:7], s38 offen offset:3072 sc1
  s_waitcnt lgkmcnt(2)
  v_mfma_f32_32x32x16_bf16 v[96:111], a[200:203], v[36:39], v[96:111]
  ds_read_b128 v[32:35], v252 offset:61440
  buffer_load_dwordx4 v[16:19], v242, s[4:7], s38 offen offset:0 sc1
  v_mfma_f32_32x32x16_bf16 v[112:127], a[204:207], v[36:39], v[112:127]
  buffer_load_dwordx4 v[20:23], v242, s[4:7], s38 offen offset:1024 sc1
  s_waitcnt lgkmcnt(2)
  v_mfma_f32_32x32x16_bf16 v[96:111], a[208:211], v[40:43], v[96:111]
  ds_read_b128 v[36:39], v252 offset:62464
  buffer_load_dwordx4 v[24:27], v242, s[4:7], s38 offen offset:2048 sc1
  v_mfma_f32_32x32x16_bf16 v[112:127], a[212:215], v[40:43], v[112:127]
  buffer_load_dwordx4 v[28:31], v242, s[4:7], s38 offen offset:3072 sc1
  s_waitcnt lgkmcnt(2)
  v_mfma_f32_32x32x16_bf16 v[96:111], a[216:219], v[44:47], v[96:111]
  ds_read_b128 v[40:43], v252 offset:63488
  v_mfma_f32_32x32x16_bf16 v[112:127], a[220:223], v[44:47], v[112:127]
  s_waitcnt lgkmcnt(2)
  v_mfma_f32_32x32x16_bf16 v[96:111], a[224:227], v[32:35], v[96:111]
  ds_read_b128 v[44:47], v252 offset:64512
  v_mfma_f32_32x32x16_bf16 v[112:127], a[228:231], v[32:35], v[112:127]
  s_waitcnt lgkmcnt(2)
  v_mfma_f32_32x32x16_bf16 v[96:111], a[232:235], v[36:39], v[96:111]
  v_mfma_f32_32x32x16_bf16 v[112:127], a[236:239], v[36:39], v[112:127]
  s_waitcnt lgkmcnt(1)
  v_mfma_f32_32x32x16_bf16 v[96:111], a[240:243], v[40:43], v[96:111]
  v_mfma_f32_32x32x16_bf16 v[112:127], a[244:247], v[40:43], v[112:127]
  s_waitcnt lgkmcnt(0)
  v_mfma_f32_32x32x16_bf16 v[96:111], a[248:251], v[44:47], v[96:111]
  v_mfma_f32_32x32x16_bf16 v[112:127], a[252:255], v[44:47], v[112:127]
  s_waitcnt vmcnt(8) lgkmcnt(0)
  s_barrier
  s_cmp_lg_u32 s33, 0
  s_cbranch_scc1 w_fl_50017
  v_mov_b32 v250, s36
  s_mov_b64 exec, 1
  buffer_store_dword v250, off, s[4:7], s40 sc1
  s_mov_b64 exec, -1
w_fl_50017:
  s_add_u32 s36, s36, 1
  s_cmp_lt_u32 s36, 64
  s_cbranch_scc1 w_top_pgu
  s_nop 7
  v_max_f32 v96, 0, v96
  v_max_f32 v97, 0, v97
  v_cvt_pk_bf16_f32 v97, v96, v97
  v_lshlrev_b32 v96, 16, v97
  v_and_b32 v97, 0xffff0000, v97
  v_cvt_pk_bf16_f32 v113, v112, v113
  v_lshlrev_b32 v112, 16, v113
  v_and_b32 v113, 0xffff0000, v113
  v_mul_f32 v96, v96, v112
  v_mul_f32 v97, v97, v113
  v_cvt_pk_bf16_f32 v80, v96, v97
  v_max_f32 v98, 0, v98
  v_max_f32 v99, 0, v99
  v_cvt_pk_bf16_f32 v99, v98, v99
  v_lshlrev_b32 v98, 16, v99
  v_and_b32 v99, 0xffff0000, v99
  v_cvt_pk_bf16_f32 v115, v114, v115
  v_lshlrev_b32 v114, 16, v115
  v_and_b32 v115, 0xffff0000, v115
  v_mul_f32 v98, v98, v114
  v_mul_f32 v99, v99, v115
  v_cvt_pk_bf16_f32 v81, v98, v99
  v_max_f32 v104, 0, v104
  v_max_f32 v105, 0, v105
  v_cvt_pk_bf16_f32 v105, v104, v105
  v_lshlrev_b32 v104, 16, v105
  v_and_b32 v105, 0xffff0000, v105
  v_cvt_pk_bf16_f32 v121, v120, v121
  v_lshlrev_b32 v120, 16, v121
  v_and_b32 v121, 0xffff0000, v121
  v_mul_f32 v104, v104, v120
  v_mul_f32 v105, v105, v121
  v_cvt_pk_bf16_f32 v82, v104, v105
  v_max_f32 v106, 0, v106
  v_max_f32 v107, 0, v107
  v_cvt_pk_bf16_f32 v107, v106, v107
  v_lshlrev_b32 v106, 16, v107
  v_and_b32 v107, 0xffff0000, v107
  v_cvt_pk_bf16_f32 v123, v122, v123
  v_lshlrev_b32 v122, 16, v123
  v_and_b32 v123, 0xffff0000, v123
  v_mul_f32 v106, v106, v122
  v_mul_f32 v107, v107, v123
  v_cvt_pk_bf16_f32 v83, v106, v107
  buffer_store_dwordx4 v[80:83], v251, s[4:7], s39 offen offset:0 sc1
  v_max_f32 v100, 0, v100
  v_max_f32 v101, 0, v101
  v_cvt_pk_bf16_f32 v101, v100, v101
  v_lshlrev_b32 v100, 16, v101
  v_and_b32 v101, 0xffff0000, v101
  v_cvt_pk_bf16_f32 v117, v116, v117
  v_lshlrev_b32 v116, 16, v117
  v_and_b32 v117, 0xffff0000, v117
  v_mul_f32 v100, v100, v116
  v_mul_f32 v101, v101, v117
  v_cvt_pk_bf16_f32 v84, v100, v101
  v_max_f32 v102, 0, v102
  v_max_f32 v103, 0, v103
  v_cvt_pk_bf16_f32 v103, v102, v103
  v_lshlrev_b32 v102, 16, v103
  v_and_b32 v103, 0xffff0000, v103
  v_cvt_pk_bf16_f32 v119, v118, v119
  v_lshlrev_b32 v118, 16, v119
  v_and_b32 v119, 0xffff0000, v119
  v_mul_f32 v102, v102, v118
  v_mul_f32 v103, v103, v119
  v_cvt_pk_bf16_f32 v85, v102, v103
  v_max_f32 v108, 0, v108
  v_max_f32 v109, 0, v109
  v_cvt_pk_bf16_f32 v109, v108, v109
  v_lshlrev_b32 v108, 16, v109
  v_and_b32 v109, 0xffff0000, v109
  v_cvt_pk_bf16_f32 v125, v124, v125
  v_lshlrev_b32 v124, 16, v125
  v_and_b32 v125, 0xffff0000, v125
  v_mul_f32 v108, v108, v124
  v_mul_f32 v109, v109, v125
  v_cvt_pk_bf16_f32 v86, v108, v109
  v_max_f32 v110, 0, v110
  v_max_f32 v111, 0, v111
  v_cvt_pk_bf16_f32 v111, v110, v111
  v_lshlrev_b32 v110, 16, v111
  v_and_b32 v111, 0xffff0000, v111
  v_cvt_pk_bf16_f32 v127, v126, v127
  v_lshlrev_b32 v126, 16, v127
  v_and_b32 v127, 0xffff0000, v127
  v_mul_f32 v110, v110, v126
  v_mul_f32 v111, v111, v127
  v_cvt_pk_bf16_f32 v87, v110, v111
  buffer_store_dwordx4 v[84:87], v251, s[4:7], s39 offen offset:1024 sc1
  s_mov_b32 s36, 63
  s_waitcnt vmcnt(0)
  s_barrier
  s_cmp_lg_u32 s33, 0
  s_cbranch_scc1 w_fl_50018
  s_add_u32 s42, s36, 1
  v_mov_b32 v250, s42
  s_mov_b64 exec, 1
  buffer_store_dword v250, off, s[4:7], s40 sc1
  s_mov_b64 exec, -1
w_fl_50018:
  s_branch w_exit
w_pqk:
  s_lshl_b32 s40, s53, 7
  s_add_u32 s40, s40, 1310720
  s_mov_b32 s36, 0
  s_lshr_b32 s42, s53, 4
  s_lshl_b32 s43, s42, 3
  s_add_u32 s43, s43, 16
  s_load_dwordx2 s[8:9], s[0:1], s43
  s_mov_b32 s10, 0x400000
  s_mov_b32 s11, 0x20000
  s_cmp_eq_u32 s42, 0
  s_mov_b32 s41, 0x3ef40000
  s_cselect_b32 s41, 0x3e890000, s41
  s_lshl_b32 s39, 0x1000000, s42
  s_and_b32 s53, s53, 15
  s_lshl2_add_u32 s42, s53, s33
  s_lshl_b32 s46, s42, 7
  s_add_u32 s47, s46, 64
  s_lshl_b32 s42, s42, 12
  s_add_u32 s39, s39, s42
  s_mov_b32 s45, 8192
  v_and_b32 v250, 15, v255
  v_lshlrev_b32 v251, 4, v250
  v_lshl_add_u32 v251, v253, 8, v251
  v_bfe_u32 v250, v255, 4, 1
  v_lshl_add_u32 v251, v250, 10, v251
  s_waitcnt lgkmcnt(0)
  s_mov_b32 s38, 3145728
  s_mov_b32 s51, s39
  s_mov_b32 s39, 7340032
  s_lshl_b32 s48, s33, 15
  v_lshrrev_b32 v250, 3, v255
  v_mul_lo_u32 v250, v250, s45
  v_bfe_u32 v248, v255, 4, 1
  v_lshlrev_b32 v248, 2, v248
  v_xor_b32 v249, v248, v255
  v_and_b32 v249, 7, v249
  v_lshl_add_u32 v247, v249, 4, v250
  s_lshl_b32 s44, s45, 3
  s_add_u32 m0, s48, 0
  s_nop 0
  buffer_load_dwordx4 v247, s[8:11], s46 offen lds
  s_add_u32 s46, s46, s44
  s_add_u32 m0, s48, 1024
  s_nop 0
  buffer_load_dwordx4 v247, s[8:11], s46 offen lds
  s_add_u32 s46, s46, s44
  s_add_u32 m0, s48, 2048
  s_nop 0
  buffer_load_dwordx4 v247, s[8:11], s46 offen lds
  s_add_u32 s46, s46, s44
  s_add_u32 m0, s48, 3072
  s_nop 0
  buffer_load_dwordx4 v247, s[8:11], s46 offen lds
  s_add_u32 s46, s46, s44
  s_add_u32 m0, s48, 4096
  s_nop 0
  buffer_load_dwordx4 v247, s[8:11], s46 offen lds
  s_add_u32 s46, s46, s44
  s_add_u32 m0, s48, 5120
  s_nop 0
  buffer_load_dwordx4 v247, s[8:11], s46 offen lds
  s_add_u32 s46, s46, s44
  s_add_u32 m0, s48, 6144
  s_nop 0
  buffer_load_dwordx4 v247, s[8:11], s46 offen lds
  s_add_u32 s46, s46, s44
  s_add_u32 m0, s48, 7168
  s_nop 0
  buffer_load_dwordx4 v247, s[8:11], s46 offen lds
  s_add_u32 s46, s46, s44
  s_add_u32 m0, s48, 8192
  s_nop 0
  buffer_load_dwordx4 v247, s[8:11], s46 offen lds
  s_add_u32 s46, s46, s44
  s_add_u32 m0, s48, 9216
  s_nop 0
  buffer_load_dwordx4 v247, s[8:11], s46 offen lds
  s_add_u32 s46, s46, s44
  s_add_u32 m0, s48, 10240
  s_nop 0
  buffer_load_dwordx4 v247, s[8:11], s46 offen lds
  s_add_u32 s46, s46, s44
  s_add_u32 m0, s48, 11264
  s_nop 0
  buffer_load_dwordx4 v247, s[8:11], s46 offen lds
  s_add_u32 s46, s46, s44
  s_add_u32 m0, s48, 12288
  s_nop 0
  buffer_load_dwordx4 v247, s[8:11], s46 offen lds
  s_add_u32 s46, s46, s44
  s_add_u32 m0, s48, 13312
  s_nop 0
  buffer_load_dwordx4 v247, s[8:11], s46 offen lds
  s_add_u32 s46, s46, s44
  s_add_u32 m0, s48, 14336
  s_nop 0
  buffer_load_dwordx4 v247, s[8:11], s46 offen lds
  s_add_u32 s46, s46, s44
  s_add_u32 m0, s48, 15360
  s_nop 0
  buffer_load_dwordx4 v247, s[8:11], s46 offen lds
  s_add_u32 s46, s46, s44
  s_add_u32 m0, s48, 16384
  s_nop 0
  buffer_load_dwordx4 v247, s[8:11], s46 offen lds
  s_add_u32 s46, s46, s44
  s_add_u32 m0, s48, 17408
  s_nop 0
  buffer_load_dwordx4 v247, s[8:11], s46 offen lds
  s_add_u32 s46, s46, s44
  s_add_u32 m0, s48, 18432
  s_nop 0
  buffer_load_dwordx4 v247, s[8:11], s46 offen lds
  s_add_u32 s46, s46, s44
  s_add_u32 m0, s48, 19456
  s_nop 0
  buffer_load_dwordx4 v247, s[8:11], s46 offen lds
  s_add_u32 s46, s46, s44
  s_add_u32 m0, s48, 20480
  s_nop 0
  buffer_load_dwordx4 v247, s[8:11], s46 offen lds
  s_add_u32 s46, s46, s44
  s_add_u32 m0, s48, 21504
  s_nop 0
  buffer_load_dwordx4 v247, s[8:11], s46 offen lds
  s_add_u32 s46, s46, s44
  s_add_u32 m0, s48, 22528
  s_nop 0
  buffer_load_dwordx4 v247, s[8:11], s46 offen lds
  s_add_u32 s46, s46, s44
  s_add_u32 m0, s48, 23552
  s_nop 0
  buffer_load_dwordx4 v247, s[8:11], s46 offen lds
  s_add_u32 s46, s46, s44
  s_add_u32 m0, s48, 24576
  s_nop 0
  buffer_load_dwordx4 v247, s[8:11], s46 offen lds
  s_add_u32 s46, s46, s44
  s_add_u32 m0, s48, 25600
  s_nop 0
  buffer_load_dwordx4 v247, s[8:11], s46 offen lds
  s_add_u32 s46, s46, s44
  s_add_u32 m0, s48, 26624
  s_nop 0
  buffer_load_dwordx4 v247, s[8:11], s46 offen lds
  s_add_u32 s46, s46, s44
  s_add_u32 m0, s48, 27648
  s_nop 0
  buffer_load_dwordx4 v247, s[8:11], s46 offen lds
  s_add_u32 s46, s46, s44
  s_add_u32 m0, s48, 28672
  s_nop 0
  buffer_load_dwordx4 v247, s[8:11], s46 offen lds
  s_add_u32 s46, s46, s44
  s_add_u32 m0, s48, 29696
  s_nop 0
  buffer_load_dwordx4 v247, s[8:11], s46 offen lds
  s_add_u32 s46, s46, s44
  s_add_u32 m0, s48, 30720
  s_nop 0
  buffer_load_dwordx4 v247, s[8:11], s46 offen lds
  s_add_u32 s46, s46, s44
  s_add_u32 m0, s48, 31744
  s_nop 0
  buffer_load_dwordx4 v247, s[8:11], s46 offen lds
  s_add_u32 s46, s46, s44
  v_and_b32 v249, 3, v255
  v_bfe_u32 v250, v255, 2, 2
  v_lshl_add_u32 v250, v253, 3, v250
  v_lshlrev_b32 v250, 7, v250
  v_bfe_u32 v248, v255, 4, 1
  v_lshl_add_u32 v250, v248, 5, v250
  v_lshl_add_u32 v250, v249, 3, v250
  v_bfe_u32 v248, v255, 3, 1
  v_lshl_add_u32 v250, v248, 6, v250
  v_add_u32 v240, s48, v250
  v_xor_b32 v241, 64, v240
  s_waitcnt vmcnt(28)
  ds_read_b64_tr_b16 a[0:1], v240 offset:0
  ds_read_b64_tr_b16 a[2:3], v240 offset:512
  ds_read_b64_tr_b16 a[4:5], v241 offset:0
  ds_read_b64_tr_b16 a[6:7], v241 offset:512
  ds_read_b64_tr_b16 a[8:9], v240 offset:2048
  ds_read_b64_tr_b16 a[10:11], v240 offset:2560
  ds_read_b64_tr_b16 a[12:13], v241 offset:2048
  ds_read_b64_tr_b16 a[14:15], v241 offset:2560
  s_waitcnt lgkmcnt(0)
  s_add_u32 m0, s48, 0
  s_nop 0
  buffer_load_dwordx4 v247, s[8:11], s46 offen lds
  s_add_u32 s46, s46, s44
  s_add_u32 m0, s48, 1024
  s_nop 0
  buffer_load_dwordx4 v247, s[8:11], s46 offen lds
  s_add_u32 s46, s46, s44
  s_add_u32 m0, s48, 2048
  s_nop 0
  buffer_load_dwordx4 v247, s[8:11], s46 offen lds
  s_add_u32 s46, s46, s44
  s_add_u32 m0, s48, 3072
  s_nop 0
  buffer_load_dwordx4 v247, s[8:11], s46 offen lds
  s_add_u32 s46, s46, s44
  s_waitcnt vmcnt(28)
  ds_read_b64_tr_b16 a[16:17], v240 offset:4096
  ds_read_b64_tr_b16 a[18:19], v240 offset:4608
  ds_read_b64_tr_b16 a[20:21], v241 offset:4096
  ds_read_b64_tr_b16 a[22:23], v241 offset:4608
  ds_read_b64_tr_b16 a[24:25], v240 offset:6144
  ds_read_b64_tr_b16 a[26:27], v240 offset:6656
  ds_read_b64_tr_b16 a[28:29], v241 offset:6144
  ds_read_b64_tr_b16 a[30:31], v241 offset:6656
  s_waitcnt lgkmcnt(0)
  s_add_u32 m0, s48, 4096
  s_nop 0
  buffer_load_dwordx4 v247, s[8:11], s46 offen lds
  s_add_u32 s46, s46, s44
  s_add_u32 m0, s48, 5120
  s_nop 0
  buffer_load_dwordx4 v247, s[8:11], s46 offen lds
  s_add_u32 s46, s46, s44
  s_add_u32 m0, s48, 6144
  s_nop 0
  buffer_load_dwordx4 v247, s[8:11], s46 offen lds
  s_add_u32 s46, s46, s44
  s_add_u32 m0, s48, 7168
  s_nop 0
  buffer_load_dwordx4 v247, s[8:11], s46 offen lds
  s_add_u32 s46, s46, s44
  s_waitcnt vmcnt(28)
  ds_read_b64_tr_b16 a[32:33], v240 offset:8192
  ds_read_b64_tr_b16 a[34:35], v240 offset:8704
  ds_read_b64_tr_b16 a[36:37], v241 offset:8192
  ds_read_b64_tr_b16 a[38:39], v241 offset:8704
  ds_read_b64_tr_b16 a[40:41], v240 offset:10240
  ds_read_b64_tr_b16 a[42:43], v240 offset:10752
  ds_read_b64_tr_b16 a[44:45], v241 offset:10240
  ds_read_b64_tr_b16 a[46:47], v241 offset:10752
  s_waitcnt lgkmcnt(0)
  s_add_u32 m0, s48, 8192
  s_nop 0
  buffer_load_dwordx4 v247, s[8:11], s46 offen lds
  s_add_u32 s46, s46, s44
  s_add_u32 m0, s48, 9216
  s_nop 0
  buffer_load_dwordx4 v247, s[8:11], s46 offen lds
  s_add_u32 s46, s46, s44
  s_add_u32 m0, s48, 10240
  s_nop 0
  buffer_load_dwordx4 v247, s[8:11], s46 offen lds
  s_add_u32 s46, s46, s44
  s_add_u32 m0, s48, 11264
  s_nop 0
  buffer_load_dwordx4 v247, s[8:11], s46 offen lds
  s_add_u32 s46, s46, s44
  s_waitcnt vmcnt(28)
  ds_read_b64_tr_b16 a[48:49], v240 offset:12288
  ds_read_b64_tr_b16 a[50:51], v240 offset:12800
  ds_read_b64_tr_b16 a[52:53], v241 offset:12288
  ds_read_b64_tr_b16 a[54:55], v241 offset:12800
  ds_read_b64_tr_b16 a[56:57], v240 offset:14336
  ds_read_b64_tr_b16 a[58:59], v240 offset:14848
  ds_read_b64_tr_b16 a[60:61], v241 offset:14336
  ds_read_b64_tr_b16 a[62:63], v241 offset:14848
  s_waitcnt lgkmcnt(0)
  s_add_u32 m0, s48, 12288
  s_nop 0
  buffer_load_dwordx4 v247, s[8:11], s46 offen lds
  s_add_u32 s46, s46, s44
  s_add_u32 m0, s48, 13312
  s_nop 0
  buffer_load_dwordx4 v247, s[8:11], s46 offen lds
  s_add_u32 s46, s46, s44
  s_add_u32 m0, s48, 14336
  s_nop 0
  buffer_load_dwordx4 v247, s[8:11], s46 offen lds
  s_add_u32 s46, s46, s44
  s_add_u32 m0, s48, 15360
  s_nop 0
  buffer_load_dwordx4 v247, s[8:11], s46 offen lds
  s_add_u32 s46, s46, s44
  s_waitcnt vmcnt(28)
  ds_read_b64_tr_b16 a[64:65], v240 offset:16384
  ds_read_b64_tr_b16 a[66:67], v240 offset:16896
  ds_read_b64_tr_b16 a[68:69], v241 offset:16384
  ds_read_b64_tr_b16 a[70:71], v241 offset:16896
  ds_read_b64_tr_b16 a[72:73], v240 offset:18432
  ds_read_b64_tr_b16 a[74:75], v240 offset:18944
  ds_read_b64_tr_b16 a[76:77], v241 offset:18432
  ds_read_b64_tr_b16 a[78:79], v241 offset:18944
  s_waitcnt lgkmcnt(0)
  s_add_u32 m0, s48, 16384
  s_nop 0
  buffer_load_dwordx4 v247, s[8:11], s46 offen lds
  s_add_u32 s46, s46, s44
  s_add_u32 m0, s48, 17408
  s_nop 0
  buffer_load_dwordx4 v247, s[8:11], s46 offen lds
  s_add_u32 s46, s46, s44
  s_add_u32 m0, s48, 18432
  s_nop 0
  buffer_load_dwordx4 v247, s[8:11], s46 offen lds
  s_add_u32 s46, s46, s44
  s_add_u32 m0, s48, 19456
  s_nop 0
  buffer_load_dwordx4 v247, s[8:11], s46 offen lds
  s_add_u32 s46, s46, s44
  s_waitcnt vmcnt(28)
  ds_read_b64_tr_b16 a[80:81], v240 offset:20480
  ds_read_b64_tr_b16 a[82:83], v240 offset:20992
  ds_read_b64_tr_b16 a[84:85], v241 offset:20480
  ds_read_b64_tr_b16 a[86:87], v241 offset:20992
  ds_read_b64_tr_b16 a[88:89], v240 offset:22528
  ds_read_b64_tr_b16 a[90:91], v240 offset:23040
  ds_read_b64_tr_b16 a[92:93], v241 offset:22528
  ds_read_b64_tr_b16 a[94:95], v241 offset:23040
  s_waitcnt lgkmcnt(0)
  s_add_u32 m0, s48, 20480
  s_nop 0
  buffer_load_dwordx4 v247, s[8:11], s46 offen lds
  s_add_u32 s46, s46, s44
  s_add_u32 m0, s48, 21504
  s_nop 0
  buffer_load_dwordx4 v247, s[8:11], s46 offen lds
  s_add_u32 s46, s46, s44
  s_add_u32 m0, s48, 22528
  s_nop 0
  buffer_load_dwordx4 v247, s[8:11], s46 offen lds
  s_add_u32 s46, s46, s44
  s_add_u32 m0, s48, 23552
  s_nop 0
  buffer_load_dwordx4 v247, s[8:11], s46 offen lds
  s_add_u32 s46, s46, s44
  s_waitcnt vmcnt(28)
  ds_read_b64_tr_b16 a[96:97], v240 offset:24576
  ds_read_b64_tr_b16 a[98:99], v240 offset:25088
  ds_read_b64_tr_b16 a[100:101], v241 offset:24576
  ds_read_b64_tr_b16 a[102:103], v241 offset:25088
  ds_read_b64_tr_b16 a[104:105], v240 offset:26624
  ds_read_b64_tr_b16 a[106:107], v240 offset:27136
  ds_read_b64_tr_b16 a[108:109], v241 offset:26624
  ds_read_b64_tr_b16 a[110:111], v241 offset:27136
  s_waitcnt lgkmcnt(0)
  s_add_u32 m0, s48, 24576
  s_nop 0
  buffer_load_dwordx4 v247, s[8:11], s46 offen lds
  s_add_u32 s46, s46, s44
  s_add_u32 m0, s48, 25600
  s_nop 0
  buffer_load_dwordx4 v247, s[8:11], s46 offen lds
  s_add_u32 s46, s46, s44
  s_add_u32 m0, s48, 26624
  s_nop 0
  buffer_load_dwordx4 v247, s[8:11], s46 offen lds
  s_add_u32 s46, s46, s44
  s_add_u32 m0, s48, 27648
  s_nop 0
  buffer_load_dwordx4 v247, s[8:11], s46 offen lds
  s_add_u32 s46, s46, s44
  s_waitcnt vmcnt(28)
  ds_read_b64_tr_b16 a[112:113], v240 offset:28672
  ds_read_b64_tr_b16 a[114:115], v240 offset:29184
  ds_read_b64_tr_b16 a[116:117], v241 offset:28672
  ds_read_b64_tr_b16 a[118:119], v241 offset:29184
  ds_read_b64_tr_b16 a[120:121], v240 offset:30720
  ds_read_b64_tr_b16 a[122:123], v240 offset:31232
  ds_read_b64_tr_b16 a[124:125], v241 offset:30720
  ds_read_b64_tr_b16 a[126:127], v241 offset:31232
  s_waitcnt lgkmcnt(0)
  s_add_u32 m0, s48, 28672
  s_nop 0
  buffer_load_dwordx4 v247, s[8:11], s46 offen lds
  s_add_u32 s46, s46, s44
  s_add_u32 m0, s48, 29696
  s_nop 0
  buffer_load_dwordx4 v247, s[8:11], s46 offen lds
  s_add_u32 s46, s46, s44
  s_add_u32 m0, s48, 30720
  s_nop 0
  buffer_load_dwordx4 v247, s[8:11], s46 offen lds
  s_add_u32 s46, s46, s44
  s_add_u32 m0, s48, 31744
  s_nop 0
  buffer_load_dwordx4 v247, s[8:11], s46 offen lds
  s_add_u32 s46, s46, s44
  s_waitcnt vmcnt(28)
  ds_read_b64_tr_b16 a[128:129], v240 offset:0
  ds_read_b64_tr_b16 a[130:131], v240 offset:512
  ds_read_b64_tr_b16 a[132:133], v241 offset:0
  ds_read_b64_tr_b16 a[134:135], v241 offset:512
  ds_read_b64_tr_b16 a[136:137], v240 offset:2048
  ds_read_b64_tr_b16 a[138:139], v240 offset:2560
  ds_read_b64_tr_b16 a[140:141], v241 offset:2048
  ds_read_b64_tr_b16 a[142:143], v241 offset:2560
  s_waitcnt lgkmcnt(0)
  s_waitcnt vmcnt(24)
  ds_read_b64_tr_b16 a[144:145], v240 offset:4096
  ds_read_b64_tr_b16 a[146:147], v240 offset:4608
  ds_read_b64_tr_b16 a[148:149], v241 offset:4096
  ds_read_b64_tr_b16 a[150:151], v241 offset:4608
  ds_read_b64_tr_b16 a[152:153], v240 offset:6144
  ds_read_b64_tr_b16 a[154:155], v240 offset:6656
  ds_read_b64_tr_b16 a[156:157], v241 offset:6144
  ds_read_b64_tr_b16 a[158:159], v241 offset:6656
  s_waitcnt lgkmcnt(0)
  s_waitcnt vmcnt(20)
  ds_read_b64_tr_b16 a[160:161], v240 offset:8192
  ds_read_b64_tr_b16 a[162:163], v240 offset:8704
  ds_read_b64_tr_b16 a[164:165], v241 offset:8192
  ds_read_b64_tr_b16 a[166:167], v241 offset:8704
  ds_read_b64_tr_b16 a[168:169], v240 offset:10240
  ds_read_b64_tr_b16 a[170:171], v240 offset:10752
  ds_read_b64_tr_b16 a[172:173], v241 offset:10240
  ds_read_b64_tr_b16 a[174:175], v241 offset:10752
  s_waitcnt lgkmcnt(0)
  s_waitcnt vmcnt(16)
  ds_read_b64_tr_b16 a[176:177], v240 offset:12288
  ds_read_b64_tr_b16 a[178:179], v240 offset:12800
  ds_read_b64_tr_b16 a[180:181], v241 offset:12288
  ds_read_b64_tr_b16 a[182:183], v241 offset:12800
  ds_read_b64_tr_b16 a[184:185], v240 offset:14336
  ds_read_b64_tr_b16 a[186:187], v240 offset:14848
  ds_read_b64_tr_b16 a[188:189], v241 offset:14336
  ds_read_b64_tr_b16 a[190:191], v241 offset:14848
  s_waitcnt lgkmcnt(0)
  s_mov_b64 exec, 1
  buffer_load_dword v128, off, s[28:31], 0 offset:132 sc1
  buffer_load_dword v129, off, s[28:31], 0 offset:36 sc1
  s_mov_b64 exec, -1
  s_waitcnt vmcnt(12)
  ds_read_b64_tr_b16 a[192:193], v240 offset:16384
  ds_read_b64_tr_b16 a[194:195], v240 offset:16896
  ds_read_b64_tr_b16 a[196:197], v241 offset:16384
  ds_read_b64_tr_b16 a[198:199], v241 offset:16896
  ds_read_b64_tr_b16 a[200:201], v240 offset:18432
  ds_read_b64_tr_b16 a[202:203], v240 offset:18944
  ds_read_b64_tr_b16 a[204:205], v241 offset:18432
  ds_read_b64_tr_b16 a[206:207], v241 offset:18944
  s_waitcnt lgkmcnt(0)
  s_waitcnt vmcnt(8)
  ds_read_b64_tr_b16 a[208:209], v240 offset:20480
  ds_read_b64_tr_b16 a[210:211], v240 offset:20992
  ds_read_b64_tr_b16 a[212:213], v241 offset:20480
  ds_read_b64_tr_b16 a[214:215], v241 offset:20992
  ds_read_b64_tr_b16 a[216:217], v240 offset:22528
  ds_read_b64_tr_b16 a[218:219], v240 offset:23040
  ds_read_b64_tr_b16 a[220:221], v241 offset:22528
  ds_read_b64_tr_b16 a[222:223], v241 offset:23040
  s_waitcnt lgkmcnt(0)
  s_waitcnt vmcnt(4)
  ds_read_b64_tr_b16 a[224:225], v240 offset:24576
  ds_read_b64_tr_b16 a[226:227], v240 offset:25088
  ds_read_b64_tr_b16 a[228:229], v241 offset:24576
  ds_read_b64_tr_b16 a[230:231], v241 offset:25088
  ds_read_b64_tr_b16 a[232:233], v240 offset:26624
  ds_read_b64_tr_b16 a[234:235], v240 offset:27136
  ds_read_b64_tr_b16 a[236:237], v241 offset:26624
  ds_read_b64_tr_b16 a[238:239], v241 offset:27136
  s_waitcnt lgkmcnt(0)
  s_waitcnt vmcnt(0)
  ds_read_b64_tr_b16 a[240:241], v240 offset:28672
  ds_read_b64_tr_b16 a[242:243], v240 offset:29184
  ds_read_b64_tr_b16 a[244:245], v241 offset:28672
  ds_read_b64_tr_b16 a[246:247], v241 offset:29184
  ds_read_b64_tr_b16 a[248:249], v240 offset:30720
  ds_read_b64_tr_b16 a[250:251], v240 offset:31232
  ds_read_b64_tr_b16 a[252:253], v241 offset:30720
  ds_read_b64_tr_b16 a[254:255], v241 offset:31232
  s_waitcnt lgkmcnt(0)
  s_mul_i32 s42, s33, 8192
  v_add_u32 v241, s42, v252
  v_add_u32 v242, 4096, v241
  v_readfirstlane_b32 s42, v128
  v_readfirstlane_b32 s43, v129
  s_lshl_b32 s43, s43, 6
  s_and_b32 s42, s42, s43
  s_cbranch_scc1 w_go_pqk
  s_mov_b64 exec, 1
w_wd_50019:
  buffer_load_dword v250, off, s[28:31], 0 offset:132 sc1
  s_waitcnt vmcnt(0)
  v_readfirstlane_b32 s43, v250
  s_cmp_ge_u32 s43, 64
  s_cbranch_scc1 w_wdd_50020
  s_cmp_eq_u32 s35, 0
  s_cbranch_scc1 w_wdd_50020
  s_sub_u32 s35, s35, 1
  s_sleep 4
  s_branch w_wd_50019
w_wdd_50020:
  s_mov_b64 exec, -1
w_wds_50021:
  s_mov_b64 exec, 1
w_wd_50022:
  buffer_load_dword v250, off, s[28:31], 0 offset:36 sc1
  s_waitcnt vmcnt(0)
  v_readfirstlane_b32 s43, v250
  s_cmp_ge_u32 s43, 1
  s_cbranch_scc1 w_wdd_50023
  s_cmp_eq_u32 s35, 0
  s_cbranch_scc1 w_wdd_50023
  s_sub_u32 s35, s35, 1
  s_sleep 4
  s_branch w_wd_50022
w_wdd_50023:
  s_mov_b64 exec, -1
w_wds_50024:
w_go_pqk:
  buffer_load_dwordx4 v[0:3], v241, s[4:7], s38 offen offset:0 sc1
  buffer_load_dwordx4 v[4:7], v241, s[4:7], s38 offen offset:1024 sc1
  buffer_load_dwordx4 v[8:11], v241, s[4:7], s38 offen offset:2048 sc1
  buffer_load_dwordx4 v[12:15], v241, s[4:7], s38 offen offset:3072 sc1
  buffer_load_dwordx4 v[16:19], v242, s[4:7], s38 offen offset:0 sc1
  buffer_load_dwordx4 v[20:23], v242, s[4:7], s38 offen offset:1024 sc1
  buffer_load_dwordx4 v[24:27], v242, s[4:7], s38 offen offset:2048 sc1
  buffer_load_dwordx4 v[28:31], v242, s[4:7], s38 offen offset:3072 sc1
  s_barrier
  s_waitcnt vmcnt(0)
  ds_write_b128 v241, v[0:3] offset:0
  ds_write_b128 v241, v[4:7] offset:1024
  ds_write_b128 v241, v[8:11] offset:2048
  ds_write_b128 v241, v[12:15] offset:3072
  ds_write_b128 v241, v[16:19] offset:4096
  ds_write_b128 v241, v[20:23] offset:5120
  ds_write_b128 v241, v[24:27] offset:6144
  ds_write_b128 v241, v[28:31] offset:7168
  s_waitcnt lgkmcnt(0)
  s_barrier
  s_add_u32 s38, s38, 32768
  buffer_load_dwordx4 v[0:3], v241, s[4:7], s38 offen offset:0 sc1
  buffer_load_dwordx4 v[4:7], v241, s[4:7], s38 offen offset:1024 sc1
  buffer_load_dwordx4 v[8:11], v241, s[4:7], s38 offen offset:2048 sc1
  buffer_load_dwordx4 v[12:15], v241, s[4:7], s38 offen offset:3072 sc1
  buffer_load_dwordx4 v[16:19], v242, s[4:7], s38 offen offset:0 sc1
  buffer_load_dwordx4 v[20:23], v242, s[4:7], s38 offen offset:1024 sc1
  buffer_load_dwordx4 v[24:27], v242, s[4:7], s38 offen offset:2048 sc1
  buffer_load_dwordx4 v[28:31], v242, s[4:7], s38 offen offset:3072 sc1
w_top_pqk:
  ds_read_b128 v[32:35], v252 offset:0
  ds_read_b128 v[36:39], v252 offset:1024
  ds_read_b128 v[40:43], v252 offset:2048
  s_waitcnt lgkmcnt(2)
  v_mfma_f32_32x32x16_bf16 v[48:63], a[0:3], v[32:35], 0
  ds_read_b128 v[44:47], v252 offset:3072
  v_mfma_f32_32x32x16_bf16 v[64:79], a[4:7], v[32:35], 0
  s_waitcnt lgkmcnt(2)
  v_mfma_f32_32x32x16_bf16 v[48:63], a[8:11], v[36:39], v[48:63]
  ds_read_b128 v[32:35], v252 offset:4096
  v_mul_f32 v96, s41, v96
  v_mul_f32 v97, s41, v97
  v_mul_f32 v98, s41, v98
  v_mfma_f32_32x32x16_bf16 v[64:79], a[12:15], v[36:39], v[64:79]
  v_mul_f32 v99, s41, v99
  v_cvt_pk_bf16_f32 v80, v96, v97
  v_cvt_pk_bf16_f32 v81, v98, v99
  v_mul_f32 v104, s41, v104
  s_waitcnt lgkmcnt(2)
  v_mfma_f32_32x32x16_bf16 v[48:63], a[16:19], v[40:43], v[48:63]
  ds_read_b128 v[36:39], v252 offset:5120
  v_mul_f32 v105, s41, v105
  v_mul_f32 v106, s41, v106
  v_mul_f32 v107, s41, v107
  v_mfma_f32_32x32x16_bf16 v[64:79], a[20:23], v[40:43], v[64:79]
  v_cvt_pk_bf16_f32 v82, v104, v105
  v_cvt_pk_bf16_f32 v83, v106, v107
  buffer_store_dwordx4 v[80:83], v251, s[4:7], s39 offen offset:0 sc1
  v_mul_f32 v100, s41, v100
  s_waitcnt lgkmcnt(2)
  v_mfma_f32_32x32x16_bf16 v[48:63], a[24:27], v[44:47], v[48:63]
  ds_read_b128 v[40:43], v252 offset:6144
  v_mul_f32 v101, s41, v101
  v_mul_f32 v102, s41, v102
  v_mul_f32 v103, s41, v103
  v_mfma_f32_32x32x16_bf16 v[64:79], a[28:31], v[44:47], v[64:79]
  v_cvt_pk_bf16_f32 v84, v100, v101
  v_cvt_pk_bf16_f32 v85, v102, v103
  v_mul_f32 v108, s41, v108
  v_mul_f32 v109, s41, v109
  s_waitcnt lgkmcnt(2)
  v_mfma_f32_32x32x16_bf16 v[48:63], a[32:35], v[32:35], v[48:63]
  ds_read_b128 v[44:47], v252 offset:7168
  v_mul_f32 v110, s41, v110
  v_mul_f32 v111, s41, v111
  v_cvt_pk_bf16_f32 v86, v108, v109
  v_mfma_f32_32x32x16_bf16 v[64:79], a[36:39], v[32:35], v[64:79]
  v_cvt_pk_bf16_f32 v87, v110, v111
  buffer_store_dwordx4 v[84:87], v251, s[4:7], s39 offen offset:512 sc1
  v_mul_f32 v112, s41, v112
  v_mul_f32 v113, s41, v113
  s_waitcnt lgkmcnt(2)
  v_mfma_f32_32x32x16_bf16 v[48:63], a[40:43], v[36:39], v[48:63]
  ds_read_b128 v[32:35], v252 offset:8192
  v_mul_f32 v114, s41, v114
  v_mul_f32 v115, s41, v115
  v_cvt_pk_bf16_f32 v88, v112, v113
  v_mfma_f32_32x32x16_bf16 v[64:79], a[44:47], v[36:39], v[64:79]
  v_cvt_pk_bf16_f32 v89, v114, v115
  v_mul_f32 v120, s41, v120
  v_mul_f32 v121, s41, v121
  v_mul_f32 v122, s41, v122
  s_waitcnt lgkmcnt(2)
  v_mfma_f32_32x32x16_bf16 v[48:63], a[48:51], v[40:43], v[48:63]
  ds_read_b128 v[36:39], v252 offset:9216
  v_mul_f32 v123, s41, v123
  v_cvt_pk_bf16_f32 v90, v120, v121
  v_cvt_pk_bf16_f32 v91, v122, v123
  v_mfma_f32_32x32x16_bf16 v[64:79], a[52:55], v[40:43], v[64:79]
  buffer_store_dwordx4 v[88:91], v251, s[4:7], s39 offen offset:2048 sc1
  v_mul_f32 v116, s41, v116
  v_mul_f32 v117, s41, v117
  v_mul_f32 v118, s41, v118
  s_waitcnt lgkmcnt(2)
  v_mfma_f32_32x32x16_bf16 v[48:63], a[56:59], v[44:47], v[48:63]
  ds_read_b128 v[40:43], v252 offset:10240
  v_mul_f32 v119, s41, v119
  v_cvt_pk_bf16_f32 v92, v116, v117
  v_cvt_pk_bf16_f32 v93, v118, v119
  v_mfma_f32_32x32x16_bf16 v[64:79], a[60:63], v[44:47], v[64:79]
  v_mul_f32 v124, s41, v124
  v_mul_f32 v125, s41, v125
  v_mul_f32 v126, s41, v126
  v_mul_f32 v127, s41, v127
  s_waitcnt lgkmcnt(2)
  v_mfma_f32_32x32x16_bf16 v[48:63], a[64:67], v[32:35], v[48:63]
  ds_read_b128 v[44:47], v252 offset:11264
  v_cvt_pk_bf16_f32 v94, v124, v125
  v_cvt_pk_bf16_f32 v95, v126, v127
  buffer_store_dwordx4 v[92:95], v251, s[4:7], s39 offen offset:2560 sc1
  v_mfma_f32_32x32x16_bf16 v[64:79], a[68:71], v[32:35], v[64:79]
  s_waitcnt lgkmcnt(2)
  v_mfma_f32_32x32x16_bf16 v[48:63], a[72:75], v[36:39], v[48:63]
  ds_read_b128 v[32:35], v252 offset:12288
  v_mfma_f32_32x32x16_bf16 v[64:79], a[76:79], v[36:39], v[64:79]
  s_waitcnt lgkmcnt(2)
  v_mfma_f32_32x32x16_bf16 v[48:63], a[80:83], v[40:43], v[48:63]
  ds_read_b128 v[36:39], v252 offset:13312
  v_mfma_f32_32x32x16_bf16 v[64:79], a[84:87], v[40:43], v[64:79]
  s_waitcnt lgkmcnt(2)
  v_mfma_f32_32x32x16_bf16 v[48:63], a[88:91], v[44:47], v[48:63]
  ds_read_b128 v[40:43], v252 offset:14336
  v_mfma_f32_32x32x16_bf16 v[64:79], a[92:95], v[44:47], v[64:79]
  s_waitcnt lgkmcnt(2)
  v_mfma_f32_32x32x16_bf16 v[48:63], a[96:99], v[32:35], v[48:63]
  ds_read_b128 v[44:47], v252 offset:15360
  v_mfma_f32_32x32x16_bf16 v[64:79], a[100:103], v[32:35], v[64:79]
  s_waitcnt lgkmcnt(2)
  v_mfma_f32_32x32x16_bf16 v[48:63], a[104:107], v[36:39], v[48:63]
  ds_read_b128 v[32:35], v252 offset:16384
  v_mfma_f32_32x32x16_bf16 v[64:79], a[108:111], v[36:39], v[64:79]
  s_waitcnt lgkmcnt(2)
  v_mfma_f32_32x32x16_bf16 v[48:63], a[112:115], v[40:43], v[48:63]
  ds_read_b128 v[36:39], v252 offset:17408
  v_mfma_f32_32x32x16_bf16 v[64:79], a[116:119], v[40:43], v[64:79]
  s_waitcnt lgkmcnt(2)
  v_mfma_f32_32x32x16_bf16 v[48:63], a[120:123], v[44:47], v[48:63]
  ds_read_b128 v[40:43], v252 offset:18432
  s_waitcnt vmcnt(4)
  s_mov_b32 s39, s51
  s_add_u32 s51, s51, 262144
  s_add_u32 s38, s38, 32768
  v_mfma_f32_32x32x16_bf16 v[64:79], a[124:127], v[44:47], v[64:79]
  ds_write_b128 v241, v[0:3] offset:32768
  s_waitcnt lgkmcnt(3)
  v_mfma_f32_32x32x16_bf16 v[48:63], a[128:131], v[32:35], v[48:63]
  ds_read_b128 v[44:47], v252 offset:19456
  ds_write_b128 v241, v[4:7] offset:33792
  v_mfma_f32_32x32x16_bf16 v[64:79], a[132:135], v[32:35], v[64:79]
  ds_write_b128 v241, v[8:11] offset:34816
  s_waitcnt lgkmcnt(5)
  v_mfma_f32_32x32x16_bf16 v[48:63], a[136:139], v[36:39], v[48:63]
  ds_read_b128 v[32:35], v252 offset:20480
  ds_write_b128 v241, v[12:15] offset:35840
  v_mfma_f32_32x32x16_bf16 v[64:79], a[140:143], v[36:39], v[64:79]
  ds_write_b128 v241, v[16:19] offset:36864
  s_waitcnt lgkmcnt(7)
  v_mfma_f32_32x32x16_bf16 v[48:63], a[144:147], v[40:43], v[48:63]
  ds_read_b128 v[36:39], v252 offset:21504
  ds_write_b128 v241, v[20:23] offset:37888
  v_mfma_f32_32x32x16_bf16 v[64:79], a[148:151], v[40:43], v[64:79]
  ds_write_b128 v241, v[24:27] offset:38912
  s_waitcnt lgkmcnt(8)
  v_mfma_f32_32x32x16_bf16 v[48:63], a[152:155], v[44:47], v[48:63]
  ds_read_b128 v[40:43], v252 offset:22528
  ds_write_b128 v241, v[28:31] offset:39936
  v_mfma_f32_32x32x16_bf16 v[64:79], a[156:159], v[44:47], v[64:79]
  s_waitcnt lgkmcnt(7)
  v_mfma_f32_32x32x16_bf16 v[48:63], a[160:163], v[32:35], v[48:63]
  ds_read_b128 v[44:47], v252 offset:23552
  v_mfma_f32_32x32x16_bf16 v[64:79], a[164:167], v[32:35], v[64:79]
  s_waitcnt lgkmcnt(5)
  v_mfma_f32_32x32x16_bf16 v[48:63], a[168:171], v[36:39], v[48:63]
  ds_read_b128 v[32:35], v252 offset:24576
  v_mfma_f32_32x32x16_bf16 v[64:79], a[172:175], v[36:39], v[64:79]
  s_waitcnt lgkmcnt(3)
  v_mfma_f32_32x32x16_bf16 v[48:63], a[176:179], v[40:43], v[48:63]
  ds_read_b128 v[36:39], v252 offset:25600
  v_mfma_f32_32x32x16_bf16 v[64:79], a[180:183], v[40:43], v[64:79]
  s_waitcnt lgkmcnt(2)
  v_mfma_f32_32x32x16_bf16 v[48:63], a[184:187], v[44:47], v[48:63]
  ds_read_b128 v[40:43], v252 offset:26624
  buffer_load_dwordx4 v[0:3], v241, s[4:7], s38 offen offset:0 sc1
  v_mfma_f32_32x32x16_bf16 v[64:79], a[188:191], v[44:47], v[64:79]
  buffer_load_dwordx4 v[4:7], v241, s[4:7], s38 offen offset:1024 sc1
  s_waitcnt lgkmcnt(2)
  v_mfma_f32_32x32x16_bf16 v[48:63], a[192:195], v[32:35], v[48:63]
  ds_read_b128 v[44:47], v252 offset:27648
  buffer_load_dwordx4 v[8:11], v241, s[4:7], s38 offen offset:2048 sc1
  v_mfma_f32_32x32x16_bf16 v[64:79], a[196:199], v[32:35], v[64:79]
  buffer_load_dwordx4 v[12:15], v241, s[4:7], s38 offen offset:3072 sc1
  s_waitcnt lgkmcnt(2)
  v_mfma_f32_32x32x16_bf16 v[48:63], a[200:203], v[36:39], v[48:63]
  ds_read_b128 v[32:35], v252 offset:28672
  buffer_load_dwordx4 v[16:19], v242, s[4:7], s38 offen offset:0 sc1
  v_mfma_f32_32x32x16_bf16 v[64:79], a[204:207], v[36:39], v[64:79]
  buffer_load_dwordx4 v[20:23], v242, s[4:7], s38 offen offset:1024 sc1
  s_waitcnt lgkmcnt(2)
  v_mfma_f32_32x32x16_bf16 v[48:63], a[208:211], v[40:43], v[48:63]
  ds_read_b128 v[36:39], v252 offset:29696
  buffer_load_dwordx4 v[24:27], v242, s[4:7], s38 offen offset:2048 sc1
  v_mfma_f32_32x32x16_bf16 v[64:79], a[212:215], v[40:43], v[64:79]
  buffer_load_dwordx4 v[28:31], v242, s[4:7], s38 offen offset:3072 sc1
  s_waitcnt lgkmcnt(2)
  v_mfma_f32_32x32x16_bf16 v[48:63], a[216:219], v[44:47], v[48:63]
  ds_read_b128 v[40:43], v252 offset:30720
  v_mfma_f32_32x32x16_bf16 v[64:79], a[220:223], v[44:47], v[64:79]
  s_waitcnt lgkmcnt(2)
  v_mfma_f32_32x32x16_bf16 v[48:63], a[224:227], v[32:35], v[48:63]
  ds_read_b128 v[44:47], v252 offset:31744
  v_mfma_f32_32x32x16_bf16 v[64:79], a[228:231], v[32:35], v[64:79]
  s_waitcnt lgkmcnt(2)
  v_mfma_f32_32x32x16_bf16 v[48:63], a[232:235], v[36:39], v[48:63]
  v_mfma_f32_32x32x16_bf16 v[64:79], a[236:239], v[36:39], v[64:79]
  s_waitcnt lgkmcnt(1)
  v_mfma_f32_32x32x16_bf16 v[48:63], a[240:243], v[40:43], v[48:63]
  v_mfma_f32_32x32x16_bf16 v[64:79], a[244:247], v[40:43], v[64:79]
  s_waitcnt lgkmcnt(0)
  v_mfma_f32_32x32x16_bf16 v[48:63], a[248:251], v[44:47], v[48:63]
  v_mfma_f32_32x32x16_bf16 v[64:79], a[252:255], v[44:47], v[64:79]
  s_waitcnt vmcnt(8) lgkmcnt(0)
  s_barrier
  s_cmp_lg_u32 s33, 0
  s_cbranch_scc1 w_fl_50025
  v_mov_b32 v250, s36
  s_mov_b64 exec, 1
  buffer_store_dword v250, off, s[4:7], s40 sc1
  s_mov_b64 exec, -1
w_fl_50025:
  s_add_u32 s36, s36, 1
  ds_read_b128 v[32:35], v252 offset:32768
  ds_read_b128 v[36:39], v252 offset:33792
  ds_read_b128 v[40:43], v252 offset:34816
  s_waitcnt lgkmcnt(2)
  v_mfma_f32_32x32x16_bf16 v[96:111], a[0:3], v[32:35], 0
  ds_read_b128 v[44:47], v252 offset:35840
  v_mfma_f32_32x32x16_bf16 v[112:127], a[4:7], v[32:35], 0
  s_waitcnt lgkmcnt(2)
  v_mfma_f32_32x32x16_bf16 v[96:111], a[8:11], v[36:39], v[96:111]
  ds_read_b128 v[32:35], v252 offset:36864
  v_mul_f32 v48, s41, v48
  v_mul_f32 v49, s41, v49
  v_mul_f32 v50, s41, v50
  v_mfma_f32_32x32x16_bf16 v[112:127], a[12:15], v[36:39], v[112:127]
  v_mul_f32 v51, s41, v51
  v_cvt_pk_bf16_f32 v80, v48, v49
  v_cvt_pk_bf16_f32 v81, v50, v51
  v_mul_f32 v56, s41, v56
  s_waitcnt lgkmcnt(2)
  v_mfma_f32_32x32x16_bf16 v[96:111], a[16:19], v[40:43], v[96:111]
  ds_read_b128 v[36:39], v252 offset:37888
  v_mul_f32 v57, s41, v57
  v_mul_f32 v58, s41, v58
  v_mul_f32 v59, s41, v59
  v_mfma_f32_32x32x16_bf16 v[112:127], a[20:23], v[40:43], v[112:127]
  v_cvt_pk_bf16_f32 v82, v56, v57
  v_cvt_pk_bf16_f32 v83, v58, v59
  buffer_store_dwordx4 v[80:83], v251, s[4:7], s39 offen offset:0 sc1
  v_mul_f32 v52, s41, v52
  s_waitcnt lgkmcnt(2)
  v_mfma_f32_32x32x16_bf16 v[96:111], a[24:27], v[44:47], v[96:111]
  ds_read_b128 v[40:43], v252 offset:38912
  v_mul_f32 v53, s41, v53
  v_mul_f32 v54, s41, v54
  v_mul_f32 v55, s41, v55
  v_mfma_f32_32x32x16_bf16 v[112:127], a[28:31], v[44:47], v[112:127]
  v_cvt_pk_bf16_f32 v84, v52, v53
  v_cvt_pk_bf16_f32 v85, v54, v55
  v_mul_f32 v60, s41, v60
  v_mul_f32 v61, s41, v61
  s_waitcnt lgkmcnt(2)
  v_mfma_f32_32x32x16_bf16 v[96:111], a[32:35], v[32:35], v[96:111]
  ds_read_b128 v[44:47], v252 offset:39936
  v_mul_f32 v62, s41, v62
  v_mul_f32 v63, s41, v63
  v_cvt_pk_bf16_f32 v86, v60, v61
  v_mfma_f32_32x32x16_bf16 v[112:127], a[36:39], v[32:35], v[112:127]
  v_cvt_pk_bf16_f32 v87, v62, v63
  buffer_store_dwordx4 v[84:87], v251, s[4:7], s39 offen offset:512 sc1
  v_mul_f32 v64, s41, v64
  v_mul_f32 v65, s41, v65
  s_waitcnt lgkmcnt(2)
  v_mfma_f32_32x32x16_bf16 v[96:111], a[40:43], v[36:39], v[96:111]
  ds_read_b128 v[32:35], v252 offset:40960
  v_mul_f32 v66, s41, v66
  v_mul_f32 v67, s41, v67
  v_cvt_pk_bf16_f32 v88, v64, v65
  v_mfma_f32_32x32x16_bf16 v[112:127], a[44:47], v[36:39], v[112:127]
  v_cvt_pk_bf16_f32 v89, v66, v67
  v_mul_f32 v72, s41, v72
  v_mul_f32 v73, s41, v73
  v_mul_f32 v74, s41, v74
  s_waitcnt lgkmcnt(2)
  v_mfma_f32_32x32x16_bf16 v[96:111], a[48:51], v[40:43], v[96:111]
  ds_read_b128 v[36:39], v252 offset:41984
  v_mul_f32 v75, s41, v75
  v_cvt_pk_bf16_f32 v90, v72, v73
  v_cvt_pk_bf16_f32 v91, v74, v75
  v_mfma_f32_32x32x16_bf16 v[112:127], a[52:55], v[40:43], v[112:127]
  buffer_store_dwordx4 v[88:91], v251, s[4:7], s39 offen offset:2048 sc1
  v_mul_f32 v68, s41, v68
  v_mul_f32 v69, s41, v69
  v_mul_f32 v70, s41, v70
  s_waitcnt lgkmcnt(2)
  v_mfma_f32_32x32x16_bf16 v[96:111], a[56:59], v[44:47], v[96:111]
  ds_read_b128 v[40:43], v252 offset:43008
  v_mul_f32 v71, s41, v71
  v_cvt_pk_bf16_f32 v92, v68, v69
  v_cvt_pk_bf16_f32 v93, v70, v71
  v_mfma_f32_32x32x16_bf16 v[112:127], a[60:63], v[44:47], v[112:127]
  v_mul_f32 v76, s41, v76
  v_mul_f32 v77, s41, v77
  v_mul_f32 v78, s41, v78
  v_mul_f32 v79, s41, v79
  s_waitcnt lgkmcnt(2)
  v_mfma_f32_32x32x16_bf16 v[96:111], a[64:67], v[32:35], v[96:111]
  ds_read_b128 v[44:47], v252 offset:44032
  v_cvt_pk_bf16_f32 v94, v76, v77
  v_cvt_pk_bf16_f32 v95, v78, v79
  buffer_store_dwordx4 v[92:95], v251, s[4:7], s39 offen offset:2560 sc1
  v_mfma_f32_32x32x16_bf16 v[112:127], a[68:71], v[32:35], v[112:127]
  s_waitcnt lgkmcnt(2)
  v_mfma_f32_32x32x16_bf16 v[96:111], a[72:75], v[36:39], v[96:111]
  ds_read_b128 v[32:35], v252 offset:45056
  v_mfma_f32_32x32x16_bf16 v[112:127], a[76:79], v[36:39], v[112:127]
  s_waitcnt lgkmcnt(2)
  v_mfma_f32_32x32x16_bf16 v[96:111], a[80:83], v[40:43], v[96:111]
  ds_read_b128 v[36:39], v252 offset:46080
  v_mfma_f32_32x32x16_bf16 v[112:127], a[84:87], v[40:43], v[112:127]
  s_waitcnt lgkmcnt(2)
  v_mfma_f32_32x32x16_bf16 v[96:111], a[88:91], v[44:47], v[96:111]
  ds_read_b128 v[40:43], v252 offset:47104
  v_mfma_f32_32x32x16_bf16 v[112:127], a[92:95], v[44:47], v[112:127]
  s_waitcnt lgkmcnt(2)
  v_mfma_f32_32x32x16_bf16 v[96:111], a[96:99], v[32:35], v[96:111]
  ds_read_b128 v[44:47], v252 offset:48128
  v_mfma_f32_32x32x16_bf16 v[112:127], a[100:103], v[32:35], v[112:127]
  s_waitcnt lgkmcnt(2)
  v_mfma_f32_32x32x16_bf16 v[96:111], a[104:107], v[36:39], v[96:111]
  ds_read_b128 v[32:35], v252 offset:49152
  v_mfma_f32_32x32x16_bf16 v[112:127], a[108:111], v[36:39], v[112:127]
  s_waitcnt lgkmcnt(2)
  v_mfma_f32_32x32x16_bf16 v[96:111], a[112:115], v[40:43], v[96:111]
  ds_read_b128 v[36:39], v252 offset:50176
  v_mfma_f32_32x32x16_bf16 v[112:127], a[116:119], v[40:43], v[112:127]
  s_waitcnt lgkmcnt(2)
  v_mfma_f32_32x32x16_bf16 v[96:111], a[120:123], v[44:47], v[96:111]
  ds_read_b128 v[40:43], v252 offset:51200
  s_waitcnt vmcnt(4)
  s_mov_b32 s39, s51
  s_add_u32 s51, s51, 262144
  s_add_u32 s38, s38, 32768
  v_mfma_f32_32x32x16_bf16 v[112:127], a[124:127], v[44:47], v[112:127]
  ds_write_b128 v241, v[0:3] offset:0
  s_waitcnt lgkmcnt(3)
  v_mfma_f32_32x32x16_bf16 v[96:111], a[128:131], v[32:35], v[96:111]
  ds_read_b128 v[44:47], v252 offset:52224
  ds_write_b128 v241, v[4:7] offset:1024
  v_mfma_f32_32x32x16_bf16 v[112:127], a[132:135], v[32:35], v[112:127]
  ds_write_b128 v241, v[8:11] offset:2048
  s_waitcnt lgkmcnt(5)
  v_mfma_f32_32x32x16_bf16 v[96:111], a[136:139], v[36:39], v[96:111]
  ds_read_b128 v[32:35], v252 offset:53248
  ds_write_b128 v241, v[12:15] offset:3072
  v_mfma_f32_32x32x16_bf16 v[112:127], a[140:143], v[36:39], v[112:127]
  ds_write_b128 v241, v[16:19] offset:4096
  s_waitcnt lgkmcnt(7)
  v_mfma_f32_32x32x16_bf16 v[96:111], a[144:147], v[40:43], v[96:111]
  ds_read_b128 v[36:39], v252 offset:54272
  ds_write_b128 v241, v[20:23] offset:5120
  v_mfma_f32_32x32x16_bf16 v[112:127], a[148:151], v[40:43], v[112:127]
  ds_write_b128 v241, v[24:27] offset:6144
  s_waitcnt lgkmcnt(8)
  v_mfma_f32_32x32x16_bf16 v[96:111], a[152:155], v[44:47], v[96:111]
  ds_read_b128 v[40:43], v252 offset:55296
  ds_write_b128 v241, v[28:31] offset:7168
  v_mfma_f32_32x32x16_bf16 v[112:127], a[156:159], v[44:47], v[112:127]
  s_waitcnt lgkmcnt(7)
  v_mfma_f32_32x32x16_bf16 v[96:111], a[160:163], v[32:35], v[96:111]
  ds_read_b128 v[44:47], v252 offset:56320
  v_mfma_f32_32x32x16_bf16 v[112:127], a[164:167], v[32:35], v[112:127]
  s_waitcnt lgkmcnt(5)
  v_mfma_f32_32x32x16_bf16 v[96:111], a[168:171], v[36:39], v[96:111]
  ds_read_b128 v[32:35], v252 offset:57344
  v_mfma_f32_32x32x16_bf16 v[112:127], a[172:175], v[36:39], v[112:127]
  s_waitcnt lgkmcnt(3)
  v_mfma_f32_32x32x16_bf16 v[96:111], a[176:179], v[40:43], v[96:111]
  ds_read_b128 v[36:39], v252 offset:58368
  v_mfma_f32_32x32x16_bf16 v[112:127], a[180:183], v[40:43], v[112:127]
  s_waitcnt lgkmcnt(2)
  v_mfma_f32_32x32x16_bf16 v[96:111], a[184:187], v[44:47], v[96:111]
  ds_read_b128 v[40:43], v252 offset:59392
  buffer_load_dwordx4 v[0:3], v241, s[4:7], s38 offen offset:0 sc1
  v_mfma_f32_32x32x16_bf16 v[112:127], a[188:191], v[44:47], v[112:127]
  buffer_load_dwordx4 v[4:7], v241, s[4:7], s38 offen offset:1024 sc1
  s_waitcnt lgkmcnt(2)
  v_mfma_f32_32x32x16_bf16 v[96:111], a[192:195], v[32:35], v[96:111]
  ds_read_b128 v[44:47], v252 offset:60416
  buffer_load_dwordx4 v[8:11], v241, s[4:7], s38 offen offset:2048 sc1
  v_mfma_f32_32x32x16_bf16 v[112:127], a[196:199], v[32:35], v[112:127]
  buffer_load_dwordx4 v[12:15], v241, s[4:7], s38 offen offset:3072 sc1
  s_waitcnt lgkmcnt(2)
  v_mfma_f32_32x32x16_bf16 v[96:111], a[200:203], v[36:39], v[96:111]
  ds_read_b128 v[32:35], v252 offset:61440
  buffer_load_dwordx4 v[16:19], v242, s[4:7], s38 offen offset:0 sc1
  v_mfma_f32_32x32x16_bf16 v[112:127], a[204:207], v[36:39], v[112:127]
  buffer_load_dwordx4 v[20:23], v242, s[4:7], s38 offen offset:1024 sc1
  s_waitcnt lgkmcnt(2)
  v_mfma_f32_32x32x16_bf16 v[96:111], a[208:211], v[40:43], v[96:111]
  ds_read_b128 v[36:39], v252 offset:62464
  buffer_load_dwordx4 v[24:27], v242, s[4:7], s38 offen offset:2048 sc1
  v_mfma_f32_32x32x16_bf16 v[112:127], a[212:215], v[40:43], v[112:127]
  buffer_load_dwordx4 v[28:31], v242, s[4:7], s38 offen offset:3072 sc1
  s_waitcnt lgkmcnt(2)
  v_mfma_f32_32x32x16_bf16 v[96:111], a[216:219], v[44:47], v[96:111]
  ds_read_b128 v[40:43], v252 offset:63488
  v_mfma_f32_32x32x16_bf16 v[112:127], a[220:223], v[44:47], v[112:127]
  s_waitcnt lgkmcnt(2)
  v_mfma_f32_32x32x16_bf16 v[96:111], a[224:227], v[32:35], v[96:111]
  ds_read_b128 v[44:47], v252 offset:64512
  v_mfma_f32_32x32x16_bf16 v[112:127], a[228:231], v[32:35], v[112:127]
  s_waitcnt lgkmcnt(2)
  v_mfma_f32_32x32x16_bf16 v[96:111], a[232:235], v[36:39], v[96:111]
  v_mfma_f32_32x32x16_bf16 v[112:127], a[236:239], v[36:39], v[112:127]
  s_waitcnt lgkmcnt(1)
  v_mfma_f32_32x32x16_bf16 v[96:111], a[240:243], v[40:43], v[96:111]
  v_mfma_f32_32x32x16_bf16 v[112:127], a[244:247], v[40:43], v[112:127]
  s_waitcnt lgkmcnt(0)
  v_mfma_f32_32x32x16_bf16 v[96:111], a[248:251], v[44:47], v[96:111]
  v_mfma_f32_32x32x16_bf16 v[112:127], a[252:255], v[44:47], v[112:127]
  s_waitcnt vmcnt(8) lgkmcnt(0)
  s_barrier
  s_cmp_lg_u32 s33, 0
  s_cbranch_scc1 w_fl_50026
  v_mov_b32 v250, s36
  s_mov_b64 exec, 1
  buffer_store_dword v250, off, s[4:7], s40 sc1
  s_mov_b64 exec, -1
w_fl_50026:
  s_add_u32 s36, s36, 1
  s_cmp_lt_u32 s36, 64
  s_cbranch_scc1 w_top_pqk
  s_nop 7
  v_mul_f32 v96, s41, v96
  v_mul_f32 v97, s41, v97
  v_mul_f32 v98, s41, v98
  v_mul_f32 v99, s41, v99
  v_cvt_pk_bf16_f32 v80, v96, v97
  v_cvt_pk_bf16_f32 v81, v98, v99
  v_mul_f32 v104, s41, v104
  v_mul_f32 v105, s41, v105
  v_mul_f32 v106, s41, v106
  v_mul_f32 v107, s41, v107
  v_cvt_pk_bf16_f32 v82, v104, v105
  v_cvt_pk_bf16_f32 v83, v106, v107
  buffer_store_dwordx4 v[80:83], v251, s[4:7], s39 offen offset:0 sc1
  v_mul_f32 v100, s41, v100
  v_mul_f32 v101, s41, v101
  v_mul_f32 v102, s41, v102
  v_mul_f32 v103, s41, v103
  v_cvt_pk_bf16_f32 v84, v100, v101
  v_cvt_pk_bf16_f32 v85, v102, v103
  v_mul_f32 v108, s41, v108
  v_mul_f32 v109, s41, v109
  v_mul_f32 v110, s41, v110
  v_mul_f32 v111, s41, v111
  v_cvt_pk_bf16_f32 v86, v108, v109
  v_cvt_pk_bf16_f32 v87, v110, v111
  buffer_store_dwordx4 v[84:87], v251, s[4:7], s39 offen offset:512 sc1
  v_mul_f32 v112, s41, v112
  v_mul_f32 v113, s41, v113
  v_mul_f32 v114, s41, v114
  v_mul_f32 v115, s41, v115
  v_cvt_pk_bf16_f32 v88, v112, v113
  v_cvt_pk_bf16_f32 v89, v114, v115
  v_mul_f32 v120, s41, v120
  v_mul_f32 v121, s41, v121
  v_mul_f32 v122, s41, v122
  v_mul_f32 v123, s41, v123
  v_cvt_pk_bf16_f32 v90, v120, v121
  v_cvt_pk_bf16_f32 v91, v122, v123
  buffer_store_dwordx4 v[88:91], v251, s[4:7], s39 offen offset:2048 sc1
  v_mul_f32 v116, s41, v116
  v_mul_f32 v117, s41, v117
  v_mul_f32 v118, s41, v118
  v_mul_f32 v119, s41, v119
  v_cvt_pk_bf16_f32 v92, v116, v117
  v_cvt_pk_bf16_f32 v93, v118, v119
  v_mul_f32 v124, s41, v124
  v_mul_f32 v125, s41, v125
  v_mul_f32 v126, s41, v126
  v_mul_f32 v127, s41, v127
  v_cvt_pk_bf16_f32 v94, v124, v125
  v_cvt_pk_bf16_f32 v95, v126, v127
  buffer_store_dwordx4 v[92:95], v251, s[4:7], s39 offen offset:2560 sc1
  s_mov_b32 s36, 63
  s_waitcnt vmcnt(0)
  s_barrier
  s_cmp_lg_u32 s33, 0
  s_cbranch_scc1 w_fl_50027
  s_add_u32 s42, s36, 1
  v_mov_b32 v250, s42
  s_mov_b64 exec, 1
  buffer_store_dword v250, off, s[4:7], s40 sc1
  s_mov_b64 exec, -1
w_fl_50027:
  s_branch w_exit
w_pv:
  s_lshl_b32 s40, s53, 7
  s_add_u32 s40, s40, 1310720
  s_mov_b32 s36, 0
  s_lshr_b32 s42, s53, 4
  s_lshl_b32 s43, s42, 3
  s_add_u32 s43, s43, 16
  s_load_dwordx2 s[8:9], s[0:1], s43
  s_mov_b32 s10, 0x400000
  s_mov_b32 s11, 0x20000
  s_cmp_eq_u32 s42, 0
  s_mov_b32 s41, 0x3ef40000
  s_cselect_b32 s41, 0x3e890000, s41
  s_lshl_b32 s39, 0x1000000, s42
  s_and_b32 s53, s53, 15
  s_lshl2_add_u32 s42, s53, s33
  s_lshl_b32 s46, s42, 7
  s_add_u32 s47, s46, 64
  s_lshl_b32 s42, s42, 12
  s_add_u32 s39, s39, s42
  s_mov_b32 s45, 8192
  v_and_b32 v250, 15, v255
  v_lshlrev_b32 v251, 4, v250
  v_lshl_add_u32 v251, v253, 8, v251
  v_bfe_u32 v250, v255, 4, 1
  v_lshl_add_u32 v251, v250, 10, v251
  s_waitcnt lgkmcnt(0)
  s_mov_b32 s38, 3145728
  s_mov_b32 s51, s39
  s_mov_b32 s39, 7340032
  s_lshl_b32 s48, s33, 15
  v_lshrrev_b32 v250, 3, v255
  v_mul_lo_u32 v250, v250, s45
  v_bfe_u32 v248, v255, 4, 1
  v_lshlrev_b32 v248, 2, v248
  v_xor_b32 v249, v248, v255
  v_and_b32 v249, 7, v249
  v_lshl_add_u32 v247, v249, 4, v250
  s_lshl_b32 s44, s45, 3
  s_add_u32 m0, s48, 0
  s_nop 0
  buffer_load_dwordx4 v247, s[8:11], s46 offen lds
  s_add_u32 s46, s46, s44
  s_add_u32 m0, s48, 1024
  s_nop 0
  buffer_load_dwordx4 v247, s[8:11], s46 offen lds
  s_add_u32 s46, s46, s44
  s_add_u32 m0, s48, 2048
  s_nop 0
  buffer_load_dwordx4 v247, s[8:11], s46 offen lds
  s_add_u32 s46, s46, s44
  s_add_u32 m0, s48, 3072
  s_nop 0
  buffer_load_dwordx4 v247, s[8:11], s46 offen lds
  s_add_u32 s46, s46, s44
  s_add_u32 m0, s48, 4096
  s_nop 0
  buffer_load_dwordx4 v247, s[8:11], s46 offen lds
  s_add_u32 s46, s46, s44
  s_add_u32 m0, s48, 5120
  s_nop 0
  buffer_load_dwordx4 v247, s[8:11], s46 offen lds
  s_add_u32 s46, s46, s44
  s_add_u32 m0, s48, 6144
  s_nop 0
  buffer_load_dwordx4 v247, s[8:11], s46 offen lds
  s_add_u32 s46, s46, s44
  s_add_u32 m0, s48, 7168
  s_nop 0
  buffer_load_dwordx4 v247, s[8:11], s46 offen lds
  s_add_u32 s46, s46, s44
  s_add_u32 m0, s48, 8192
  s_nop 0
  buffer_load_dwordx4 v247, s[8:11], s46 offen lds
  s_add_u32 s46, s46, s44
  s_add_u32 m0, s48, 9216
  s_nop 0
  buffer_load_dwordx4 v247, s[8:11], s46 offen lds
  s_add_u32 s46, s46, s44
  s_add_u32 m0, s48, 10240
  s_nop 0
  buffer_load_dwordx4 v247, s[8:11], s46 offen lds
  s_add_u32 s46, s46, s44
  s_add_u32 m0, s48, 11264
  s_nop 0
  buffer_load_dwordx4 v247, s[8:11], s46 offen lds
  s_add_u32 s46, s46, s44
  s_add_u32 m0, s48, 12288
  s_nop 0
  buffer_load_dwordx4 v247, s[8:11], s46 offen lds
  s_add_u32 s46, s46, s44
  s_add_u32 m0, s48, 13312
  s_nop 0
  buffer_load_dwordx4 v247, s[8:11], s46 offen lds
  s_add_u32 s46, s46, s44
  s_add_u32 m0, s48, 14336
  s_nop 0
  buffer_load_dwordx4 v247, s[8:11], s46 offen lds
  s_add_u32 s46, s46, s44
  s_add_u32 m0, s48, 15360
  s_nop 0
  buffer_load_dwordx4 v247, s[8:11], s46 offen lds
  s_add_u32 s46, s46, s44
  s_add_u32 m0, s48, 16384
  s_nop 0
  buffer_load_dwordx4 v247, s[8:11], s46 offen lds
  s_add_u32 s46, s46, s44
  s_add_u32 m0, s48, 17408
  s_nop 0
  buffer_load_dwordx4 v247, s[8:11], s46 offen lds
  s_add_u32 s46, s46, s44
  s_add_u32 m0, s48, 18432
  s_nop 0
  buffer_load_dwordx4 v247, s[8:11], s46 offen lds
  s_add_u32 s46, s46, s44
  s_add_u32 m0, s48, 19456
  s_nop 0
  buffer_load_dwordx4 v247, s[8:11], s46 offen lds
  s_add_u32 s46, s46, s44
  s_add_u32 m0, s48, 20480
  s_nop 0
  buffer_load_dwordx4 v247, s[8:11], s46 offen lds
  s_add_u32 s46, s46, s44
  s_add_u32 m0, s48, 21504
  s_nop 0
  buffer_load_dwordx4 v247, s[8:11], s46 offen lds
  s_add_u32 s46, s46, s44
  s_add_u32 m0, s48, 22528
  s_nop 0
  buffer_load_dwordx4 v247, s[8:11], s46 offen lds
  s_add_u32 s46, s46, s44
  s_add_u32 m0, s48, 23552
  s_nop 0
  buffer_load_dwordx4 v247, s[8:11], s46 offen lds
  s_add_u32 s46, s46, s44
  s_add_u32 m0, s48, 24576
  s_nop 0
  buffer_load_dwordx4 v247, s[8:11], s46 offen lds
  s_add_u32 s46, s46, s44
  s_add_u32 m0, s48, 25600
  s_nop 0
  buffer_load_dwordx4 v247, s[8:11], s46 offen lds
  s_add_u32 s46, s46, s44
  s_add_u32 m0, s48, 26624
  s_nop 0
  buffer_load_dwordx4 v247, s[8:11], s46 offen lds
  s_add_u32 s46, s46, s44
  s_add_u32 m0, s48, 27648
  s_nop 0
  buffer_load_dwordx4 v247, s[8:11], s46 offen lds
  s_add_u32 s46, s46, s44
  s_add_u32 m0, s48, 28672
  s_nop 0
  buffer_load_dwordx4 v247, s[8:11], s46 offen lds
  s_add_u32 s46, s46, s44
  s_add_u32 m0, s48, 29696
  s_nop 0
  buffer_load_dwordx4 v247, s[8:11], s46 offen lds
  s_add_u32 s46, s46, s44
  s_add_u32 m0, s48, 30720
  s_nop 0
  buffer_load_dwordx4 v247, s[8:11], s46 offen lds
  s_add_u32 s46, s46, s44
  s_add_u32 m0, s48, 31744
  s_nop 0
  buffer_load_dwordx4 v247, s[8:11], s46 offen lds
  s_add_u32 s46, s46, s44
  v_and_b32 v249, 3, v255
  v_bfe_u32 v250, v255, 2, 2
  v_lshl_add_u32 v250, v253, 3, v250
  v_lshlrev_b32 v250, 7, v250
  v_bfe_u32 v248, v255, 4, 1
  v_lshl_add_u32 v250, v248, 5, v250
  v_lshl_add_u32 v250, v249, 3, v250
  v_bfe_u32 v248, v255, 3, 1
  v_lshl_add_u32 v250, v248, 6, v250
  v_add_u32 v240, s48, v250
  v_xor_b32 v241, 64, v240
  s_waitcnt vmcnt(28)
  ds_read_b64_tr_b16 a[0:1], v240 offset:0
  ds_read_b64_tr_b16 a[2:3], v240 offset:512
  ds_read_b64_tr_b16 a[4:5], v241 offset:0
  ds_read_b64_tr_b16 a[6:7], v241 offset:512
  ds_read_b64_tr_b16 a[8:9], v240 offset:2048
  ds_read_b64_tr_b16 a[10:11], v240 offset:2560
  ds_read_b64_tr_b16 a[12:13], v241 offset:2048
  ds_read_b64_tr_b16 a[14:15], v241 offset:2560
  s_waitcnt lgkmcnt(0)
  s_add_u32 m0, s48, 0
  s_nop 0
  buffer_load_dwordx4 v247, s[8:11], s46 offen lds
  s_add_u32 s46, s46, s44
  s_add_u32 m0, s48, 1024
  s_nop 0
  buffer_load_dwordx4 v247, s[8:11], s46 offen lds
  s_add_u32 s46, s46, s44
  s_add_u32 m0, s48, 2048
  s_nop 0
  buffer_load_dwordx4 v247, s[8:11], s46 offen lds
  s_add_u32 s46, s46, s44
  s_add_u32 m0, s48, 3072
  s_nop 0
  buffer_load_dwordx4 v247, s[8:11], s46 offen lds
  s_add_u32 s46, s46, s44
  s_waitcnt vmcnt(28)
  ds_read_b64_tr_b16 a[16:17], v240 offset:4096
  ds_read_b64_tr_b16 a[18:19], v240 offset:4608
  ds_read_b64_tr_b16 a[20:21], v241 offset:4096
  ds_read_b64_tr_b16 a[22:23], v241 offset:4608
  ds_read_b64_tr_b16 a[24:25], v240 offset:6144
  ds_read_b64_tr_b16 a[26:27], v240 offset:6656
  ds_read_b64_tr_b16 a[28:29], v241 offset:6144
  ds_read_b64_tr_b16 a[30:31], v241 offset:6656
  s_waitcnt lgkmcnt(0)
  s_add_u32 m0, s48, 4096
  s_nop 0
  buffer_load_dwordx4 v247, s[8:11], s46 offen lds
  s_add_u32 s46, s46, s44
  s_add_u32 m0, s48, 5120
  s_nop 0
  buffer_load_dwordx4 v247, s[8:11], s46 offen lds
  s_add_u32 s46, s46, s44
  s_add_u32 m0, s48, 6144
  s_nop 0
  buffer_load_dwordx4 v247, s[8:11], s46 offen lds
  s_add_u32 s46, s46, s44
  s_add_u32 m0, s48, 7168
  s_nop 0
  buffer_load_dwordx4 v247, s[8:11], s46 offen lds
  s_add_u32 s46, s46, s44
  s_waitcnt vmcnt(28)
  ds_read_b64_tr_b16 a[32:33], v240 offset:8192
  ds_read_b64_tr_b16 a[34:35], v240 offset:8704
  ds_read_b64_tr_b16 a[36:37], v241 offset:8192
  ds_read_b64_tr_b16 a[38:39], v241 offset:8704
  ds_read_b64_tr_b16 a[40:41], v240 offset:10240
  ds_read_b64_tr_b16 a[42:43], v240 offset:10752
  ds_read_b64_tr_b16 a[44:45], v241 offset:10240
  ds_read_b64_tr_b16 a[46:47], v241 offset:10752
  s_waitcnt lgkmcnt(0)
  s_add_u32 m0, s48, 8192
  s_nop 0
  buffer_load_dwordx4 v247, s[8:11], s46 offen lds
  s_add_u32 s46, s46, s44
  s_add_u32 m0, s48, 9216
  s_nop 0
  buffer_load_dwordx4 v247, s[8:11], s46 offen lds
  s_add_u32 s46, s46, s44
  s_add_u32 m0, s48, 10240
  s_nop 0
  buffer_load_dwordx4 v247, s[8:11], s46 offen lds
  s_add_u32 s46, s46, s44
  s_add_u32 m0, s48, 11264
  s_nop 0
  buffer_load_dwordx4 v247, s[8:11], s46 offen lds
  s_add_u32 s46, s46, s44
  s_waitcnt vmcnt(28)
  ds_read_b64_tr_b16 a[48:49], v240 offset:12288
  ds_read_b64_tr_b16 a[50:51], v240 offset:12800
  ds_read_b64_tr_b16 a[52:53], v241 offset:12288
  ds_read_b64_tr_b16 a[54:55], v241 offset:12800
  ds_read_b64_tr_b16 a[56:57], v240 offset:14336
  ds_read_b64_tr_b16 a[58:59], v240 offset:14848
  ds_read_b64_tr_b16 a[60:61], v241 offset:14336
  ds_read_b64_tr_b16 a[62:63], v241 offset:14848
  s_waitcnt lgkmcnt(0)
  s_add_u32 m0, s48, 12288
  s_nop 0
  buffer_load_dwordx4 v247, s[8:11], s46 offen lds
  s_add_u32 s46, s46, s44
  s_add_u32 m0, s48, 13312
  s_nop 0
  buffer_load_dwordx4 v247, s[8:11], s46 offen lds
  s_add_u32 s46, s46, s44
  s_add_u32 m0, s48, 14336
  s_nop 0
  buffer_load_dwordx4 v247, s[8:11], s46 offen lds
  s_add_u32 s46, s46, s44
  s_add_u32 m0, s48, 15360
  s_nop 0
  buffer_load_dwordx4 v247, s[8:11], s46 offen lds
  s_add_u32 s46, s46, s44
  s_waitcnt vmcnt(28)
  ds_read_b64_tr_b16 a[64:65], v240 offset:16384
  ds_read_b64_tr_b16 a[66:67], v240 offset:16896
  ds_read_b64_tr_b16 a[68:69], v241 offset:16384
  ds_read_b64_tr_b16 a[70:71], v241 offset:16896
  ds_read_b64_tr_b16 a[72:73], v240 offset:18432
  ds_read_b64_tr_b16 a[74:75], v240 offset:18944
  ds_read_b64_tr_b16 a[76:77], v241 offset:18432
  ds_read_b64_tr_b16 a[78:79], v241 offset:18944
  s_waitcnt lgkmcnt(0)
  s_add_u32 m0, s48, 16384
  s_nop 0
  buffer_load_dwordx4 v247, s[8:11], s46 offen lds
  s_add_u32 s46, s46, s44
  s_add_u32 m0, s48, 17408
  s_nop 0
  buffer_load_dwordx4 v247, s[8:11], s46 offen lds
  s_add_u32 s46, s46, s44
  s_add_u32 m0, s48, 18432
  s_nop 0
  buffer_load_dwordx4 v247, s[8:11], s46 offen lds
  s_add_u32 s46, s46, s44
  s_add_u32 m0, s48, 19456
  s_nop 0
  buffer_load_dwordx4 v247, s[8:11], s46 offen lds
  s_add_u32 s46, s46, s44
  s_waitcnt vmcnt(28)
  ds_read_b64_tr_b16 a[80:81], v240 offset:20480
  ds_read_b64_tr_b16 a[82:83], v240 offset:20992
  ds_read_b64_tr_b16 a[84:85], v241 offset:20480
  ds_read_b64_tr_b16 a[86:87], v241 offset:20992
  ds_read_b64_tr_b16 a[88:89], v240 offset:22528
  ds_read_b64_tr_b16 a[90:91], v240 offset:23040
  ds_read_b64_tr_b16 a[92:93], v241 offset:22528
  ds_read_b64_tr_b16 a[94:95], v241 offset:23040
  s_waitcnt lgkmcnt(0)
  s_add_u32 m0, s48, 20480
  s_nop 0
  buffer_load_dwordx4 v247, s[8:11], s46 offen lds
  s_add_u32 s46, s46, s44
  s_add_u32 m0, s48, 21504
  s_nop 0
  buffer_load_dwordx4 v247, s[8:11], s46 offen lds
  s_add_u32 s46, s46, s44
  s_add_u32 m0, s48, 22528
  s_nop 0
  buffer_load_dwordx4 v247, s[8:11], s46 offen lds
  s_add_u32 s46, s46, s44
  s_add_u32 m0, s48, 23552
  s_nop 0
  buffer_load_dwordx4 v247, s[8:11], s46 offen lds
  s_add_u32 s46, s46, s44
  s_waitcnt vmcnt(28)
  ds_read_b64_tr_b16 a[96:97], v240 offset:24576
  ds_read_b64_tr_b16 a[98:99], v240 offset:25088
  ds_read_b64_tr_b16 a[100:101], v241 offset:24576
  ds_read_b64_tr_b16 a[102:103], v241 offset:25088
  ds_read_b64_tr_b16 a[104:105], v240 offset:26624
  ds_read_b64_tr_b16 a[106:107], v240 offset:27136
  ds_read_b64_tr_b16 a[108:109], v241 offset:26624
  ds_read_b64_tr_b16 a[110:111], v241 offset:27136
  s_waitcnt lgkmcnt(0)
  s_add_u32 m0, s48, 24576
  s_nop 0
  buffer_load_dwordx4 v247, s[8:11], s46 offen lds
  s_add_u32 s46, s46, s44
  s_add_u32 m0, s48, 25600
  s_nop 0
  buffer_load_dwordx4 v247, s[8:11], s46 offen lds
  s_add_u32 s46, s46, s44
  s_add_u32 m0, s48, 26624
  s_nop 0
  buffer_load_dwordx4 v247, s[8:11], s46 offen lds
  s_add_u32 s46, s46, s44
  s_add_u32 m0, s48, 27648
  s_nop 0
  buffer_load_dwordx4 v247, s[8:11], s46 offen lds
  s_add_u32 s46, s46, s44
  s_waitcnt vmcnt(28)
  ds_read_b64_tr_b16 a[112:113], v240 offset:28672
  ds_read_b64_tr_b16 a[114:115], v240 offset:29184
  ds_read_b64_tr_b16 a[116:117], v241 offset:28672
  ds_read_b64_tr_b16 a[118:119], v241 offset:29184
  ds_read_b64_tr_b16 a[120:121], v240 offset:30720
  ds_read_b64_tr_b16 a[122:123], v240 offset:31232
  ds_read_b64_tr_b16 a[124:125], v241 offset:30720
  ds_read_b64_tr_b16 a[126:127], v241 offset:31232
  s_waitcnt lgkmcnt(0)
  s_add_u32 m0, s48, 28672
  s_nop 0
  buffer_load_dwordx4 v247, s[8:11], s46 offen lds
  s_add_u32 s46, s46, s44
  s_add_u32 m0, s48, 29696
  s_nop 0
  buffer_load_dwordx4 v247, s[8:11], s46 offen lds
  s_add_u32 s46, s46, s44
  s_add_u32 m0, s48, 30720
  s_nop 0
  buffer_load_dwordx4 v247, s[8:11], s46 offen lds
  s_add_u32 s46, s46, s44
  s_add_u32 m0, s48, 31744
  s_nop 0
  buffer_load_dwordx4 v247, s[8:11], s46 offen lds
  s_add_u32 s46, s46, s44
  s_waitcnt vmcnt(28)
  ds_read_b64_tr_b16 a[128:129], v240 offset:0
  ds_read_b64_tr_b16 a[130:131], v240 offset:512
  ds_read_b64_tr_b16 a[132:133], v241 offset:0
  ds_read_b64_tr_b16 a[134:135], v241 offset:512
  ds_read_b64_tr_b16 a[136:137], v240 offset:2048
  ds_read_b64_tr_b16 a[138:139], v240 offset:2560
  ds_read_b64_tr_b16 a[140:141], v241 offset:2048
  ds_read_b64_tr_b16 a[142:143], v241 offset:2560
  s_waitcnt lgkmcnt(0)
  s_waitcnt vmcnt(24)
  ds_read_b64_tr_b16 a[144:145], v240 offset:4096
  ds_read_b64_tr_b16 a[146:147], v240 offset:4608
  ds_read_b64_tr_b16 a[148:149], v241 offset:4096
  ds_read_b64_tr_b16 a[150:151], v241 offset:4608
  ds_read_b64_tr_b16 a[152:153], v240 offset:6144
  ds_read_b64_tr_b16 a[154:155], v240 offset:6656
  ds_read_b64_tr_b16 a[156:157], v241 offset:6144
  ds_read_b64_tr_b16 a[158:159], v241 offset:6656
  s_waitcnt lgkmcnt(0)
  s_waitcnt vmcnt(20)
  ds_read_b64_tr_b16 a[160:161], v240 offset:8192
  ds_read_b64_tr_b16 a[162:163], v240 offset:8704
  ds_read_b64_tr_b16 a[164:165], v241 offset:8192
  ds_read_b64_tr_b16 a[166:167], v241 offset:8704
  ds_read_b64_tr_b16 a[168:169], v240 offset:10240
  ds_read_b64_tr_b16 a[170:171], v240 offset:10752
  ds_read_b64_tr_b16 a[172:173], v241 offset:10240
  ds_read_b64_tr_b16 a[174:175], v241 offset:10752
  s_waitcnt lgkmcnt(0)
  s_waitcnt vmcnt(16)
  ds_read_b64_tr_b16 a[176:177], v240 offset:12288
  ds_read_b64_tr_b16 a[178:179], v240 offset:12800
  ds_read_b64_tr_b16 a[180:181], v241 offset:12288
  ds_read_b64_tr_b16 a[182:183], v241 offset:12800
  ds_read_b64_tr_b16 a[184:185], v240 offset:14336
  ds_read_b64_tr_b16 a[186:187], v240 offset:14848
  ds_read_b64_tr_b16 a[188:189], v241 offset:14336
  ds_read_b64_tr_b16 a[190:191], v241 offset:14848
  s_waitcnt lgkmcnt(0)
  s_mov_b64 exec, 1
  buffer_load_dword v128, off, s[28:31], 0 offset:132 sc1
  buffer_load_dword v129, off, s[28:31], 0 offset:36 sc1
  s_mov_b64 exec, -1
  s_waitcnt vmcnt(12)
  ds_read_b64_tr_b16 a[192:193], v240 offset:16384
  ds_read_b64_tr_b16 a[194:195], v240 offset:16896
  ds_read_b64_tr_b16 a[196:197], v241 offset:16384
  ds_read_b64_tr_b16 a[198:199], v241 offset:16896
  ds_read_b64_tr_b16 a[200:201], v240 offset:18432
  ds_read_b64_tr_b16 a[202:203], v240 offset:18944
  ds_read_b64_tr_b16 a[204:205], v241 offset:18432
  ds_read_b64_tr_b16 a[206:207], v241 offset:18944
  s_waitcnt lgkmcnt(0)
  s_waitcnt vmcnt(8)
  ds_read_b64_tr_b16 a[208:209], v240 offset:20480
  ds_read_b64_tr_b16 a[210:211], v240 offset:20992
  ds_read_b64_tr_b16 a[212:213], v241 offset:20480
  ds_read_b64_tr_b16 a[214:215], v241 offset:20992
  ds_read_b64_tr_b16 a[216:217], v240 offset:22528
  ds_read_b64_tr_b16 a[218:219], v240 offset:23040
  ds_read_b64_tr_b16 a[220:221], v241 offset:22528
  ds_read_b64_tr_b16 a[222:223], v241 offset:23040
  s_waitcnt lgkmcnt(0)
  s_waitcnt vmcnt(4)
  ds_read_b64_tr_b16 a[224:225], v240 offset:24576
  ds_read_b64_tr_b16 a[226:227], v240 offset:25088
  ds_read_b64_tr_b16 a[228:229], v241 offset:24576
  ds_read_b64_tr_b16 a[230:231], v241 offset:25088
  ds_read_b64_tr_b16 a[232:233], v240 offset:26624
  ds_read_b64_tr_b16 a[234:235], v240 offset:27136
  ds_read_b64_tr_b16 a[236:237], v241 offset:26624
  ds_read_b64_tr_b16 a[238:239], v241 offset:27136
  s_waitcnt lgkmcnt(0)
  s_waitcnt vmcnt(0)
  ds_read_b64_tr_b16 a[240:241], v240 offset:28672
  ds_read_b64_tr_b16 a[242:243], v240 offset:29184
  ds_read_b64_tr_b16 a[244:245], v241 offset:28672
  ds_read_b64_tr_b16 a[246:247], v241 offset:29184
  ds_read_b64_tr_b16 a[248:249], v240 offset:30720
  ds_read_b64_tr_b16 a[250:251], v240 offset:31232
  ds_read_b64_tr_b16 a[252:253], v241 offset:30720
  ds_read_b64_tr_b16 a[254:255], v241 offset:31232
  s_waitcnt lgkmcnt(0)
  s_mul_i32 s42, s33, 8192
  v_add_u32 v241, s42, v252
  v_add_u32 v242, 4096, v241
  v_readfirstlane_b32 s42, v128
  v_readfirstlane_b32 s43, v129
  s_lshl_b32 s43, s43, 6
  s_and_b32 s42, s42, s43
  s_cbranch_scc1 w_go_pv
  s_mov_b64 exec, 1
w_wd_50028:
  buffer_load_dword v250, off, s[28:31], 0 offset:132 sc1
  s_waitcnt vmcnt(0)
  v_readfirstlane_b32 s43, v250
  s_cmp_ge_u32 s43, 64
  s_cbranch_scc1 w_wdd_50029
  s_cmp_eq_u32 s35, 0
  s_cbranch_scc1 w_wdd_50029
  s_sub_u32 s35, s35, 1
  s_sleep 4
  s_branch w_wd_50028
w_wdd_50029:
  s_mov_b64 exec, -1
w_wds_50030:
  s_mov_b64 exec, 1
w_wd_50031:
  buffer_load_dword v250, off, s[28:31], 0 offset:36 sc1
  s_waitcnt vmcnt(0)
  v_readfirstlane_b32 s43, v250
  s_cmp_ge_u32 s43, 1
  s_cbranch_scc1 w_wdd_50032
  s_cmp_eq_u32 s35, 0
  s_cbranch_scc1 w_wdd_50032
  s_sub_u32 s35, s35, 1
  s_sleep 4
  s_branch w_wd_50031
w_wdd_50032:
  s_mov_b64 exec, -1
w_wds_50033:
w_go_pv:
  buffer_load_dwordx4 v[0:3], v241, s[4:7], s38 offen offset:0 sc1
  buffer_load_dwordx4 v[4:7], v241, s[4:7], s38 offen offset:1024 sc1
  buffer_load_dwordx4 v[8:11], v241, s[4:7], s38 offen offset:2048 sc1
  buffer_load_dwordx4 v[12:15], v241, s[4:7], s38 offen offset:3072 sc1
  buffer_load_dwordx4 v[16:19], v242, s[4:7], s38 offen offset:0 sc1
  buffer_load_dwordx4 v[20:23], v242, s[4:7], s38 offen offset:1024 sc1
  buffer_load_dwordx4 v[24:27], v242, s[4:7], s38 offen offset:2048 sc1
  buffer_load_dwordx4 v[28:31], v242, s[4:7], s38 offen offset:3072 sc1
  s_barrier
  s_waitcnt vmcnt(0)
  ds_write_b128 v241, v[0:3] offset:0
  ds_write_b128 v241, v[4:7] offset:1024
  ds_write_b128 v241, v[8:11] offset:2048
  ds_write_b128 v241, v[12:15] offset:3072
  ds_write_b128 v241, v[16:19] offset:4096
  ds_write_b128 v241, v[20:23] offset:5120
  ds_write_b128 v241, v[24:27] offset:6144
  ds_write_b128 v241, v[28:31] offset:7168
  s_waitcnt lgkmcnt(0)
  s_barrier
  s_add_u32 s38, s38, 32768
  buffer_load_dwordx4 v[0:3], v241, s[4:7], s38 offen offset:0 sc1
  buffer_load_dwordx4 v[4:7], v241, s[4:7], s38 offen offset:1024 sc1
  buffer_load_dwordx4 v[8:11], v241, s[4:7], s38 offen offset:2048 sc1
  buffer_load_dwordx4 v[12:15], v241, s[4:7], s38 offen offset:3072 sc1
  buffer_load_dwordx4 v[16:19], v242, s[4:7], s38 offen offset:0 sc1
  buffer_load_dwordx4 v[20:23], v242, s[4:7], s38 offen offset:1024 sc1
  buffer_load_dwordx4 v[24:27], v242, s[4:7], s38 offen offset:2048 sc1
  buffer_load_dwordx4 v[28:31], v242, s[4:7], s38 offen offset:3072 sc1
w_top_pv:
  ds_read_b128 v[32:35], v252 offset:0
  ds_read_b128 v[36:39], v252 offset:1024
  ds_read_b128 v[40:43], v252 offset:2048
  s_waitcnt lgkmcnt(2)
  v_mfma_f32_32x32x16_bf16 v[48:63], v[32:35], a[0:3], 0
  ds_read_b128 v[44:47], v252 offset:3072
  v_mfma_f32_32x32x16_bf16 v[64:79], v[32:35], a[4:7], 0
  s_waitcnt lgkmcnt(2)
  v_mfma_f32_32x32x16_bf16 v[48:63], v[36:39], a[8:11], v[48:63]
  ds_read_b128 v[32:35], v252 offset:4096
  v_cvt_pk_bf16_f32 v80, v96, v97
  v_cvt_pk_bf16_f32 v81, v98, v99
  v_cvt_pk_bf16_f32 v82, v104, v105
  v_mfma_f32_32x32x16_bf16 v[64:79], v[36:39], a[12:15], v[64:79]
  v_cvt_pk_bf16_f32 v83, v106, v107
  buffer_store_dwordx4 v[80:83], v251, s[4:7], s39 offen offset:0 sc1
  v_cvt_pk_bf16_f32 v84, v100, v101
  v_cvt_pk_bf16_f32 v85, v102, v103
  s_waitcnt lgkmcnt(2)
  v_mfma_f32_32x32x16_bf16 v[48:63], v[40:43], a[16:19], v[48:63]
  ds_read_b128 v[36:39], v252 offset:5120
  v_cvt_pk_bf16_f32 v86, v108, v109
  v_cvt_pk_bf16_f32 v87, v110, v111
  buffer_store_dwordx4 v[84:87], v251, s[4:7], s39 offen offset:512 sc1
  v_mfma_f32_32x32x16_bf16 v[64:79], v[40:43], a[20:23], v[64:79]
  v_cvt_pk_bf16_f32 v88, v112, v113
  v_cvt_pk_bf16_f32 v89, v114, v115
  v_cvt_pk_bf16_f32 v90, v120, v121
  v_cvt_pk_bf16_f32 v91, v122, v123
  s_waitcnt lgkmcnt(2)
  v_mfma_f32_32x32x16_bf16 v[48:63], v[44:47], a[24:27], v[48:63]
  ds_read_b128 v[40:43], v252 offset:6144
  buffer_store_dwordx4 v[88:91], v251, s[4:7], s39 offen offset:2048 sc1
  v_cvt_pk_bf16_f32 v92, v116, v117
  v_cvt_pk_bf16_f32 v93, v118, v119
  v_mfma_f32_32x32x16_bf16 v[64:79], v[44:47], a[28:31], v[64:79]
  v_cvt_pk_bf16_f32 v94, v124, v125
  v_cvt_pk_bf16_f32 v95, v126, v127
  buffer_store_dwordx4 v[92:95], v251, s[4:7], s39 offen offset:2560 sc1
  s_waitcnt lgkmcnt(2)
  v_mfma_f32_32x32x16_bf16 v[48:63], v[32:35], a[32:35], v[48:63]
  ds_read_b128 v[44:47], v252 offset:7168
  v_mfma_f32_32x32x16_bf16 v[64:79], v[32:35], a[36:39], v[64:79]
  s_waitcnt lgkmcnt(2)
  v_mfma_f32_32x32x16_bf16 v[48:63], v[36:39], a[40:43], v[48:63]
  ds_read_b128 v[32:35], v252 offset:8192
  v_mfma_f32_32x32x16_bf16 v[64:79], v[36:39], a[44:47], v[64:79]
  s_waitcnt lgkmcnt(2)
  v_mfma_f32_32x32x16_bf16 v[48:63], v[40:43], a[48:51], v[48:63]
  ds_read_b128 v[36:39], v252 offset:9216
  v_mfma_f32_32x32x16_bf16 v[64:79], v[40:43], a[52:55], v[64:79]
  s_waitcnt lgkmcnt(2)
  v_mfma_f32_32x32x16_bf16 v[48:63], v[44:47], a[56:59], v[48:63]
  ds_read_b128 v[40:43], v252 offset:10240
  v_mfma_f32_32x32x16_bf16 v[64:79], v[44:47], a[60:63], v[64:79]
  s_waitcnt lgkmcnt(2)
  v_mfma_f32_32x32x16_bf16 v[48:63], v[32:35], a[64:67], v[48:63]
  ds_read_b128 v[44:47], v252 offset:11264
  v_mfma_f32_32x32x16_bf16 v[64:79], v[32:35], a[68:71], v[64:79]
  s_waitcnt lgkmcnt(2)
  v_mfma_f32_32x32x16_bf16 v[48:63], v[36:39], a[72:75], v[48:63]
  ds_read_b128 v[32:35], v252 offset:12288
  v_mfma_f32_32x32x16_bf16 v[64:79], v[36:39], a[76:79], v[64:79]
  s_waitcnt lgkmcnt(2)
  v_mfma_f32_32x32x16_bf16 v[48:63], v[40:43], a[80:83], v[48:63]
  ds_read_b128 v[36:39], v252 offset:13312
  v_mfma_f32_32x32x16_bf16 v[64:79], v[40:43], a[84:87], v[64:79]
  s_waitcnt lgkmcnt(2)
  v_mfma_f32_32x32x16_bf16 v[48:63], v[44:47], a[88:91], v[48:63]
  ds_read_b128 v[40:43], v252 offset:14336
  v_mfma_f32_32x32x16_bf16 v[64:79], v[44:47], a[92:95], v[64:79]
  s_waitcnt lgkmcnt(2)
  v_mfma_f32_32x32x16_bf16 v[48:63], v[32:35], a[96:99], v[48:63]
  ds_read_b128 v[44:47], v252 offset:15360
  v_mfma_f32_32x32x16_bf16 v[64:79], v[32:35], a[100:103], v[64:79]
  s_waitcnt lgkmcnt(2)
  v_mfma_f32_32x32x16_bf16 v[48:63], v[36:39], a[104:107], v[48:63]
  ds_read_b128 v[32:35], v252 offset:16384
  v_mfma_f32_32x32x16_bf16 v[64:79], v[36:39], a[108:111], v[64:79]
  s_waitcnt lgkmcnt(2)
  v_mfma_f32_32x32x16_bf16 v[48:63], v[40:43], a[112:115], v[48:63]
  ds_read_b128 v[36:39], v252 offset:17408
  v_mfma_f32_32x32x16_bf16 v[64:79], v[40:43], a[116:119], v[64:79]
  s_waitcnt lgkmcnt(2)
  v_mfma_f32_32x32x16_bf16 v[48:63], v[44:47], a[120:123], v[48:63]
  ds_read_b128 v[40:43], v252 offset:18432
  s_waitcnt vmcnt(4)
  s_mov_b32 s39, s51
  s_add_u32 s51, s51, 262144
  s_add_u32 s38, s38, 32768
  v_mfma_f32_32x32x16_bf16 v[64:79], v[44:47], a[124:127], v[64:79]
  ds_write_b128 v241, v[0:3] offset:32768
  s_waitcnt lgkmcnt(3)
  v_mfma_f32_32x32x16_bf16 v[48:63], v[32:35], a[128:131], v[48:63]
  ds_read_b128 v[44:47], v252 offset:19456
  ds_write_b128 v241, v[4:7] offset:33792
  v_mfma_f32_32x32x16_bf16 v[64:79], v[32:35], a[132:135], v[64:79]
  ds_write_b128 v241, v[8:11] offset:34816
  s_waitcnt lgkmcnt(5)
  v_mfma_f32_32x32x16_bf16 v[48:63], v[36:39], a[136:139], v[48:63]
  ds_read_b128 v[32:35], v252 offset:20480
  ds_write_b128 v241, v[12:15] offset:35840
  v_mfma_f32_32x32x16_bf16 v[64:79], v[36:39], a[140:143], v[64:79]
  ds_write_b128 v241, v[16:19] offset:36864
  s_waitcnt lgkmcnt(7)
  v_mfma_f32_32x32x16_bf16 v[48:63], v[40:43], a[144:147], v[48:63]
  ds_read_b128 v[36:39], v252 offset:21504
  ds_write_b128 v241, v[20:23] offset:37888
  v_mfma_f32_32x32x16_bf16 v[64:79], v[40:43], a[148:151], v[64:79]
  ds_write_b128 v241, v[24:27] offset:38912
  s_waitcnt lgkmcnt(8)
  v_mfma_f32_32x32x16_bf16 v[48:63], v[44:47], a[152:155], v[48:63]
  ds_read_b128 v[40:43], v252 offset:22528
  ds_write_b128 v241, v[28:31] offset:39936
  v_mfma_f32_32x32x16_bf16 v[64:79], v[44:47], a[156:159], v[64:79]
  s_waitcnt lgkmcnt(7)
  v_mfma_f32_32x32x16_bf16 v[48:63], v[32:35], a[160:163], v[48:63]
  ds_read_b128 v[44:47], v252 offset:23552
  v_mfma_f32_32x32x16_bf16 v[64:79], v[32:35], a[164:167], v[64:79]
  s_waitcnt lgkmcnt(5)
  v_mfma_f32_32x32x16_bf16 v[48:63], v[36:39], a[168:171], v[48:63]
  ds_read_b128 v[32:35], v252 offset:24576
  v_mfma_f32_32x32x16_bf16 v[64:79], v[36:39], a[172:175], v[64:79]
  s_waitcnt lgkmcnt(3)
  v_mfma_f32_32x32x16_bf16 v[48:63], v[40:43], a[176:179], v[48:63]
  ds_read_b128 v[36:39], v252 offset:25600
  v_mfma_f32_32x32x16_bf16 v[64:79], v[40:43], a[180:183], v[64:79]
  s_waitcnt lgkmcnt(2)
  v_mfma_f32_32x32x16_bf16 v[48:63], v[44:47], a[184:187], v[48:63]
  ds_read_b128 v[40:43], v252 offset:26624
  buffer_load_dwordx4 v[0:3], v241, s[4:7], s38 offen offset:0 sc1
  v_mfma_f32_32x32x16_bf16 v[64:79], v[44:47], a[188:191], v[64:79]
  buffer_load_dwordx4 v[4:7], v241, s[4:7], s38 offen offset:1024 sc1
  s_waitcnt lgkmcnt(2)
  v_mfma_f32_32x32x16_bf16 v[48:63], v[32:35], a[192:195], v[48:63]
  ds_read_b128 v[44:47], v252 offset:27648
  buffer_load_dwordx4 v[8:11], v241, s[4:7], s38 offen offset:2048 sc1
  v_mfma_f32_32x32x16_bf16 v[64:79], v[32:35], a[196:199], v[64:79]
  buffer_load_dwordx4 v[12:15], v241, s[4:7], s38 offen offset:3072 sc1
  s_waitcnt lgkmcnt(2)
  v_mfma_f32_32x32x16_bf16 v[48:63], v[36:39], a[200:203], v[48:63]
  ds_read_b128 v[32:35], v252 offset:28672
  buffer_load_dwordx4 v[16:19], v242, s[4:7], s38 offen offset:0 sc1
  v_mfma_f32_32x32x16_bf16 v[64:79], v[36:39], a[204:207], v[64:79]
  buffer_load_dwordx4 v[20:23], v242, s[4:7], s38 offen offset:1024 sc1
  s_waitcnt lgkmcnt(2)
  v_mfma_f32_32x32x16_bf16 v[48:63], v[40:43], a[208:211], v[48:63]
  ds_read_b128 v[36:39], v252 offset:29696
  buffer_load_dwordx4 v[24:27], v242, s[4:7], s38 offen offset:2048 sc1
  v_mfma_f32_32x32x16_bf16 v[64:79], v[40:43], a[212:215], v[64:79]
  buffer_load_dwordx4 v[28:31], v242, s[4:7], s38 offen offset:3072 sc1
  s_waitcnt lgkmcnt(2)
  v_mfma_f32_32x32x16_bf16 v[48:63], v[44:47], a[216:219], v[48:63]
  ds_read_b128 v[40:43], v252 offset:30720
  v_mfma_f32_32x32x16_bf16 v[64:79], v[44:47], a[220:223], v[64:79]
  s_waitcnt lgkmcnt(2)
  v_mfma_f32_32x32x16_bf16 v[48:63], v[32:35], a[224:227], v[48:63]
  ds_read_b128 v[44:47], v252 offset:31744
  v_mfma_f32_32x32x16_bf16 v[64:79], v[32:35], a[228:231], v[64:79]
  s_waitcnt lgkmcnt(2)
  v_mfma_f32_32x32x16_bf16 v[48:63], v[36:39], a[232:235], v[48:63]
  v_mfma_f32_32x32x16_bf16 v[64:79], v[36:39], a[236:239], v[64:79]
  s_waitcnt lgkmcnt(1)
  v_mfma_f32_32x32x16_bf16 v[48:63], v[40:43], a[240:243], v[48:63]
  v_mfma_f32_32x32x16_bf16 v[64:79], v[40:43], a[244:247], v[64:79]
  s_waitcnt lgkmcnt(0)
  v_mfma_f32_32x32x16_bf16 v[48:63], v[44:47], a[248:251], v[48:63]
  v_mfma_f32_32x32x16_bf16 v[64:79], v[44:47], a[252:255], v[64:79]
  s_waitcnt vmcnt(8) lgkmcnt(0)
  s_barrier
  s_cmp_lg_u32 s33, 0
  s_cbranch_scc1 w_fl_50034
  v_mov_b32 v250, s36
  s_mov_b64 exec, 1
  buffer_store_dword v250, off, s[4:7], s40 sc1
  s_mov_b64 exec, -1
w_fl_50034:
  s_add_u32 s36, s36, 1
  ds_read_b128 v[32:35], v252 offset:32768
  ds_read_b128 v[36:39], v252 offset:33792
  ds_read_b128 v[40:43], v252 offset:34816
  s_waitcnt lgkmcnt(2)
  v_mfma_f32_32x32x16_bf16 v[96:111], v[32:35], a[0:3], 0
  ds_read_b128 v[44:47], v252 offset:35840
  v_mfma_f32_32x32x16_bf16 v[112:127], v[32:35], a[4:7], 0
  s_waitcnt lgkmcnt(2)
  v_mfma_f32_32x32x16_bf16 v[96:111], v[36:39], a[8:11], v[96:111]
  ds_read_b128 v[32:35], v252 offset:36864
  v_cvt_pk_bf16_f32 v80, v48, v49
  v_cvt_pk_bf16_f32 v81, v50, v51
  v_cvt_pk_bf16_f32 v82, v56, v57
  v_mfma_f32_32x32x16_bf16 v[112:127], v[36:39], a[12:15], v[112:127]
  v_cvt_pk_bf16_f32 v83, v58, v59
  buffer_store_dwordx4 v[80:83], v251, s[4:7], s39 offen offset:0 sc1
  v_cvt_pk_bf16_f32 v84, v52, v53
  v_cvt_pk_bf16_f32 v85, v54, v55
  s_waitcnt lgkmcnt(2)
  v_mfma_f32_32x32x16_bf16 v[96:111], v[40:43], a[16:19], v[96:111]
  ds_read_b128 v[36:39], v252 offset:37888
  v_cvt_pk_bf16_f32 v86, v60, v61
  v_cvt_pk_bf16_f32 v87, v62, v63
  buffer_store_dwordx4 v[84:87], v251, s[4:7], s39 offen offset:512 sc1
  v_mfma_f32_32x32x16_bf16 v[112:127], v[40:43], a[20:23], v[112:127]
  v_cvt_pk_bf16_f32 v88, v64, v65
  v_cvt_pk_bf16_f32 v89, v66, v67
  v_cvt_pk_bf16_f32 v90, v72, v73
  v_cvt_pk_bf16_f32 v91, v74, v75
  s_waitcnt lgkmcnt(2)
  v_mfma_f32_32x32x16_bf16 v[96:111], v[44:47], a[24:27], v[96:111]
  ds_read_b128 v[40:43], v252 offset:38912
  buffer_store_dwordx4 v[88:91], v251, s[4:7], s39 offen offset:2048 sc1
  v_cvt_pk_bf16_f32 v92, v68, v69
  v_cvt_pk_bf16_f32 v93, v70, v71
  v_mfma_f32_32x32x16_bf16 v[112:127], v[44:47], a[28:31], v[112:127]
  v_cvt_pk_bf16_f32 v94, v76, v77
  v_cvt_pk_bf16_f32 v95, v78, v79
  buffer_store_dwordx4 v[92:95], v251, s[4:7], s39 offen offset:2560 sc1
  s_waitcnt lgkmcnt(2)
  v_mfma_f32_32x32x16_bf16 v[96:111], v[32:35], a[32:35], v[96:111]
  ds_read_b128 v[44:47], v252 offset:39936
  v_mfma_f32_32x32x16_bf16 v[112:127], v[32:35], a[36:39], v[112:127]
  s_waitcnt lgkmcnt(2)
  v_mfma_f32_32x32x16_bf16 v[96:111], v[36:39], a[40:43], v[96:111]
  ds_read_b128 v[32:35], v252 offset:40960
  v_mfma_f32_32x32x16_bf16 v[112:127], v[36:39], a[44:47], v[112:127]
  s_waitcnt lgkmcnt(2)
  v_mfma_f32_32x32x16_bf16 v[96:111], v[40:43], a[48:51], v[96:111]
  ds_read_b128 v[36:39], v252 offset:41984
  v_mfma_f32_32x32x16_bf16 v[112:127], v[40:43], a[52:55], v[112:127]
  s_waitcnt lgkmcnt(2)
  v_mfma_f32_32x32x16_bf16 v[96:111], v[44:47], a[56:59], v[96:111]
  ds_read_b128 v[40:43], v252 offset:43008
  v_mfma_f32_32x32x16_bf16 v[112:127], v[44:47], a[60:63], v[112:127]
  s_waitcnt lgkmcnt(2)
  v_mfma_f32_32x32x16_bf16 v[96:111], v[32:35], a[64:67], v[96:111]
  ds_read_b128 v[44:47], v252 offset:44032
  v_mfma_f32_32x32x16_bf16 v[112:127], v[32:35], a[68:71], v[112:127]
  s_waitcnt lgkmcnt(2)
  v_mfma_f32_32x32x16_bf16 v[96:111], v[36:39], a[72:75], v[96:111]
  ds_read_b128 v[32:35], v252 offset:45056
  v_mfma_f32_32x32x16_bf16 v[112:127], v[36:39], a[76:79], v[112:127]
  s_waitcnt lgkmcnt(2)
  v_mfma_f32_32x32x16_bf16 v[96:111], v[40:43], a[80:83], v[96:111]
  ds_read_b128 v[36:39], v252 offset:46080
  v_mfma_f32_32x32x16_bf16 v[112:127], v[40:43], a[84:87], v[112:127]
  s_waitcnt lgkmcnt(2)
  v_mfma_f32_32x32x16_bf16 v[96:111], v[44:47], a[88:91], v[96:111]
  ds_read_b128 v[40:43], v252 offset:47104
  v_mfma_f32_32x32x16_bf16 v[112:127], v[44:47], a[92:95], v[112:127]
  s_waitcnt lgkmcnt(2)
  v_mfma_f32_32x32x16_bf16 v[96:111], v[32:35], a[96:99], v[96:111]
  ds_read_b128 v[44:47], v252 offset:48128
  v_mfma_f32_32x32x16_bf16 v[112:127], v[32:35], a[100:103], v[112:127]
  s_waitcnt lgkmcnt(2)
  v_mfma_f32_32x32x16_bf16 v[96:111], v[36:39], a[104:107], v[96:111]
  ds_read_b128 v[32:35], v252 offset:49152
  v_mfma_f32_32x32x16_bf16 v[112:127], v[36:39], a[108:111], v[112:127]
  s_waitcnt lgkmcnt(2)
  v_mfma_f32_32x32x16_bf16 v[96:111], v[40:43], a[112:115], v[96:111]
  ds_read_b128 v[36:39], v252 offset:50176
  v_mfma_f32_32x32x16_bf16 v[112:127], v[40:43], a[116:119], v[112:127]
  s_waitcnt lgkmcnt(2)
  v_mfma_f32_32x32x16_bf16 v[96:111], v[44:47], a[120:123], v[96:111]
  ds_read_b128 v[40:43], v252 offset:51200
  s_waitcnt vmcnt(4)
  s_mov_b32 s39, s51
  s_add_u32 s51, s51, 262144
  s_add_u32 s38, s38, 32768
  v_mfma_f32_32x32x16_bf16 v[112:127], v[44:47], a[124:127], v[112:127]
  ds_write_b128 v241, v[0:3] offset:0
  s_waitcnt lgkmcnt(3)
  v_mfma_f32_32x32x16_bf16 v[96:111], v[32:35], a[128:131], v[96:111]
  ds_read_b128 v[44:47], v252 offset:52224
  ds_write_b128 v241, v[4:7] offset:1024
  v_mfma_f32_32x32x16_bf16 v[112:127], v[32:35], a[132:135], v[112:127]
  ds_write_b128 v241, v[8:11] offset:2048
  s_waitcnt lgkmcnt(5)
  v_mfma_f32_32x32x16_bf16 v[96:111], v[36:39], a[136:139], v[96:111]
  ds_read_b128 v[32:35], v252 offset:53248
  ds_write_b128 v241, v[12:15] offset:3072
  v_mfma_f32_32x32x16_bf16 v[112:127], v[36:39], a[140:143], v[112:127]
  ds_write_b128 v241, v[16:19] offset:4096
  s_waitcnt lgkmcnt(7)
  v_mfma_f32_32x32x16_bf16 v[96:111], v[40:43], a[144:147], v[96:111]
  ds_read_b128 v[36:39], v252 offset:54272
  ds_write_b128 v241, v[20:23] offset:5120
  v_mfma_f32_32x32x16_bf16 v[112:127], v[40:43], a[148:151], v[112:127]
  ds_write_b128 v241, v[24:27] offset:6144
  s_waitcnt lgkmcnt(8)
  v_mfma_f32_32x32x16_bf16 v[96:111], v[44:47], a[152:155], v[96:111]
  ds_read_b128 v[40:43], v252 offset:55296
  ds_write_b128 v241, v[28:31] offset:7168
  v_mfma_f32_32x32x16_bf16 v[112:127], v[44:47], a[156:159], v[112:127]
  s_waitcnt lgkmcnt(7)
  v_mfma_f32_32x32x16_bf16 v[96:111], v[32:35], a[160:163], v[96:111]
  ds_read_b128 v[44:47], v252 offset:56320
  v_mfma_f32_32x32x16_bf16 v[112:127], v[32:35], a[164:167], v[112:127]
  s_waitcnt lgkmcnt(5)
  v_mfma_f32_32x32x16_bf16 v[96:111], v[36:39], a[168:171], v[96:111]
  ds_read_b128 v[32:35], v252 offset:57344
  v_mfma_f32_32x32x16_bf16 v[112:127], v[36:39], a[172:175], v[112:127]
  s_waitcnt lgkmcnt(3)
  v_mfma_f32_32x32x16_bf16 v[96:111], v[40:43], a[176:179], v[96:111]
  ds_read_b128 v[36:39], v252 offset:58368
  v_mfma_f32_32x32x16_bf16 v[112:127], v[40:43], a[180:183], v[112:127]
  s_waitcnt lgkmcnt(2)
  v_mfma_f32_32x32x16_bf16 v[96:111], v[44:47], a[184:187], v[96:111]
  ds_read_b128 v[40:43], v252 offset:59392
  buffer_load_dwordx4 v[0:3], v241, s[4:7], s38 offen offset:0 sc1
  v_mfma_f32_32x32x16_bf16 v[112:127], v[44:47], a[188:191], v[112:127]
  buffer_load_dwordx4 v[4:7], v241, s[4:7], s38 offen offset:1024 sc1
  s_waitcnt lgkmcnt(2)
  v_mfma_f32_32x32x16_bf16 v[96:111], v[32:35], a[192:195], v[96:111]
  ds_read_b128 v[44:47], v252 offset:60416
  buffer_load_dwordx4 v[8:11], v241, s[4:7], s38 offen offset:2048 sc1
  v_mfma_f32_32x32x16_bf16 v[112:127], v[32:35], a[196:199], v[112:127]
  buffer_load_dwordx4 v[12:15], v241, s[4:7], s38 offen offset:3072 sc1
  s_waitcnt lgkmcnt(2)
  v_mfma_f32_32x32x16_bf16 v[96:111], v[36:39], a[200:203], v[96:111]
  ds_read_b128 v[32:35], v252 offset:61440
  buffer_load_dwordx4 v[16:19], v242, s[4:7], s38 offen offset:0 sc1
  v_mfma_f32_32x32x16_bf16 v[112:127], v[36:39], a[204:207], v[112:127]
  buffer_load_dwordx4 v[20:23], v242, s[4:7], s38 offen offset:1024 sc1
  s_waitcnt lgkmcnt(2)
  v_mfma_f32_32x32x16_bf16 v[96:111], v[40:43], a[208:211], v[96:111]
  ds_read_b128 v[36:39], v252 offset:62464
  buffer_load_dwordx4 v[24:27], v242, s[4:7], s38 offen offset:2048 sc1
  v_mfma_f32_32x32x16_bf16 v[112:127], v[40:43], a[212:215], v[112:127]
  buffer_load_dwordx4 v[28:31], v242, s[4:7], s38 offen offset:3072 sc1
  s_waitcnt lgkmcnt(2)
  v_mfma_f32_32x32x16_bf16 v[96:111], v[44:47], a[216:219], v[96:111]
  ds_read_b128 v[40:43], v252 offset:63488
  v_mfma_f32_32x32x16_bf16 v[112:127], v[44:47], a[220:223], v[112:127]
  s_waitcnt lgkmcnt(2)
  v_mfma_f32_32x32x16_bf16 v[96:111], v[32:35], a[224:227], v[96:111]
  ds_read_b128 v[44:47], v252 offset:64512
  v_mfma_f32_32x32x16_bf16 v[112:127], v[32:35], a[228:231], v[112:127]
  s_waitcnt lgkmcnt(2)
  v_mfma_f32_32x32x16_bf16 v[96:111], v[36:39], a[232:235], v[96:111]
  v_mfma_f32_32x32x16_bf16 v[112:127], v[36:39], a[236:239], v[112:127]
  s_waitcnt lgkmcnt(1)
  v_mfma_f32_32x32x16_bf16 v[96:111], v[40:43], a[240:243], v[96:111]
  v_mfma_f32_32x32x16_bf16 v[112:127], v[40:43], a[244:247], v[112:127]
  s_waitcnt lgkmcnt(0)
  v_mfma_f32_32x32x16_bf16 v[96:111], v[44:47], a[248:251], v[96:111]
  v_mfma_f32_32x32x16_bf16 v[112:127], v[44:47], a[252:255], v[112:127]
  s_waitcnt vmcnt(8) lgkmcnt(0)
  s_barrier
  s_cmp_lg_u32 s33, 0
  s_cbranch_scc1 w_fl_50035
  v_mov_b32 v250, s36
  s_mov_b64 exec, 1
  buffer_store_dword v250, off, s[4:7], s40 sc1
  s_mov_b64 exec, -1
w_fl_50035:
  s_add_u32 s36, s36, 1
  s_cmp_lt_u32 s36, 64
  s_cbranch_scc1 w_top_pv
  s_nop 7
  v_cvt_pk_bf16_f32 v80, v96, v97
  v_cvt_pk_bf16_f32 v81, v98, v99
  v_cvt_pk_bf16_f32 v82, v104, v105
  v_cvt_pk_bf16_f32 v83, v106, v107
  buffer_store_dwordx4 v[80:83], v251, s[4:7], s39 offen offset:0 sc1
  v_cvt_pk_bf16_f32 v84, v100, v101
  v_cvt_pk_bf16_f32 v85, v102, v103
  v_cvt_pk_bf16_f32 v86, v108, v109
  v_cvt_pk_bf16_f32 v87, v110, v111
  buffer_store_dwordx4 v[84:87], v251, s[4:7], s39 offen offset:512 sc1
  v_cvt_pk_bf16_f32 v88, v112, v113
  v_cvt_pk_bf16_f32 v89, v114, v115
  v_cvt_pk_bf16_f32 v90, v120, v121
  v_cvt_pk_bf16_f32 v91, v122, v123
  buffer_store_dwordx4 v[88:91], v251, s[4:7], s39 offen offset:2048 sc1
  v_cvt_pk_bf16_f32 v92, v116, v117
  v_cvt_pk_bf16_f32 v93, v118, v119
  v_cvt_pk_bf16_f32 v94, v124, v125
  v_cvt_pk_bf16_f32 v95, v126, v127
  buffer_store_dwordx4 v[92:95], v251, s[4:7], s39 offen offset:2560 sc1
  s_mov_b32 s36, 63
  s_waitcnt vmcnt(0)
  s_barrier
  s_cmp_lg_u32 s33, 0
  s_cbranch_scc1 w_fl_50036
  s_add_u32 s42, s36, 1
  v_mov_b32 v250, s42
  s_mov_b64 exec, 1
  buffer_store_dword v250, off, s[4:7], s40 sc1
  s_mov_b64 exec, -1
w_fl_50036:
  s_branch w_exit
w_mqk:
  s_lshr_b32 s42, s53, 4
  s_lshl_b32 s43, s42, 3
  s_add_u32 s43, s43, 16
  s_load_dwordx2 s[8:9], s[0:1], s43
  s_mov_b32 s10, 0x400000
  s_mov_b32 s11, 0x20000
  s_cmp_eq_u32 s42, 0
  s_mov_b32 s41, 0x3ef40000
  s_cselect_b32 s41, 0x3e890000, s41
  s_lshl_b32 s39, 0x1000000, s42
  s_and_b32 s53, s53, 15
  s_lshl2_add_u32 s42, s53, s33
  s_lshl_b32 s46, s42, 7
  s_add_u32 s47, s46, 64
  s_lshl_b32 s42, s42, 12
  s_add_u32 s39, s39, s42
  s_add_u32 s42, s36, 64
  s_lshl_b32 s42, s42, 18
  s_add_u32 s39, s39, s42
  s_mov_b32 s45, 8192
  v_and_b32 v250, 15, v255
  v_lshlrev_b32 v251, 4, v250
  v_lshl_add_u32 v251, v253, 8, v251
  v_bfe_u32 v250, v255, 4, 1
  v_lshl_add_u32 v251, v250, 10, v251
  s_waitcnt lgkmcnt(0)
  s_lshl2_add_u32 s42, s53, s33
  s_lshl_b32 s42, s42, 10
  s_lshl_b32 s39, s36, 16
  s_add_u32 s39, s39, s42
  s_add_u32 s39, s39, 150994944
  s_lshl_b32 s48, s33, 15
  v_lshrrev_b32 v250, 3, v255
  v_mul_lo_u32 v250, v250, s45
  v_bfe_u32 v248, v255, 4, 1
  v_lshlrev_b32 v248, 2, v248
  v_xor_b32 v249, v248, v255
  v_and_b32 v249, 7, v249
  v_lshl_add_u32 v247, v249, 4, v250
  s_lshl_b32 s44, s45, 3
  s_add_u32 m0, s48, 0
  s_nop 0
  buffer_load_dwordx4 v247, s[8:11], s46 offen lds
  s_add_u32 s46, s46, s44
  s_add_u32 m0, s48, 1024
  s_nop 0
  buffer_load_dwordx4 v247, s[8:11], s46 offen lds
  s_add_u32 s46, s46, s44
  s_add_u32 m0, s48, 2048
  s_nop 0
  buffer_load_dwordx4 v247, s[8:11], s46 offen lds
  s_add_u32 s46, s46, s44
  s_add_u32 m0, s48, 3072
  s_nop 0
  buffer_load_dwordx4 v247, s[8:11], s46 offen lds
  s_add_u32 s46, s46, s44
  s_add_u32 m0, s48, 4096
  s_nop 0
  buffer_load_dwordx4 v247, s[8:11], s46 offen lds
  s_add_u32 s46, s46, s44
  s_add_u32 m0, s48, 5120
  s_nop 0
  buffer_load_dwordx4 v247, s[8:11], s46 offen lds
  s_add_u32 s46, s46, s44
  s_add_u32 m0, s48, 6144
  s_nop 0
  buffer_load_dwordx4 v247, s[8:11], s46 offen lds
  s_add_u32 s46, s46, s44
  s_add_u32 m0, s48, 7168
  s_nop 0
  buffer_load_dwordx4 v247, s[8:11], s46 offen lds
  s_add_u32 s46, s46, s44
  s_add_u32 m0, s48, 8192
  s_nop 0
  buffer_load_dwordx4 v247, s[8:11], s46 offen lds
  s_add_u32 s46, s46, s44
  s_add_u32 m0, s48, 9216
  s_nop 0
  buffer_load_dwordx4 v247, s[8:11], s46 offen lds
  s_add_u32 s46, s46, s44
  s_add_u32 m0, s48, 10240
  s_nop 0
  buffer_load_dwordx4 v247, s[8:11], s46 offen lds
  s_add_u32 s46, s46, s44
  s_add_u32 m0, s48, 11264
  s_nop 0
  buffer_load_dwordx4 v247, s[8:11], s46 offen lds
  s_add_u32 s46, s46, s44
  s_add_u32 m0, s48, 12288
  s_nop 0
  buffer_load_dwordx4 v247, s[8:11], s46 offen lds
  s_add_u32 s46, s46, s44
  s_add_u32 m0, s48, 13312
  s_nop 0
  buffer_load_dwordx4 v247, s[8:11], s46 offen lds
  s_add_u32 s46, s46, s44
  s_add_u32 m0, s48, 14336
  s_nop 0
  buffer_load_dwordx4 v247, s[8:11], s46 offen lds
  s_add_u32 s46, s46, s44
  s_add_u32 m0, s48, 15360
  s_nop 0
  buffer_load_dwordx4 v247, s[8:11], s46 offen lds
  s_add_u32 s46, s46, s44
  s_add_u32 m0, s48, 16384
  s_nop 0
  buffer_load_dwordx4 v247, s[8:11], s46 offen lds
  s_add_u32 s46, s46, s44
  s_add_u32 m0, s48, 17408
  s_nop 0
  buffer_load_dwordx4 v247, s[8:11], s46 offen lds
  s_add_u32 s46, s46, s44
  s_add_u32 m0, s48, 18432
  s_nop 0
  buffer_load_dwordx4 v247, s[8:11], s46 offen lds
  s_add_u32 s46, s46, s44
  s_add_u32 m0, s48, 19456
  s_nop 0
  buffer_load_dwordx4 v247, s[8:11], s46 offen lds
  s_add_u32 s46, s46, s44
  s_add_u32 m0, s48, 20480
  s_nop 0
  buffer_load_dwordx4 v247, s[8:11], s46 offen lds
  s_add_u32 s46, s46, s44
  s_add_u32 m0, s48, 21504
  s_nop 0
  buffer_load_dwordx4 v247, s[8:11], s46 offen lds
  s_add_u32 s46, s46, s44
  s_add_u32 m0, s48, 22528
  s_nop 0
  buffer_load_dwordx4 v247, s[8:11], s46 offen lds
  s_add_u32 s46, s46, s44
  s_add_u32 m0, s48, 23552
  s_nop 0
  buffer_load_dwordx4 v247, s[8:11], s46 offen lds
  s_add_u32 s46, s46, s44
  s_add_u32 m0, s48, 24576
  s_nop 0
  buffer_load_dwordx4 v247, s[8:11], s46 offen lds
  s_add_u32 s46, s46, s44
  s_add_u32 m0, s48, 25600
  s_nop 0
  buffer_load_dwordx4 v247, s[8:11], s46 offen lds
  s_add_u32 s46, s46, s44
  s_add_u32 m0, s48, 26624
  s_nop 0
  buffer_load_dwordx4 v247, s[8:11], s46 offen lds
  s_add_u32 s46, s46, s44
  s_add_u32 m0, s48, 27648
  s_nop 0
  buffer_load_dwordx4 v247, s[8:11], s46 offen lds
  s_add_u32 s46, s46, s44
  s_add_u32 m0, s48, 28672
  s_nop 0
  buffer_load_dwordx4 v247, s[8:11], s46 offen lds
  s_add_u32 s46, s46, s44
  s_add_u32 m0, s48, 29696
  s_nop 0
  buffer_load_dwordx4 v247, s[8:11], s46 offen lds
  s_add_u32 s46, s46, s44
  s_add_u32 m0, s48, 30720
  s_nop 0
  buffer_load_dwordx4 v247, s[8:11], s46 offen lds
  s_add_u32 s46, s46, s44
  s_add_u32 m0, s48, 31744
  s_nop 0
  buffer_load_dwordx4 v247, s[8:11], s46 offen lds
  s_add_u32 s46, s46, s44
  v_and_b32 v249, 3, v255
  v_bfe_u32 v250, v255, 2, 2
  v_lshl_add_u32 v250, v253, 3, v250
  v_lshlrev_b32 v250, 7, v250
  v_bfe_u32 v248, v255, 4, 1
  v_lshl_add_u32 v250, v248, 5, v250
  v_lshl_add_u32 v250, v249, 3, v250
  v_bfe_u32 v248, v255, 3, 1
  v_lshl_add_u32 v250, v248, 6, v250
  v_add_u32 v240, s48, v250
  v_xor_b32 v241, 64, v240
  s_waitcnt vmcnt(28)
  ds_read_b64_tr_b16 a[0:1], v240 offset:0
  ds_read_b64_tr_b16 a[2:3], v240 offset:512
  ds_read_b64_tr_b16 a[4:5], v241 offset:0
  ds_read_b64_tr_b16 a[6:7], v241 offset:512
  ds_read_b64_tr_b16 a[8:9], v240 offset:2048
  ds_read_b64_tr_b16 a[10:11], v240 offset:2560
  ds_read_b64_tr_b16 a[12:13], v241 offset:2048
  ds_read_b64_tr_b16 a[14:15], v241 offset:2560
  s_waitcnt lgkmcnt(0)
  s_add_u32 m0, s48, 0
  s_nop 0
  buffer_load_dwordx4 v247, s[8:11], s46 offen lds
  s_add_u32 s46, s46, s44
  s_add_u32 m0, s48, 1024
  s_nop 0
  buffer_load_dwordx4 v247, s[8:11], s46 offen lds
  s_add_u32 s46, s46, s44
  s_add_u32 m0, s48, 2048
  s_nop 0
  buffer_load_dwordx4 v247, s[8:11], s46 offen lds
  s_add_u32 s46, s46, s44
  s_add_u32 m0, s48, 3072
  s_nop 0
  buffer_load_dwordx4 v247, s[8:11], s46 offen lds
  s_add_u32 s46, s46, s44
  s_waitcnt vmcnt(28)
  ds_read_b64_tr_b16 a[16:17], v240 offset:4096
  ds_read_b64_tr_b16 a[18:19], v240 offset:4608
  ds_read_b64_tr_b16 a[20:21], v241 offset:4096
  ds_read_b64_tr_b16 a[22:23], v241 offset:4608
  ds_read_b64_tr_b16 a[24:25], v240 offset:6144
  ds_read_b64_tr_b16 a[26:27], v240 offset:6656
  ds_read_b64_tr_b16 a[28:29], v241 offset:6144
  ds_read_b64_tr_b16 a[30:31], v241 offset:6656
  s_waitcnt lgkmcnt(0)
  s_add_u32 m0, s48, 4096
  s_nop 0
  buffer_load_dwordx4 v247, s[8:11], s46 offen lds
  s_add_u32 s46, s46, s44
  s_add_u32 m0, s48, 5120
  s_nop 0
  buffer_load_dwordx4 v247, s[8:11], s46 offen lds
  s_add_u32 s46, s46, s44
  s_add_u32 m0, s48, 6144
  s_nop 0
  buffer_load_dwordx4 v247, s[8:11], s46 offen lds
  s_add_u32 s46, s46, s44
  s_add_u32 m0, s48, 7168
  s_nop 0
  buffer_load_dwordx4 v247, s[8:11], s46 offen lds
  s_add_u32 s46, s46, s44
  s_waitcnt vmcnt(28)
  ds_read_b64_tr_b16 a[32:33], v240 offset:8192
  ds_read_b64_tr_b16 a[34:35], v240 offset:8704
  ds_read_b64_tr_b16 a[36:37], v241 offset:8192
  ds_read_b64_tr_b16 a[38:39], v241 offset:8704
  ds_read_b64_tr_b16 a[40:41], v240 offset:10240
  ds_read_b64_tr_b16 a[42:43], v240 offset:10752
  ds_read_b64_tr_b16 a[44:45], v241 offset:10240
  ds_read_b64_tr_b16 a[46:47], v241 offset:10752
  s_waitcnt lgkmcnt(0)
  s_add_u32 m0, s48, 8192
  s_nop 0
  buffer_load_dwordx4 v247, s[8:11], s46 offen lds
  s_add_u32 s46, s46, s44
  s_add_u32 m0, s48, 9216
  s_nop 0
  buffer_load_dwordx4 v247, s[8:11], s46 offen lds
  s_add_u32 s46, s46, s44
  s_add_u32 m0, s48, 10240
  s_nop 0
  buffer_load_dwordx4 v247, s[8:11], s46 offen lds
  s_add_u32 s46, s46, s44
  s_add_u32 m0, s48, 11264
  s_nop 0
  buffer_load_dwordx4 v247, s[8:11], s46 offen lds
  s_add_u32 s46, s46, s44
  s_waitcnt vmcnt(28)
  ds_read_b64_tr_b16 a[48:49], v240 offset:12288
  ds_read_b64_tr_b16 a[50:51], v240 offset:12800
  ds_read_b64_tr_b16 a[52:53], v241 offset:12288
  ds_read_b64_tr_b16 a[54:55], v241 offset:12800
  ds_read_b64_tr_b16 a[56:57], v240 offset:14336
  ds_read_b64_tr_b16 a[58:59], v240 offset:14848
  ds_read_b64_tr_b16 a[60:61], v241 offset:14336
  ds_read_b64_tr_b16 a[62:63], v241 offset:14848
  s_waitcnt lgkmcnt(0)
  s_add_u32 m0, s48, 12288
  s_nop 0
  buffer_load_dwordx4 v247, s[8:11], s46 offen lds
  s_add_u32 s46, s46, s44
  s_add_u32 m0, s48, 13312
  s_nop 0
  buffer_load_dwordx4 v247, s[8:11], s46 offen lds
  s_add_u32 s46, s46, s44
  s_add_u32 m0, s48, 14336
  s_nop 0
  buffer_load_dwordx4 v247, s[8:11], s46 offen lds
  s_add_u32 s46, s46, s44
  s_add_u32 m0, s48, 15360
  s_nop 0
  buffer_load_dwordx4 v247, s[8:11], s46 offen lds
  s_add_u32 s46, s46, s44
  s_waitcnt vmcnt(28)
  ds_read_b64_tr_b16 a[64:65], v240 offset:16384
  ds_read_b64_tr_b16 a[66:67], v240 offset:16896
  ds_read_b64_tr_b16 a[68:69], v241 offset:16384
  ds_read_b64_tr_b16 a[70:71], v241 offset:16896
  ds_read_b64_tr_b16 a[72:73], v240 offset:18432
  ds_read_b64_tr_b16 a[74:75], v240 offset:18944
  ds_read_b64_tr_b16 a[76:77], v241 offset:18432
  ds_read_b64_tr_b16 a[78:79], v241 offset:18944
  s_waitcnt lgkmcnt(0)
  s_add_u32 m0, s48, 16384
  s_nop 0
  buffer_load_dwordx4 v247, s[8:11], s46 offen lds
  s_add_u32 s46, s46, s44
  s_add_u32 m0, s48, 17408
  s_nop 0
  buffer_load_dwordx4 v247, s[8:11], s46 offen lds
  s_add_u32 s46, s46, s44
  s_add_u32 m0, s48, 18432
  s_nop 0
  buffer_load_dwordx4 v247, s[8:11], s46 offen lds
  s_add_u32 s46, s46, s44
  s_add_u32 m0, s48, 19456
  s_nop 0
  buffer_load_dwordx4 v247, s[8:11], s46 offen lds
  s_add_u32 s46, s46, s44
  s_waitcnt vmcnt(28)
  ds_read_b64_tr_b16 a[80:81], v240 offset:20480
  ds_read_b64_tr_b16 a[82:83], v240 offset:20992
  ds_read_b64_tr_b16 a[84:85], v241 offset:20480
  ds_read_b64_tr_b16 a[86:87], v241 offset:20992
  ds_read_b64_tr_b16 a[88:89], v240 offset:22528
  ds_read_b64_tr_b16 a[90:91], v240 offset:23040
  ds_read_b64_tr_b16 a[92:93], v241 offset:22528
  ds_read_b64_tr_b16 a[94:95], v241 offset:23040
  s_waitcnt lgkmcnt(0)
  s_add_u32 m0, s48, 20480
  s_nop 0
  buffer_load_dwordx4 v247, s[8:11], s46 offen lds
  s_add_u32 s46, s46, s44
  s_add_u32 m0, s48, 21504
  s_nop 0
  buffer_load_dwordx4 v247, s[8:11], s46 offen lds
  s_add_u32 s46, s46, s44
  s_add_u32 m0, s48, 22528
  s_nop 0
  buffer_load_dwordx4 v247, s[8:11], s46 offen lds
  s_add_u32 s46, s46, s44
  s_add_u32 m0, s48, 23552
  s_nop 0
  buffer_load_dwordx4 v247, s[8:11], s46 offen lds
  s_add_u32 s46, s46, s44
  s_waitcnt vmcnt(28)
  ds_read_b64_tr_b16 a[96:97], v240 offset:24576
  ds_read_b64_tr_b16 a[98:99], v240 offset:25088
  ds_read_b64_tr_b16 a[100:101], v241 offset:24576
  ds_read_b64_tr_b16 a[102:103], v241 offset:25088
  ds_read_b64_tr_b16 a[104:105], v240 offset:26624
  ds_read_b64_tr_b16 a[106:107], v240 offset:27136
  ds_read_b64_tr_b16 a[108:109], v241 offset:26624
  ds_read_b64_tr_b16 a[110:111], v241 offset:27136
  s_waitcnt lgkmcnt(0)
  s_add_u32 m0, s48, 24576
  s_nop 0
  buffer_load_dwordx4 v247, s[8:11], s46 offen lds
  s_add_u32 s46, s46, s44
  s_add_u32 m0, s48, 25600
  s_nop 0
  buffer_load_dwordx4 v247, s[8:11], s46 offen lds
  s_add_u32 s46, s46, s44
  s_add_u32 m0, s48, 26624
  s_nop 0
  buffer_load_dwordx4 v247, s[8:11], s46 offen lds
  s_add_u32 s46, s46, s44
  s_add_u32 m0, s48, 27648
  s_nop 0
  buffer_load_dwordx4 v247, s[8:11], s46 offen lds
  s_add_u32 s46, s46, s44
  s_waitcnt vmcnt(28)
  ds_read_b64_tr_b16 a[112:113], v240 offset:28672
  ds_read_b64_tr_b16 a[114:115], v240 offset:29184
  ds_read_b64_tr_b16 a[116:117], v241 offset:28672
  ds_read_b64_tr_b16 a[118:119], v241 offset:29184
  ds_read_b64_tr_b16 a[120:121], v240 offset:30720
  ds_read_b64_tr_b16 a[122:123], v240 offset:31232
  ds_read_b64_tr_b16 a[124:125], v241 offset:30720
  ds_read_b64_tr_b16 a[126:127], v241 offset:31232
  s_waitcnt lgkmcnt(0)
  s_add_u32 m0, s48, 28672
  s_nop 0
  buffer_load_dwordx4 v247, s[8:11], s46 offen lds
  s_add_u32 s46, s46, s44
  s_add_u32 m0, s48, 29696
  s_nop 0
  buffer_load_dwordx4 v247, s[8:11], s46 offen lds
  s_add_u32 s46, s46, s44
  s_add_u32 m0, s48, 30720
  s_nop 0
  buffer_load_dwordx4 v247, s[8:11], s46 offen lds
  s_add_u32 s46, s46, s44
  s_add_u32 m0, s48, 31744
  s_nop 0
  buffer_load_dwordx4 v247, s[8:11], s46 offen lds
  s_add_u32 s46, s46, s44
  s_waitcnt vmcnt(28)
  ds_read_b64_tr_b16 a[128:129], v240 offset:0
  ds_read_b64_tr_b16 a[130:131], v240 offset:512
  ds_read_b64_tr_b16 a[132:133], v241 offset:0
  ds_read_b64_tr_b16 a[134:135], v241 offset:512
  ds_read_b64_tr_b16 a[136:137], v240 offset:2048
  ds_read_b64_tr_b16 a[138:139], v240 offset:2560
  ds_read_b64_tr_b16 a[140:141], v241 offset:2048
  ds_read_b64_tr_b16 a[142:143], v241 offset:2560
  s_waitcnt lgkmcnt(0)
  s_waitcnt vmcnt(24)
  ds_read_b64_tr_b16 a[144:145], v240 offset:4096
  ds_read_b64_tr_b16 a[146:147], v240 offset:4608
  ds_read_b64_tr_b16 a[148:149], v241 offset:4096
  ds_read_b64_tr_b16 a[150:151], v241 offset:4608
  ds_read_b64_tr_b16 a[152:153], v240 offset:6144
  ds_read_b64_tr_b16 a[154:155], v240 offset:6656
  ds_read_b64_tr_b16 a[156:157], v241 offset:6144
  ds_read_b64_tr_b16 a[158:159], v241 offset:6656
  s_waitcnt lgkmcnt(0)
  s_waitcnt vmcnt(20)
  ds_read_b64_tr_b16 a[160:161], v240 offset:8192
  ds_read_b64_tr_b16 a[162:163], v240 offset:8704
  ds_read_b64_tr_b16 a[164:165], v241 offset:8192
  ds_read_b64_tr_b16 a[166:167], v241 offset:8704
  ds_read_b64_tr_b16 a[168:169], v240 offset:10240
  ds_read_b64_tr_b16 a[170:171], v240 offset:10752
  ds_read_b64_tr_b16 a[172:173], v241 offset:10240
  ds_read_b64_tr_b16 a[174:175], v241 offset:10752
  s_waitcnt lgkmcnt(0)
  s_waitcnt vmcnt(16)
  ds_read_b64_tr_b16 a[176:177], v240 offset:12288
  ds_read_b64_tr_b16 a[178:179], v240 offset:12800
  ds_read_b64_tr_b16 a[180:181], v241 offset:12288
  ds_read_b64_tr_b16 a[182:183], v241 offset:12800
  ds_read_b64_tr_b16 a[184:185], v240 offset:14336
  ds_read_b64_tr_b16 a[186:187], v240 offset:14848
  ds_read_b64_tr_b16 a[188:189], v241 offset:14336
  ds_read_b64_tr_b16 a[190:191], v241 offset:14848
  s_waitcnt lgkmcnt(0)
  s_waitcnt vmcnt(12)
  ds_read_b64_tr_b16 a[192:193], v240 offset:16384
  ds_read_b64_tr_b16 a[194:195], v240 offset:16896
  ds_read_b64_tr_b16 a[196:197], v241 offset:16384
  ds_read_b64_tr_b16 a[198:199], v241 offset:16896
  ds_read_b64_tr_b16 a[200:201], v240 offset:18432
  ds_read_b64_tr_b16 a[202:203], v240 offset:18944
  ds_read_b64_tr_b16 a[204:205], v241 offset:18432
  ds_read_b64_tr_b16 a[206:207], v241 offset:18944
  s_waitcnt lgkmcnt(0)
  s_waitcnt vmcnt(8)
  ds_read_b64_tr_b16 a[208:209], v240 offset:20480
  ds_read_b64_tr_b16 a[210:211], v240 offset:20992
  ds_read_b64_tr_b16 a[212:213], v241 offset:20480
  ds_read_b64_tr_b16 a[214:215], v241 offset:20992
  ds_read_b64_tr_b16 a[216:217], v240 offset:22528
  ds_read_b64_tr_b16 a[218:219], v240 offset:23040
  ds_read_b64_tr_b16 a[220:221], v241 offset:22528
  ds_read_b64_tr_b16 a[222:223], v241 offset:23040
  s_waitcnt lgkmcnt(0)
  s_waitcnt vmcnt(4)
  ds_read_b64_tr_b16 a[224:225], v240 offset:24576
  ds_read_b64_tr_b16 a[226:227], v240 offset:25088
  ds_read_b64_tr_b16 a[228:229], v241 offset:24576
  ds_read_b64_tr_b16 a[230:231], v241 offset:25088
  ds_read_b64_tr_b16 a[232:233], v240 offset:26624
  ds_read_b64_tr_b16 a[234:235], v240 offset:27136
  ds_read_b64_tr_b16 a[236:237], v241 offset:26624
  ds_read_b64_tr_b16 a[238:239], v241 offset:27136
  s_waitcnt lgkmcnt(0)
  s_waitcnt vmcnt(0)
  ds_read_b64_tr_b16 a[240:241], v240 offset:28672
  ds_read_b64_tr_b16 a[242:243], v240 offset:29184
  ds_read_b64_tr_b16 a[244:245], v241 offset:28672
  ds_read_b64_tr_b16 a[246:247], v241 offset:29184
  ds_read_b64_tr_b16 a[248:249], v240 offset:30720
  ds_read_b64_tr_b16 a[250:251], v240 offset:31232
  ds_read_b64_tr_b16 a[252:253], v241 offset:30720
  ds_read_b64_tr_b16 a[254:255], v241 offset:31232
  s_waitcnt lgkmcnt(0)
  s_barrier
  s_mul_i32 s42, s33, 8192
  v_add_u32 v241, s42, v252
  v_add_u32 v242, 4096, v241
  v_mov_b32 v0, 0
  v_mov_b32 v16, -1
  v_mov_b32 v1, 0
  v_mov_b32 v17, -1
  v_mov_b32 v2, 0
  v_mov_b32 v18, -1
  v_mov_b32 v3, 0
  v_mov_b32 v19, -1
  ds_write_b128 v241, v[0:3] offset:0
  ds_write_b128 v241, v[0:3] offset:1024
  ds_write_b128 v241, v[0:3] offset:2048
  ds_write_b128 v241, v[0:3] offset:3072
  ds_write_b128 v241, v[0:3] offset:4096
  ds_write_b128 v241, v[0:3] offset:5120
  ds_write_b128 v241, v[0:3] offset:6144
  ds_write_b128 v241, v[0:3] offset:7168
  s_mov_b32 s51, s39
  buffer_store_dwordx4 v[16:19], v252, s[4:7], s51 offen sc1
  s_add_u32 s51, s51, 131072
  buffer_store_dwordx4 v[16:19], v252, s[4:7], s51 offen sc1
  s_add_u32 s51, s51, 131072
  buffer_store_dwordx4 v[16:19], v252, s[4:7], s51 offen sc1
  s_add_u32 s51, s51, 131072
  buffer_store_dwordx4 v[16:19], v252, s[4:7], s51 offen sc1
  s_add_u32 s51, s51, 131072
  v_lshlrev_b32 v251, 3, v255
  v_lshrrev_b32 v250, 4, v255
  v_lshlrev_b32 v243, 9, v250
  v_bfe_u32 v250, v255, 1, 1
  v_lshl_add_u32 v243, v250, 11, v243
  v_bfe_u32 v250, v255, 2, 2
  v_lshl_add_u32 v243, v250, 6, v243
  v_and_b32 v250, 1, v255
  v_lshl_add_u32 v243, v250, 5, v243
  s_lshl_b32 s42, s33, 13
  v_add_u32 v243, s42, v243
  s_lshl_b32 s38, s36, 13
  s_lshl_b32 s42, s33, 11
  s_add_u32 s38, s38, s42
  s_add_u32 s38, s38, 176160768
  s_waitcnt vmcnt(0)
  s_barrier
  s_cmp_lg_u32 s33, 0
  s_cbranch_scc1 w_cu_50037
  v_mov_b32 v250, 1
  s_mov_b64 exec, 1
  buffer_atomic_add v250, off, s[28:31], 0 offset:164
  s_mov_b64 exec, -1
w_cu_50037:
  s_cmp_lg_u32 s33, 0
  s_cbranch_scc1 w_wds_50040
  s_mov_b64 exec, 1
w_wd_50038:
  buffer_load_dword v250, off, s[28:31], 0 offset:4 sc1
  s_waitcnt vmcnt(0)
  v_readfirstlane_b32 s43, v250
  s_and_b32 s43, s43, 0xffff
  s_cmp_ge_u32 s43, 32
  s_cbranch_scc1 w_wdd_50039
  s_cmp_eq_u32 s35, 0
  s_cbranch_scc1 w_wdd_50039
  s_sub_u32 s35, s35, 1
  s_sleep 4
  s_branch w_wd_50038
w_wdd_50039:
  s_mov_b64 exec, -1
w_wds_50040:
  s_barrier
  s_waitcnt lgkmcnt(0)
w_mem_mqk:
  buffer_load_dwordx4 v[0:3], v252, s[4:7], s38 offen offset:0 sc1
  buffer_load_dwordx4 v[4:7], v252, s[4:7], s38 offen offset:1024 sc1
  s_waitcnt vmcnt(0)
  v_max3_u32 v250, v0, v1, v2
  v_max3_u32 v250, v250, v3, v4
  v_max3_u32 v250, v250, v5, v6
  v_max_u32 v250, v250, v7
  v_cmp_eq_u32 vcc, -1, v250
  s_cbranch_vccz w_memok_mqk
  s_cmp_eq_u32 s35, 0
  s_cbranch_scc1 w_memok_mqk
  s_sub_u32 s35, s35, 1
  s_sleep 1
  s_branch w_mem_mqk
w_memok_mqk:
  ds_write_b128 v243, v[0:3] offset:0
  ds_write_b128 v243, v[0:3] offset:272
  ds_write_b128 v243, v[4:7] offset:4096
  ds_write_b128 v243, v[4:7] offset:4368
  s_add_u32 s38, s38, 16384
  s_waitcnt lgkmcnt(0)
  s_barrier
  ds_read_b128 v[96:99], v252 offset:0
  ds_read_b128 v[100:103], v252 offset:1024
  ds_read_b128 v[104:107], v252 offset:2048
  ds_read_b128 v[108:111], v252 offset:3072
  ds_read_b128 v[112:115], v252 offset:4096
  ds_read_b128 v[116:119], v252 offset:5120
  s_waitcnt lgkmcnt(5)
  v_mfma_f32_16x16x32_bf16 v[48:51], a[0:3], v[96:99], 0
  ds_read_b128 v[120:123], v252 offset:6144
  v_mfma_f32_16x16x32_bf16 v[52:55], a[4:7], v[96:99], 0
  s_waitcnt lgkmcnt(5)
  v_mfma_f32_16x16x32_bf16 v[48:51], a[8:11], v[100:103], v[48:51]
  ds_read_b128 v[124:127], v252 offset:7168
  v_mfma_f32_16x16x32_bf16 v[52:55], a[12:15], v[100:103], v[52:55]
  s_waitcnt lgkmcnt(5)
  v_mfma_f32_16x16x32_bf16 v[48:51], a[16:19], v[104:107], v[48:51]
  ds_read_b128 v[96:99], v252 offset:8192
  v_mfma_f32_16x16x32_bf16 v[52:55], a[20:23], v[104:107], v[52:55]
  s_waitcnt lgkmcnt(5)
  v_mfma_f32_16x16x32_bf16 v[48:51], a[24:27], v[108:111], v[48:51]
  ds_read_b128 v[100:103], v252 offset:9216
  v_mfma_f32_16x16x32_bf16 v[52:55], a[28:31], v[108:111], v[52:55]
  s_waitcnt lgkmcnt(5)
  v_mfma_f32_16x16x32_bf16 v[48:51], a[32:35], v[112:115], v[48:51]
  ds_read_b128 v[104:107], v252 offset:10240
  v_mfma_f32_16x16x32_bf16 v[52:55], a[36:39], v[112:115], v[52:55]
  s_waitcnt lgkmcnt(5)
  v_mfma_f32_16x16x32_bf16 v[48:51], a[40:43], v[116:119], v[48:51]
  ds_read_b128 v[108:111], v252 offset:11264
  v_mfma_f32_16x16x32_bf16 v[52:55], a[44:47], v[116:119], v[52:55]
  s_waitcnt lgkmcnt(5)
  v_mfma_f32_16x16x32_bf16 v[48:51], a[48:51], v[120:123], v[48:51]
  ds_read_b128 v[112:115], v252 offset:12288
  v_mfma_f32_16x16x32_bf16 v[52:55], a[52:55], v[120:123], v[52:55]
  s_waitcnt lgkmcnt(5)
  v_mfma_f32_16x16x32_bf16 v[48:51], a[56:59], v[124:127], v[48:51]
  ds_read_b128 v[116:119], v252 offset:13312
  v_mfma_f32_16x16x32_bf16 v[52:55], a[60:63], v[124:127], v[52:55]
  s_waitcnt lgkmcnt(5)
  v_mfma_f32_16x16x32_bf16 v[48:51], a[64:67], v[96:99], v[48:51]
  ds_read_b128 v[120:123], v252 offset:14336
  v_mfma_f32_16x16x32_bf16 v[52:55], a[68:71], v[96:99], v[52:55]
  s_waitcnt lgkmcnt(5)
  v_mfma_f32_16x16x32_bf16 v[48:51], a[72:75], v[100:103], v[48:51]
  ds_read_b128 v[124:127], v252 offset:15360
  v_mfma_f32_16x16x32_bf16 v[52:55], a[76:79], v[100:103], v[52:55]
  s_waitcnt lgkmcnt(5)
  v_mfma_f32_16x16x32_bf16 v[48:51], a[80:83], v[104:107], v[48:51]
  ds_read_b128 v[96:99], v252 offset:16384
  v_mfma_f32_16x16x32_bf16 v[52:55], a[84:87], v[104:107], v[52:55]
  s_waitcnt lgkmcnt(5)
  v_mfma_f32_16x16x32_bf16 v[48:51], a[88:91], v[108:111], v[48:51]
  ds_read_b128 v[100:103], v252 offset:17408
  v_mfma_f32_16x16x32_bf16 v[52:55], a[92:95], v[108:111], v[52:55]
  s_waitcnt lgkmcnt(5)
  v_mfma_f32_16x16x32_bf16 v[48:51], a[96:99], v[112:115], v[48:51]
  ds_read_b128 v[104:107], v252 offset:18432
  v_mfma_f32_16x16x32_bf16 v[52:55], a[100:103], v[112:115], v[52:55]
  s_waitcnt lgkmcnt(5)
  v_mfma_f32_16x16x32_bf16 v[48:51], a[104:107], v[116:119], v[48:51]
  ds_read_b128 v[108:111], v252 offset:19456
  v_mfma_f32_16x16x32_bf16 v[52:55], a[108:111], v[116:119], v[52:55]
  s_waitcnt lgkmcnt(5)
  v_mfma_f32_16x16x32_bf16 v[48:51], a[112:115], v[120:123], v[48:51]
  ds_read_b128 v[112:115], v252 offset:20480
  v_mfma_f32_16x16x32_bf16 v[52:55], a[116:119], v[120:123], v[52:55]
  s_waitcnt lgkmcnt(5)
  v_mfma_f32_16x16x32_bf16 v[48:51], a[120:123], v[124:127], v[48:51]
  ds_read_b128 v[116:119], v252 offset:21504
  v_mfma_f32_16x16x32_bf16 v[52:55], a[124:127], v[124:127], v[52:55]
  s_waitcnt lgkmcnt(5)
  v_mfma_f32_16x16x32_bf16 v[48:51], a[128:131], v[96:99], v[48:51]
  ds_read_b128 v[120:123], v252 offset:22528
  v_mfma_f32_16x16x32_bf16 v[52:55], a[132:135], v[96:99], v[52:55]
  s_waitcnt lgkmcnt(5)
  v_mfma_f32_16x16x32_bf16 v[48:51], a[136:139], v[100:103], v[48:51]
  ds_read_b128 v[124:127], v252 offset:23552
  v_mfma_f32_16x16x32_bf16 v[52:55], a[140:143], v[100:103], v[52:55]
  s_waitcnt lgkmcnt(5)
  v_mfma_f32_16x16x32_bf16 v[48:51], a[144:147], v[104:107], v[48:51]
  ds_read_b128 v[96:99], v252 offset:24576
  v_mfma_f32_16x16x32_bf16 v[52:55], a[148:151], v[104:107], v[52:55]
  s_waitcnt lgkmcnt(5)
  v_mfma_f32_16x16x32_bf16 v[48:51], a[152:155], v[108:111], v[48:51]
  ds_read_b128 v[100:103], v252 offset:25600
  v_mfma_f32_16x16x32_bf16 v[52:55], a[156:159], v[108:111], v[52:55]
  s_waitcnt lgkmcnt(5)
  v_mfma_f32_16x16x32_bf16 v[48:51], a[160:163], v[112:115], v[48:51]
  ds_read_b128 v[104:107], v252 offset:26624
  v_mfma_f32_16x16x32_bf16 v[52:55], a[164:167], v[112:115], v[52:55]
  s_waitcnt lgkmcnt(5)
  v_mfma_f32_16x16x32_bf16 v[48:51], a[168:171], v[116:119], v[48:51]
  ds_read_b128 v[108:111], v252 offset:27648
  v_mfma_f32_16x16x32_bf16 v[52:55], a[172:175], v[116:119], v[52:55]
  s_waitcnt lgkmcnt(5)
  v_mfma_f32_16x16x32_bf16 v[48:51], a[176:179], v[120:123], v[48:51]
  ds_read_b128 v[112:115], v252 offset:28672
  v_mfma_f32_16x16x32_bf16 v[52:55], a[180:183], v[120:123], v[52:55]
  s_waitcnt lgkmcnt(5)
  v_mfma_f32_16x16x32_bf16 v[48:51], a[184:187], v[124:127], v[48:51]
  ds_read_b128 v[116:119], v252 offset:29696
  v_mfma_f32_16x16x32_bf16 v[52:55], a[188:191], v[124:127], v[52:55]
  s_waitcnt lgkmcnt(5)
  v_mfma_f32_16x16x32_bf16 v[48:51], a[192:195], v[96:99], v[48:51]
  ds_read_b128 v[120:123], v252 offset:30720
  v_mfma_f32_16x16x32_bf16 v[52:55], a[196:199], v[96:99], v[52:55]
  s_waitcnt lgkmcnt(5)
  v_mfma_f32_16x16x32_bf16 v[48:51], a[200:203], v[100:103], v[48:51]
  ds_read_b128 v[124:127], v252 offset:31744
  v_mfma_f32_16x16x32_bf16 v[52:55], a[204:207], v[100:103], v[52:55]
  s_waitcnt lgkmcnt(5)
  v_mfma_f32_16x16x32_bf16 v[48:51], a[208:211], v[104:107], v[48:51]
  v_mfma_f32_16x16x32_bf16 v[52:55], a[212:215], v[104:107], v[52:55]
  s_waitcnt lgkmcnt(4)
  v_mfma_f32_16x16x32_bf16 v[48:51], a[216:219], v[108:111], v[48:51]
  v_mfma_f32_16x16x32_bf16 v[52:55], a[220:223], v[108:111], v[52:55]
  s_waitcnt lgkmcnt(3)
  v_mfma_f32_16x16x32_bf16 v[48:51], a[224:227], v[112:115], v[48:51]
  v_mfma_f32_16x16x32_bf16 v[52:55], a[228:231], v[112:115], v[52:55]
  s_waitcnt lgkmcnt(2)
  v_mfma_f32_16x16x32_bf16 v[48:51], a[232:235], v[116:119], v[48:51]
  v_mfma_f32_16x16x32_bf16 v[52:55], a[236:239], v[116:119], v[52:55]
  s_waitcnt lgkmcnt(1)
  v_mfma_f32_16x16x32_bf16 v[48:51], a[240:243], v[120:123], v[48:51]
  v_mfma_f32_16x16x32_bf16 v[52:55], a[244:247], v[120:123], v[52:55]
  s_waitcnt lgkmcnt(0)
  v_mfma_f32_16x16x32_bf16 v[48:51], a[248:251], v[124:127], v[48:51]
  v_mfma_f32_16x16x32_bf16 v[52:55], a[252:255], v[124:127], v[52:55]
  s_nop 3
  v_mul_f32 v48, s41, v48
  v_mul_f32 v49, s41, v49
  v_mul_f32 v50, s41, v50
  v_mul_f32 v51, s41, v51
  v_cvt_pk_bf16_f32 v80, v48, v49
  v_cvt_pk_bf16_f32 v81, v50, v51
  buffer_store_dwordx2 v[80:81], v251, s[4:7], s39 offen offset:0 sc1
  v_mul_f32 v52, s41, v52
  v_mul_f32 v53, s41, v53
  v_mul_f32 v54, s41, v54
  v_mul_f32 v55, s41, v55
  v_cvt_pk_bf16_f32 v82, v52, v53
  v_cvt_pk_bf16_f32 v83, v54, v55
  buffer_store_dwordx2 v[82:83], v251, s[4:7], s39 offen offset:512 sc1
  buffer_store_dwordx4 v[16:19], v252, s[4:7], s51 offen sc1
  s_add_u32 s51, s51, 131072
  s_barrier
  s_add_u32 s36, s36, 2
  s_add_u32 s39, s39, 131072
  s_cmp_lt_u32 s36, 64
  s_cbranch_scc1 w_mem_mqk
  s_branch w_exit
w_mv:
  s_lshr_b32 s42, s53, 4
  s_lshl_b32 s43, s42, 3
  s_add_u32 s43, s43, 16
  s_load_dwordx2 s[8:9], s[0:1], s43
  s_mov_b32 s10, 0x400000
  s_mov_b32 s11, 0x20000
  s_cmp_eq_u32 s42, 0
  s_mov_b32 s41, 0x3ef40000
  s_cselect_b32 s41, 0x3e890000, s41
  s_lshl_b32 s39, 0x1000000, s42
  s_and_b32 s53, s53, 15
  s_lshl2_add_u32 s42, s53, s33
  s_lshl_b32 s46, s42, 7
  s_add_u32 s47, s46, 64
  s_lshl_b32 s42, s42, 12
  s_add_u32 s39, s39, s42
  s_add_u32 s42, s36, 64
  s_lshl_b32 s42, s42, 18
  s_add_u32 s39, s39, s42
  s_mov_b32 s45, 8192
  v_and_b32 v250, 15, v255
  v_lshlrev_b32 v251, 4, v250
  v_lshl_add_u32 v251, v253, 8, v251
  v_bfe_u32 v250, v255, 4, 1
  v_lshl_add_u32 v251, v250, 10, v251
  s_waitcnt lgkmcnt(0)
  s_lshl2_add_u32 s42, s53, s33
  s_lshl_b32 s42, s42, 10
  s_lshl_b32 s39, s36, 16
  s_add_u32 s39, s39, s42
  s_add_u32 s39, s39, 159383552
  s_lshl_b32 s48, s33, 15
  v_lshrrev_b32 v250, 3, v255
  v_mul_lo_u32 v250, v250, s45
  v_bfe_u32 v248, v255, 4, 1
  v_lshlrev_b32 v248, 2, v248
  v_xor_b32 v249, v248, v255
  v_and_b32 v249, 7, v249
  v_lshl_add_u32 v247, v249, 4, v250
  s_lshl_b32 s44, s45, 3
  s_add_u32 m0, s48, 0
  s_nop 0
  buffer_load_dwordx4 v247, s[8:11], s46 offen lds
  s_add_u32 s46, s46, s44
  s_add_u32 m0, s48, 1024
  s_nop 0
  buffer_load_dwordx4 v247, s[8:11], s46 offen lds
  s_add_u32 s46, s46, s44
  s_add_u32 m0, s48, 2048
  s_nop 0
  buffer_load_dwordx4 v247, s[8:11], s46 offen lds
  s_add_u32 s46, s46, s44
  s_add_u32 m0, s48, 3072
  s_nop 0
  buffer_load_dwordx4 v247, s[8:11], s46 offen lds
  s_add_u32 s46, s46, s44
  s_add_u32 m0, s48, 4096
  s_nop 0
  buffer_load_dwordx4 v247, s[8:11], s46 offen lds
  s_add_u32 s46, s46, s44
  s_add_u32 m0, s48, 5120
  s_nop 0
  buffer_load_dwordx4 v247, s[8:11], s46 offen lds
  s_add_u32 s46, s46, s44
  s_add_u32 m0, s48, 6144
  s_nop 0
  buffer_load_dwordx4 v247, s[8:11], s46 offen lds
  s_add_u32 s46, s46, s44
  s_add_u32 m0, s48, 7168
  s_nop 0
  buffer_load_dwordx4 v247, s[8:11], s46 offen lds
  s_add_u32 s46, s46, s44
  s_add_u32 m0, s48, 8192
  s_nop 0
  buffer_load_dwordx4 v247, s[8:11], s46 offen lds
  s_add_u32 s46, s46, s44
  s_add_u32 m0, s48, 9216
  s_nop 0
  buffer_load_dwordx4 v247, s[8:11], s46 offen lds
  s_add_u32 s46, s46, s44
  s_add_u32 m0, s48, 10240
  s_nop 0
  buffer_load_dwordx4 v247, s[8:11], s46 offen lds
  s_add_u32 s46, s46, s44
  s_add_u32 m0, s48, 11264
  s_nop 0
  buffer_load_dwordx4 v247, s[8:11], s46 offen lds
  s_add_u32 s46, s46, s44
  s_add_u32 m0, s48, 12288
  s_nop 0
  buffer_load_dwordx4 v247, s[8:11], s46 offen lds
  s_add_u32 s46, s46, s44
  s_add_u32 m0, s48, 13312
  s_nop 0
  buffer_load_dwordx4 v247, s[8:11], s46 offen lds
  s_add_u32 s46, s46, s44
  s_add_u32 m0, s48, 14336
  s_nop 0
  buffer_load_dwordx4 v247, s[8:11], s46 offen lds
  s_add_u32 s46, s46, s44
  s_add_u32 m0, s48, 15360
  s_nop 0
  buffer_load_dwordx4 v247, s[8:11], s46 offen lds
  s_add_u32 s46, s46, s44
  s_add_u32 m0, s48, 16384
  s_nop 0
  buffer_load_dwordx4 v247, s[8:11], s46 offen lds
  s_add_u32 s46, s46, s44
  s_add_u32 m0, s48, 17408
  s_nop 0
  buffer_load_dwordx4 v247, s[8:11], s46 offen lds
  s_add_u32 s46, s46, s44
  s_add_u32 m0, s48, 18432
  s_nop 0
  buffer_load_dwordx4 v247, s[8:11], s46 offen lds
  s_add_u32 s46, s46, s44
  s_add_u32 m0, s48, 19456
  s_nop 0
  buffer_load_dwordx4 v247, s[8:11], s46 offen lds
  s_add_u32 s46, s46, s44
  s_add_u32 m0, s48, 20480
  s_nop 0
  buffer_load_dwordx4 v247, s[8:11], s46 offen lds
  s_add_u32 s46, s46, s44
  s_add_u32 m0, s48, 21504
  s_nop 0
  buffer_load_dwordx4 v247, s[8:11], s46 offen lds
  s_add_u32 s46, s46, s44
  s_add_u32 m0, s48, 22528
  s_nop 0
  buffer_load_dwordx4 v247, s[8:11], s46 offen lds
  s_add_u32 s46, s46, s44
  s_add_u32 m0, s48, 23552
  s_nop 0
  buffer_load_dwordx4 v247, s[8:11], s46 offen lds
  s_add_u32 s46, s46, s44
  s_add_u32 m0, s48, 24576
  s_nop 0
  buffer_load_dwordx4 v247, s[8:11], s46 offen lds
  s_add_u32 s46, s46, s44
  s_add_u32 m0, s48, 25600
  s_nop 0
  buffer_load_dwordx4 v247, s[8:11], s46 offen lds
  s_add_u32 s46, s46, s44
  s_add_u32 m0, s48, 26624
  s_nop 0
  buffer_load_dwordx4 v247, s[8:11], s46 offen lds
  s_add_u32 s46, s46, s44
  s_add_u32 m0, s48, 27648
  s_nop 0
  buffer_load_dwordx4 v247, s[8:11], s46 offen lds
  s_add_u32 s46, s46, s44
  s_add_u32 m0, s48, 28672
  s_nop 0
  buffer_load_dwordx4 v247, s[8:11], s46 offen lds
  s_add_u32 s46, s46, s44
  s_add_u32 m0, s48, 29696
  s_nop 0
  buffer_load_dwordx4 v247, s[8:11], s46 offen lds
  s_add_u32 s46, s46, s44
  s_add_u32 m0, s48, 30720
  s_nop 0
  buffer_load_dwordx4 v247, s[8:11], s46 offen lds
  s_add_u32 s46, s46, s44
  s_add_u32 m0, s48, 31744
  s_nop 0
  buffer_load_dwordx4 v247, s[8:11], s46 offen lds
  s_add_u32 s46, s46, s44
  v_and_b32 v249, 3, v255
  v_bfe_u32 v250, v255, 2, 2
  v_lshl_add_u32 v250, v253, 3, v250
  v_lshlrev_b32 v250, 7, v250
  v_bfe_u32 v248, v255, 4, 1
  v_lshl_add_u32 v250, v248, 5, v250
  v_lshl_add_u32 v250, v249, 3, v250
  v_bfe_u32 v248, v255, 3, 1
  v_lshl_add_u32 v250, v248, 6, v250
  v_add_u32 v240, s48, v250
  v_xor_b32 v241, 64, v240
  s_waitcnt vmcnt(28)
  ds_read_b64_tr_b16 a[0:1], v240 offset:0
  ds_read_b64_tr_b16 a[2:3], v240 offset:512
  ds_read_b64_tr_b16 a[4:5], v241 offset:0
  ds_read_b64_tr_b16 a[6:7], v241 offset:512
  ds_read_b64_tr_b16 a[8:9], v240 offset:2048
  ds_read_b64_tr_b16 a[10:11], v240 offset:2560
  ds_read_b64_tr_b16 a[12:13], v241 offset:2048
  ds_read_b64_tr_b16 a[14:15], v241 offset:2560
  s_waitcnt lgkmcnt(0)
  s_add_u32 m0, s48, 0
  s_nop 0
  buffer_load_dwordx4 v247, s[8:11], s46 offen lds
  s_add_u32 s46, s46, s44
  s_add_u32 m0, s48, 1024
  s_nop 0
  buffer_load_dwordx4 v247, s[8:11], s46 offen lds
  s_add_u32 s46, s46, s44
  s_add_u32 m0, s48, 2048
  s_nop 0
  buffer_load_dwordx4 v247, s[8:11], s46 offen lds
  s_add_u32 s46, s46, s44
  s_add_u32 m0, s48, 3072
  s_nop 0
  buffer_load_dwordx4 v247, s[8:11], s46 offen lds
  s_add_u32 s46, s46, s44
  s_waitcnt vmcnt(28)
  ds_read_b64_tr_b16 a[16:17], v240 offset:4096
  ds_read_b64_tr_b16 a[18:19], v240 offset:4608
  ds_read_b64_tr_b16 a[20:21], v241 offset:4096
  ds_read_b64_tr_b16 a[22:23], v241 offset:4608
  ds_read_b64_tr_b16 a[24:25], v240 offset:6144
  ds_read_b64_tr_b16 a[26:27], v240 offset:6656
  ds_read_b64_tr_b16 a[28:29], v241 offset:6144
  ds_read_b64_tr_b16 a[30:31], v241 offset:6656
  s_waitcnt lgkmcnt(0)
  s_add_u32 m0, s48, 4096
  s_nop 0
  buffer_load_dwordx4 v247, s[8:11], s46 offen lds
  s_add_u32 s46, s46, s44
  s_add_u32 m0, s48, 5120
  s_nop 0
  buffer_load_dwordx4 v247, s[8:11], s46 offen lds
  s_add_u32 s46, s46, s44
  s_add_u32 m0, s48, 6144
  s_nop 0
  buffer_load_dwordx4 v247, s[8:11], s46 offen lds
  s_add_u32 s46, s46, s44
  s_add_u32 m0, s48, 7168
  s_nop 0
  buffer_load_dwordx4 v247, s[8:11], s46 offen lds
  s_add_u32 s46, s46, s44
  s_waitcnt vmcnt(28)
  ds_read_b64_tr_b16 a[32:33], v240 offset:8192
  ds_read_b64_tr_b16 a[34:35], v240 offset:8704
  ds_read_b64_tr_b16 a[36:37], v241 offset:8192
  ds_read_b64_tr_b16 a[38:39], v241 offset:8704
  ds_read_b64_tr_b16 a[40:41], v240 offset:10240
  ds_read_b64_tr_b16 a[42:43], v240 offset:10752
  ds_read_b64_tr_b16 a[44:45], v241 offset:10240
  ds_read_b64_tr_b16 a[46:47], v241 offset:10752
  s_waitcnt lgkmcnt(0)
  s_add_u32 m0, s48, 8192
  s_nop 0
  buffer_load_dwordx4 v247, s[8:11], s46 offen lds
  s_add_u32 s46, s46, s44
  s_add_u32 m0, s48, 9216
  s_nop 0
  buffer_load_dwordx4 v247, s[8:11], s46 offen lds
  s_add_u32 s46, s46, s44
  s_add_u32 m0, s48, 10240
  s_nop 0
  buffer_load_dwordx4 v247, s[8:11], s46 offen lds
  s_add_u32 s46, s46, s44
  s_add_u32 m0, s48, 11264
  s_nop 0
  buffer_load_dwordx4 v247, s[8:11], s46 offen lds
  s_add_u32 s46, s46, s44
  s_waitcnt vmcnt(28)
  ds_read_b64_tr_b16 a[48:49], v240 offset:12288
  ds_read_b64_tr_b16 a[50:51], v240 offset:12800
  ds_read_b64_tr_b16 a[52:53], v241 offset:12288
  ds_read_b64_tr_b16 a[54:55], v241 offset:12800
  ds_read_b64_tr_b16 a[56:57], v240 offset:14336
  ds_read_b64_tr_b16 a[58:59], v240 offset:14848
  ds_read_b64_tr_b16 a[60:61], v241 offset:14336
  ds_read_b64_tr_b16 a[62:63], v241 offset:14848
  s_waitcnt lgkmcnt(0)
  s_add_u32 m0, s48, 12288
  s_nop 0
  buffer_load_dwordx4 v247, s[8:11], s46 offen lds
  s_add_u32 s46, s46, s44
  s_add_u32 m0, s48, 13312
  s_nop 0
  buffer_load_dwordx4 v247, s[8:11], s46 offen lds
  s_add_u32 s46, s46, s44
  s_add_u32 m0, s48, 14336
  s_nop 0
  buffer_load_dwordx4 v247, s[8:11], s46 offen lds
  s_add_u32 s46, s46, s44
  s_add_u32 m0, s48, 15360
  s_nop 0
  buffer_load_dwordx4 v247, s[8:11], s46 offen lds
  s_add_u32 s46, s46, s44
  s_waitcnt vmcnt(28)
  ds_read_b64_tr_b16 a[64:65], v240 offset:16384
  ds_read_b64_tr_b16 a[66:67], v240 offset:16896
  ds_read_b64_tr_b16 a[68:69], v241 offset:16384
  ds_read_b64_tr_b16 a[70:71], v241 offset:16896
  ds_read_b64_tr_b16 a[72:73], v240 offset:18432
  ds_read_b64_tr_b16 a[74:75], v240 offset:18944
  ds_read_b64_tr_b16 a[76:77], v241 offset:18432
  ds_read_b64_tr_b16 a[78:79], v241 offset:18944
  s_waitcnt lgkmcnt(0)
  s_add_u32 m0, s48, 16384
  s_nop 0
  buffer_load_dwordx4 v247, s[8:11], s46 offen lds
  s_add_u32 s46, s46, s44
  s_add_u32 m0, s48, 17408
  s_nop 0
  buffer_load_dwordx4 v247, s[8:11], s46 offen lds
  s_add_u32 s46, s46, s44
  s_add_u32 m0, s48, 18432
  s_nop 0
  buffer_load_dwordx4 v247, s[8:11], s46 offen lds
  s_add_u32 s46, s46, s44
  s_add_u32 m0, s48, 19456
  s_nop 0
  buffer_load_dwordx4 v247, s[8:11], s46 offen lds
  s_add_u32 s46, s46, s44
  s_waitcnt vmcnt(28)
  ds_read_b64_tr_b16 a[80:81], v240 offset:20480
  ds_read_b64_tr_b16 a[82:83], v240 offset:20992
  ds_read_b64_tr_b16 a[84:85], v241 offset:20480
  ds_read_b64_tr_b16 a[86:87], v241 offset:20992
  ds_read_b64_tr_b16 a[88:89], v240 offset:22528
  ds_read_b64_tr_b16 a[90:91], v240 offset:23040
  ds_read_b64_tr_b16 a[92:93], v241 offset:22528
  ds_read_b64_tr_b16 a[94:95], v241 offset:23040
  s_waitcnt lgkmcnt(0)
  s_add_u32 m0, s48, 20480
  s_nop 0
  buffer_load_dwordx4 v247, s[8:11], s46 offen lds
  s_add_u32 s46, s46, s44
  s_add_u32 m0, s48, 21504
  s_nop 0
  buffer_load_dwordx4 v247, s[8:11], s46 offen lds
  s_add_u32 s46, s46, s44
  s_add_u32 m0, s48, 22528
  s_nop 0
  buffer_load_dwordx4 v247, s[8:11], s46 offen lds
  s_add_u32 s46, s46, s44
  s_add_u32 m0, s48, 23552
  s_nop 0
  buffer_load_dwordx4 v247, s[8:11], s46 offen lds
  s_add_u32 s46, s46, s44
  s_waitcnt vmcnt(28)
  ds_read_b64_tr_b16 a[96:97], v240 offset:24576
  ds_read_b64_tr_b16 a[98:99], v240 offset:25088
  ds_read_b64_tr_b16 a[100:101], v241 offset:24576
  ds_read_b64_tr_b16 a[102:103], v241 offset:25088
  ds_read_b64_tr_b16 a[104:105], v240 offset:26624
  ds_read_b64_tr_b16 a[106:107], v240 offset:27136
  ds_read_b64_tr_b16 a[108:109], v241 offset:26624
  ds_read_b64_tr_b16 a[110:111], v241 offset:27136
  s_waitcnt lgkmcnt(0)
  s_add_u32 m0, s48, 24576
  s_nop 0
  buffer_load_dwordx4 v247, s[8:11], s46 offen lds
  s_add_u32 s46, s46, s44
  s_add_u32 m0, s48, 25600
  s_nop 0
  buffer_load_dwordx4 v247, s[8:11], s46 offen lds
  s_add_u32 s46, s46, s44
  s_add_u32 m0, s48, 26624
  s_nop 0
  buffer_load_dwordx4 v247, s[8:11], s46 offen lds
  s_add_u32 s46, s46, s44
  s_add_u32 m0, s48, 27648
  s_nop 0
  buffer_load_dwordx4 v247, s[8:11], s46 offen lds
  s_add_u32 s46, s46, s44
  s_waitcnt vmcnt(28)
  ds_read_b64_tr_b16 a[112:113], v240 offset:28672
  ds_read_b64_tr_b16 a[114:115], v240 offset:29184
  ds_read_b64_tr_b16 a[116:117], v241 offset:28672
  ds_read_b64_tr_b16 a[118:119], v241 offset:29184
  ds_read_b64_tr_b16 a[120:121], v240 offset:30720
  ds_read_b64_tr_b16 a[122:123], v240 offset:31232
  ds_read_b64_tr_b16 a[124:125], v241 offset:30720
  ds_read_b64_tr_b16 a[126:127], v241 offset:31232
  s_waitcnt lgkmcnt(0)
  s_add_u32 m0, s48, 28672
  s_nop 0
  buffer_load_dwordx4 v247, s[8:11], s46 offen lds
  s_add_u32 s46, s46, s44
  s_add_u32 m0, s48, 29696
  s_nop 0
  buffer_load_dwordx4 v247, s[8:11], s46 offen lds
  s_add_u32 s46, s46, s44
  s_add_u32 m0, s48, 30720
  s_nop 0
  buffer_load_dwordx4 v247, s[8:11], s46 offen lds
  s_add_u32 s46, s46, s44
  s_add_u32 m0, s48, 31744
  s_nop 0
  buffer_load_dwordx4 v247, s[8:11], s46 offen lds
  s_add_u32 s46, s46, s44
  s_waitcnt vmcnt(28)
  ds_read_b64_tr_b16 a[128:129], v240 offset:0
  ds_read_b64_tr_b16 a[130:131], v240 offset:512
  ds_read_b64_tr_b16 a[132:133], v241 offset:0
  ds_read_b64_tr_b16 a[134:135], v241 offset:512
  ds_read_b64_tr_b16 a[136:137], v240 offset:2048
  ds_read_b64_tr_b16 a[138:139], v240 offset:2560
  ds_read_b64_tr_b16 a[140:141], v241 offset:2048
  ds_read_b64_tr_b16 a[142:143], v241 offset:2560
  s_waitcnt lgkmcnt(0)
  s_waitcnt vmcnt(24)
  ds_read_b64_tr_b16 a[144:145], v240 offset:4096
  ds_read_b64_tr_b16 a[146:147], v240 offset:4608
  ds_read_b64_tr_b16 a[148:149], v241 offset:4096
  ds_read_b64_tr_b16 a[150:151], v241 offset:4608
  ds_read_b64_tr_b16 a[152:153], v240 offset:6144
  ds_read_b64_tr_b16 a[154:155], v240 offset:6656
  ds_read_b64_tr_b16 a[156:157], v241 offset:6144
  ds_read_b64_tr_b16 a[158:159], v241 offset:6656
  s_waitcnt lgkmcnt(0)
  s_waitcnt vmcnt(20)
  ds_read_b64_tr_b16 a[160:161], v240 offset:8192
  ds_read_b64_tr_b16 a[162:163], v240 offset:8704
  ds_read_b64_tr_b16 a[164:165], v241 offset:8192
  ds_read_b64_tr_b16 a[166:167], v241 offset:8704
  ds_read_b64_tr_b16 a[168:169], v240 offset:10240
  ds_read_b64_tr_b16 a[170:171], v240 offset:10752
  ds_read_b64_tr_b16 a[172:173], v241 offset:10240
  ds_read_b64_tr_b16 a[174:175], v241 offset:10752
  s_waitcnt lgkmcnt(0)
  s_waitcnt vmcnt(16)
  ds_read_b64_tr_b16 a[176:177], v240 offset:12288
  ds_read_b64_tr_b16 a[178:179], v240 offset:12800
  ds_read_b64_tr_b16 a[180:181], v241 offset:12288
  ds_read_b64_tr_b16 a[182:183], v241 offset:12800
  ds_read_b64_tr_b16 a[184:185], v240 offset:14336
  ds_read_b64_tr_b16 a[186:187], v240 offset:14848
  ds_read_b64_tr_b16 a[188:189], v241 offset:14336
  ds_read_b64_tr_b16 a[190:191], v241 offset:14848
  s_waitcnt lgkmcnt(0)
  s_waitcnt vmcnt(12)
  ds_read_b64_tr_b16 a[192:193], v240 offset:16384
  ds_read_b64_tr_b16 a[194:195], v240 offset:16896
  ds_read_b64_tr_b16 a[196:197], v241 offset:16384
  ds_read_b64_tr_b16 a[198:199], v241 offset:16896
  ds_read_b64_tr_b16 a[200:201], v240 offset:18432
  ds_read_b64_tr_b16 a[202:203], v240 offset:18944
  ds_read_b64_tr_b16 a[204:205], v241 offset:18432
  ds_read_b64_tr_b16 a[206:207], v241 offset:18944
  s_waitcnt lgkmcnt(0)
  s_waitcnt vmcnt(8)
  ds_read_b64_tr_b16 a[208:209], v240 offset:20480
  ds_read_b64_tr_b16 a[210:211], v240 offset:20992
  ds_read_b64_tr_b16 a[212:213], v241 offset:20480
  ds_read_b64_tr_b16 a[214:215], v241 offset:20992
  ds_read_b64_tr_b16 a[216:217], v240 offset:22528
  ds_read_b64_tr_b16 a[218:219], v240 offset:23040
  ds_read_b64_tr_b16 a[220:221], v241 offset:22528
  ds_read_b64_tr_b16 a[222:223], v241 offset:23040
  s_waitcnt lgkmcnt(0)
  s_waitcnt vmcnt(4)
  ds_read_b64_tr_b16 a[224:225], v240 offset:24576
  ds_read_b64_tr_b16 a[226:227], v240 offset:25088
  ds_read_b64_tr_b16 a[228:229], v241 offset:24576
  ds_read_b64_tr_b16 a[230:231], v241 offset:25088
  ds_read_b64_tr_b16 a[232:233], v240 offset:26624
  ds_read_b64_tr_b16 a[234:235], v240 offset:27136
  ds_read_b64_tr_b16 a[236:237], v241 offset:26624
  ds_read_b64_tr_b16 a[238:239], v241 offset:27136
  s_waitcnt lgkmcnt(0)
  s_waitcnt vmcnt(0)
  ds_read_b64_tr_b16 a[240:241], v240 offset:28672
  ds_read_b64_tr_b16 a[242:243], v240 offset:29184
  ds_read_b64_tr_b16 a[244:245], v241 offset:28672
  ds_read_b64_tr_b16 a[246:247], v241 offset:29184
  ds_read_b64_tr_b16 a[248:249], v240 offset:30720
  ds_read_b64_tr_b16 a[250:251], v240 offset:31232
  ds_read_b64_tr_b16 a[252:253], v241 offset:30720
  ds_read_b64_tr_b16 a[254:255], v241 offset:31232
  s_waitcnt lgkmcnt(0)
  s_barrier
  s_mul_i32 s42, s33, 8192
  v_add_u32 v241, s42, v252
  v_add_u32 v242, 4096, v241
  v_mov_b32 v0, 0
  v_mov_b32 v16, -1
  v_mov_b32 v1, 0
  v_mov_b32 v17, -1
  v_mov_b32 v2, 0
  v_mov_b32 v18, -1
  v_mov_b32 v3, 0
  v_mov_b32 v19, -1
  ds_write_b128 v241, v[0:3] offset:0
  ds_write_b128 v241, v[0:3] offset:1024
  ds_write_b128 v241, v[0:3] offset:2048
  ds_write_b128 v241, v[0:3] offset:3072
  ds_write_b128 v241, v[0:3] offset:4096
  ds_write_b128 v241, v[0:3] offset:5120
  ds_write_b128 v241, v[0:3] offset:6144
  ds_write_b128 v241, v[0:3] offset:7168
  s_mov_b32 s51, s39
  buffer_store_dwordx4 v[16:19], v252, s[4:7], s51 offen sc1
  s_add_u32 s51, s51, 131072
  buffer_store_dwordx4 v[16:19], v252, s[4:7], s51 offen sc1
  s_add_u32 s51, s51, 131072
  buffer_store_dwordx4 v[16:19], v252, s[4:7], s51 offen sc1
  s_add_u32 s51, s51, 131072
  buffer_store_dwordx4 v[16:19], v252, s[4:7], s51 offen sc1
  s_add_u32 s51, s51, 131072
  v_lshlrev_b32 v251, 3, v255
  v_lshrrev_b32 v250, 4, v255
  v_lshlrev_b32 v243, 9, v250
  v_bfe_u32 v250, v255, 1, 1
  v_lshl_add_u32 v243, v250, 11, v243
  v_bfe_u32 v250, v255, 2, 2
  v_lshl_add_u32 v243, v250, 5, v243
  v_and_b32 v250, 1, v255
  v_lshl_add_u32 v243, v250, 4, v243
  s_lshl_b32 s42, s33, 13
  v_add_u32 v243, s42, v243
  s_lshl_b32 s38, s36, 13
  s_lshl_b32 s42, s33, 11
  s_add_u32 s38, s38, s42
  s_add_u32 s38, s38, 176160768
  s_waitcnt vmcnt(0)
  s_barrier
  s_cmp_lg_u32 s33, 0
  s_cbranch_scc1 w_cu_50041
  v_mov_b32 v250, 1
  s_mov_b64 exec, 1
  buffer_atomic_add v250, off, s[28:31], 0 offset:164
  s_mov_b64 exec, -1
w_cu_50041:
  s_cmp_lg_u32 s33, 0
  s_cbranch_scc1 w_wds_50044
  s_mov_b64 exec, 1
w_wd_50042:
  buffer_load_dword v250, off, s[28:31], 0 offset:4 sc1
  s_waitcnt vmcnt(0)
  v_readfirstlane_b32 s43, v250
  s_and_b32 s43, s43, 0xffff
  s_cmp_ge_u32 s43, 32
  s_cbranch_scc1 w_wdd_50043
  s_cmp_eq_u32 s35, 0
  s_cbranch_scc1 w_wdd_50043
  s_sub_u32 s35, s35, 1
  s_sleep 4
  s_branch w_wd_50042
w_wdd_50043:
  s_mov_b64 exec, -1
w_wds_50044:
  s_barrier
  s_waitcnt lgkmcnt(0)
w_mem_mv:
  buffer_load_dwordx4 v[0:3], v252, s[4:7], s38 offen offset:0 sc1
  buffer_load_dwordx4 v[4:7], v252, s[4:7], s38 offen offset:1024 sc1
  s_waitcnt vmcnt(0)
  v_max3_u32 v250, v0, v1, v2
  v_max3_u32 v250, v250, v3, v4
  v_max3_u32 v250, v250, v5, v6
  v_max_u32 v250, v250, v7
  v_cmp_eq_u32 vcc, -1, v250
  s_cbranch_vccz w_memok_mv
  s_cmp_eq_u32 s35, 0
  s_cbranch_scc1 w_memok_mv
  s_sub_u32 s35, s35, 1
  s_sleep 1
  s_branch w_mem_mv
w_memok_mv:
  ds_write_b128 v243, v[0:3] offset:0
  ds_write_b128 v243, v[0:3] offset:384
  ds_write_b128 v243, v[4:7] offset:4096
  ds_write_b128 v243, v[4:7] offset:4480
  s_add_u32 s38, s38, 16384
  s_waitcnt lgkmcnt(0)
  s_barrier
  ds_read_b128 v[96:99], v252 offset:0
  ds_read_b128 v[100:103], v252 offset:1024
  ds_read_b128 v[104:107], v252 offset:2048
  ds_read_b128 v[108:111], v252 offset:3072
  ds_read_b128 v[112:115], v252 offset:4096
  ds_read_b128 v[116:119], v252 offset:5120
  s_waitcnt lgkmcnt(5)
  v_mfma_f32_16x16x32_bf16 v[48:51], v[96:99], a[0:3], 0
  ds_read_b128 v[120:123], v252 offset:6144
  v_mfma_f32_16x16x32_bf16 v[52:55], v[96:99], a[4:7], 0
  s_waitcnt lgkmcnt(5)
  v_mfma_f32_16x16x32_bf16 v[48:51], v[100:103], a[8:11], v[48:51]
  ds_read_b128 v[124:127], v252 offset:7168
  v_mfma_f32_16x16x32_bf16 v[52:55], v[100:103], a[12:15], v[52:55]
  s_waitcnt lgkmcnt(5)
  v_mfma_f32_16x16x32_bf16 v[48:51], v[104:107], a[16:19], v[48:51]
  ds_read_b128 v[96:99], v252 offset:8192
  v_mfma_f32_16x16x32_bf16 v[52:55], v[104:107], a[20:23], v[52:55]
  s_waitcnt lgkmcnt(5)
  v_mfma_f32_16x16x32_bf16 v[48:51], v[108:111], a[24:27], v[48:51]
  ds_read_b128 v[100:103], v252 offset:9216
  v_mfma_f32_16x16x32_bf16 v[52:55], v[108:111], a[28:31], v[52:55]
  s_waitcnt lgkmcnt(5)
  v_mfma_f32_16x16x32_bf16 v[48:51], v[112:115], a[32:35], v[48:51]
  ds_read_b128 v[104:107], v252 offset:10240
  v_mfma_f32_16x16x32_bf16 v[52:55], v[112:115], a[36:39], v[52:55]
  s_waitcnt lgkmcnt(5)
  v_mfma_f32_16x16x32_bf16 v[48:51], v[116:119], a[40:43], v[48:51]
  ds_read_b128 v[108:111], v252 offset:11264
  v_mfma_f32_16x16x32_bf16 v[52:55], v[116:119], a[44:47], v[52:55]
  s_waitcnt lgkmcnt(5)
  v_mfma_f32_16x16x32_bf16 v[48:51], v[120:123], a[48:51], v[48:51]
  ds_read_b128 v[112:115], v252 offset:12288
  v_mfma_f32_16x16x32_bf16 v[52:55], v[120:123], a[52:55], v[52:55]
  s_waitcnt lgkmcnt(5)
  v_mfma_f32_16x16x32_bf16 v[48:51], v[124:127], a[56:59], v[48:51]
  ds_read_b128 v[116:119], v252 offset:13312
  v_mfma_f32_16x16x32_bf16 v[52:55], v[124:127], a[60:63], v[52:55]
  s_waitcnt lgkmcnt(5)
  v_mfma_f32_16x16x32_bf16 v[48:51], v[96:99], a[64:67], v[48:51]
  ds_read_b128 v[120:123], v252 offset:14336
  v_mfma_f32_16x16x32_bf16 v[52:55], v[96:99], a[68:71], v[52:55]
  s_waitcnt lgkmcnt(5)
  v_mfma_f32_16x16x32_bf16 v[48:51], v[100:103], a[72:75], v[48:51]
  ds_read_b128 v[124:127], v252 offset:15360
  v_mfma_f32_16x16x32_bf16 v[52:55], v[100:103], a[76:79], v[52:55]
  s_waitcnt lgkmcnt(5)
  v_mfma_f32_16x16x32_bf16 v[48:51], v[104:107], a[80:83], v[48:51]
  ds_read_b128 v[96:99], v252 offset:16384
  v_mfma_f32_16x16x32_bf16 v[52:55], v[104:107], a[84:87], v[52:55]
  s_waitcnt lgkmcnt(5)
  v_mfma_f32_16x16x32_bf16 v[48:51], v[108:111], a[88:91], v[48:51]
  ds_read_b128 v[100:103], v252 offset:17408
  v_mfma_f32_16x16x32_bf16 v[52:55], v[108:111], a[92:95], v[52:55]
  s_waitcnt lgkmcnt(5)
  v_mfma_f32_16x16x32_bf16 v[48:51], v[112:115], a[96:99], v[48:51]
  ds_read_b128 v[104:107], v252 offset:18432
  v_mfma_f32_16x16x32_bf16 v[52:55], v[112:115], a[100:103], v[52:55]
  s_waitcnt lgkmcnt(5)
  v_mfma_f32_16x16x32_bf16 v[48:51], v[116:119], a[104:107], v[48:51]
  ds_read_b128 v[108:111], v252 offset:19456
  v_mfma_f32_16x16x32_bf16 v[52:55], v[116:119], a[108:111], v[52:55]
  s_waitcnt lgkmcnt(5)
  v_mfma_f32_16x16x32_bf16 v[48:51], v[120:123], a[112:115], v[48:51]
  ds_read_b128 v[112:115], v252 offset:20480
  v_mfma_f32_16x16x32_bf16 v[52:55], v[120:123], a[116:119], v[52:55]
  s_waitcnt lgkmcnt(5)
  v_mfma_f32_16x16x32_bf16 v[48:51], v[124:127], a[120:123], v[48:51]
  ds_read_b128 v[116:119], v252 offset:21504
  v_mfma_f32_16x16x32_bf16 v[52:55], v[124:127], a[124:127], v[52:55]
  s_waitcnt lgkmcnt(5)
  v_mfma_f32_16x16x32_bf16 v[48:51], v[96:99], a[128:131], v[48:51]
  ds_read_b128 v[120:123], v252 offset:22528
  v_mfma_f32_16x16x32_bf16 v[52:55], v[96:99], a[132:135], v[52:55]
  s_waitcnt lgkmcnt(5)
  v_mfma_f32_16x16x32_bf16 v[48:51], v[100:103], a[136:139], v[48:51]
  ds_read_b128 v[124:127], v252 offset:23552
  v_mfma_f32_16x16x32_bf16 v[52:55], v[100:103], a[140:143], v[52:55]
  s_waitcnt lgkmcnt(5)
  v_mfma_f32_16x16x32_bf16 v[48:51], v[104:107], a[144:147], v[48:51]
  ds_read_b128 v[96:99], v252 offset:24576
  v_mfma_f32_16x16x32_bf16 v[52:55], v[104:107], a[148:151], v[52:55]
  s_waitcnt lgkmcnt(5)
  v_mfma_f32_16x16x32_bf16 v[48:51], v[108:111], a[152:155], v[48:51]
  ds_read_b128 v[100:103], v252 offset:25600
  v_mfma_f32_16x16x32_bf16 v[52:55], v[108:111], a[156:159], v[52:55]
  s_waitcnt lgkmcnt(5)
  v_mfma_f32_16x16x32_bf16 v[48:51], v[112:115], a[160:163], v[48:51]
  ds_read_b128 v[104:107], v252 offset:26624
  v_mfma_f32_16x16x32_bf16 v[52:55], v[112:115], a[164:167], v[52:55]
  s_waitcnt lgkmcnt(5)
  v_mfma_f32_16x16x32_bf16 v[48:51], v[116:119], a[168:171], v[48:51]
  ds_read_b128 v[108:111], v252 offset:27648
  v_mfma_f32_16x16x32_bf16 v[52:55], v[116:119], a[172:175], v[52:55]
  s_waitcnt lgkmcnt(5)
  v_mfma_f32_16x16x32_bf16 v[48:51], v[120:123], a[176:179], v[48:51]
  ds_read_b128 v[112:115], v252 offset:28672
  v_mfma_f32_16x16x32_bf16 v[52:55], v[120:123], a[180:183], v[52:55]
  s_waitcnt lgkmcnt(5)
  v_mfma_f32_16x16x32_bf16 v[48:51], v[124:127], a[184:187], v[48:51]
  ds_read_b128 v[116:119], v252 offset:29696
  v_mfma_f32_16x16x32_bf16 v[52:55], v[124:127], a[188:191], v[52:55]
  s_waitcnt lgkmcnt(5)
  v_mfma_f32_16x16x32_bf16 v[48:51], v[96:99], a[192:195], v[48:51]
  ds_read_b128 v[120:123], v252 offset:30720
  v_mfma_f32_16x16x32_bf16 v[52:55], v[96:99], a[196:199], v[52:55]
  s_waitcnt lgkmcnt(5)
  v_mfma_f32_16x16x32_bf16 v[48:51], v[100:103], a[200:203], v[48:51]
  ds_read_b128 v[124:127], v252 offset:31744
  v_mfma_f32_16x16x32_bf16 v[52:55], v[100:103], a[204:207], v[52:55]
  s_waitcnt lgkmcnt(5)
  v_mfma_f32_16x16x32_bf16 v[48:51], v[104:107], a[208:211], v[48:51]
  v_mfma_f32_16x16x32_bf16 v[52:55], v[104:107], a[212:215], v[52:55]
  s_waitcnt lgkmcnt(4)
  v_mfma_f32_16x16x32_bf16 v[48:51], v[108:111], a[216:219], v[48:51]
  v_mfma_f32_16x16x32_bf16 v[52:55], v[108:111], a[220:223], v[52:55]
  s_waitcnt lgkmcnt(3)
  v_mfma_f32_16x16x32_bf16 v[48:51], v[112:115], a[224:227], v[48:51]
  v_mfma_f32_16x16x32_bf16 v[52:55], v[112:115], a[228:231], v[52:55]
  s_waitcnt lgkmcnt(2)
  v_mfma_f32_16x16x32_bf16 v[48:51], v[116:119], a[232:235], v[48:51]
  v_mfma_f32_16x16x32_bf16 v[52:55], v[116:119], a[236:239], v[52:55]
  s_waitcnt lgkmcnt(1)
  v_mfma_f32_16x16x32_bf16 v[48:51], v[120:123], a[240:243], v[48:51]
  v_mfma_f32_16x16x32_bf16 v[52:55], v[120:123], a[244:247], v[52:55]
  s_waitcnt lgkmcnt(0)
  v_mfma_f32_16x16x32_bf16 v[48:51], v[124:127], a[248:251], v[48:51]
  v_mfma_f32_16x16x32_bf16 v[52:55], v[124:127], a[252:255], v[52:55]
  s_nop 3
  v_cvt_pk_bf16_f32 v80, v48, v49
  v_cvt_pk_bf16_f32 v81, v50, v51
  buffer_store_dwordx2 v[80:81], v251, s[4:7], s39 offen offset:0 sc1
  s_nop 0
  v_cvt_pk_bf16_f32 v82, v52, v53
  v_cvt_pk_bf16_f32 v83, v54, v55
  buffer_store_dwordx2 v[82:83], v251, s[4:7], s39 offen offset:512 sc1
  buffer_store_dwordx4 v[16:19], v252, s[4:7], s51 offen sc1
  s_add_u32 s51, s51, 131072
  s_barrier
  s_add_u32 s36, s36, 2
  s_add_u32 s39, s39, 131072
  s_cmp_lt_u32 s36, 64
  s_cbranch_scc1 w_mem_mv
  s_branch w_exit
w_d:
  s_load_dwordx2 s[8:9], s[0:1], 80
  s_mov_b32 s10, 0x1c0000
  s_mov_b32 s11, 0x20000
  s_and_b32 s36, s53, 1
  s_lshr_b32 s42, s53, 1
  s_lshl_b32 s40, s36, 3
  s_add_u32 s40, s40, s42
  s_lshl_b32 s40, s40, 7
  s_add_u32 s40, s40, 1335296
  s_and_b32 s51, s42, 3
  s_lshr_b32 s52, s53, 3
  s_mul_i32 s46, s51, 458752
  s_mul_i32 s38, s51, 28672
  s_mul_i32 s43, s36, 114688
  s_add_u32 s38, s38, s43
  s_add_u32 s38, s38, 100663296
  s_add_u32 s51, s51, 8
  s_lshl2_add_u32 s42, s52, s33
  s_lshl_b32 s43, s42, 7
  s_add_u32 s46, s46, s43
  s_add_u32 s47, s46, 64
  s_lshl_b32 s39, s42, 12
  s_lshl_b32 s43, s51, 15
  s_add_u32 s39, s39, s43
  s_mul_i32 s43, s36, 393216
  s_add_u32 s39, s39, s43
  s_add_u32 s39, s39, 117440512
  s_mov_b32 s45, 1024
  v_mov_b32 v251, v252
  s_mov_b32 s49, 1316864
  v_lshlrev_b32 v246, 7, v255
  s_waitcnt lgkmcnt(0)
  s_cmp_lg_u32 s33, 0
  s_cbranch_scc1 w_wds_50047
  s_mov_b64 exec, 1
w_wd_50045:
  buffer_load_dword v250, off, s[28:31], 0 offset:36 sc1
  s_waitcnt vmcnt(0)
  v_readfirstlane_b32 s43, v250
  s_cmp_ge_u32 s43, 1
  s_cbranch_scc1 w_wdd_50046
  s_cmp_eq_u32 s35, 0
  s_cbranch_scc1 w_wdd_50046
  s_sub_u32 s35, s35, 1
  s_sleep 4
  s_branch w_wd_50045
w_wdd_50046:
  s_mov_b64 exec, -1
w_wds_50047:
  s_barrier
  s_lshl_b32 s48, s33, 15
  v_lshrrev_b32 v250, 3, v255
  v_mul_lo_u32 v250, v250, s45
  v_bfe_u32 v248, v255, 4, 1
  v_lshlrev_b32 v248, 2, v248
  v_xor_b32 v249, v248, v255
  v_and_b32 v249, 7, v249
  v_lshl_add_u32 v247, v249, 4, v250
  s_lshl_b32 s44, s45, 3
  s_add_u32 m0, s48, 0
  s_nop 0
  buffer_load_dwordx4 v247, s[8:11], s46 offen lds
  s_add_u32 s46, s46, s44
  s_add_u32 m0, s48, 1024
  s_nop 0
  buffer_load_dwordx4 v247, s[8:11], s46 offen lds
  s_add_u32 s46, s46, s44
  s_add_u32 m0, s48, 2048
  s_nop 0
  buffer_load_dwordx4 v247, s[8:11], s46 offen lds
  s_add_u32 s46, s46, s44
  s_add_u32 m0, s48, 3072
  s_nop 0
  buffer_load_dwordx4 v247, s[8:11], s46 offen lds
  s_add_u32 s46, s46, s44
  s_add_u32 m0, s48, 4096
  s_nop 0
  buffer_load_dwordx4 v247, s[8:11], s46 offen lds
  s_add_u32 s46, s46, s44
  s_add_u32 m0, s48, 5120
  s_nop 0
  buffer_load_dwordx4 v247, s[8:11], s46 offen lds
  s_add_u32 s46, s46, s44
  s_add_u32 m0, s48, 6144
  s_nop 0
  buffer_load_dwordx4 v247, s[8:11], s46 offen lds
  s_add_u32 s46, s46, s44
  s_add_u32 m0, s48, 7168
  s_nop 0
  buffer_load_dwordx4 v247, s[8:11], s46 offen lds
  s_add_u32 s46, s46, s44
  s_add_u32 m0, s48, 8192
  s_nop 0
  buffer_load_dwordx4 v247, s[8:11], s46 offen lds
  s_add_u32 s46, s46, s44
  s_add_u32 m0, s48, 9216
  s_nop 0
  buffer_load_dwordx4 v247, s[8:11], s46 offen lds
  s_add_u32 s46, s46, s44
  s_add_u32 m0, s48, 10240
  s_nop 0
  buffer_load_dwordx4 v247, s[8:11], s46 offen lds
  s_add_u32 s46, s46, s44
  s_add_u32 m0, s48, 11264
  s_nop 0
  buffer_load_dwordx4 v247, s[8:11], s46 offen lds
  s_add_u32 s46, s46, s44
  s_add_u32 m0, s48, 12288
  s_nop 0
  buffer_load_dwordx4 v247, s[8:11], s46 offen lds
  s_add_u32 s46, s46, s44
  s_add_u32 m0, s48, 13312
  s_nop 0
  buffer_load_dwordx4 v247, s[8:11], s46 offen lds
  s_add_u32 s46, s46, s44
  s_add_u32 m0, s48, 14336
  s_nop 0
  buffer_load_dwordx4 v247, s[8:11], s46 offen lds
  s_add_u32 s46, s46, s44
  s_add_u32 m0, s48, 15360
  s_nop 0
  buffer_load_dwordx4 v247, s[8:11], s46 offen lds
  s_add_u32 s46, s46, s44
  s_add_u32 m0, s48, 16384
  s_nop 0
  buffer_load_dwordx4 v247, s[8:11], s46 offen lds
  s_add_u32 s46, s46, s44
  s_add_u32 m0, s48, 17408
  s_nop 0
  buffer_load_dwordx4 v247, s[8:11], s46 offen lds
  s_add_u32 s46, s46, s44
  s_add_u32 m0, s48, 18432
  s_nop 0
  buffer_load_dwordx4 v247, s[8:11], s46 offen lds
  s_add_u32 s46, s46, s44
  s_add_u32 m0, s48, 19456
  s_nop 0
  buffer_load_dwordx4 v247, s[8:11], s46 offen lds
  s_add_u32 s46, s46, s44
  s_add_u32 m0, s48, 20480
  s_nop 0
  buffer_load_dwordx4 v247, s[8:11], s46 offen lds
  s_add_u32 s46, s46, s44
  s_add_u32 m0, s48, 21504
  s_nop 0
  buffer_load_dwordx4 v247, s[8:11], s46 offen lds
  s_add_u32 s46, s46, s44
  s_add_u32 m0, s48, 22528
  s_nop 0
  buffer_load_dwordx4 v247, s[8:11], s46 offen lds
  s_add_u32 s46, s46, s44
  s_add_u32 m0, s48, 23552
  s_nop 0
  buffer_load_dwordx4 v247, s[8:11], s46 offen lds
  s_add_u32 s46, s46, s44
  s_add_u32 m0, s48, 24576
  s_nop 0
  buffer_load_dwordx4 v247, s[8:11], s46 offen lds
  s_add_u32 s46, s46, s44
  s_add_u32 m0, s48, 25600
  s_nop 0
  buffer_load_dwordx4 v247, s[8:11], s46 offen lds
  s_add_u32 s46, s46, s44
  s_add_u32 m0, s48, 26624
  s_nop 0
  buffer_load_dwordx4 v247, s[8:11], s46 offen lds
  s_add_u32 s46, s46, s44
  s_add_u32 m0, s48, 27648
  s_nop 0
  buffer_load_dwordx4 v247, s[8:11], s46 offen lds
  s_add_u32 s46, s46, s44
  s_add_u32 m0, s48, 28672
  s_nop 0
  buffer_load_dwordx4 v247, s[8:11], s46 offen lds
  s_add_u32 s46, s46, s44
  s_add_u32 m0, s48, 29696
  s_nop 0
  buffer_load_dwordx4 v247, s[8:11], s46 offen lds
  s_add_u32 s46, s46, s44
  s_add_u32 m0, s48, 30720
  s_nop 0
  buffer_load_dwordx4 v247, s[8:11], s46 offen lds
  s_add_u32 s46, s46, s44
  s_add_u32 m0, s48, 31744
  s_nop 0
  buffer_load_dwordx4 v247, s[8:11], s46 offen lds
  s_add_u32 s46, s46, s44
  v_and_b32 v249, 3, v255
  v_bfe_u32 v250, v255, 2, 2
  v_lshl_add_u32 v250, v253, 2, v250
  v_lshlrev_b32 v250, 7, v250
  v_bfe_u32 v248, v255, 4, 1
  v_lshl_add_u32 v250, v248, 4, v250
  v_and_b32 v248, 1, v255
  v_lshl_add_u32 v250, v248, 5, v250
  v_bfe_u32 v248, v255, 1, 1
  v_lshl_add_u32 v250, v248, 3, v250
  v_bfe_u32 v248, v255, 3, 1
  v_lshl_add_u32 v250, v248, 6, v250
  v_add_u32 v240, s48, v250
  v_xor_b32 v241, 64, v240
  s_waitcnt vmcnt(28)
  ds_read_b64_tr_b16 a[0:1], v240 offset:0
  ds_read_b64_tr_b16 a[2:3], v240 offset:2048
  ds_read_b64_tr_b16 a[4:5], v241 offset:0
  ds_read_b64_tr_b16 a[6:7], v241 offset:2048
  ds_read_b64_tr_b16 a[8:9], v240 offset:1024
  ds_read_b64_tr_b16 a[10:11], v240 offset:3072
  ds_read_b64_tr_b16 a[12:13], v241 offset:1024
  ds_read_b64_tr_b16 a[14:15], v241 offset:3072
  s_waitcnt lgkmcnt(0)
  s_add_u32 m0, s48, 0
  s_nop 0
  buffer_load_dwordx4 v247, s[8:11], s46 offen lds
  s_add_u32 s46, s46, s44
  s_add_u32 m0, s48, 1024
  s_nop 0
  buffer_load_dwordx4 v247, s[8:11], s46 offen lds
  s_add_u32 s46, s46, s44
  s_add_u32 m0, s48, 2048
  s_nop 0
  buffer_load_dwordx4 v247, s[8:11], s46 offen lds
  s_add_u32 s46, s46, s44
  s_add_u32 m0, s48, 3072
  s_nop 0
  buffer_load_dwordx4 v247, s[8:11], s46 offen lds
  s_add_u32 s46, s46, s44
  s_waitcnt vmcnt(28)
  ds_read_b64_tr_b16 a[16:17], v240 offset:4096
  ds_read_b64_tr_b16 a[18:19], v240 offset:6144
  ds_read_b64_tr_b16 a[20:21], v241 offset:4096
  ds_read_b64_tr_b16 a[22:23], v241 offset:6144
  ds_read_b64_tr_b16 a[24:25], v240 offset:5120
  ds_read_b64_tr_b16 a[26:27], v240 offset:7168
  ds_read_b64_tr_b16 a[28:29], v241 offset:5120
  ds_read_b64_tr_b16 a[30:31], v241 offset:7168
  s_waitcnt lgkmcnt(0)
  s_add_u32 m0, s48, 4096
  s_nop 0
  buffer_load_dwordx4 v247, s[8:11], s46 offen lds
  s_add_u32 s46, s46, s44
  s_add_u32 m0, s48, 5120
  s_nop 0
  buffer_load_dwordx4 v247, s[8:11], s46 offen lds
  s_add_u32 s46, s46, s44
  s_add_u32 m0, s48, 6144
  s_nop 0
  buffer_load_dwordx4 v247, s[8:11], s46 offen lds
  s_add_u32 s46, s46, s44
  s_add_u32 m0, s48, 7168
  s_nop 0
  buffer_load_dwordx4 v247, s[8:11], s46 offen lds
  s_add_u32 s46, s46, s44
  s_waitcnt vmcnt(28)
  ds_read_b64_tr_b16 a[32:33], v240 offset:8192
  ds_read_b64_tr_b16 a[34:35], v240 offset:10240
  ds_read_b64_tr_b16 a[36:37], v241 offset:8192
  ds_read_b64_tr_b16 a[38:39], v241 offset:10240
  ds_read_b64_tr_b16 a[40:41], v240 offset:9216
  ds_read_b64_tr_b16 a[42:43], v240 offset:11264
  ds_read_b64_tr_b16 a[44:45], v241 offset:9216
  ds_read_b64_tr_b16 a[46:47], v241 offset:11264
  s_waitcnt lgkmcnt(0)
  s_add_u32 m0, s48, 8192
  s_nop 0
  buffer_load_dwordx4 v247, s[8:11], s46 offen lds
  s_add_u32 s46, s46, s44
  s_add_u32 m0, s48, 9216
  s_nop 0
  buffer_load_dwordx4 v247, s[8:11], s46 offen lds
  s_add_u32 s46, s46, s44
  s_add_u32 m0, s48, 10240
  s_nop 0
  buffer_load_dwordx4 v247, s[8:11], s46 offen lds
  s_add_u32 s46, s46, s44
  s_add_u32 m0, s48, 11264
  s_nop 0
  buffer_load_dwordx4 v247, s[8:11], s46 offen lds
  s_add_u32 s46, s46, s44
  s_waitcnt vmcnt(28)
  ds_read_b64_tr_b16 a[48:49], v240 offset:12288
  ds_read_b64_tr_b16 a[50:51], v240 offset:14336
  ds_read_b64_tr_b16 a[52:53], v241 offset:12288
  ds_read_b64_tr_b16 a[54:55], v241 offset:14336
  ds_read_b64_tr_b16 a[56:57], v240 offset:13312
  ds_read_b64_tr_b16 a[58:59], v240 offset:15360
  ds_read_b64_tr_b16 a[60:61], v241 offset:13312
  ds_read_b64_tr_b16 a[62:63], v241 offset:15360
  s_waitcnt lgkmcnt(0)
  s_add_u32 m0, s48, 12288
  s_nop 0
  buffer_load_dwordx4 v247, s[8:11], s46 offen lds
  s_add_u32 s46, s46, s44
  s_add_u32 m0, s48, 13312
  s_nop 0
  buffer_load_dwordx4 v247, s[8:11], s46 offen lds
  s_add_u32 s46, s46, s44
  s_add_u32 m0, s48, 14336
  s_nop 0
  buffer_load_dwordx4 v247, s[8:11], s46 offen lds
  s_add_u32 s46, s46, s44
  s_add_u32 m0, s48, 15360
  s_nop 0
  buffer_load_dwordx4 v247, s[8:11], s46 offen lds
  s_add_u32 s46, s46, s44
  s_waitcnt vmcnt(28)
  ds_read_b64_tr_b16 a[64:65], v240 offset:16384
  ds_read_b64_tr_b16 a[66:67], v240 offset:18432
  ds_read_b64_tr_b16 a[68:69], v241 offset:16384
  ds_read_b64_tr_b16 a[70:71], v241 offset:18432
  ds_read_b64_tr_b16 a[72:73], v240 offset:17408
  ds_read_b64_tr_b16 a[74:75], v240 offset:19456
  ds_read_b64_tr_b16 a[76:77], v241 offset:17408
  ds_read_b64_tr_b16 a[78:79], v241 offset:19456
  s_waitcnt lgkmcnt(0)
  s_add_u32 m0, s48, 16384
  s_nop 0
  buffer_load_dwordx4 v247, s[8:11], s46 offen lds
  s_add_u32 s46, s46, s44
  s_add_u32 m0, s48, 17408
  s_nop 0
  buffer_load_dwordx4 v247, s[8:11], s46 offen lds
  s_add_u32 s46, s46, s44
  s_add_u32 m0, s48, 18432
  s_nop 0
  buffer_load_dwordx4 v247, s[8:11], s46 offen lds
  s_add_u32 s46, s46, s44
  s_add_u32 m0, s48, 19456
  s_nop 0
  buffer_load_dwordx4 v247, s[8:11], s46 offen lds
  s_add_u32 s46, s46, s44
  s_waitcnt vmcnt(28)
  ds_read_b64_tr_b16 a[80:81], v240 offset:20480
  ds_read_b64_tr_b16 a[82:83], v240 offset:22528
  ds_read_b64_tr_b16 a[84:85], v241 offset:20480
  ds_read_b64_tr_b16 a[86:87], v241 offset:22528
  ds_read_b64_tr_b16 a[88:89], v240 offset:21504
  ds_read_b64_tr_b16 a[90:91], v240 offset:23552
  ds_read_b64_tr_b16 a[92:93], v241 offset:21504
  ds_read_b64_tr_b16 a[94:95], v241 offset:23552
  s_waitcnt lgkmcnt(0)
  s_add_u32 m0, s48, 20480
  s_nop 0
  buffer_load_dwordx4 v247, s[8:11], s46 offen lds
  s_add_u32 s46, s46, s44
  s_add_u32 m0, s48, 21504
  s_nop 0
  buffer_load_dwordx4 v247, s[8:11], s46 offen lds
  s_add_u32 s46, s46, s44
  s_add_u32 m0, s48, 22528
  s_nop 0
  buffer_load_dwordx4 v247, s[8:11], s46 offen lds
  s_add_u32 s46, s46, s44
  s_add_u32 m0, s48, 23552
  s_nop 0
  buffer_load_dwordx4 v247, s[8:11], s46 offen lds
  s_add_u32 s46, s46, s44
  s_waitcnt vmcnt(28)
  ds_read_b64_tr_b16 a[96:97], v240 offset:24576
  ds_read_b64_tr_b16 a[98:99], v240 offset:26624
  ds_read_b64_tr_b16 a[100:101], v241 offset:24576
  ds_read_b64_tr_b16 a[102:103], v241 offset:26624
  ds_read_b64_tr_b16 a[104:105], v240 offset:25600
  ds_read_b64_tr_b16 a[106:107], v240 offset:27648
  ds_read_b64_tr_b16 a[108:109], v241 offset:25600
  ds_read_b64_tr_b16 a[110:111], v241 offset:27648
  s_waitcnt lgkmcnt(0)
  s_add_u32 m0, s48, 24576
  s_nop 0
  buffer_load_dwordx4 v247, s[8:11], s46 offen lds
  s_add_u32 s46, s46, s44
  s_add_u32 m0, s48, 25600
  s_nop 0
  buffer_load_dwordx4 v247, s[8:11], s46 offen lds
  s_add_u32 s46, s46, s44
  s_add_u32 m0, s48, 26624
  s_nop 0
  buffer_load_dwordx4 v247, s[8:11], s46 offen lds
  s_add_u32 s46, s46, s44
  s_add_u32 m0, s48, 27648
  s_nop 0
  buffer_load_dwordx4 v247, s[8:11], s46 offen lds
  s_add_u32 s46, s46, s44
  s_waitcnt vmcnt(28)
  ds_read_b64_tr_b16 a[112:113], v240 offset:28672
  ds_read_b64_tr_b16 a[114:115], v240 offset:30720
  ds_read_b64_tr_b16 a[116:117], v241 offset:28672
  ds_read_b64_tr_b16 a[118:119], v241 offset:30720
  ds_read_b64_tr_b16 a[120:121], v240 offset:29696
  ds_read_b64_tr_b16 a[122:123], v240 offset:31744
  ds_read_b64_tr_b16 a[124:125], v241 offset:29696
  ds_read_b64_tr_b16 a[126:127], v241 offset:31744
  s_waitcnt lgkmcnt(0)
  s_add_u32 m0, s48, 28672
  s_nop 0
  buffer_load_dwordx4 v247, s[8:11], s46 offen lds
  s_add_u32 s46, s46, s44
  s_add_u32 m0, s48, 29696
  s_nop 0
  buffer_load_dwordx4 v247, s[8:11], s46 offen lds
  s_add_u32 s46, s46, s44
  s_add_u32 m0, s48, 30720
  s_nop 0
  buffer_load_dwordx4 v247, s[8:11], s46 offen lds
  s_add_u32 s46, s46, s44
  s_add_u32 m0, s48, 31744
  s_nop 0
  buffer_load_dwordx4 v247, s[8:11], s46 offen lds
  s_add_u32 s46, s46, s44
  s_waitcnt vmcnt(28)
  ds_read_b64_tr_b16 a[128:129], v240 offset:0
  ds_read_b64_tr_b16 a[130:131], v240 offset:2048
  ds_read_b64_tr_b16 a[132:133], v241 offset:0
  ds_read_b64_tr_b16 a[134:135], v241 offset:2048
  ds_read_b64_tr_b16 a[136:137], v240 offset:1024
  ds_read_b64_tr_b16 a[138:139], v240 offset:3072
  ds_read_b64_tr_b16 a[140:141], v241 offset:1024
  ds_read_b64_tr_b16 a[142:143], v241 offset:3072
  s_waitcnt lgkmcnt(0)
  s_waitcnt vmcnt(24)
  ds_read_b64_tr_b16 a[144:145], v240 offset:4096
  ds_read_b64_tr_b16 a[146:147], v240 offset:6144
  ds_read_b64_tr_b16 a[148:149], v241 offset:4096
  ds_read_b64_tr_b16 a[150:151], v241 offset:6144
  ds_read_b64_tr_b16 a[152:153], v240 offset:5120
  ds_read_b64_tr_b16 a[154:155], v240 offset:7168
  ds_read_b64_tr_b16 a[156:157], v241 offset:5120
  ds_read_b64_tr_b16 a[158:159], v241 offset:7168
  s_waitcnt lgkmcnt(0)
  s_waitcnt vmcnt(20)
  ds_read_b64_tr_b16 a[160:161], v240 offset:8192
  ds_read_b64_tr_b16 a[162:163], v240 offset:10240
  ds_read_b64_tr_b16 a[164:165], v241 offset:8192
  ds_read_b64_tr_b16 a[166:167], v241 offset:10240
  ds_read_b64_tr_b16 a[168:169], v240 offset:9216
  ds_read_b64_tr_b16 a[170:171], v240 offset:11264
  ds_read_b64_tr_b16 a[172:173], v241 offset:9216
  ds_read_b64_tr_b16 a[174:175], v241 offset:11264
  s_waitcnt lgkmcnt(0)
  s_waitcnt vmcnt(16)
  ds_read_b64_tr_b16 a[176:177], v240 offset:12288
  ds_read_b64_tr_b16 a[178:179], v240 offset:14336
  ds_read_b64_tr_b16 a[180:181], v241 offset:12288
  ds_read_b64_tr_b16 a[182:183], v241 offset:14336
  ds_read_b64_tr_b16 a[184:185], v240 offset:13312
  ds_read_b64_tr_b16 a[186:187], v240 offset:15360
  ds_read_b64_tr_b16 a[188:189], v241 offset:13312
  ds_read_b64_tr_b16 a[190:191], v241 offset:15360
  s_waitcnt lgkmcnt(0)
  s_waitcnt vmcnt(12)
  ds_read_b64_tr_b16 a[192:193], v240 offset:16384
  ds_read_b64_tr_b16 a[194:195], v240 offset:18432
  ds_read_b64_tr_b16 a[196:197], v241 offset:16384
  ds_read_b64_tr_b16 a[198:199], v241 offset:18432
  ds_read_b64_tr_b16 a[200:201], v240 offset:17408
  ds_read_b64_tr_b16 a[202:203], v240 offset:19456
  ds_read_b64_tr_b16 a[204:205], v241 offset:17408
  ds_read_b64_tr_b16 a[206:207], v241 offset:19456
  s_waitcnt lgkmcnt(0)
  s_waitcnt vmcnt(8)
  ds_read_b64_tr_b16 a[208:209], v240 offset:20480
  ds_read_b64_tr_b16 a[210:211], v240 offset:22528
  ds_read_b64_tr_b16 a[212:213], v241 offset:20480
  ds_read_b64_tr_b16 a[214:215], v241 offset:22528
  ds_read_b64_tr_b16 a[216:217], v240 offset:21504
  ds_read_b64_tr_b16 a[218:219], v240 offset:23552
  ds_read_b64_tr_b16 a[220:221], v241 offset:21504
  ds_read_b64_tr_b16 a[222:223], v241 offset:23552
  s_waitcnt lgkmcnt(0)
  s_waitcnt vmcnt(4)
  ds_read_b64_tr_b16 a[224:225], v240 offset:24576
  ds_read_b64_tr_b16 a[226:227], v240 offset:26624
  ds_read_b64_tr_b16 a[228:229], v241 offset:24576
  ds_read_b64_tr_b16 a[230:231], v241 offset:26624
  ds_read_b64_tr_b16 a[232:233], v240 offset:25600
  ds_read_b64_tr_b16 a[234:235], v240 offset:27648
  ds_read_b64_tr_b16 a[236:237], v241 offset:25600
  ds_read_b64_tr_b16 a[238:239], v241 offset:27648
  s_waitcnt lgkmcnt(0)
  s_waitcnt vmcnt(0)
  ds_read_b64_tr_b16 a[240:241], v240 offset:28672
  ds_read_b64_tr_b16 a[242:243], v240 offset:30720
  ds_read_b64_tr_b16 a[244:245], v241 offset:28672
  ds_read_b64_tr_b16 a[246:247], v241 offset:30720
  ds_read_b64_tr_b16 a[248:249], v240 offset:29696
  ds_read_b64_tr_b16 a[250:251], v240 offset:31744
  ds_read_b64_tr_b16 a[252:253], v241 offset:29696
  ds_read_b64_tr_b16 a[254:255], v241 offset:31744
  s_waitcnt lgkmcnt(0)
  s_barrier
  s_mul_i32 s42, s33, 7168
  v_add_u32 v241, s42, v252
  v_add_u32 v242, 4096, v241
  s_add_u32 s50, s36, 1
  s_mov_b64 exec, 0x3fff
w_pl_50048:
  buffer_load_dword v250, v246, s[4:7], s49 offen sc1
  s_waitcnt vmcnt(0)
  v_cmp_gt_u32 vcc, s50, v250
  s_cbranch_vccz w_pld_50049
  s_cmp_eq_u32 s35, 0
  s_cbranch_scc1 w_pld_50049
  s_sub_u32 s35, s35, 1
  s_sleep 16
  s_branch w_pl_50048
w_pld_50049:
  s_mov_b64 exec, -1
  buffer_load_dwordx4 v[0:3], v241, s[4:7], s38 offen offset:0 sc1
  buffer_load_dwordx4 v[4:7], v241, s[4:7], s38 offen offset:1024 sc1
  buffer_load_dwordx4 v[8:11], v241, s[4:7], s38 offen offset:2048 sc1
  buffer_load_dwordx4 v[12:15], v241, s[4:7], s38 offen offset:3072 sc1
  buffer_load_dwordx4 v[16:19], v242, s[4:7], s38 offen offset:0 sc1
  buffer_load_dwordx4 v[20:23], v242, s[4:7], s38 offen offset:1024 sc1
  buffer_load_dwordx4 v[24:27], v242, s[4:7], s38 offen offset:2048 sc1
  s_waitcnt vmcnt(0)
w_top_d:
  ds_write_b128 v241, v[0:3] offset:0
  ds_write_b128 v241, v[4:7] offset:1024
  ds_write_b128 v241, v[8:11] offset:2048
  ds_write_b128 v241, v[12:15] offset:3072
  ds_write_b128 v241, v[16:19] offset:4096
  ds_write_b128 v241, v[20:23] offset:5120
  ds_write_b128 v241, v[24:27] offset:6144
  s_waitcnt lgkmcnt(0)
  s_barrier
  s_add_u32 s38, s38, 229376
  s_add_u32 s50, s36, 3
  s_cmp_gt_u32 s50, 64
  s_cbranch_scc1 w_gemm_d
  s_mov_b64 exec, 0x3fff
w_pl_50050:
  buffer_load_dword v250, v246, s[4:7], s49 offen sc1
  s_waitcnt vmcnt(0)
  v_cmp_gt_u32 vcc, s50, v250
  s_cbranch_vccz w_pld_50051
  s_cmp_eq_u32 s35, 0
  s_cbranch_scc1 w_pld_50051
  s_sub_u32 s35, s35, 1
  s_sleep 8
  s_branch w_pl_50050
w_pld_50051:
  s_mov_b64 exec, -1
  buffer_load_dwordx4 v[0:3], v241, s[4:7], s38 offen offset:0 sc1
  buffer_load_dwordx4 v[4:7], v241, s[4:7], s38 offen offset:1024 sc1
  buffer_load_dwordx4 v[8:11], v241, s[4:7], s38 offen offset:2048 sc1
  buffer_load_dwordx4 v[12:15], v241, s[4:7], s38 offen offset:3072 sc1
  buffer_load_dwordx4 v[16:19], v242, s[4:7], s38 offen offset:0 sc1
  buffer_load_dwordx4 v[20:23], v242, s[4:7], s38 offen offset:1024 sc1
  buffer_load_dwordx4 v[24:27], v242, s[4:7], s38 offen offset:2048 sc1
w_gemm_d:
  ds_read_b128 v[32:35], v252 offset:0
  ds_read_b128 v[36:39], v252 offset:1024
  ds_read_b128 v[40:43], v252 offset:2048
  s_waitcnt lgkmcnt(2)
  v_mfma_f32_32x32x16_bf16 v[48:63], a[0:3], v[32:35], 0
  ds_read_b128 v[44:47], v252 offset:3072
  v_mfma_f32_32x32x16_bf16 v[64:79], a[4:7], v[32:35], 0
  s_waitcnt lgkmcnt(2)
  v_mfma_f32_32x32x16_bf16 v[48:63], a[8:11], v[36:39], v[48:63]
  ds_read_b128 v[32:35], v252 offset:4096
  v_mfma_f32_32x32x16_bf16 v[64:79], a[12:15], v[36:39], v[64:79]
  s_waitcnt lgkmcnt(2)
  v_mfma_f32_32x32x16_bf16 v[48:63], a[16:19], v[40:43], v[48:63]
  ds_read_b128 v[36:39], v252 offset:5120
  v_mfma_f32_32x32x16_bf16 v[64:79], a[20:23], v[40:43], v[64:79]
  s_waitcnt lgkmcnt(2)
  v_mfma_f32_32x32x16_bf16 v[48:63], a[24:27], v[44:47], v[48:63]
  ds_read_b128 v[40:43], v252 offset:6144
  v_mfma_f32_32x32x16_bf16 v[64:79], a[28:31], v[44:47], v[64:79]
  s_waitcnt lgkmcnt(2)
  v_mfma_f32_32x32x16_bf16 v[48:63], a[32:35], v[32:35], v[48:63]
  ds_read_b128 v[44:47], v252 offset:7168
  v_mfma_f32_32x32x16_bf16 v[64:79], a[36:39], v[32:35], v[64:79]
  s_waitcnt lgkmcnt(2)
  v_mfma_f32_32x32x16_bf16 v[48:63], a[40:43], v[36:39], v[48:63]
  ds_read_b128 v[32:35], v252 offset:8192
  v_mfma_f32_32x32x16_bf16 v[64:79], a[44:47], v[36:39], v[64:79]
  s_waitcnt lgkmcnt(2)
  v_mfma_f32_32x32x16_bf16 v[48:63], a[48:51], v[40:43], v[48:63]
  ds_read_b128 v[36:39], v252 offset:9216
  v_mfma_f32_32x32x16_bf16 v[64:79], a[52:55], v[40:43], v[64:79]
  s_waitcnt lgkmcnt(2)
  v_mfma_f32_32x32x16_bf16 v[48:63], a[56:59], v[44:47], v[48:63]
  ds_read_b128 v[40:43], v252 offset:10240
  v_mfma_f32_32x32x16_bf16 v[64:79], a[60:63], v[44:47], v[64:79]
  s_waitcnt lgkmcnt(2)
  v_mfma_f32_32x32x16_bf16 v[48:63], a[64:67], v[32:35], v[48:63]
  ds_read_b128 v[44:47], v252 offset:11264
  v_mfma_f32_32x32x16_bf16 v[64:79], a[68:71], v[32:35], v[64:79]
  s_waitcnt lgkmcnt(2)
  v_mfma_f32_32x32x16_bf16 v[48:63], a[72:75], v[36:39], v[48:63]
  ds_read_b128 v[32:35], v252 offset:12288
  v_mfma_f32_32x32x16_bf16 v[64:79], a[76:79], v[36:39], v[64:79]
  s_waitcnt lgkmcnt(2)
  v_mfma_f32_32x32x16_bf16 v[48:63], a[80:83], v[40:43], v[48:63]
  ds_read_b128 v[36:39], v252 offset:13312
  v_mfma_f32_32x32x16_bf16 v[64:79], a[84:87], v[40:43], v[64:79]
  s_waitcnt lgkmcnt(2)
  v_mfma_f32_32x32x16_bf16 v[48:63], a[88:91], v[44:47], v[48:63]
  ds_read_b128 v[40:43], v252 offset:14336
  v_mfma_f32_32x32x16_bf16 v[64:79], a[92:95], v[44:47], v[64:79]
  s_waitcnt lgkmcnt(2)
  v_mfma_f32_32x32x16_bf16 v[48:63], a[96:99], v[32:35], v[48:63]
  ds_read_b128 v[44:47], v252 offset:15360
  v_mfma_f32_32x32x16_bf16 v[64:79], a[100:103], v[32:35], v[64:79]
  s_waitcnt lgkmcnt(2)
  v_mfma_f32_32x32x16_bf16 v[48:63], a[104:107], v[36:39], v[48:63]
  ds_read_b128 v[32:35], v252 offset:16384
  v_mfma_f32_32x32x16_bf16 v[64:79], a[108:111], v[36:39], v[64:79]
  s_waitcnt lgkmcnt(2)
  v_mfma_f32_32x32x16_bf16 v[48:63], a[112:115], v[40:43], v[48:63]
  ds_read_b128 v[36:39], v252 offset:17408
  v_mfma_f32_32x32x16_bf16 v[64:79], a[116:119], v[40:43], v[64:79]
  s_waitcnt lgkmcnt(2)
  v_mfma_f32_32x32x16_bf16 v[48:63], a[120:123], v[44:47], v[48:63]
  ds_read_b128 v[40:43], v252 offset:18432
  v_mfma_f32_32x32x16_bf16 v[64:79], a[124:127], v[44:47], v[64:79]
  s_waitcnt lgkmcnt(2)
  v_mfma_f32_32x32x16_bf16 v[48:63], a[128:131], v[32:35], v[48:63]
  ds_read_b128 v[44:47], v252 offset:19456
  v_mfma_f32_32x32x16_bf16 v[64:79], a[132:135], v[32:35], v[64:79]
  s_waitcnt lgkmcnt(2)
  v_mfma_f32_32x32x16_bf16 v[48:63], a[136:139], v[36:39], v[48:63]
  ds_read_b128 v[32:35], v252 offset:20480
  v_mfma_f32_32x32x16_bf16 v[64:79], a[140:143], v[36:39], v[64:79]
  s_waitcnt lgkmcnt(2)
  v_mfma_f32_32x32x16_bf16 v[48:63], a[144:147], v[40:43], v[48:63]
  ds_read_b128 v[36:39], v252 offset:21504
  v_mfma_f32_32x32x16_bf16 v[64:79], a[148:151], v[40:43], v[64:79]
  s_waitcnt lgkmcnt(2)
  v_mfma_f32_32x32x16_bf16 v[48:63], a[152:155], v[44:47], v[48:63]
  ds_read_b128 v[40:43], v252 offset:22528
  v_mfma_f32_32x32x16_bf16 v[64:79], a[156:159], v[44:47], v[64:79]
  s_waitcnt lgkmcnt(2)
  v_mfma_f32_32x32x16_bf16 v[48:63], a[160:163], v[32:35], v[48:63]
  ds_read_b128 v[44:47], v252 offset:23552
  v_mfma_f32_32x32x16_bf16 v[64:79], a[164:167], v[32:35], v[64:79]
  s_waitcnt lgkmcnt(2)
  v_mfma_f32_32x32x16_bf16 v[48:63], a[168:171], v[36:39], v[48:63]
  ds_read_b128 v[32:35], v252 offset:24576
  v_mfma_f32_32x32x16_bf16 v[64:79], a[172:175], v[36:39], v[64:79]
  s_waitcnt lgkmcnt(2)
  v_mfma_f32_32x32x16_bf16 v[48:63], a[176:179], v[40:43], v[48:63]
  ds_read_b128 v[36:39], v252 offset:25600
  v_mfma_f32_32x32x16_bf16 v[64:79], a[180:183], v[40:43], v[64:79]
  s_waitcnt lgkmcnt(2)
  v_mfma_f32_32x32x16_bf16 v[48:63], a[184:187], v[44:47], v[48:63]
  ds_read_b128 v[40:43], v252 offset:26624
  v_mfma_f32_32x32x16_bf16 v[64:79], a[188:191], v[44:47], v[64:79]
  s_waitcnt lgkmcnt(2)
  v_mfma_f32_32x32x16_bf16 v[48:63], a[192:195], v[32:35], v[48:63]
  ds_read_b128 v[44:47], v252 offset:27648
  v_mfma_f32_32x32x16_bf16 v[64:79], a[196:199], v[32:35], v[64:79]
  s_waitcnt lgkmcnt(2)
  v_mfma_f32_32x32x16_bf16 v[48:63], a[200:203], v[36:39], v[48:63]
  v_mfma_f32_32x32x16_bf16 v[64:79], a[204:207], v[36:39], v[64:79]
  s_waitcnt lgkmcnt(1)
  v_mfma_f32_32x32x16_bf16 v[48:63], a[208:211], v[40:43], v[48:63]
  v_mfma_f32_32x32x16_bf16 v[64:79], a[212:215], v[40:43], v[64:79]
  s_waitcnt lgkmcnt(0)
  v_mfma_f32_32x32x16_bf16 v[48:63], a[216:219], v[44:47], v[48:63]
  v_mfma_f32_32x32x16_bf16 v[64:79], a[220:223], v[44:47], v[64:79]
  s_nop 3
  v_cvt_pk_bf16_f32 v80, v48, v49
  v_cvt_pk_bf16_f32 v81, v50, v51
  v_cvt_pk_bf16_f32 v82, v52, v53
  v_cvt_pk_bf16_f32 v83, v54, v55
  buffer_store_dwordx4 v[80:83], v251, s[4:7], s39 offen offset:0 sc1
  v_cvt_pk_bf16_f32 v84, v56, v57
  v_cvt_pk_bf16_f32 v85, v58, v59
  v_cvt_pk_bf16_f32 v86, v60, v61
  v_cvt_pk_bf16_f32 v87, v62, v63
  buffer_store_dwordx4 v[84:87], v251, s[4:7], s39 offen offset:1024 sc1
  v_cvt_pk_bf16_f32 v88, v64, v65
  v_cvt_pk_bf16_f32 v89, v66, v67
  v_cvt_pk_bf16_f32 v90, v68, v69
  v_cvt_pk_bf16_f32 v91, v70, v71
  buffer_store_dwordx4 v[88:91], v251, s[4:7], s39 offen offset:2048 sc1
  v_cvt_pk_bf16_f32 v92, v72, v73
  v_cvt_pk_bf16_f32 v93, v74, v75
  v_cvt_pk_bf16_f32 v94, v76, v77
  v_cvt_pk_bf16_f32 v95, v78, v79
  buffer_store_dwordx4 v[92:95], v251, s[4:7], s39 offen offset:3072 sc1
  s_waitcnt vmcnt(0)
  s_barrier
  s_cmp_lg_u32 s33, 0
  s_cbranch_scc1 w_fl_50052
  s_add_u32 s42, s36, 1
  v_mov_b32 v250, s42
  s_mov_b64 exec, 1
  buffer_store_dword v250, off, s[4:7], s40 sc1
  s_mov_b64 exec, -1
w_fl_50052:
  s_add_u32 s36, s36, 2
  s_add_u32 s39, s39, 786432
  s_cmp_lt_u32 s36, 64
  s_cbranch_scc1 w_top_d
  s_branch w_exit
w_xy:
  s_load_dwordx2 s[8:9], s[0:1], 40
  s_mov_b32 s10, 0x400000
  s_mov_b32 s11, 0x20000
  s_mul_i32 s42, s53, 43
  s_lshr_b32 s42, s42, 7
  s_mul_i32 s43, s42, 3
  s_sub_u32 s36, s53, s43
  s_and_b32 s52, s42, 1
  s_lshr_b32 s51, s42, 1
  s_lshl1_add_u32 s40, s36, s52
  s_lshl3_add_u32 s40, s40, s51
  s_lshl_b32 s40, s40, 7
  s_add_u32 s40, s40, 1327104
  s_lshl_b32 s46, s51, 19
  s_lshl2_add_u32 s42, s52, s33
  s_lshl_b32 s43, s42, 7
  s_add_u32 s46, s46, s43
  s_add_u32 s47, s46, 64
  s_lshl_b32 s39, s42, 12
  s_lshl_b32 s43, s51, 15
  s_add_u32 s39, s39, s43
  s_mul_i32 s43, s36, 393216
  s_add_u32 s39, s39, s43
  s_add_u32 s39, s39, 117440512
  s_mov_b32 s45, 1024
  v_mov_b32 v251, v252
  s_lshl2_add_u32 s42, s51, s33
  s_lshl_b32 s38, s42, 13
  s_lshl_b32 s43, s36, 18
  s_add_u32 s38, s38, s43
  s_add_u32 s38, s38, 16777216
  s_lshl_b32 s54, s42, 11
  s_lshl_b32 s43, s36, 16
  s_add_u32 s54, s54, s43
  s_add_u32 s54, s54, 150994944
  s_lshr_b32 s49, s42, 1
  s_lshl_b32 s49, s49, 7
  s_add_u32 s49, s49, 1310720
  s_waitcnt lgkmcnt(0)
  s_cmp_lg_u32 s33, 0
  s_cbranch_scc1 w_wds_50055
  s_mov_b64 exec, 1
w_wd_50053:
  buffer_load_dword v250, off, s[28:31], 0 offset:36 sc1
  s_waitcnt vmcnt(0)
  v_readfirstlane_b32 s43, v250
  s_cmp_ge_u32 s43, 1
  s_cbranch_scc1 w_wdd_50054
  s_cmp_eq_u32 s35, 0
  s_cbranch_scc1 w_wdd_50054
  s_sub_u32 s35, s35, 1
  s_sleep 16
  s_branch w_wd_50053
w_wdd_50054:
  s_mov_b64 exec, -1
w_wds_50055:
  s_barrier
  s_lshl_b32 s48, s33, 15
  v_lshrrev_b32 v250, 3, v255
  v_mul_lo_u32 v250, v250, s45
  v_bfe_u32 v248, v255, 4, 1
  v_lshlrev_b32 v248, 2, v248
  v_xor_b32 v249, v248, v255
  v_and_b32 v249, 7, v249
  v_lshl_add_u32 v247, v249, 4, v250
  s_lshl_b32 s44, s45, 3
  s_add_u32 m0, s48, 0
  s_nop 0
  buffer_load_dwordx4 v247, s[8:11], s46 offen lds
  s_add_u32 s46, s46, s44
  s_add_u32 m0, s48, 1024
  s_nop 0
  buffer_load_dwordx4 v247, s[8:11], s46 offen lds
  s_add_u32 s46, s46, s44
  s_add_u32 m0, s48, 2048
  s_nop 0
  buffer_load_dwordx4 v247, s[8:11], s46 offen lds
  s_add_u32 s46, s46, s44
  s_add_u32 m0, s48, 3072
  s_nop 0
  buffer_load_dwordx4 v247, s[8:11], s46 offen lds
  s_add_u32 s46, s46, s44
  s_add_u32 m0, s48, 4096
  s_nop 0
  buffer_load_dwordx4 v247, s[8:11], s46 offen lds
  s_add_u32 s46, s46, s44
  s_add_u32 m0, s48, 5120
  s_nop 0
  buffer_load_dwordx4 v247, s[8:11], s46 offen lds
  s_add_u32 s46, s46, s44
  s_add_u32 m0, s48, 6144
  s_nop 0
  buffer_load_dwordx4 v247, s[8:11], s46 offen lds
  s_add_u32 s46, s46, s44
  s_add_u32 m0, s48, 7168
  s_nop 0
  buffer_load_dwordx4 v247, s[8:11], s46 offen lds
  s_add_u32 s46, s46, s44
  s_add_u32 m0, s48, 8192
  s_nop 0
  buffer_load_dwordx4 v247, s[8:11], s46 offen lds
  s_add_u32 s46, s46, s44
  s_add_u32 m0, s48, 9216
  s_nop 0
  buffer_load_dwordx4 v247, s[8:11], s46 offen lds
  s_add_u32 s46, s46, s44
  s_add_u32 m0, s48, 10240
  s_nop 0
  buffer_load_dwordx4 v247, s[8:11], s46 offen lds
  s_add_u32 s46, s46, s44
  s_add_u32 m0, s48, 11264
  s_nop 0
  buffer_load_dwordx4 v247, s[8:11], s46 offen lds
  s_add_u32 s46, s46, s44
  s_add_u32 m0, s48, 12288
  s_nop 0
  buffer_load_dwordx4 v247, s[8:11], s46 offen lds
  s_add_u32 s46, s46, s44
  s_add_u32 m0, s48, 13312
  s_nop 0
  buffer_load_dwordx4 v247, s[8:11], s46 offen lds
  s_add_u32 s46, s46, s44
  s_add_u32 m0, s48, 14336
  s_nop 0
  buffer_load_dwordx4 v247, s[8:11], s46 offen lds
  s_add_u32 s46, s46, s44
  s_add_u32 m0, s48, 15360
  s_nop 0
  buffer_load_dwordx4 v247, s[8:11], s46 offen lds
  s_add_u32 s46, s46, s44
  s_add_u32 m0, s48, 16384
  s_nop 0
  buffer_load_dwordx4 v247, s[8:11], s46 offen lds
  s_add_u32 s46, s46, s44
  s_add_u32 m0, s48, 17408
  s_nop 0
  buffer_load_dwordx4 v247, s[8:11], s46 offen lds
  s_add_u32 s46, s46, s44
  s_add_u32 m0, s48, 18432
  s_nop 0
  buffer_load_dwordx4 v247, s[8:11], s46 offen lds
  s_add_u32 s46, s46, s44
  s_add_u32 m0, s48, 19456
  s_nop 0
  buffer_load_dwordx4 v247, s[8:11], s46 offen lds
  s_add_u32 s46, s46, s44
  s_add_u32 m0, s48, 20480
  s_nop 0
  buffer_load_dwordx4 v247, s[8:11], s46 offen lds
  s_add_u32 s46, s46, s44
  s_add_u32 m0, s48, 21504
  s_nop 0
  buffer_load_dwordx4 v247, s[8:11], s46 offen lds
  s_add_u32 s46, s46, s44
  s_add_u32 m0, s48, 22528
  s_nop 0
  buffer_load_dwordx4 v247, s[8:11], s46 offen lds
  s_add_u32 s46, s46, s44
  s_add_u32 m0, s48, 23552
  s_nop 0
  buffer_load_dwordx4 v247, s[8:11], s46 offen lds
  s_add_u32 s46, s46, s44
  s_add_u32 m0, s48, 24576
  s_nop 0
  buffer_load_dwordx4 v247, s[8:11], s46 offen lds
  s_add_u32 s46, s46, s44
  s_add_u32 m0, s48, 25600
  s_nop 0
  buffer_load_dwordx4 v247, s[8:11], s46 offen lds
  s_add_u32 s46, s46, s44
  s_add_u32 m0, s48, 26624
  s_nop 0
  buffer_load_dwordx4 v247, s[8:11], s46 offen lds
  s_add_u32 s46, s46, s44
  s_add_u32 m0, s48, 27648
  s_nop 0
  buffer_load_dwordx4 v247, s[8:11], s46 offen lds
  s_add_u32 s46, s46, s44
  s_add_u32 m0, s48, 28672
  s_nop 0
  buffer_load_dwordx4 v247, s[8:11], s46 offen lds
  s_add_u32 s46, s46, s44
  s_add_u32 m0, s48, 29696
  s_nop 0
  buffer_load_dwordx4 v247, s[8:11], s46 offen lds
  s_add_u32 s46, s46, s44
  s_add_u32 m0, s48, 30720
  s_nop 0
  buffer_load_dwordx4 v247, s[8:11], s46 offen lds
  s_add_u32 s46, s46, s44
  s_add_u32 m0, s48, 31744
  s_nop 0
  buffer_load_dwordx4 v247, s[8:11], s46 offen lds
  s_add_u32 s46, s46, s44
  v_and_b32 v249, 3, v255
  v_bfe_u32 v250, v255, 2, 2
  v_lshl_add_u32 v250, v253, 2, v250
  v_lshlrev_b32 v250, 7, v250
  v_bfe_u32 v248, v255, 4, 1
  v_lshl_add_u32 v250, v248, 4, v250
  v_and_b32 v248, 1, v255
  v_lshl_add_u32 v250, v248, 5, v250
  v_bfe_u32 v248, v255, 1, 1
  v_lshl_add_u32 v250, v248, 3, v250
  v_bfe_u32 v248, v255, 3, 1
  v_lshl_add_u32 v250, v248, 6, v250
  v_add_u32 v240, s48, v250
  v_xor_b32 v241, 64, v240
  s_waitcnt vmcnt(28)
  ds_read_b64_tr_b16 a[0:1], v240 offset:0
  ds_read_b64_tr_b16 a[2:3], v240 offset:2048
  ds_read_b64_tr_b16 a[4:5], v241 offset:0
  ds_read_b64_tr_b16 a[6:7], v241 offset:2048
  ds_read_b64_tr_b16 a[8:9], v240 offset:1024
  ds_read_b64_tr_b16 a[10:11], v240 offset:3072
  ds_read_b64_tr_b16 a[12:13], v241 offset:1024
  ds_read_b64_tr_b16 a[14:15], v241 offset:3072
  s_waitcnt lgkmcnt(0)
  s_add_u32 m0, s48, 0
  s_nop 0
  buffer_load_dwordx4 v247, s[8:11], s46 offen lds
  s_add_u32 s46, s46, s44
  s_add_u32 m0, s48, 1024
  s_nop 0
  buffer_load_dwordx4 v247, s[8:11], s46 offen lds
  s_add_u32 s46, s46, s44
  s_add_u32 m0, s48, 2048
  s_nop 0
  buffer_load_dwordx4 v247, s[8:11], s46 offen lds
  s_add_u32 s46, s46, s44
  s_add_u32 m0, s48, 3072
  s_nop 0
  buffer_load_dwordx4 v247, s[8:11], s46 offen lds
  s_add_u32 s46, s46, s44
  s_waitcnt vmcnt(28)
  ds_read_b64_tr_b16 a[16:17], v240 offset:4096
  ds_read_b64_tr_b16 a[18:19], v240 offset:6144
  ds_read_b64_tr_b16 a[20:21], v241 offset:4096
  ds_read_b64_tr_b16 a[22:23], v241 offset:6144
  ds_read_b64_tr_b16 a[24:25], v240 offset:5120
  ds_read_b64_tr_b16 a[26:27], v240 offset:7168
  ds_read_b64_tr_b16 a[28:29], v241 offset:5120
  ds_read_b64_tr_b16 a[30:31], v241 offset:7168
  s_waitcnt lgkmcnt(0)
  s_add_u32 m0, s48, 4096
  s_nop 0
  buffer_load_dwordx4 v247, s[8:11], s46 offen lds
  s_add_u32 s46, s46, s44
  s_add_u32 m0, s48, 5120
  s_nop 0
  buffer_load_dwordx4 v247, s[8:11], s46 offen lds
  s_add_u32 s46, s46, s44
  s_add_u32 m0, s48, 6144
  s_nop 0
  buffer_load_dwordx4 v247, s[8:11], s46 offen lds
  s_add_u32 s46, s46, s44
  s_add_u32 m0, s48, 7168
  s_nop 0
  buffer_load_dwordx4 v247, s[8:11], s46 offen lds
  s_add_u32 s46, s46, s44
  s_waitcnt vmcnt(28)
  ds_read_b64_tr_b16 a[32:33], v240 offset:8192
  ds_read_b64_tr_b16 a[34:35], v240 offset:10240
  ds_read_b64_tr_b16 a[36:37], v241 offset:8192
  ds_read_b64_tr_b16 a[38:39], v241 offset:10240
  ds_read_b64_tr_b16 a[40:41], v240 offset:9216
  ds_read_b64_tr_b16 a[42:43], v240 offset:11264
  ds_read_b64_tr_b16 a[44:45], v241 offset:9216
  ds_read_b64_tr_b16 a[46:47], v241 offset:11264
  s_waitcnt lgkmcnt(0)
  s_add_u32 m0, s48, 8192
  s_nop 0
  buffer_load_dwordx4 v247, s[8:11], s46 offen lds
  s_add_u32 s46, s46, s44
  s_add_u32 m0, s48, 9216
  s_nop 0
  buffer_load_dwordx4 v247, s[8:11], s46 offen lds
  s_add_u32 s46, s46, s44
  s_add_u32 m0, s48, 10240
  s_nop 0
  buffer_load_dwordx4 v247, s[8:11], s46 offen lds
  s_add_u32 s46, s46, s44
  s_add_u32 m0, s48, 11264
  s_nop 0
  buffer_load_dwordx4 v247, s[8:11], s46 offen lds
  s_add_u32 s46, s46, s44
  s_waitcnt vmcnt(28)
  ds_read_b64_tr_b16 a[48:49], v240 offset:12288
  ds_read_b64_tr_b16 a[50:51], v240 offset:14336
  ds_read_b64_tr_b16 a[52:53], v241 offset:12288
  ds_read_b64_tr_b16 a[54:55], v241 offset:14336
  ds_read_b64_tr_b16 a[56:57], v240 offset:13312
  ds_read_b64_tr_b16 a[58:59], v240 offset:15360
  ds_read_b64_tr_b16 a[60:61], v241 offset:13312
  ds_read_b64_tr_b16 a[62:63], v241 offset:15360
  s_waitcnt lgkmcnt(0)
  s_add_u32 m0, s48, 12288
  s_nop 0
  buffer_load_dwordx4 v247, s[8:11], s46 offen lds
  s_add_u32 s46, s46, s44
  s_add_u32 m0, s48, 13312
  s_nop 0
  buffer_load_dwordx4 v247, s[8:11], s46 offen lds
  s_add_u32 s46, s46, s44
  s_add_u32 m0, s48, 14336
  s_nop 0
  buffer_load_dwordx4 v247, s[8:11], s46 offen lds
  s_add_u32 s46, s46, s44
  s_add_u32 m0, s48, 15360
  s_nop 0
  buffer_load_dwordx4 v247, s[8:11], s46 offen lds
  s_add_u32 s46, s46, s44
  s_waitcnt vmcnt(28)
  ds_read_b64_tr_b16 a[64:65], v240 offset:16384
  ds_read_b64_tr_b16 a[66:67], v240 offset:18432
  ds_read_b64_tr_b16 a[68:69], v241 offset:16384
  ds_read_b64_tr_b16 a[70:71], v241 offset:18432
  ds_read_b64_tr_b16 a[72:73], v240 offset:17408
  ds_read_b64_tr_b16 a[74:75], v240 offset:19456
  ds_read_b64_tr_b16 a[76:77], v241 offset:17408
  ds_read_b64_tr_b16 a[78:79], v241 offset:19456
  s_waitcnt lgkmcnt(0)
  s_add_u32 m0, s48, 16384
  s_nop 0
  buffer_load_dwordx4 v247, s[8:11], s46 offen lds
  s_add_u32 s46, s46, s44
  s_add_u32 m0, s48, 17408
  s_nop 0
  buffer_load_dwordx4 v247, s[8:11], s46 offen lds
  s_add_u32 s46, s46, s44
  s_add_u32 m0, s48, 18432
  s_nop 0
  buffer_load_dwordx4 v247, s[8:11], s46 offen lds
  s_add_u32 s46, s46, s44
  s_add_u32 m0, s48, 19456
  s_nop 0
  buffer_load_dwordx4 v247, s[8:11], s46 offen lds
  s_add_u32 s46, s46, s44
  s_waitcnt vmcnt(28)
  ds_read_b64_tr_b16 a[80:81], v240 offset:20480
  ds_read_b64_tr_b16 a[82:83], v240 offset:22528
  ds_read_b64_tr_b16 a[84:85], v241 offset:20480
  ds_read_b64_tr_b16 a[86:87], v241 offset:22528
  ds_read_b64_tr_b16 a[88:89], v240 offset:21504
  ds_read_b64_tr_b16 a[90:91], v240 offset:23552
  ds_read_b64_tr_b16 a[92:93], v241 offset:21504
  ds_read_b64_tr_b16 a[94:95], v241 offset:23552
  s_waitcnt lgkmcnt(0)
  s_add_u32 m0, s48, 20480
  s_nop 0
  buffer_load_dwordx4 v247, s[8:11], s46 offen lds
  s_add_u32 s46, s46, s44
  s_add_u32 m0, s48, 21504
  s_nop 0
  buffer_load_dwordx4 v247, s[8:11], s46 offen lds
  s_add_u32 s46, s46, s44
  s_add_u32 m0, s48, 22528
  s_nop 0
  buffer_load_dwordx4 v247, s[8:11], s46 offen lds
  s_add_u32 s46, s46, s44
  s_add_u32 m0, s48, 23552
  s_nop 0
  buffer_load_dwordx4 v247, s[8:11], s46 offen lds
  s_add_u32 s46, s46, s44
  s_waitcnt vmcnt(28)
  ds_read_b64_tr_b16 a[96:97], v240 offset:24576
  ds_read_b64_tr_b16 a[98:99], v240 offset:26624
  ds_read_b64_tr_b16 a[100:101], v241 offset:24576
  ds_read_b64_tr_b16 a[102:103], v241 offset:26624
  ds_read_b64_tr_b16 a[104:105], v240 offset:25600
  ds_read_b64_tr_b16 a[106:107], v240 offset:27648
  ds_read_b64_tr_b16 a[108:109], v241 offset:25600
  ds_read_b64_tr_b16 a[110:111], v241 offset:27648
  s_waitcnt lgkmcnt(0)
  s_add_u32 m0, s48, 24576
  s_nop 0
  buffer_load_dwordx4 v247, s[8:11], s46 offen lds
  s_add_u32 s46, s46, s44
  s_add_u32 m0, s48, 25600
  s_nop 0
  buffer_load_dwordx4 v247, s[8:11], s46 offen lds
  s_add_u32 s46, s46, s44
  s_add_u32 m0, s48, 26624
  s_nop 0
  buffer_load_dwordx4 v247, s[8:11], s46 offen lds
  s_add_u32 s46, s46, s44
  s_add_u32 m0, s48, 27648
  s_nop 0
  buffer_load_dwordx4 v247, s[8:11], s46 offen lds
  s_add_u32 s46, s46, s44
  s_waitcnt vmcnt(28)
  ds_read_b64_tr_b16 a[112:113], v240 offset:28672
  ds_read_b64_tr_b16 a[114:115], v240 offset:30720
  ds_read_b64_tr_b16 a[116:117], v241 offset:28672
  ds_read_b64_tr_b16 a[118:119], v241 offset:30720
  ds_read_b64_tr_b16 a[120:121], v240 offset:29696
  ds_read_b64_tr_b16 a[122:123], v240 offset:31744
  ds_read_b64_tr_b16 a[124:125], v241 offset:29696
  ds_read_b64_tr_b16 a[126:127], v241 offset:31744
  s_waitcnt lgkmcnt(0)
  s_add_u32 m0, s48, 28672
  s_nop 0
  buffer_load_dwordx4 v247, s[8:11], s46 offen lds
  s_add_u32 s46, s46, s44
  s_add_u32 m0, s48, 29696
  s_nop 0
  buffer_load_dwordx4 v247, s[8:11], s46 offen lds
  s_add_u32 s46, s46, s44
  s_add_u32 m0, s48, 30720
  s_nop 0
  buffer_load_dwordx4 v247, s[8:11], s46 offen lds
  s_add_u32 s46, s46, s44
  s_add_u32 m0, s48, 31744
  s_nop 0
  buffer_load_dwordx4 v247, s[8:11], s46 offen lds
  s_add_u32 s46, s46, s44
  s_waitcnt vmcnt(28)
  ds_read_b64_tr_b16 a[128:129], v240 offset:0
  ds_read_b64_tr_b16 a[130:131], v240 offset:2048
  ds_read_b64_tr_b16 a[132:133], v241 offset:0
  ds_read_b64_tr_b16 a[134:135], v241 offset:2048
  ds_read_b64_tr_b16 a[136:137], v240 offset:1024
  ds_read_b64_tr_b16 a[138:139], v240 offset:3072
  ds_read_b64_tr_b16 a[140:141], v241 offset:1024
  ds_read_b64_tr_b16 a[142:143], v241 offset:3072
  s_waitcnt lgkmcnt(0)
  s_waitcnt vmcnt(24)
  ds_read_b64_tr_b16 a[144:145], v240 offset:4096
  ds_read_b64_tr_b16 a[146:147], v240 offset:6144
  ds_read_b64_tr_b16 a[148:149], v241 offset:4096
  ds_read_b64_tr_b16 a[150:151], v241 offset:6144
  ds_read_b64_tr_b16 a[152:153], v240 offset:5120
  ds_read_b64_tr_b16 a[154:155], v240 offset:7168
  ds_read_b64_tr_b16 a[156:157], v241 offset:5120
  ds_read_b64_tr_b16 a[158:159], v241 offset:7168
  s_waitcnt lgkmcnt(0)
  s_waitcnt vmcnt(20)
  ds_read_b64_tr_b16 a[160:161], v240 offset:8192
  ds_read_b64_tr_b16 a[162:163], v240 offset:10240
  ds_read_b64_tr_b16 a[164:165], v241 offset:8192
  ds_read_b64_tr_b16 a[166:167], v241 offset:10240
  ds_read_b64_tr_b16 a[168:169], v240 offset:9216
  ds_read_b64_tr_b16 a[170:171], v240 offset:11264
  ds_read_b64_tr_b16 a[172:173], v241 offset:9216
  ds_read_b64_tr_b16 a[174:175], v241 offset:11264
  s_waitcnt lgkmcnt(0)
  s_waitcnt vmcnt(16)
  ds_read_b64_tr_b16 a[176:177], v240 offset:12288
  ds_read_b64_tr_b16 a[178:179], v240 offset:14336
  ds_read_b64_tr_b16 a[180:181], v241 offset:12288
  ds_read_b64_tr_b16 a[182:183], v241 offset:14336
  ds_read_b64_tr_b16 a[184:185], v240 offset:13312
  ds_read_b64_tr_b16 a[186:187], v240 offset:15360
  ds_read_b64_tr_b16 a[188:189], v241 offset:13312
  ds_read_b64_tr_b16 a[190:191], v241 offset:15360
  s_waitcnt lgkmcnt(0)
  s_waitcnt vmcnt(12)
  ds_read_b64_tr_b16 a[192:193], v240 offset:16384
  ds_read_b64_tr_b16 a[194:195], v240 offset:18432
  ds_read_b64_tr_b16 a[196:197], v241 offset:16384
  ds_read_b64_tr_b16 a[198:199], v241 offset:18432
  ds_read_b64_tr_b16 a[200:201], v240 offset:17408
  ds_read_b64_tr_b16 a[202:203], v240 offset:19456
  ds_read_b64_tr_b16 a[204:205], v241 offset:17408
  ds_read_b64_tr_b16 a[206:207], v241 offset:19456
  s_waitcnt lgkmcnt(0)
  s_waitcnt vmcnt(8)
  ds_read_b64_tr_b16 a[208:209], v240 offset:20480
  ds_read_b64_tr_b16 a[210:211], v240 offset:22528
  ds_read_b64_tr_b16 a[212:213], v241 offset:20480
  ds_read_b64_tr_b16 a[214:215], v241 offset:22528
  ds_read_b64_tr_b16 a[216:217], v240 offset:21504
  ds_read_b64_tr_b16 a[218:219], v240 offset:23552
  ds_read_b64_tr_b16 a[220:221], v241 offset:21504
  ds_read_b64_tr_b16 a[222:223], v241 offset:23552
  s_waitcnt lgkmcnt(0)
  s_waitcnt vmcnt(4)
  ds_read_b64_tr_b16 a[224:225], v240 offset:24576
  ds_read_b64_tr_b16 a[226:227], v240 offset:26624
  ds_read_b64_tr_b16 a[228:229], v241 offset:24576
  ds_read_b64_tr_b16 a[230:231], v241 offset:26624
  ds_read_b64_tr_b16 a[232:233], v240 offset:25600
  ds_read_b64_tr_b16 a[234:235], v240 offset:27648
  ds_read_b64_tr_b16 a[236:237], v241 offset:25600
  ds_read_b64_tr_b16 a[238:239], v241 offset:27648
  s_waitcnt lgkmcnt(0)
  s_waitcnt vmcnt(0)
  ds_read_b64_tr_b16 a[240:241], v240 offset:28672
  ds_read_b64_tr_b16 a[242:243], v240 offset:30720
  ds_read_b64_tr_b16 a[244:245], v241 offset:28672
  ds_read_b64_tr_b16 a[246:247], v241 offset:30720
  ds_read_b64_tr_b16 a[248:249], v240 offset:29696
  ds_read_b64_tr_b16 a[250:251], v240 offset:31744
  ds_read_b64_tr_b16 a[252:253], v241 offset:29696
  ds_read_b64_tr_b16 a[254:255], v241 offset:31744
  s_waitcnt lgkmcnt(0)
  s_barrier
  v_lshrrev_b32 v249, 4, v255
  v_and_b32 v248, 15, v255
  v_lshlrev_b32 v247, 2, v249
  v_cmp_le_u32 s[56:57], v247, v248
  v_add_u32 v247, 1, v247
  v_cmp_le_u32 s[58:59], v247, v248
  v_add_u32 v247, 1, v247
  v_cmp_le_u32 s[60:61], v247, v248
  v_add_u32 v247, 1, v247
  v_cmp_le_u32 s[62:63], v247, v248
  v_add_u32 v247, 1, v247
  s_mov_b32 s64, -1
  s_mov_b32 s65, 0
  v_mov_b32 v218, 0xff800000
  v_lshlrev_b32 v219, 9, v249
  v_lshl_add_u32 v219, v248, 4, v219
  s_lshl_b32 s42, s33, 13
  v_add_u32 v219, s42, v219
  v_add_u32 v241, 4096, v252
  v_and_b32 v232, 7, v255
  v_lshlrev_b32 v232, 4, v232
  v_lshl_add_u32 v232, v249, 7, v232
  v_lshlrev_b32 v233, 3, v254
  v_lshlrev_b32 v246, 11, v255
  s_cmp_lg_u32 s33, 0
  s_cbranch_scc1 w_wds_50058
  s_mov_b64 exec, 1
w_wd_50056:
  buffer_load_dword v250, off, s[28:31], 0 offset:164 sc1
  s_waitcnt vmcnt(0)
  v_readfirstlane_b32 s43, v250
  s_cmp_ge_u32 s43, 96
  s_cbranch_scc1 w_wdd_50057
  s_cmp_eq_u32 s35, 0
  s_cbranch_scc1 w_wdd_50057
  s_sub_u32 s35, s35, 1
  s_sleep 16
  s_branch w_wd_50056
w_wdd_50057:
  s_mov_b64 exec, -1
w_wds_50058:
  s_barrier
  s_add_u32 s50, s36, 1
  s_mov_b64 exec, 0x7
w_pl_50059:
  buffer_load_dword v250, v246, s[4:7], s49 offen sc1
  s_waitcnt vmcnt(0)
  v_cmp_gt_u32 vcc, s50, v250
  s_cbranch_vccz w_pld_50060
  s_cmp_eq_u32 s35, 0
  s_cbranch_scc1 w_pld_50060
  s_sub_u32 s35, s35, 1
  s_sleep 16
  s_branch w_pl_50059
w_pld_50060:
  s_mov_b64 exec, -1
  s_add_u32 s44, s38, 0
  buffer_load_dwordx4 v[0:3], v252, s[4:7], s44 offen offset:0 sc1
  buffer_load_dwordx4 v[4:7], v252, s[4:7], s44 offen offset:1024 sc1
  buffer_load_dwordx4 v[8:11], v252, s[4:7], s44 offen offset:2048 sc1
  buffer_load_dwordx4 v[12:15], v252, s[4:7], s44 offen offset:3072 sc1
  buffer_load_dwordx4 v[16:19], v241, s[4:7], s44 offen offset:0 sc1
  buffer_load_dwordx4 v[20:23], v241, s[4:7], s44 offen offset:1024 sc1
  buffer_load_dwordx4 v[24:27], v241, s[4:7], s44 offen offset:2048 sc1
  buffer_load_dwordx4 v[28:31], v241, s[4:7], s44 offen offset:3072 sc1
  s_add_u32 s44, s38, 16777216
  buffer_load_dwordx4 v[32:35], v252, s[4:7], s44 offen offset:0 sc1
  buffer_load_dwordx4 v[36:39], v252, s[4:7], s44 offen offset:1024 sc1
  buffer_load_dwordx4 v[40:43], v252, s[4:7], s44 offen offset:2048 sc1
  buffer_load_dwordx4 v[44:47], v252, s[4:7], s44 offen offset:3072 sc1
  buffer_load_dwordx4 v[48:51], v241, s[4:7], s44 offen offset:0 sc1
  buffer_load_dwordx4 v[52:55], v241, s[4:7], s44 offen offset:1024 sc1
  buffer_load_dwordx4 v[56:59], v241, s[4:7], s44 offen offset:2048 sc1
  buffer_load_dwordx4 v[60:63], v241, s[4:7], s44 offen offset:3072 sc1
  s_add_u32 s44, s38, 50331648
  buffer_load_dwordx4 v[64:67], v252, s[4:7], s44 offen offset:0 sc1
  buffer_load_dwordx4 v[68:71], v252, s[4:7], s44 offen offset:1024 sc1
  buffer_load_dwordx4 v[72:75], v252, s[4:7], s44 offen offset:2048 sc1
  buffer_load_dwordx4 v[76:79], v252, s[4:7], s44 offen offset:3072 sc1
  buffer_load_dwordx4 v[80:83], v241, s[4:7], s44 offen offset:0 sc1
  buffer_load_dwordx4 v[84:87], v241, s[4:7], s44 offen offset:1024 sc1
  buffer_load_dwordx4 v[88:91], v241, s[4:7], s44 offen offset:2048 sc1
  buffer_load_dwordx4 v[92:95], v241, s[4:7], s44 offen offset:3072 sc1
  s_waitcnt vmcnt(0)
  s_mov_b32 s66, 0
w_top_xy:
  v_mfma_f32_16x16x32_bf16 v[128:131], v[32:35], v[0:3], 0
  v_mfma_f32_16x16x32_bf16 v[132:135], v[32:35], v[4:7], 0
  v_mfma_f32_16x16x32_bf16 v[136:139], v[36:39], v[4:7], 0
  v_mfma_f32_16x16x32_bf16 v[128:131], v[40:43], v[8:11], v[128:131]
  v_mfma_f32_16x16x32_bf16 v[132:135], v[40:43], v[12:15], v[132:135]
  v_mfma_f32_16x16x32_bf16 v[136:139], v[44:47], v[12:15], v[136:139]
  v_mfma_f32_16x16x32_bf16 v[128:131], v[48:51], v[16:19], v[128:131]
  v_mfma_f32_16x16x32_bf16 v[132:135], v[48:51], v[20:23], v[132:135]
  v_mfma_f32_16x16x32_bf16 v[136:139], v[52:55], v[20:23], v[136:139]
  v_mfma_f32_16x16x32_bf16 v[128:131], v[56:59], v[24:27], v[128:131]
  v_mfma_f32_16x16x32_bf16 v[132:135], v[56:59], v[28:31], v[132:135]
  v_mfma_f32_16x16x32_bf16 v[136:139], v[60:63], v[28:31], v[136:139]
  s_add_u32 s50, s36, 4
  s_min_u32 s50, s50, 64
  v_cndmask_b32 v128, v218, v128, s[56:57]
  s_nop 4
  v_cndmask_b32 v136, v218, v136, s[56:57]
  v_cndmask_b32 v129, v218, v129, s[58:59]
  v_cndmask_b32 v137, v218, v137, s[58:59]
  v_cndmask_b32 v130, v218, v130, s[60:61]
  v_cndmask_b32 v138, v218, v138, s[60:61]
  v_cndmask_b32 v131, v218, v131, s[62:63]
  v_cndmask_b32 v139, v218, v139, s[62:63]
  v_max3_f32 v212, v128, v129, v130
  v_max_f32 v212, v212, v131
  v_max3_f32 v213, v132, v133, v134
  v_max3_f32 v213, v213, v135, v136
  v_max3_f32 v213, v213, v137, v138
  v_max_f32 v213, v213, v139
  s_cmp_ge_u32 s66, s50
  s_cbranch_scc1 w_pok_xy
  s_mov_b64 exec, 0x7
w_pl_50061:
  buffer_load_dword v250, v246, s[4:7], s49 offen sc1
  s_waitcnt vmcnt(0)
  v_cmp_gt_u32 vcc, s50, v250
  s_cbranch_vccz w_pld_50062
  s_cmp_eq_u32 s35, 0
  s_cbranch_scc1 w_pld_50062
  s_sub_u32 s35, s35, 1
  s_sleep 2
  s_branch w_pl_50061
w_pld_50062:
  s_mov_b64 exec, -1
  v_readlane_b32 s66, v250, 0
  v_readlane_b32 s67, v250, 1
  v_readlane_b32 s68, v250, 2
  s_min_u32 s66, s66, s67
  s_min_u32 s66, s66, s68
w_pok_xy:
  s_add_u32 s44, s54, 8388608
  s_cmp_lt_u32 s36, 61
  s_cselect_b32 s42, 786432, 0
  s_add_u32 s38, s38, s42
w_km_xy:
  buffer_load_dwordx4 v[96:99], v232, s[4:7], s54 offen offset:0 sc1
  buffer_load_dwordx4 v[100:103], v232, s[4:7], s54 offen offset:512 sc1
  buffer_load_dwordx4 v[104:107], v232, s[4:7], s54 offen offset:1024 sc1
  buffer_load_dwordx4 v[108:111], v232, s[4:7], s54 offen offset:1536 sc1
  buffer_load_dwordx2 v[112:113], v233, s[4:7], s44 offen offset:0 sc1
  buffer_load_dwordx2 v[114:115], v233, s[4:7], s44 offen offset:256 sc1
  buffer_load_dwordx2 v[116:117], v233, s[4:7], s44 offen offset:512 sc1
  buffer_load_dwordx2 v[118:119], v233, s[4:7], s44 offen offset:768 sc1
  buffer_load_dwordx2 v[120:121], v233, s[4:7], s44 offen offset:1024 sc1
  buffer_load_dwordx2 v[122:123], v233, s[4:7], s44 offen offset:1280 sc1
  buffer_load_dwordx2 v[124:125], v233, s[4:7], s44 offen offset:1536 sc1
  buffer_load_dwordx2 v[126:127], v233, s[4:7], s44 offen offset:1792 sc1
  s_waitcnt vmcnt(0)
  v_max3_u32 v250, v96, v97, v98
  v_max3_u32 v250, v250, v99, v100
  v_max3_u32 v250, v250, v101, v102
  v_max3_u32 v250, v250, v103, v104
  v_max3_u32 v250, v250, v105, v106
  v_max3_u32 v250, v250, v107, v108
  v_max3_u32 v250, v250, v109, v110
  v_max3_u32 v250, v250, v111, v112
  v_max3_u32 v250, v250, v113, v114
  v_max3_u32 v250, v250, v115, v116
  v_max3_u32 v250, v250, v117, v118
  v_max3_u32 v250, v250, v119, v120
  v_max3_u32 v250, v250, v121, v122
  v_max3_u32 v250, v250, v123, v124
  v_max3_u32 v250, v250, v125, v126
  v_max_u32 v250, v250, v127
  v_cmp_eq_u32 vcc, -1, v250
  s_cbranch_vccz w_kmok_xy
  s_cmp_eq_u32 s35, 0
  s_cbranch_scc1 w_kmok_xy
  s_sub_u32 s35, s35, 1
  s_sleep 1
  s_branch w_km_xy
w_kmok_xy:
  s_add_u32 s54, s54, 196608
  v_mfma_f32_16x16x32_bf16 v[140:143], v[96:99], v[0:3], 0
  v_mfma_f32_16x16x32_bf16 v[144:147], v[96:99], v[4:7], 0
  v_mfma_f32_16x16x32_bf16 v[140:143], v[100:103], v[8:11], v[140:143]
  v_mfma_f32_16x16x32_bf16 v[144:147], v[100:103], v[12:15], v[144:147]
  v_mfma_f32_16x16x32_bf16 v[140:143], v[104:107], v[16:19], v[140:143]
  v_mfma_f32_16x16x32_bf16 v[144:147], v[104:107], v[20:23], v[144:147]
  v_mfma_f32_16x16x32_bf16 v[140:143], v[108:111], v[24:27], v[140:143]
  v_mfma_f32_16x16x32_bf16 v[144:147], v[108:111], v[28:31], v[144:147]
  s_cmp_ge_u32 s36, 61
  s_cbranch_scc1 w_nol_xy
  s_add_u32 s44, s38, 16777216
  buffer_load_dwordx4 v[32:35], v252, s[4:7], s44 offen offset:0 sc1
  buffer_load_dwordx4 v[36:39], v252, s[4:7], s44 offen offset:1024 sc1
  buffer_load_dwordx4 v[40:43], v252, s[4:7], s44 offen offset:2048 sc1
  buffer_load_dwordx4 v[44:47], v252, s[4:7], s44 offen offset:3072 sc1
  buffer_load_dwordx4 v[48:51], v241, s[4:7], s44 offen offset:0 sc1
  buffer_load_dwordx4 v[52:55], v241, s[4:7], s44 offen offset:1024 sc1
  buffer_load_dwordx4 v[56:59], v241, s[4:7], s44 offen offset:2048 sc1
  buffer_load_dwordx4 v[60:63], v241, s[4:7], s44 offen offset:3072 sc1
  s_add_u32 s44, s38, 0
  buffer_load_dwordx4 v[0:3], v252, s[4:7], s44 offen offset:0 sc1
  buffer_load_dwordx4 v[4:7], v252, s[4:7], s44 offen offset:1024 sc1
  buffer_load_dwordx4 v[8:11], v252, s[4:7], s44 offen offset:2048 sc1
  buffer_load_dwordx4 v[12:15], v252, s[4:7], s44 offen offset:3072 sc1
  buffer_load_dwordx4 v[16:19], v241, s[4:7], s44 offen offset:0 sc1
  buffer_load_dwordx4 v[20:23], v241, s[4:7], s44 offen offset:1024 sc1
  buffer_load_dwordx4 v[24:27], v241, s[4:7], s44 offen offset:2048 sc1
  buffer_load_dwordx4 v[28:31], v241, s[4:7], s44 offen offset:3072 sc1
w_nol_xy:
  s_nop 3
  v_cndmask_b32 v140, v218, v140, s[64:65]
  v_cndmask_b32 v141, v218, v141, s[64:65]
  v_cndmask_b32 v142, v218, v142, s[64:65]
  v_cndmask_b32 v143, v218, v143, s[64:65]
  v_max3_f32 v212, v212, v140, v141
  v_max3_f32 v212, v212, v142, v143
  v_cndmask_b32 v144, v218, v144, s[64:65]
  v_cndmask_b32 v145, v218, v145, s[64:65]
  v_cndmask_b32 v146, v218, v146, s[64:65]
  v_cndmask_b32 v147, v218, v147, s[64:65]
  v_max3_f32 v213, v213, v144, v145
  v_max3_f32 v213, v213, v146, v147
  v_mov_b32 v216, v212
  v_mov_b32 v217, v213
  s_nop 0
  v_permlane16_swap_b32 v212, v216
  v_permlane16_swap_b32 v213, v217
  s_nop 0
  v_max_f32 v212, v212, v216
  v_max_f32 v213, v213, v217
  v_mov_b32 v216, v212
  v_mov_b32 v217, v213
  s_nop 0
  v_permlane32_swap_b32 v212, v216
  v_permlane32_swap_b32 v213, v217
  s_nop 0
  v_max_f32 v212, v212, v216
  v_max_f32 v213, v213, v217
  v_sub_f32 v128, v128, v212
  v_sub_f32 v129, v129, v212
  v_sub_f32 v130, v130, v212
  v_sub_f32 v131, v131, v212
  v_exp_f32 v128, v128
  v_exp_f32 v129, v129
  v_exp_f32 v130, v130
  v_exp_f32 v131, v131
  v_sub_f32 v140, v140, v212
  v_sub_f32 v141, v141, v212
  v_sub_f32 v142, v142, v212
  v_sub_f32 v143, v143, v212
  v_exp_f32 v140, v140
  v_exp_f32 v141, v141
  v_exp_f32 v142, v142
  v_exp_f32 v143, v143
  v_sub_f32 v132, v132, v213
  v_sub_f32 v133, v133, v213
  v_sub_f32 v134, v134, v213
  v_sub_f32 v135, v135, v213
  v_exp_f32 v132, v132
  v_exp_f32 v133, v133
  v_exp_f32 v134, v134
  v_exp_f32 v135, v135
  v_sub_f32 v136, v136, v213
  v_sub_f32 v137, v137, v213
  v_sub_f32 v138, v138, v213
  v_sub_f32 v139, v139, v213
  v_exp_f32 v136, v136
  v_exp_f32 v137, v137
  v_exp_f32 v138, v138
  v_exp_f32 v139, v139
  v_sub_f32 v144, v144, v213
  v_sub_f32 v145, v145, v213
  v_sub_f32 v146, v146, v213
  v_sub_f32 v147, v147, v213
  v_exp_f32 v144, v144
  v_exp_f32 v145, v145
  v_exp_f32 v146, v146
  v_exp_f32 v147, v147
  v_add_f32 v214, v128, v129
  v_add_f32 v214, v214, v130
  v_add_f32 v214, v214, v131
  v_add_f32 v214, v214, v140
  v_add_f32 v214, v214, v141
  v_add_f32 v214, v214, v142
  v_add_f32 v214, v214, v143
  v_add_f32 v215, v132, v133
  v_add_f32 v215, v215, v134
  v_add_f32 v215, v215, v135
  v_add_f32 v215, v215, v136
  v_add_f32 v215, v215, v137
  v_add_f32 v215, v215, v138
  v_add_f32 v215, v215, v139
  v_add_f32 v215, v215, v144
  v_add_f32 v215, v215, v145
  v_add_f32 v215, v215, v146
  v_add_f32 v215, v215, v147
  v_mov_b32 v216, v214
  v_mov_b32 v217, v215
  s_nop 0
  v_permlane16_swap_b32 v214, v216
  v_permlane16_swap_b32 v215, v217
  s_nop 0
  v_add_f32 v214, v214, v216
  v_add_f32 v215, v215, v217
  v_mov_b32 v216, v214
  v_mov_b32 v217, v215
  s_nop 0
  v_permlane32_swap_b32 v214, v216
  v_permlane32_swap_b32 v215, v217
  s_nop 0
  v_add_f32 v214, v214, v216
  v_add_f32 v215, v215, v217
  v_rcp_f32 v214, v214
  v_rcp_f32 v215, v215
  v_mul_f32 v128, v128, v214
  v_mul_f32 v129, v129, v214
  v_mul_f32 v130, v130, v214
  v_mul_f32 v131, v131, v214
  v_cvt_pk_bf16_f32 v220, v128, v129
  v_cvt_pk_bf16_f32 v221, v130, v131
  v_mul_f32 v132, v132, v215
  v_mul_f32 v133, v133, v215
  v_mul_f32 v134, v134, v215
  v_mul_f32 v135, v135, v215
  v_cvt_pk_bf16_f32 v224, v132, v133
  v_cvt_pk_bf16_f32 v225, v134, v135
  v_mul_f32 v136, v136, v215
  v_mul_f32 v137, v137, v215
  v_mul_f32 v138, v138, v215
  v_mul_f32 v139, v139, v215
  v_cvt_pk_bf16_f32 v226, v136, v137
  v_cvt_pk_bf16_f32 v227, v138, v139
  v_mul_f32 v140, v140, v214
  v_mul_f32 v141, v141, v214
  v_mul_f32 v142, v142, v214
  v_mul_f32 v143, v143, v214
  v_cvt_pk_bf16_f32 v222, v140, v141
  v_cvt_pk_bf16_f32 v223, v142, v143
  v_mul_f32 v144, v144, v215
  v_mul_f32 v145, v145, v215
  v_mul_f32 v146, v146, v215
  v_mul_f32 v147, v147, v215
  v_cvt_pk_bf16_f32 v228, v144, v145
  v_cvt_pk_bf16_f32 v229, v146, v147
  v_mfma_f32_16x16x16_bf16 v[148:151], v[64:65], v[220:221], 0
  v_mfma_f32_16x16x32_bf16 v[152:155], v[64:67], v[224:227], 0
  v_mfma_f32_16x16x16_bf16 v[156:159], v[68:69], v[220:221], 0
  v_mfma_f32_16x16x32_bf16 v[160:163], v[68:71], v[224:227], 0
  v_mfma_f32_16x16x16_bf16 v[164:167], v[72:73], v[220:221], 0
  v_mfma_f32_16x16x32_bf16 v[168:171], v[72:75], v[224:227], 0
  v_mfma_f32_16x16x16_bf16 v[172:175], v[76:77], v[220:221], 0
  v_mfma_f32_16x16x32_bf16 v[176:179], v[76:79], v[224:227], 0
  v_mfma_f32_16x16x16_bf16 v[180:183], v[80:81], v[220:221], 0
  v_mfma_f32_16x16x32_bf16 v[184:187], v[80:83], v[224:227], 0
  v_mfma_f32_16x16x16_bf16 v[188:191], v[84:85], v[220:221], 0
  v_mfma_f32_16x16x32_bf16 v[192:195], v[84:87], v[224:227], 0
  v_mfma_f32_16x16x16_bf16 v[196:199], v[88:89], v[220:221], 0
  v_mfma_f32_16x16x32_bf16 v[200:203], v[88:91], v[224:227], 0
  v_mfma_f32_16x16x16_bf16 v[204:207], v[92:93], v[220:221], 0
  v_mfma_f32_16x16x32_bf16 v[208:211], v[92:95], v[224:227], 0
  s_cmp_ge_u32 s36, 61
  s_cbranch_scc1 w_nov_xy
  s_add_u32 s44, s38, 50331648
  buffer_load_dwordx4 v[64:67], v252, s[4:7], s44 offen offset:0 sc1
  buffer_load_dwordx4 v[68:71], v252, s[4:7], s44 offen offset:1024 sc1
  buffer_load_dwordx4 v[72:75], v252, s[4:7], s44 offen offset:2048 sc1
  buffer_load_dwordx4 v[76:79], v252, s[4:7], s44 offen offset:3072 sc1
  buffer_load_dwordx4 v[80:83], v241, s[4:7], s44 offen offset:0 sc1
  buffer_load_dwordx4 v[84:87], v241, s[4:7], s44 offen offset:1024 sc1
  buffer_load_dwordx4 v[88:91], v241, s[4:7], s44 offen offset:2048 sc1
  buffer_load_dwordx4 v[92:95], v241, s[4:7], s44 offen offset:3072 sc1
w_nov_xy:
  v_mfma_f32_16x16x16_bf16 v[148:151], v[112:113], v[222:223], v[148:151]
  v_mfma_f32_16x16x16_bf16 v[152:155], v[112:113], v[228:229], v[152:155]
  v_mfma_f32_16x16x16_bf16 v[156:159], v[114:115], v[222:223], v[156:159]
  v_mfma_f32_16x16x16_bf16 v[160:163], v[114:115], v[228:229], v[160:163]
  v_mfma_f32_16x16x16_bf16 v[164:167], v[116:117], v[222:223], v[164:167]
  v_mfma_f32_16x16x16_bf16 v[168:171], v[116:117], v[228:229], v[168:171]
  v_mfma_f32_16x16x16_bf16 v[172:175], v[118:119], v[222:223], v[172:175]
  v_mfma_f32_16x16x16_bf16 v[176:179], v[118:119], v[228:229], v[176:179]
  v_mfma_f32_16x16x16_bf16 v[180:183], v[120:121], v[222:223], v[180:183]
  v_mfma_f32_16x16x16_bf16 v[184:187], v[120:121], v[228:229], v[184:187]
  v_mfma_f32_16x16x16_bf16 v[188:191], v[122:123], v[222:223], v[188:191]
  v_mfma_f32_16x16x16_bf16 v[192:195], v[122:123], v[228:229], v[192:195]
  v_mfma_f32_16x16x16_bf16 v[196:199], v[124:125], v[222:223], v[196:199]
  v_mfma_f32_16x16x16_bf16 v[200:203], v[124:125], v[228:229], v[200:203]
  v_mfma_f32_16x16x16_bf16 v[204:207], v[126:127], v[222:223], v[204:207]
  v_mfma_f32_16x16x16_bf16 v[208:211], v[126:127], v[228:229], v[208:211]
  v_cvt_pk_bf16_f32 v96, v148, v149
  v_cvt_pk_bf16_f32 v97, v150, v151
  v_cvt_pk_bf16_f32 v98, v156, v157
  v_cvt_pk_bf16_f32 v99, v158, v159
  ds_write_b128 v219, v[96:99] offset:0
  v_cvt_pk_bf16_f32 v100, v152, v153
  v_cvt_pk_bf16_f32 v101, v154, v155
  v_cvt_pk_bf16_f32 v102, v160, v161
  v_cvt_pk_bf16_f32 v103, v162, v163
  ds_write_b128 v219, v[100:103] offset:256
  v_cvt_pk_bf16_f32 v104, v164, v165
  v_cvt_pk_bf16_f32 v105, v166, v167
  v_cvt_pk_bf16_f32 v106, v172, v173
  v_cvt_pk_bf16_f32 v107, v174, v175
  ds_write_b128 v219, v[104:107] offset:2048
  v_cvt_pk_bf16_f32 v108, v168, v169
  v_cvt_pk_bf16_f32 v109, v170, v171
  v_cvt_pk_bf16_f32 v110, v176, v177
  v_cvt_pk_bf16_f32 v111, v178, v179
  ds_write_b128 v219, v[108:111] offset:2304
  s_waitcnt lgkmcnt(0)
  v_cvt_pk_bf16_f32 v96, v180, v181
  v_cvt_pk_bf16_f32 v97, v182, v183
  v_cvt_pk_bf16_f32 v98, v188, v189
  v_cvt_pk_bf16_f32 v99, v190, v191
  ds_write_b128 v219, v[96:99] offset:4096
  v_cvt_pk_bf16_f32 v100, v184, v185
  v_cvt_pk_bf16_f32 v101, v186, v187
  v_cvt_pk_bf16_f32 v102, v192, v193
  v_cvt_pk_bf16_f32 v103, v194, v195
  ds_write_b128 v219, v[100:103] offset:4352
  v_cvt_pk_bf16_f32 v104, v196, v197
  v_cvt_pk_bf16_f32 v105, v198, v199
  v_cvt_pk_bf16_f32 v106, v204, v205
  v_cvt_pk_bf16_f32 v107, v206, v207
  ds_write_b128 v219, v[104:107] offset:6144
  v_cvt_pk_bf16_f32 v108, v200, v201
  v_cvt_pk_bf16_f32 v109, v202, v203
  v_cvt_pk_bf16_f32 v110, v208, v209
  v_cvt_pk_bf16_f32 v111, v210, v211
  ds_write_b128 v219, v[108:111] offset:6400
  s_waitcnt lgkmcnt(0)
  s_barrier
  ds_read_b128 v[180:183], v252 offset:0
  ds_read_b128 v[184:187], v252 offset:1024
  ds_read_b128 v[188:191], v252 offset:2048
  s_waitcnt lgkmcnt(2)
  v_mfma_f32_32x32x16_bf16 v[148:163], a[0:3], v[180:183], 0
  ds_read_b128 v[192:195], v252 offset:3072
  v_mfma_f32_32x32x16_bf16 v[164:179], a[4:7], v[180:183], 0
  s_waitcnt lgkmcnt(2)
  v_mfma_f32_32x32x16_bf16 v[148:163], a[8:11], v[184:187], v[148:163]
  ds_read_b128 v[180:183], v252 offset:4096
  v_mfma_f32_32x32x16_bf16 v[164:179], a[12:15], v[184:187], v[164:179]
  s_waitcnt lgkmcnt(2)
  v_mfma_f32_32x32x16_bf16 v[148:163], a[16:19], v[188:191], v[148:163]
  ds_read_b128 v[184:187], v252 offset:5120
  v_mfma_f32_32x32x16_bf16 v[164:179], a[20:23], v[188:191], v[164:179]
  s_waitcnt lgkmcnt(2)
  v_mfma_f32_32x32x16_bf16 v[148:163], a[24:27], v[192:195], v[148:163]
  ds_read_b128 v[188:191], v252 offset:6144
  v_mfma_f32_32x32x16_bf16 v[164:179], a[28:31], v[192:195], v[164:179]
  s_waitcnt lgkmcnt(2)
  v_mfma_f32_32x32x16_bf16 v[148:163], a[32:35], v[180:183], v[148:163]
  ds_read_b128 v[192:195], v252 offset:7168
  v_mfma_f32_32x32x16_bf16 v[164:179], a[36:39], v[180:183], v[164:179]
  s_waitcnt lgkmcnt(2)
  v_mfma_f32_32x32x16_bf16 v[148:163], a[40:43], v[184:187], v[148:163]
  ds_read_b128 v[180:183], v252 offset:8192
  v_mfma_f32_32x32x16_bf16 v[164:179], a[44:47], v[184:187], v[164:179]
  s_waitcnt lgkmcnt(2)
  v_mfma_f32_32x32x16_bf16 v[148:163], a[48:51], v[188:191], v[148:163]
  ds_read_b128 v[184:187], v252 offset:9216
  v_mfma_f32_32x32x16_bf16 v[164:179], a[52:55], v[188:191], v[164:179]
  s_waitcnt lgkmcnt(2)
  v_mfma_f32_32x32x16_bf16 v[148:163], a[56:59], v[192:195], v[148:163]
  ds_read_b128 v[188:191], v252 offset:10240
  v_mfma_f32_32x32x16_bf16 v[164:179], a[60:63], v[192:195], v[164:179]
  s_waitcnt lgkmcnt(2)
  v_mfma_f32_32x32x16_bf16 v[148:163], a[64:67], v[180:183], v[148:163]
  ds_read_b128 v[192:195], v252 offset:11264
  v_mfma_f32_32x32x16_bf16 v[164:179], a[68:71], v[180:183], v[164:179]
  s_waitcnt lgkmcnt(2)
  v_mfma_f32_32x32x16_bf16 v[148:163], a[72:75], v[184:187], v[148:163]
  ds_read_b128 v[180:183], v252 offset:12288
  v_mfma_f32_32x32x16_bf16 v[164:179], a[76:79], v[184:187], v[164:179]
  s_waitcnt lgkmcnt(2)
  v_mfma_f32_32x32x16_bf16 v[148:163], a[80:83], v[188:191], v[148:163]
  ds_read_b128 v[184:187], v252 offset:13312
  v_mfma_f32_32x32x16_bf16 v[164:179], a[84:87], v[188:191], v[164:179]
  s_waitcnt lgkmcnt(2)
  v_mfma_f32_32x32x16_bf16 v[148:163], a[88:91], v[192:195], v[148:163]
  ds_read_b128 v[188:191], v252 offset:14336
  v_mfma_f32_32x32x16_bf16 v[164:179], a[92:95], v[192:195], v[164:179]
  s_waitcnt lgkmcnt(2)
  v_mfma_f32_32x32x16_bf16 v[148:163], a[96:99], v[180:183], v[148:163]
  ds_read_b128 v[192:195], v252 offset:15360
  v_mfma_f32_32x32x16_bf16 v[164:179], a[100:103], v[180:183], v[164:179]
  s_waitcnt lgkmcnt(2)
  v_mfma_f32_32x32x16_bf16 v[148:163], a[104:107], v[184:187], v[148:163]
  ds_read_b128 v[180:183], v252 offset:16384
  v_mfma_f32_32x32x16_bf16 v[164:179], a[108:111], v[184:187], v[164:179]
  s_waitcnt lgkmcnt(2)
  v_mfma_f32_32x32x16_bf16 v[148:163], a[112:115], v[188:191], v[148:163]
  ds_read_b128 v[184:187], v252 offset:17408
  v_mfma_f32_32x32x16_bf16 v[164:179], a[116:119], v[188:191], v[164:179]
  s_waitcnt lgkmcnt(2)
  v_mfma_f32_32x32x16_bf16 v[148:163], a[120:123], v[192:195], v[148:163]
  ds_read_b128 v[188:191], v252 offset:18432
  v_mfma_f32_32x32x16_bf16 v[164:179], a[124:127], v[192:195], v[164:179]
  s_waitcnt lgkmcnt(2)
  v_mfma_f32_32x32x16_bf16 v[148:163], a[128:131], v[180:183], v[148:163]
  ds_read_b128 v[192:195], v252 offset:19456
  v_mfma_f32_32x32x16_bf16 v[164:179], a[132:135], v[180:183], v[164:179]
  s_waitcnt lgkmcnt(2)
  v_mfma_f32_32x32x16_bf16 v[148:163], a[136:139], v[184:187], v[148:163]
  ds_read_b128 v[180:183], v252 offset:20480
  v_mfma_f32_32x32x16_bf16 v[164:179], a[140:143], v[184:187], v[164:179]
  s_waitcnt lgkmcnt(2)
  v_mfma_f32_32x32x16_bf16 v[148:163], a[144:147], v[188:191], v[148:163]
  ds_read_b128 v[184:187], v252 offset:21504
  v_mfma_f32_32x32x16_bf16 v[164:179], a[148:151], v[188:191], v[164:179]
  s_waitcnt lgkmcnt(2)
  v_mfma_f32_32x32x16_bf16 v[148:163], a[152:155], v[192:195], v[148:163]
  ds_read_b128 v[188:191], v252 offset:22528
  v_mfma_f32_32x32x16_bf16 v[164:179], a[156:159], v[192:195], v[164:179]
  s_waitcnt lgkmcnt(2)
  v_mfma_f32_32x32x16_bf16 v[148:163], a[160:163], v[180:183], v[148:163]
  ds_read_b128 v[192:195], v252 offset:23552
  v_mfma_f32_32x32x16_bf16 v[164:179], a[164:167], v[180:183], v[164:179]
  s_waitcnt lgkmcnt(2)
  v_mfma_f32_32x32x16_bf16 v[148:163], a[168:171], v[184:187], v[148:163]
  ds_read_b128 v[180:183], v252 offset:24576
  v_mfma_f32_32x32x16_bf16 v[164:179], a[172:175], v[184:187], v[164:179]
  s_waitcnt lgkmcnt(2)
  v_mfma_f32_32x32x16_bf16 v[148:163], a[176:179], v[188:191], v[148:163]
  ds_read_b128 v[184:187], v252 offset:25600
  v_mfma_f32_32x32x16_bf16 v[164:179], a[180:183], v[188:191], v[164:179]
  s_waitcnt lgkmcnt(2)
  v_mfma_f32_32x32x16_bf16 v[148:163], a[184:187], v[192:195], v[148:163]
  ds_read_b128 v[188:191], v252 offset:26624
  v_mfma_f32_32x32x16_bf16 v[164:179], a[188:191], v[192:195], v[164:179]
  s_waitcnt lgkmcnt(2)
  v_mfma_f32_32x32x16_bf16 v[148:163], a[192:195], v[180:183], v[148:163]
  ds_read_b128 v[192:195], v252 offset:27648
  v_mfma_f32_32x32x16_bf16 v[164:179], a[196:199], v[180:183], v[164:179]
  s_waitcnt lgkmcnt(2)
  v_mfma_f32_32x32x16_bf16 v[148:163], a[200:203], v[184:187], v[148:163]
  ds_read_b128 v[180:183], v252 offset:28672
  v_mfma_f32_32x32x16_bf16 v[164:179], a[204:207], v[184:187], v[164:179]
  s_waitcnt lgkmcnt(2)
  v_mfma_f32_32x32x16_bf16 v[148:163], a[208:211], v[188:191], v[148:163]
  ds_read_b128 v[184:187], v252 offset:29696
  v_mfma_f32_32x32x16_bf16 v[164:179], a[212:215], v[188:191], v[164:179]
  s_waitcnt lgkmcnt(2)
  v_mfma_f32_32x32x16_bf16 v[148:163], a[216:219], v[192:195], v[148:163]
  ds_read_b128 v[188:191], v252 offset:30720
  v_mfma_f32_32x32x16_bf16 v[164:179], a[220:223], v[192:195], v[164:179]
  s_waitcnt lgkmcnt(2)
  v_mfma_f32_32x32x16_bf16 v[148:163], a[224:227], v[180:183], v[148:163]
  ds_read_b128 v[192:195], v252 offset:31744
  v_mfma_f32_32x32x16_bf16 v[164:179], a[228:231], v[180:183], v[164:179]
  s_waitcnt lgkmcnt(2)
  v_mfma_f32_32x32x16_bf16 v[148:163], a[232:235], v[184:187], v[148:163]
  v_mfma_f32_32x32x16_bf16 v[164:179], a[236:239], v[184:187], v[164:179]
  s_waitcnt lgkmcnt(1)
  v_mfma_f32_32x32x16_bf16 v[148:163], a[240:243], v[188:191], v[148:163]
  v_mfma_f32_32x32x16_bf16 v[164:179], a[244:247], v[188:191], v[164:179]
  s_waitcnt lgkmcnt(0)
  v_mfma_f32_32x32x16_bf16 v[148:163], a[248:251], v[192:195], v[148:163]
  v_mfma_f32_32x32x16_bf16 v[164:179], a[252:255], v[192:195], v[164:179]
  s_nop 3
  v_cvt_pk_bf16_f32 v196, v148, v149
  v_cvt_pk_bf16_f32 v197, v150, v151
  v_cvt_pk_bf16_f32 v198, v152, v153
  v_cvt_pk_bf16_f32 v199, v154, v155
  buffer_store_dwordx4 v[196:199], v251, s[4:7], s39 offen offset:0 sc1
  v_cvt_pk_bf16_f32 v200, v156, v157
  v_cvt_pk_bf16_f32 v201, v158, v159
  v_cvt_pk_bf16_f32 v202, v160, v161
  v_cvt_pk_bf16_f32 v203, v162, v163
  buffer_store_dwordx4 v[200:203], v251, s[4:7], s39 offen offset:1024 sc1
  v_cvt_pk_bf16_f32 v204, v164, v165
  v_cvt_pk_bf16_f32 v205, v166, v167
  v_cvt_pk_bf16_f32 v206, v168, v169
  v_cvt_pk_bf16_f32 v207, v170, v171
  buffer_store_dwordx4 v[204:207], v251, s[4:7], s39 offen offset:2048 sc1
  v_cvt_pk_bf16_f32 v208, v172, v173
  v_cvt_pk_bf16_f32 v209, v174, v175
  v_cvt_pk_bf16_f32 v210, v176, v177
  v_cvt_pk_bf16_f32 v211, v178, v179
  buffer_store_dwordx4 v[208:211], v251, s[4:7], s39 offen offset:3072 sc1
  s_waitcnt vmcnt(0)
  s_barrier
  s_cmp_lg_u32 s33, 0
  s_cbranch_scc1 w_fl_50063
  s_add_u32 s42, s36, 1
  v_mov_b32 v250, s42
  s_mov_b64 exec, 1
  buffer_store_dword v250, off, s[4:7], s40 sc1
  s_mov_b64 exec, -1
w_fl_50063:
  s_add_u32 s36, s36, 3
  s_add_u32 s39, s39, 1179648
  s_cmp_lt_u32 s36, 64
  s_cbranch_scc1 w_top_xy
  s_branch w_exit
  s_endpgm
.section .rodata,"a"
.p2align 6
.amdhsa_kernel parallel_sum__memory_aug_recurrent_mem_tr__glu_gated_reglu__prompt_kernel
  .amdhsa_next_free_vgpr 512
  .amdhsa_next_free_sgpr 102
  .amdhsa_accum_offset 256
  .amdhsa_group_segment_fixed_size 0
  .amdhsa_kernarg_size 112
  .amdhsa_user_sgpr_count 2
  .amdhsa_user_sgpr_kernarg_segment_ptr 1
  .amdhsa_system_sgpr_workgroup_id_x 1
.end_amdhsa_kernel
```
